```python
import torch

def _softmax(x, axis=-1):
    return torch.softmax(x, dim=axis)
def _gelu(x):
    return torch.nn.functional.gelu(x, approximate="tanh")
def _silu(x):
    return torch.nn.functional.silu(x)
def _sigmoid(x):
    return torch.sigmoid(x)
def _layernorm(x, axis=-1, eps=1e-5):
    m = x.mean(dim=axis, keepdim=True)
    v = x.var(dim=axis, keepdim=True, unbiased=False)
    return (x - m) / torch.sqrt(v + eps)
def _scatter_add(tgt, idx, src, axis=0):
    return tgt.clone().index_add_(axis, idx, src)
def _segment_sum(src, seg, n):
    out = torch.zeros((n,) + src.shape[1:], dtype=src.dtype)
    return out.index_add_(0, seg, src)
def _pad(x, pw):
    flat = tuple(v for pair in reversed(pw) for v in pair)
    return torch.nn.functional.pad(x, flat)

kernel_name = 'parallel_sum__grouped_kv_mqa__geglu_ffn__prompt'

def setup_inputs():

    _w = (lambda a: (lambda t: t.to(torch.bfloat16) if t.is_floating_point() else t)(torch.as_tensor(a)))
    def _A_setup():
        B, S, D, H = 1, 2048, 576, 32
        Dh = D // H
        return {
            "x": _w((lambda *s: torch.randn(*s, dtype=torch.bfloat16) * 0.05)(B, S, D)),
            "wq": _w((lambda *s: torch.randn(*s, dtype=torch.bfloat16) * 0.2)(D, H * Dh)),
            "wk": _w((lambda *s: torch.randn(*s, dtype=torch.bfloat16) * 0.2)(D, Dh)),
            "wv": _w((lambda *s: torch.randn(*s, dtype=torch.bfloat16) * 0.1)(D, Dh)),
            "wo": _w((lambda *s: torch.randn(*s, dtype=torch.bfloat16) * 0.1)(H * Dh, D)),
        }
    _A_in = _A_setup()

    def _B_setup():
        B, S, D, F = 1, 2048, 576, 4608
        return {
            "x": _w((lambda *s: torch.randn(*s, dtype=torch.bfloat16) * 0.05)(B, S, D)),
            "w_gate": _w((lambda *s: torch.randn(*s, dtype=torch.bfloat16) * 0.1)(D, F)),
            "w_up": _w((lambda *s: torch.randn(*s, dtype=torch.bfloat16) * 0.1)(D, F)),
            "w_down": _w((lambda *s: torch.randn(*s, dtype=torch.bfloat16) * 0.1)(F, D)),
        }
    _B_in = _B_setup()

    return {
        "A_x": _A_in["x"],
        "A_wq": _A_in["wq"],
        "A_wk": _A_in["wk"],
        "A_wv": _A_in["wv"],
        "A_wo": _A_in["wo"],
        "B_x": _B_in["x"],
        "B_w_gate": _B_in["w_gate"],
        "B_w_up": _B_in["w_up"],
        "B_w_down": _B_in["w_down"],
    }

def reference(A_x, A_wq, A_wk, A_wv, A_wo, B_x, B_w_gate, B_w_up, B_w_down):
    def _A_ref(x, wq, wk, wv, wo):
        B, S, D = x.shape
        H = 32
        Dh = D // H
        q = (lambda x, *d: x.permute(*d))((x @ wq).reshape(B, S, H, Dh), 0, 2, 1, 3)
        k = x @ wk
        v = x @ wv
        scores = torch.einsum("bhqd,bkd->bhqk", q, k) * (Dh ** -0.5)
        p = _softmax(scores, axis=-1)
        o = torch.einsum("bhqk,bkd->bhqd", p, v)
        return (lambda x, *d: x.permute(*d))(o, 0, 2, 1, 3).reshape(B, S, H * Dh) @ wo

    def _B_ref(x, w_gate, w_up, w_down):
        return (_gelu(x @ w_gate) * (x @ w_up)) @ w_down

    x = A_x
    xn = _layernorm(x, axis=-1)
    return x + _A_ref(xn, A_wq, A_wk, A_wv, A_wo) + _B_ref(xn, B_w_gate, B_w_up, B_w_down)
```

```asm
; @launch grid=(256,1,1) block=(256,1,1) lds=163840
.amdgcn_target "amdgcn-amd-amdhsa--gfx950"
.text
.globl parallel_sum__grouped_kv_mqa__geglu_ffn__prompt_kernel
.p2align 8
.type parallel_sum__grouped_kv_mqa__geglu_ffn__prompt_kernel,@function
parallel_sum__grouped_kv_mqa__geglu_ffn__prompt_kernel:
    s_cmp_ge_u32 s2, 256
    s_cbranch_scc1 L_end
    s_load_dwordx16 s[48:63], s[0:1], 0
    s_load_dwordx8 s[64:71], s[0:1], 64
    v_lshrrev_b32 v2, 6, v0
    v_and_b32 v1, 63, v0
    v_readfirstlane_b32 s76, v2
    s_and_b32 s90, s2, 7
    s_lshr_b32 s91, s2, 3
    s_bitcmp1_b32 s2, 3
    s_cselect_b32 s79, 1, 0
    s_lshr_b32 s91, s91, 1
    s_and_b32 s78, s90, 3
    s_lshl_b32 s78, s78, 1
    s_and_b32 s92, s91, 1
    s_add_u32 s78, s78, s92
    s_lshl_b32 s80, s92, 1
    s_add_u32 s80, s80, s79
    s_lshr_b32 s81, s91, 1
    s_lshr_b32 s77, s90, 2
    s_lshl_b32 s77, s77, 3
    s_add_u32 s77, s77, s81
    s_lshl_b32 s82, s76, 10
    v_lshlrev_b32 v6, 4, v1
    v_lshrrev_b32 v2, 3, v1
    v_and_b32 v3, 7, v1
    s_lshl_b32 s90, s76, 5
    v_add_u32 v4, s90, v2
    v_mul_u32_u24 v4, 1152, v4
    v_lshl_add_u32 v20, v3, 4, v4
    v_and_b32 v2, 48, v1
    v_xor_b32 v28, v20, v2
    v_xor_b32 v29, 64, v28
    v_add_u32 v29, 9216, v29
    s_mul_i32 s90, s79, 0
    s_sub_u32 s91, 18432, s90
    v_add_u32 v30, s91, v28
    v_add_u32 v31, s91, v29
    v_add_u32 v28, s90, v28
    v_add_u32 v29, s90, v29
    s_mul_i32 s90, s77, 147456
    s_mul_i32 s91, s78, 1152
    s_getpc_b64 s[100:101]
L_pc:
    s_lshr_b32 s92, s2, 3
    s_lshl_b32 s92, s92, 2
    s_add_u32 s92, s92, s76
    v_min_u32 v32, 4, v1
    v_lshl_add_u32 v32, v32, 7, s92
    v_lshlrev_b32 v32, 7, v32
    v_min_u32 v32, L_end-L_pc, v32
    v_mov_b32 v33, s101
    v_add_co_u32 v32, vcc, s100, v32
    s_nop 1
    v_addc_co_u32 v33, vcc, 0, v33, vcc
    global_load_dword v5, v[32:33], off
    s_waitcnt lgkmcnt(0)
    s_add_u32 s8, s48, s90
    s_addc_u32 s9, s49, 0
    s_and_b32 s9, s9, 0xffff
    s_mov_b32 s10, 147456
    s_mov_b32 s11, 0x20000
    s_add_u32 m0, s82, 0
    s_nop 0
    buffer_load_dwordx4 v28, s[8:11], 0 offen offset:0 lds
    s_add_u32 m0, s82, 36864
    s_nop 0
    buffer_load_dwordx4 v29, s[8:11], 0 offen offset:0 lds
    s_add_u32 m0, s82, 3968
    s_nop 0
    buffer_load_dwordx4 v28, s[8:11], 0 offen offset:128 lds
    s_add_u32 m0, s82, 40832
    s_nop 0
    buffer_load_dwordx4 v29, s[8:11], 0 offen offset:128 lds
    s_add_u32 m0, s82, 7936
    s_nop 0
    buffer_load_dwordx4 v28, s[8:11], 0 offen offset:256 lds
    s_add_u32 m0, s82, 44800
    s_nop 0
    buffer_load_dwordx4 v29, s[8:11], 0 offen offset:256 lds
    s_add_u32 m0, s82, 11904
    s_nop 0
    buffer_load_dwordx4 v28, s[8:11], 0 offen offset:384 lds
    s_add_u32 m0, s82, 48768
    s_nop 0
    buffer_load_dwordx4 v29, s[8:11], 0 offen offset:384 lds
    s_add_u32 m0, s82, 15872
    s_nop 0
    buffer_load_dwordx4 v28, s[8:11], 0 offen offset:512 lds
    s_add_u32 m0, s82, 52736
    s_nop 0
    buffer_load_dwordx4 v29, s[8:11], 0 offen offset:512 lds
    s_add_u32 s12, s60, s91
    s_addc_u32 s13, s61, 0
    s_and_b32 s13, s13, 0xffff
    s_sub_u32 s14, 5308416, s91
    s_mov_b32 s15, 0x20000
    s_add_u32 s16, s62, s91
    s_addc_u32 s17, s63, 0
    s_and_b32 s17, s17, 0xffff
    s_sub_u32 s18, 5308416, s91
    s_mov_b32 s19, 0x20000
    s_bitcmp1_b32 s78, 1
    s_cselect_b32 s40, s54, s52
    s_cselect_b32 s41, s55, s53
    s_and_b32 s41, s41, 0xffff
    s_mov_b32 s42, 20736
    s_mov_b32 s43, 0x20000
    s_cmp_ge_u32 s76, 2
    s_cselect_b32 s72, s16, s12
    s_cselect_b32 s73, s17, s13
    s_mov_b32 s74, s14
    s_mov_b32 s75, 0x20000
    s_cmp_eq_u32 s79, 0
    s_cselect_b32 s84, 128, 0
    s_and_b32 s90, s76, 1
    s_lshl_b32 s91, s81, 1
    s_add_u32 s90, s90, s91
    v_lshlrev_b32 v2, 4, v1
    v_add_u32 v2, s90, v2
    v_mul_u32_u24 v25, 9216, v2
    v_mul_u32_u24 v26, 1152, v2
    v_mov_b32 v3, 1073741824
    v_cmp_gt_u32 vcc, 36, v1
    s_nop 1
    v_cndmask_b32 v25, v3, v25, vcc
    v_cndmask_b32 v26, v3, v26, vcc
    s_mul_i32 s90, s77, 147456
    s_add_u32 s28, s66, s90
    s_addc_u32 s29, s67, 0
    s_and_b32 s29, s29, 0xffff
    s_mov_b32 s30, 147456
    s_mov_b32 s31, 0x20000
    s_mul_i32 s90, s78, 663552
    s_mul_i32 s91, s78, 144
    s_add_u32 s20, s64, s90
    s_addc_u32 s21, s65, 0
    s_and_b32 s21, s21, 0xffff
    s_mov_b32 s22, 663552
    s_mov_b32 s23, 0x20000
    s_add_u32 s36, s50, s91
    s_addc_u32 s37, s51, 0
    s_and_b32 s37, s37, 0xffff
    s_sub_u32 s38, 663552, s91
    s_mov_b32 s39, 0x20000
    s_mov_b32 s24, s70
    s_and_b32 s25, s71, 0xffff
    s_mov_b32 s26, 33554432
    s_mov_b32 s27, 0x20000
    s_mov_b32 s32, s68
    s_and_b32 s33, s69, 0xffff
    s_mov_b32 s34, 256
    s_mov_b32 s35, 0x20000
    s_mov_b32 s44, s56
    s_and_b32 s45, s57, 0xffff
    s_mov_b32 s46, 663552
    s_mov_b32 s47, 0x20000
    s_add_u32 s90, s84, 2359296
    s_add_u32 s56, s12, s90
    s_addc_u32 s57, s13, 0
    s_mov_b32 s58, 285824
    s_mov_b32 s59, 0x20000
    v_lshrrev_b32 v2, 2, v1
    v_lshlrev_b32 v2, 7, v2
    v_and_b32 v3, 3, v1
    v_lshl_add_u32 v2, v3, 3, v2
    v_bfe_u32 v3, v1, 3, 2
    v_xor_b32 v4, 0, v3
    v_lshl_add_u32 v8, v4, 5, v2
    v_add_u32 v12, 0x10000, v8
    v_add_u32 v16, 0x20000, v8
    v_xor_b32 v4, 1, v3
    v_lshl_add_u32 v9, v4, 5, v2
    v_add_u32 v13, 0x10000, v9
    v_add_u32 v17, 0x20000, v9
    v_xor_b32 v4, 2, v3
    v_lshl_add_u32 v10, v4, 5, v2
    v_add_u32 v14, 0x10000, v10
    v_add_u32 v18, 0x20000, v10
    v_xor_b32 v4, 3, v3
    v_lshl_add_u32 v11, v4, 5, v2
    v_add_u32 v15, 0x10000, v11
    v_add_u32 v19, 0x20000, v11
    v_bfe_u32 v2, v1, 1, 2
    v_lshrrev_b32 v3, 4, v1
    v_xor_b32 v22, v2, v3
    v_and_b32 v3, 1, v1
    v_lshlrev_b32 v3, 4, v3
    v_lshl_add_u32 v21, v22, 5, v3
    v_lshrrev_b32 v2, 5, v1
    v_bfe_u32 v3, v1, 3, 2
    v_lshl_add_u32 v2, v2, 3, v3
    s_and_b32 s90, s76, 1
    s_lshl_b32 s90, s90, 4
    s_lshr_b32 s91, s76, 1
    s_lshl_b32 s91, s91, 2
    s_add_u32 s90, s90, s91
    v_add_u32 v23, s90, v2
    v_mul_u32_u24 v24, 9216, v23
    v_add_u32 v24, v24, v21
    s_mov_b32 s89, 0xc09d30fc
    s_mov_b32 s4, 0
    s_mov_b32 s5, -1
    s_mov_b32 s86, 294912
    v_bfe_u32 v2, v1, 1, 3
    v_lshrrev_b32 v3, 4, v1
    v_xor_b32 v2, v2, v3
    v_and_b32 v4, 7, v1
    v_lshl_add_u32 v2, v4, 3, v2
    v_lshl_add_u32 v2, v2, 4, s82
    v_bfe_u32 v4, v1, 3, 1
    v_mul_u32_u24 v4, 36864, v4
    v_add_u32 v7, v2, v4
    v_xor_b32 v27, 64, v7
    v_and_b32 v2, 15, v1
    v_lshlrev_b32 v3, 2, v3
    v_sub_u32 v2, v2, v3
    v_mov_b32 v3, 0x3f803f80
    v_cmp_eq_u32 s[60:61], 0, v2
    v_accvgpr_write_b32 a252, v3
    v_cmp_eq_u32 s[62:63], 1, v2
    v_accvgpr_write_b32 a253, v3
    v_cmp_eq_u32 s[64:65], 2, v2
    v_accvgpr_write_b32 a254, v3
    v_cmp_eq_u32 s[66:67], 3, v2
    v_accvgpr_write_b32 a255, v3
    s_and_b32 s92, s81, 3
    s_lshl_b32 s92, s92, 2
    s_add_u32 s92, s92, s76
    s_mul_i32 s92, s92, 1408
    s_cmp_eq_u32 s79, 0
    s_cselect_b32 s92, 1073741824, s92
    v_min_u32 v4, 10, v1
    v_lshlrev_b32 v4, 7, v4
    s_cmp_eq_u32 s79, 1
    s_cbranch_scc1 L_p1pre
    s_add_u32 m0, s82, 19840
    s_nop 0
    buffer_load_dwordx4 v28, s[8:11], 0 offen offset:640 lds
    s_add_u32 m0, s82, 56704
    s_nop 0
    buffer_load_dwordx4 v29, s[8:11], 0 offen offset:640 lds
    s_add_u32 m0, s82, 23808
    s_nop 0
    buffer_load_dwordx4 v28, s[8:11], 0 offen offset:768 lds
    s_add_u32 m0, s82, 60672
    s_nop 0
    buffer_load_dwordx4 v29, s[8:11], 0 offen offset:768 lds
    s_add_u32 m0, s82, 27776
    s_nop 0
    buffer_load_dwordx4 v28, s[8:11], 0 offen offset:896 lds
    s_add_u32 m0, s82, 64640
    s_nop 0
    buffer_load_dwordx4 v29, s[8:11], 0 offen offset:896 lds
    s_mov_b64 exec, 0
    s_cmp_eq_u32 s76, 0
    s_cbranch_scc1 L_w1
    s_cmp_eq_u32 s76, 1
    s_cbranch_scc1 L_w2
    s_cmp_eq_u32 s76, 2
    s_cbranch_scc1 L_w3
    s_branch L_w4
L_p1pre:
    v_and_b32 v196, 15, v1
    v_lshrrev_b32 v197, 4, v1
    v_mov_b32 v198, 1073741824
    v_mov_b32 v235, 0
    v_mov_b32 v219, 0xdddddddd
    v_lshrrev_b32 v192, 1, v1
    v_mul_u32_u24 v193, 36, v192
    v_and_b32 v195, 1, v1
    v_lshl_add_u32 v193, v195, 4, v193
    s_and_b32 s90, s78, 1
    s_lshl_b32 s90, s90, 5
    s_mul_i32 s91, s76, 1152
    s_add_u32 s90, s90, s91
    v_add_u32 v208, s90, v193
    v_mul_u32_u24 v192, 1152, v192
    v_lshl_add_u32 v192, v195, 4, v192
    v_cndmask_b32 v224, v192, v198, s[4:5]
    v_bfe_u32 v192, v1, 2, 2
    v_lshl_add_u32 v192, v197, 3, v192
    v_and_b32 v193, 3, v1
    v_lshlrev_b32 v194, 3, v193
    v_lshl_add_u32 v194, v192, 5, v194
    v_add_u32 v210, 147456, v194
    v_add_u32 v194, v194, v194
    v_add_u32 v214, 73728, v194
    v_lshrrev_b32 v192, 2, v1
    v_lshlrev_b32 v194, 5, v192
    v_lshl_add_u32 v194, v193, 3, v194
    v_add_u32 v231, 73728, v194
    s_lshl_b32 s90, s76, 4
    v_add_u32 v192, s90, v192
    v_mul_u32_u24 v192, 1152, v192
    v_mul_u32_u24 v193, 36, v193
    v_add3_u32 v213, v192, v193, 32
    s_add_u32 m0, s82, 19840
    s_nop 0
    buffer_load_dwordx4 v28, s[8:11], 0 offen offset:640 lds
    v_mul_u32_u24 v192, 1152, v23
    v_mul_u32_u24 v193, 36, v22
    v_lshlrev_b32 v194, 4, v195
    v_add3_u32 v212, v192, v193, v194
    v_and_b32 v192, 7, v1
    v_lshlrev_b32 v215, 2, v192
    v_lshlrev_b32 v192, 2, v1
    v_cndmask_b32 v211, v192, v198, s[4:5]
    s_bitcmp1_b32 s78, 1
    s_cselect_b32 s91, 8, 9
    s_cselect_b32 s70, 1.0, 0x3fc62901
    s_and_b32 s90, s78, 3
    s_cmp_eq_u32 s90, 3
    s_cselect_b32 s91, 6, s91
    v_lshrrev_b32 v192, 5, v1
    v_lshlrev_b32 v192, s91, v192
    v_lshl_add_u32 v192, v196, 4, v192
    s_cmp_eq_u32 s90, 1
    s_cselect_b32 s91, 3, 1
    v_and_b32 v193, s91, v197
    v_cmp_eq_u32 vcc, 0, v193
    s_cmp_eq_u32 s90, 3
    s_cselect_b32 s91, 4, 16
    s_cselect_b32 s93, 2, 16
    v_cndmask_b32 v192, v198, v192, vcc
    v_cmp_gt_u32 vcc, s91, v196
    v_mov_b32 v193, 0x3f803f80
    s_lshr_b32 s91, s77, 1
    v_cndmask_b32 v209, v198, v192, vcc
    v_cmp_gt_u32 vcc, s93, v196
    s_lshl_b32 s83, s91, 2
    s_mul_i32 s91, s91, 20480
    v_cndmask_b32 v233, 0, -1, vcc
    v_cmp_eq_u32 vcc, s93, v196
    s_add_u32 m0, s82, 56704
    s_nop 0
    buffer_load_dwordx4 v29, s[8:11], 0 offen offset:640 lds
    s_cmp_eq_u32 s76, 0
    s_cselect_b32 s97, s83, 1073741824
    v_cndmask_b32 v234, 0, v193, vcc
    s_lshl_b32 s83, s77, 2
    s_add_u32 s83, s83, 128
    s_cmp_eq_u32 s76, 0
    s_cselect_b32 s1, s83, 1073741824
    s_and_b32 s93, s77, 1
    s_mul_i32 s69, s93, 640
    s_lshl_b32 s93, s93, 2
    s_add_u32 s93, s93, s76
    s_lshr_b32 s83, s78, 2
    s_xor_b32 s83, s83, 0
    s_lshl_b32 s68, s93, 1
    s_add_u32 s68, s68, s83
    s_mul_i32 s68, s68, 640
    s_add_u32 s68, s68, 8192
    s_lshl_b32 s83, s83, 8
    s_add_u32 s69, s69, s83
    s_lshl_b32 s93, s93, 10
    s_add_u32 s93, s93, s83
    s_bitcmp1_b32 s78, 1
    s_cselect_b32 s68, s68, s93
    s_and_b32 s93, s78, 1
    s_lshl_b32 s93, s93, 9
    s_add_u32 s68, s68, s93
    s_add_u32 s68, s68, s91
    s_lshl_b32 s93, s76, 2
    s_add_u32 s69, s69, s93
    s_add_u32 s69, s69, s91
    s_add_u32 s69, s69, 18432
    s_cmp_eq_u32 s90, 1
    s_cselect_b32 s69, s69, 1073741824
    s_cselect_b32 s68, 1073741824, s68
    s_add_u32 m0, s82, 23808
    s_nop 0
    buffer_load_dwordx4 v28, s[8:11], 0 offen offset:768 lds
    s_lshl_b32 s90, s77, 3
    s_add_u32 s90, s90, s78
    s_lshl_b32 s90, s90, 2
    s_add_u32 s90, s90, s76
    s_lshl_b32 s95, s90, 7
    s_add_u32 s95, s95, 262144
    s_lshl_b32 s94, s90, 12
    s_add_u32 s94, s94, 524288
    s_mul_i32 s90, s78, 508
    s_sub_u32 s0, s95, s90
    s_lshl_b32 s90, s77, 2
    s_add_u32 s90, s90, s76
    s_mul_i32 s71, s90, 36864
    s_add_u32 s71, s71, 3145728
    s_mul_i32 s85, s76, 5120
    s_lshl_b32 s90, s76, 12
    s_add_u32 s48, s90, 94208
    s_mul_i32 s50, s77, 1179648
    s_add_u32 s50, s50, s90
    s_add_u32 s50, s50, 6291456
    s_lshr_b32 s91, s78, 2
    s_mul_i32 s90, s78, 147456
    s_add_u32 s90, s90, 131072
    s_add_u32 s99, s50, s90
    s_lshl_b32 s90, s78, 14
    s_add_u32 s50, s50, s90
    s_and_b32 s93, s78, 3
    s_lshl_b32 s93, s93, 5
    s_add_u32 s93, s93, 1024
    s_lshl_b32 s90, s76, 1
    s_add_u32 s90, s90, s91
    s_mul_i32 s90, s90, 18432
    s_add_u32 s49, s90, s93
    s_lshl_b32 s96, s81, 2
    s_add_u32 m0, s82, 60672
    s_nop 0
    buffer_load_dwordx4 v29, s[8:11], 0 offen offset:768 lds
    s_add_u32 s96, s96, s76
    s_mul_i32 s96, s96, 20736
    s_mov_b32 s51, 640
    s_mov_b32 s3, 0
    buffer_store_dword v235, v211, s[24:27], s95 offen sc1
    v_min_u32 v192, 40, v1
    v_lshlrev_b32 v225, 7, v192
    v_add_u32 v216, 110592, v6
    v_add_u32 v192, 129024, v6
    v_mov_b32 v193, 119328
    v_cndmask_b32 v217, v192, v193, s[4:5]
    v_and_b32 v192, 31, v1
    v_cmp_eq_u32 vcc, 22, v192
    v_min_u32 v193, 19, v192
    v_lshrrev_b32 v192, 5, v1
    v_cndmask_b32 v193, v193, 18, vcc
    v_lshlrev_b32 v194, 8, v192
    v_cmp_lt_u32 vcc, 15, v193
    v_lshlrev_b32 v218, 6, v192
    v_add_u32 v218, 256, v218
    v_cndmask_b32 v194, v194, v218, vcc
    v_lshl_add_u32 v194, v193, 4, v194
    v_add_u32 v218, 118784, v194
    v_bfe_u32 v193, v1, 3, 2
    v_mad_u32_u24 v194, v192, 18, v193
    s_lshl_b32 s90, s76, 2
    v_add_u32 v194, s90, v194
    v_mul_u32_u24 v194, 1152, v194
    s_lshl_b32 s83, s78, 7
    v_add3_u32 v220, v194, v21, s83
    v_lshrrev_b32 v194, 1, v193
    v_lshl_add_u32 v193, v194, 4, v193
    v_mul_u32_u24 v194, 72, v192
    s_and_b32 s90, s76, 1
    s_add_u32 m0, s82, 27776
    s_nop 0
    buffer_load_dwordx4 v28, s[8:11], 0 offen offset:896 lds
    s_mul_i32 s90, s90, 144
    s_lshr_b32 s91, s76, 1
    s_mul_i32 s91, s91, 36
    s_add_u32 s90, s90, s91
    s_add_u32 s90, s90, 16
    v_add3_u32 v194, v194, v193, s90
    v_mul_u32_u24 v194, 1152, v194
    v_add3_u32 v221, v194, v21, s83
    v_bfe_u32 v193, v1, 1, 2
    v_bfe_u32 v194, v1, 3, 1
    v_mad_u32_u24 v194, v194, 18, v193
    v_lshl_add_u32 v194, v197, 2, v194
    s_mul_i32 s90, s76, 36
    v_add_u32 v194, s90, v194
    v_mul_u32_u24 v194, 1152, v194
    v_lshl_add_u32 v194, v195, 4, v194
    v_add_u32 v222, s93, v194
    v_lshrrev_b32 v194, 1, v193
    v_lshl_add_u32 v193, v194, 4, v193
    v_bfe_u32 v194, v1, 3, 2
    v_mul_u32_u24 v194, 72, v194
    v_add3_u32 v193, v193, v194, 16
    v_mad_u32_u24 v193, v192, 36, v193
    s_mul_i32 s90, s76, 288
    v_add_u32 v193, s90, v193
    v_mul_u32_u24 v193, 1152, v193
    v_lshl_add_u32 v193, v195, 4, v193
    v_add_u32 v223, s93, v193
    s_lshr_b32 s90, s2, 4
    s_lshl_b32 s90, s90, 2
    s_add_u32 s90, s90, s76
    v_min_u32 v192, 9, v1
    v_lshl_add_u32 v192, v192, 6, s90
    v_lshlrev_b32 v192, 7, v192
    s_add_u32 m0, s82, 64640
    s_nop 0
    buffer_load_dwordx4 v29, s[8:11], 0 offen offset:896 lds
    v_min_u32 v192, L_end-L_pc, v192
    v_mov_b32 v253, s101
    v_add_co_u32 v252, vcc, s100, v192
    s_nop 1
    v_addc_co_u32 v253, vcc, 0, v253, vcc
    s_mov_b64 exec, 0
    s_cmp_eq_u32 s76, 0
    s_cbranch_scc1 L_w10
    s_cmp_eq_u32 s76, 1
    s_cbranch_scc1 L_w11
    s_cmp_eq_u32 s76, 2
    s_cbranch_scc1 L_w12
    s_branch L_w13
.p2align 12
L_ln:
L_wb:
    s_mov_b64 exec, -1
    s_waitcnt vmcnt(14)
    ds_read_b128 v[76:79], v7 offset:0
    ds_read_b128 v[80:83], v27 offset:0
    s_waitcnt vmcnt(12)
    ds_read_b128 v[84:87], v7 offset:4096
    ds_read_b128 v[88:91], v27 offset:4096
    s_waitcnt lgkmcnt(2)
    v_mfma_f32_16x16x32_bf16 v[32:35], a[252:255], v[76:79], 0
    s_waitcnt vmcnt(10)
    ds_read_b128 v[92:95], v7 offset:8192
    v_lshlrev_b32 v40, 16, v76
    v_lshlrev_b32 v41, 16, v77
    v_lshlrev_b32 v42, 16, v78
    v_lshlrev_b32_e64 v43, 16, v79
    v_mfma_f32_16x16x32_bf16 v[36:39], v[76:79], v[76:79], 0
    s_add_u32 m0, s82, 31744
    ds_read_b128 v[96:99], v27 offset:8192
    buffer_load_dwordx4 v28, s[8:11], 0 offen offset:1024 lds
    v_and_b32 v76, 0xffff0000, v76
    v_and_b32 v77, 0xffff0000, v77
    v_and_b32 v78, 0xffff0000, v78
    v_and_b32 v79, 0xffff0000, v79
    v_mfma_f32_16x16x32_bf16 v[32:35], a[252:255], v[80:83], v[32:35]
    s_add_u32 m0, s82, 68608
    s_nop 0
    buffer_load_dwordx4 v29, s[8:11], 0 offen offset:1024 lds
    v_lshlrev_b32 v44, 16, v80
    v_lshlrev_b32 v45, 16, v81
    v_lshlrev_b32 v46, 16, v82
    v_lshlrev_b32_e64 v47, 16, v83
    v_mfma_f32_16x16x32_bf16 v[36:39], v[80:83], v[80:83], v[36:39]
    s_waitcnt lgkmcnt(2)
    v_and_b32 v80, 0xffff0000, v80
    v_and_b32 v81, 0xffff0000, v81
    v_and_b32 v82, 0xffff0000, v82
    v_and_b32 v83, 0xffff0000, v83
    v_mfma_f32_16x16x32_bf16 v[32:35], a[252:255], v[84:87], v[32:35]
    s_waitcnt vmcnt(10)
    ds_read_b128 v[100:103], v7 offset:12288
    v_lshlrev_b32 v48, 16, v84
    v_lshlrev_b32 v49, 16, v85
    v_lshlrev_b32 v50, 16, v86
    v_lshlrev_b32 v51, 16, v87
    v_mfma_f32_16x16x32_bf16 v[36:39], v[84:87], v[84:87], v[36:39]
    s_add_u32 m0, s82, 73728
    ds_read_b128 v[104:107], v27 offset:12288
    buffer_load_dwordx4 v30, s[8:11], 0 offen offset:0 lds
    v_and_b32 v84, 0xffff0000, v84
    v_and_b32 v85, 0xffff0000, v85
    v_and_b32 v86, 0xffff0000, v86
    v_and_b32 v87, 0xffff0000, v87
    v_mfma_f32_16x16x32_bf16 v[32:35], a[252:255], v[88:91], v[32:35]
    s_add_u32 m0, s82, 110592
    s_nop 0
    buffer_load_dwordx4 v31, s[8:11], 0 offen offset:0 lds
    v_lshlrev_b32 v52, 16, v88
    v_lshlrev_b32 v53, 16, v89
    v_lshlrev_b32 v54, 16, v90
    v_lshlrev_b32_e64 v55, 16, v91
    v_mfma_f32_16x16x32_bf16 v[36:39], v[88:91], v[88:91], v[36:39]
    s_waitcnt lgkmcnt(2)
    v_and_b32 v88, 0xffff0000, v88
    v_and_b32 v89, 0xffff0000, v89
    v_and_b32 v90, 0xffff0000, v90
    v_and_b32 v91, 0xffff0000, v91
    v_mfma_f32_16x16x32_bf16 v[32:35], a[252:255], v[92:95], v[32:35]
    s_waitcnt vmcnt(10)
    ds_read_b128 v[108:111], v7 offset:16384
    v_lshlrev_b32 v56, 16, v92
    v_lshlrev_b32 v57, 16, v93
    v_lshlrev_b32 v58, 16, v94
    v_lshlrev_b32 v59, 16, v95
    v_mfma_f32_16x16x32_bf16 v[36:39], v[92:95], v[92:95], v[36:39]
    s_add_u32 m0, s82, 77696
    ds_read_b128 v[148:151], v27 offset:16384
    buffer_load_dwordx4 v30, s[8:11], 0 offen offset:128 lds
    v_and_b32 v92, 0xffff0000, v92
    v_and_b32 v93, 0xffff0000, v93
    v_and_b32 v94, 0xffff0000, v94
    v_and_b32 v95, 0xffff0000, v95
    v_mfma_f32_16x16x32_bf16 v[32:35], a[252:255], v[96:99], v[32:35]
    s_add_u32 m0, s82, 114560
    s_nop 0
    buffer_load_dwordx4 v31, s[8:11], 0 offen offset:128 lds
    v_lshlrev_b32 v60, 16, v96
    v_lshlrev_b32 v61, 16, v97
    v_lshlrev_b32 v62, 16, v98
    v_lshlrev_b32_e64 v63, 16, v99
    v_mfma_f32_16x16x32_bf16 v[36:39], v[96:99], v[96:99], v[36:39]
    s_waitcnt lgkmcnt(2)
    v_and_b32 v96, 0xffff0000, v96
    v_and_b32 v97, 0xffff0000, v97
    v_and_b32 v98, 0xffff0000, v98
    v_and_b32 v99, 0xffff0000, v99
    v_mfma_f32_16x16x32_bf16 v[32:35], a[252:255], v[100:103], v[32:35]
    s_waitcnt vmcnt(10)
    ds_read_b128 v[152:155], v7 offset:20480
    v_lshlrev_b32 v64, 16, v100
    v_lshlrev_b32 v65, 16, v101
    v_lshlrev_b32 v66, 16, v102
    v_lshlrev_b32 v67, 16, v103
    v_mfma_f32_16x16x32_bf16 v[36:39], v[100:103], v[100:103], v[36:39]
    s_add_u32 m0, s82, 81664
    ds_read_b128 v[156:159], v27 offset:20480
    buffer_load_dwordx4 v30, s[8:11], 0 offen offset:256 lds
    v_and_b32 v100, 0xffff0000, v100
    v_and_b32 v101, 0xffff0000, v101
    v_and_b32 v102, 0xffff0000, v102
    v_and_b32 v103, 0xffff0000, v103
    v_mfma_f32_16x16x32_bf16 v[32:35], a[252:255], v[104:107], v[32:35]
    s_add_u32 m0, s82, 118528
    s_nop 0
    buffer_load_dwordx4 v31, s[8:11], 0 offen offset:256 lds
    v_lshlrev_b32 v68, 16, v104
    v_lshlrev_b32 v69, 16, v105
    v_lshlrev_b32 v70, 16, v106
    v_lshlrev_b32_e64 v71, 16, v107
    v_mfma_f32_16x16x32_bf16 v[36:39], v[104:107], v[104:107], v[36:39]
    s_waitcnt lgkmcnt(2)
    v_and_b32 v104, 0xffff0000, v104
    v_and_b32 v105, 0xffff0000, v105
    v_and_b32 v106, 0xffff0000, v106
    v_and_b32 v107, 0xffff0000, v107
    v_mfma_f32_16x16x32_bf16 v[32:35], a[252:255], v[108:111], v[32:35]
    s_waitcnt vmcnt(10)
    ds_read_b128 v[160:163], v7 offset:24576
    v_lshlrev_b32 v72, 16, v108
    v_lshlrev_b32 v73, 16, v109
    v_lshlrev_b32 v74, 16, v110
    v_lshlrev_b32 v75, 16, v111
    v_mfma_f32_16x16x32_bf16 v[36:39], v[108:111], v[108:111], v[36:39]
    s_add_u32 m0, s82, 85632
    ds_read_b128 v[164:167], v27 offset:24576
    buffer_load_dwordx4 v30, s[8:11], 0 offen offset:384 lds
    v_and_b32 v108, 0xffff0000, v108
    v_and_b32 v109, 0xffff0000, v109
    v_and_b32 v110, 0xffff0000, v110
    v_and_b32 v111, 0xffff0000, v111
    v_mfma_f32_16x16x32_bf16 v[32:35], a[252:255], v[148:151], v[32:35]
    s_add_u32 m0, s82, 122496
    s_nop 0
    buffer_load_dwordx4 v31, s[8:11], 0 offen offset:384 lds
    v_lshlrev_b32 v112, 16, v148
    v_lshlrev_b32 v113, 16, v149
    v_lshlrev_b32 v114, 16, v150
    v_lshlrev_b32_e64 v115, 16, v151
    v_mfma_f32_16x16x32_bf16 v[36:39], v[148:151], v[148:151], v[36:39]
    s_waitcnt lgkmcnt(2)
    v_and_b32 v148, 0xffff0000, v148
    v_and_b32 v149, 0xffff0000, v149
    v_and_b32 v150, 0xffff0000, v150
    v_and_b32 v151, 0xffff0000, v151
    v_mfma_f32_16x16x32_bf16 v[32:35], a[252:255], v[152:155], v[32:35]
    s_waitcnt vmcnt(10)
    ds_read_b128 v[168:171], v7 offset:28672
    v_lshlrev_b32 v116, 16, v152
    v_lshlrev_b32 v117, 16, v153
    v_lshlrev_b32 v118, 16, v154
    v_lshlrev_b32 v119, 16, v155
    v_mfma_f32_16x16x32_bf16 v[36:39], v[152:155], v[152:155], v[36:39]
    s_add_u32 m0, s82, 89600
    ds_read_b128 v[172:175], v27 offset:28672
    buffer_load_dwordx4 v30, s[8:11], 0 offen offset:512 lds
    v_and_b32 v152, 0xffff0000, v152
    v_and_b32 v153, 0xffff0000, v153
    v_and_b32 v154, 0xffff0000, v154
    v_and_b32 v155, 0xffff0000, v155
    v_mfma_f32_16x16x32_bf16 v[32:35], a[252:255], v[156:159], v[32:35]
    s_add_u32 m0, s82, 126464
    s_nop 0
    buffer_load_dwordx4 v31, s[8:11], 0 offen offset:512 lds
    v_lshlrev_b32 v120, 16, v156
    v_lshlrev_b32 v121, 16, v157
    v_lshlrev_b32 v122, 16, v158
    v_lshlrev_b32_e64 v123, 16, v159
    v_mfma_f32_16x16x32_bf16 v[36:39], v[156:159], v[156:159], v[36:39]
    s_waitcnt lgkmcnt(2)
    v_and_b32 v156, 0xffff0000, v156
    v_and_b32 v157, 0xffff0000, v157
    v_and_b32 v158, 0xffff0000, v158
    v_and_b32 v159, 0xffff0000, v159
    v_mfma_f32_16x16x32_bf16 v[32:35], a[252:255], v[160:163], v[32:35]
    s_waitcnt vmcnt(10)
    ds_read_b128 v[176:179], v7 offset:32768
    v_lshlrev_b32 v124, 16, v160
    v_lshlrev_b32 v125, 16, v161
    v_lshlrev_b32 v126, 16, v162
    v_lshlrev_b32 v127, 16, v163
    v_mfma_f32_16x16x32_bf16 v[36:39], v[160:163], v[160:163], v[36:39]
    s_add_u32 m0, s82, 93568
    ds_read_b128 v[180:183], v27 offset:32768
    buffer_load_dwordx4 v30, s[8:11], 0 offen offset:640 lds
    v_and_b32 v160, 0xffff0000, v160
    v_and_b32 v161, 0xffff0000, v161
    v_and_b32 v162, 0xffff0000, v162
    v_and_b32 v163, 0xffff0000, v163
    v_mfma_f32_16x16x32_bf16 v[32:35], a[252:255], v[164:167], v[32:35]
    s_add_u32 m0, s82, 130432
    s_nop 0
    buffer_load_dwordx4 v31, s[8:11], 0 offen offset:640 lds
    v_lshlrev_b32 v128, 16, v164
    v_lshlrev_b32 v129, 16, v165
    v_lshlrev_b32 v130, 16, v166
    v_lshlrev_b32_e64 v131, 16, v167
    v_mfma_f32_16x16x32_bf16 v[36:39], v[164:167], v[164:167], v[36:39]
    s_waitcnt lgkmcnt(2)
    v_and_b32 v164, 0xffff0000, v164
    v_and_b32 v165, 0xffff0000, v165
    v_and_b32 v166, 0xffff0000, v166
    v_and_b32 v167, 0xffff0000, v167
    v_mfma_f32_16x16x32_bf16 v[32:35], a[252:255], v[168:171], v[32:35]
    v_lshlrev_b32 v132, 16, v168
    v_lshlrev_b32 v133, 16, v169
    v_lshlrev_b32 v134, 16, v170
    v_lshlrev_b32_e64 v135, 16, v171
    v_mfma_f32_16x16x32_bf16 v[36:39], v[168:171], v[168:171], v[36:39]
    buffer_load_dword v5, v4, s[40:43], s92 offen
    v_and_b32 v168, 0xffff0000, v168
    v_and_b32 v169, 0xffff0000, v169
    v_and_b32 v170, 0xffff0000, v170
    v_and_b32 v171, 0xffff0000, v171
    v_mfma_f32_16x16x32_bf16 v[32:35], a[252:255], v[172:175], v[32:35]
    s_add_u32 m0, s82, 97536
    s_nop 0
    buffer_load_dwordx4 v30, s[8:11], 0 offen offset:768 lds
    v_lshlrev_b32 v136, 16, v172
    v_lshlrev_b32 v137, 16, v173
    v_lshlrev_b32 v138, 16, v174
    v_lshlrev_b32_e64 v139, 16, v175
    v_mfma_f32_16x16x32_bf16 v[36:39], v[172:175], v[172:175], v[36:39]
    s_waitcnt lgkmcnt(0)
    v_and_b32 v172, 0xffff0000, v172
    v_and_b32 v173, 0xffff0000, v173
    v_and_b32 v174, 0xffff0000, v174
    v_and_b32 v175, 0xffff0000, v175
    v_mfma_f32_16x16x32_bf16 v[32:35], a[252:255], v[176:179], v[32:35]
    v_lshlrev_b32 v140, 16, v176
    v_lshlrev_b32 v141, 16, v177
    v_lshlrev_b32 v142, 16, v178
    v_lshlrev_b32_e64 v143, 16, v179
    v_mfma_f32_16x16x32_bf16 v[36:39], v[176:179], v[176:179], v[36:39]
    s_add_u32 m0, s82, 134400
    s_nop 0
    buffer_load_dwordx4 v31, s[8:11], 0 offen offset:768 lds
    v_and_b32 v176, 0xffff0000, v176
    v_and_b32 v177, 0xffff0000, v177
    v_and_b32 v178, 0xffff0000, v178
    v_and_b32 v179, 0xffff0000, v179
    v_mfma_f32_16x16x32_bf16 v[32:35], a[252:255], v[180:183], v[32:35]
    s_add_u32 m0, s82, 101504
    s_nop 0
    buffer_load_dwordx4 v30, s[8:11], 0 offen offset:896 lds
    v_lshlrev_b32 v144, 16, v180
    v_lshlrev_b32 v145, 16, v181
    v_lshlrev_b32 v146, 16, v182
    v_lshlrev_b32 v147, 16, v183
    v_mfma_f32_16x16x32_bf16 v[36:39], v[180:183], v[180:183], v[36:39]
    v_and_b32 v180, 0xffff0000, v180
    v_and_b32 v181, 0xffff0000, v181
    v_and_b32 v182, 0xffff0000, v182
    v_and_b32 v183, 0xffff0000, v183
    v_add_u32 v7, 73728, v7
    v_add_u32 v27, 73728, v27
    s_nop 1
    v_cndmask_b32 v36, 0, v36, s[60:61]
    v_cndmask_b32 v36, v36, v37, s[62:63]
    v_cndmask_b32 v36, v36, v38, s[64:65]
    v_cndmask_b32 v36, v36, v39, s[66:67]
    v_mov_b32 v37, v36
    v_mul_f32 v32, 0x3ae38e39, v32
    s_nop 0
    v_permlane16_swap_b32 v36, v37
    v_add_f32 v36, v36, v37
    v_mov_b32 v37, v36
    v_mul_f32 v33, v32, v32
    s_nop 0
    v_permlane32_swap_b32 v36, v37
    v_add_f32 v36, v36, v37
    v_mul_f32 v36, 0x3ae38e39, v36
    v_sub_f32 v36, v36, v33
    v_max_f32 v36, 0, v36
    v_add_f32 v36, 0x3727c5ac, v36
    v_rsq_f32 v36, v36
    s_nop 0
    v_mul_f32 v2, 0x3eeff558, v36
    v_mul_f32 v3, v2, -v32
    s_add_u32 m0, s82, 138368
    s_nop 0
    s_nop 0
    buffer_load_dwordx4 v31, s[8:11], 0 offen offset:896 lds
    v_pk_fma_f32 v[40:41], v[40:41], v[2:3], v[2:3] op_sel:[0,0,1] op_sel_hi:[1,0,1]
    v_pk_fma_f32 v[76:77], v[76:77], v[2:3], v[2:3] op_sel:[0,0,1] op_sel_hi:[1,0,1]
    v_pk_fma_f32 v[42:43], v[42:43], v[2:3], v[2:3] op_sel:[0,0,1] op_sel_hi:[1,0,1]
    v_pk_fma_f32 v[78:79], v[78:79], v[2:3], v[2:3] op_sel:[0,0,1] op_sel_hi:[1,0,1]
    v_cvt_pk_bf16_f32 v40, v40, v76
    v_cvt_pk_bf16_f32 v41, v41, v77
    v_cvt_pk_bf16_f32 v42, v42, v78
    v_cvt_pk_bf16_f32 v43, v43, v79
    v_accvgpr_write_b32 a0, v40
    v_accvgpr_write_b32 a1, v41
    v_accvgpr_write_b32 a2, v42
    v_accvgpr_write_b32 a3, v43
    v_pk_fma_f32 v[44:45], v[44:45], v[2:3], v[2:3] op_sel:[0,0,1] op_sel_hi:[1,0,1]
    v_pk_fma_f32 v[80:81], v[80:81], v[2:3], v[2:3] op_sel:[0,0,1] op_sel_hi:[1,0,1]
    v_pk_fma_f32 v[46:47], v[46:47], v[2:3], v[2:3] op_sel:[0,0,1] op_sel_hi:[1,0,1]
    v_pk_fma_f32 v[82:83], v[82:83], v[2:3], v[2:3] op_sel:[0,0,1] op_sel_hi:[1,0,1]
    v_cvt_pk_bf16_f32 v44, v44, v80
    v_cvt_pk_bf16_f32 v45, v45, v81
    v_cvt_pk_bf16_f32 v46, v46, v82
    v_cvt_pk_bf16_f32 v47, v47, v83
    v_accvgpr_write_b32 a4, v44
    v_accvgpr_write_b32 a5, v45
    v_accvgpr_write_b32 a6, v46
    v_accvgpr_write_b32 a7, v47
    s_add_u32 m0, s82, 105472
    s_nop 0
    s_nop 0
    buffer_load_dwordx4 v30, s[8:11], 0 offen offset:1024 lds
    v_pk_fma_f32 v[48:49], v[48:49], v[2:3], v[2:3] op_sel:[0,0,1] op_sel_hi:[1,0,1]
    v_pk_fma_f32 v[84:85], v[84:85], v[2:3], v[2:3] op_sel:[0,0,1] op_sel_hi:[1,0,1]
    v_pk_fma_f32 v[50:51], v[50:51], v[2:3], v[2:3] op_sel:[0,0,1] op_sel_hi:[1,0,1]
    v_pk_fma_f32 v[86:87], v[86:87], v[2:3], v[2:3] op_sel:[0,0,1] op_sel_hi:[1,0,1]
    v_cvt_pk_bf16_f32 v48, v48, v84
    v_cvt_pk_bf16_f32 v49, v49, v85
    v_cvt_pk_bf16_f32 v50, v50, v86
    v_cvt_pk_bf16_f32 v51, v51, v87
    v_accvgpr_write_b32 a8, v48
    v_accvgpr_write_b32 a9, v49
    v_accvgpr_write_b32 a10, v50
    v_accvgpr_write_b32 a11, v51
    v_pk_fma_f32 v[52:53], v[52:53], v[2:3], v[2:3] op_sel:[0,0,1] op_sel_hi:[1,0,1]
    v_pk_fma_f32 v[88:89], v[88:89], v[2:3], v[2:3] op_sel:[0,0,1] op_sel_hi:[1,0,1]
    v_pk_fma_f32 v[54:55], v[54:55], v[2:3], v[2:3] op_sel:[0,0,1] op_sel_hi:[1,0,1]
    v_pk_fma_f32 v[90:91], v[90:91], v[2:3], v[2:3] op_sel:[0,0,1] op_sel_hi:[1,0,1]
    v_cvt_pk_bf16_f32 v52, v52, v88
    v_cvt_pk_bf16_f32 v53, v53, v89
    v_cvt_pk_bf16_f32 v54, v54, v90
    v_cvt_pk_bf16_f32 v55, v55, v91
    v_accvgpr_write_b32 a12, v52
    v_accvgpr_write_b32 a13, v53
    v_accvgpr_write_b32 a14, v54
    v_accvgpr_write_b32 a15, v55
    s_add_u32 m0, s82, 142336
    s_nop 0
    s_nop 0
    buffer_load_dwordx4 v31, s[8:11], 0 offen offset:1024 lds
    v_pk_fma_f32 v[56:57], v[56:57], v[2:3], v[2:3] op_sel:[0,0,1] op_sel_hi:[1,0,1]
    v_pk_fma_f32 v[92:93], v[92:93], v[2:3], v[2:3] op_sel:[0,0,1] op_sel_hi:[1,0,1]
    v_pk_fma_f32 v[58:59], v[58:59], v[2:3], v[2:3] op_sel:[0,0,1] op_sel_hi:[1,0,1]
    v_pk_fma_f32 v[94:95], v[94:95], v[2:3], v[2:3] op_sel:[0,0,1] op_sel_hi:[1,0,1]
    v_cvt_pk_bf16_f32 v56, v56, v92
    v_cvt_pk_bf16_f32 v57, v57, v93
    v_cvt_pk_bf16_f32 v58, v58, v94
    v_cvt_pk_bf16_f32 v59, v59, v95
    v_accvgpr_write_b32 a16, v56
    v_accvgpr_write_b32 a17, v57
    v_accvgpr_write_b32 a18, v58
    v_accvgpr_write_b32 a19, v59
    v_pk_fma_f32 v[60:61], v[60:61], v[2:3], v[2:3] op_sel:[0,0,1] op_sel_hi:[1,0,1]
    v_pk_fma_f32 v[96:97], v[96:97], v[2:3], v[2:3] op_sel:[0,0,1] op_sel_hi:[1,0,1]
    v_pk_fma_f32 v[62:63], v[62:63], v[2:3], v[2:3] op_sel:[0,0,1] op_sel_hi:[1,0,1]
    v_pk_fma_f32 v[98:99], v[98:99], v[2:3], v[2:3] op_sel:[0,0,1] op_sel_hi:[1,0,1]
    v_cvt_pk_bf16_f32 v60, v60, v96
    v_cvt_pk_bf16_f32 v61, v61, v97
    v_cvt_pk_bf16_f32 v62, v62, v98
    v_cvt_pk_bf16_f32 v63, v63, v99
    v_accvgpr_write_b32 a20, v60
    v_accvgpr_write_b32 a21, v61
    v_accvgpr_write_b32 a22, v62
    v_accvgpr_write_b32 a23, v63
    v_pk_fma_f32 v[64:65], v[64:65], v[2:3], v[2:3] op_sel:[0,0,1] op_sel_hi:[1,0,1]
    v_pk_fma_f32 v[100:101], v[100:101], v[2:3], v[2:3] op_sel:[0,0,1] op_sel_hi:[1,0,1]
    v_pk_fma_f32 v[66:67], v[66:67], v[2:3], v[2:3] op_sel:[0,0,1] op_sel_hi:[1,0,1]
    v_pk_fma_f32 v[102:103], v[102:103], v[2:3], v[2:3] op_sel:[0,0,1] op_sel_hi:[1,0,1]
    v_cvt_pk_bf16_f32 v64, v64, v100
    v_cvt_pk_bf16_f32 v65, v65, v101
    v_cvt_pk_bf16_f32 v66, v66, v102
    v_cvt_pk_bf16_f32 v67, v67, v103
    v_accvgpr_write_b32 a24, v64
    v_accvgpr_write_b32 a25, v65
    v_accvgpr_write_b32 a26, v66
    v_accvgpr_write_b32 a27, v67
    v_pk_fma_f32 v[68:69], v[68:69], v[2:3], v[2:3] op_sel:[0,0,1] op_sel_hi:[1,0,1]
    v_pk_fma_f32 v[104:105], v[104:105], v[2:3], v[2:3] op_sel:[0,0,1] op_sel_hi:[1,0,1]
    v_pk_fma_f32 v[70:71], v[70:71], v[2:3], v[2:3] op_sel:[0,0,1] op_sel_hi:[1,0,1]
    v_pk_fma_f32 v[106:107], v[106:107], v[2:3], v[2:3] op_sel:[0,0,1] op_sel_hi:[1,0,1]
    v_cvt_pk_bf16_f32 v68, v68, v104
    v_cvt_pk_bf16_f32 v69, v69, v105
    v_cvt_pk_bf16_f32 v70, v70, v106
    v_cvt_pk_bf16_f32 v71, v71, v107
    v_accvgpr_write_b32 a28, v68
    v_accvgpr_write_b32 a29, v69
    v_accvgpr_write_b32 a30, v70
    v_accvgpr_write_b32 a31, v71
    v_pk_fma_f32 v[72:73], v[72:73], v[2:3], v[2:3] op_sel:[0,0,1] op_sel_hi:[1,0,1]
    v_pk_fma_f32 v[108:109], v[108:109], v[2:3], v[2:3] op_sel:[0,0,1] op_sel_hi:[1,0,1]
    v_pk_fma_f32 v[74:75], v[74:75], v[2:3], v[2:3] op_sel:[0,0,1] op_sel_hi:[1,0,1]
    v_pk_fma_f32 v[110:111], v[110:111], v[2:3], v[2:3] op_sel:[0,0,1] op_sel_hi:[1,0,1]
    v_cvt_pk_bf16_f32 v72, v72, v108
    v_cvt_pk_bf16_f32 v73, v73, v109
    v_cvt_pk_bf16_f32 v74, v74, v110
    v_cvt_pk_bf16_f32 v75, v75, v111
    v_accvgpr_write_b32 a32, v72
    v_accvgpr_write_b32 a33, v73
    v_accvgpr_write_b32 a34, v74
    v_accvgpr_write_b32 a35, v75
    v_pk_fma_f32 v[112:113], v[112:113], v[2:3], v[2:3] op_sel:[0,0,1] op_sel_hi:[1,0,1]
    v_pk_fma_f32 v[148:149], v[148:149], v[2:3], v[2:3] op_sel:[0,0,1] op_sel_hi:[1,0,1]
    v_pk_fma_f32 v[114:115], v[114:115], v[2:3], v[2:3] op_sel:[0,0,1] op_sel_hi:[1,0,1]
    v_pk_fma_f32 v[150:151], v[150:151], v[2:3], v[2:3] op_sel:[0,0,1] op_sel_hi:[1,0,1]
    v_cvt_pk_bf16_f32 v112, v112, v148
    v_cvt_pk_bf16_f32 v113, v113, v149
    v_cvt_pk_bf16_f32 v114, v114, v150
    v_cvt_pk_bf16_f32 v115, v115, v151
    v_accvgpr_write_b32 a36, v112
    v_accvgpr_write_b32 a37, v113
    v_accvgpr_write_b32 a38, v114
    v_accvgpr_write_b32 a39, v115
    v_pk_fma_f32 v[116:117], v[116:117], v[2:3], v[2:3] op_sel:[0,0,1] op_sel_hi:[1,0,1]
    v_pk_fma_f32 v[152:153], v[152:153], v[2:3], v[2:3] op_sel:[0,0,1] op_sel_hi:[1,0,1]
    v_pk_fma_f32 v[118:119], v[118:119], v[2:3], v[2:3] op_sel:[0,0,1] op_sel_hi:[1,0,1]
    v_pk_fma_f32 v[154:155], v[154:155], v[2:3], v[2:3] op_sel:[0,0,1] op_sel_hi:[1,0,1]
    v_cvt_pk_bf16_f32 v116, v116, v152
    v_cvt_pk_bf16_f32 v117, v117, v153
    v_cvt_pk_bf16_f32 v118, v118, v154
    v_cvt_pk_bf16_f32 v119, v119, v155
    v_accvgpr_write_b32 a40, v116
    v_accvgpr_write_b32 a41, v117
    v_accvgpr_write_b32 a42, v118
    v_accvgpr_write_b32 a43, v119
    v_pk_fma_f32 v[120:121], v[120:121], v[2:3], v[2:3] op_sel:[0,0,1] op_sel_hi:[1,0,1]
    v_pk_fma_f32 v[156:157], v[156:157], v[2:3], v[2:3] op_sel:[0,0,1] op_sel_hi:[1,0,1]
    v_pk_fma_f32 v[122:123], v[122:123], v[2:3], v[2:3] op_sel:[0,0,1] op_sel_hi:[1,0,1]
    v_pk_fma_f32 v[158:159], v[158:159], v[2:3], v[2:3] op_sel:[0,0,1] op_sel_hi:[1,0,1]
    v_cvt_pk_bf16_f32 v120, v120, v156
    v_cvt_pk_bf16_f32 v121, v121, v157
    v_cvt_pk_bf16_f32 v122, v122, v158
    v_cvt_pk_bf16_f32 v123, v123, v159
    v_accvgpr_write_b32 a44, v120
    v_accvgpr_write_b32 a45, v121
    v_accvgpr_write_b32 a46, v122
    v_accvgpr_write_b32 a47, v123
    v_pk_fma_f32 v[124:125], v[124:125], v[2:3], v[2:3] op_sel:[0,0,1] op_sel_hi:[1,0,1]
    v_pk_fma_f32 v[160:161], v[160:161], v[2:3], v[2:3] op_sel:[0,0,1] op_sel_hi:[1,0,1]
    v_pk_fma_f32 v[126:127], v[126:127], v[2:3], v[2:3] op_sel:[0,0,1] op_sel_hi:[1,0,1]
    v_pk_fma_f32 v[162:163], v[162:163], v[2:3], v[2:3] op_sel:[0,0,1] op_sel_hi:[1,0,1]
    v_cvt_pk_bf16_f32 v124, v124, v160
    v_cvt_pk_bf16_f32 v125, v125, v161
    v_cvt_pk_bf16_f32 v126, v126, v162
    v_cvt_pk_bf16_f32 v127, v127, v163
    v_accvgpr_write_b32 a48, v124
    v_accvgpr_write_b32 a49, v125
    v_accvgpr_write_b32 a50, v126
    v_accvgpr_write_b32 a51, v127
    v_pk_fma_f32 v[128:129], v[128:129], v[2:3], v[2:3] op_sel:[0,0,1] op_sel_hi:[1,0,1]
    v_pk_fma_f32 v[164:165], v[164:165], v[2:3], v[2:3] op_sel:[0,0,1] op_sel_hi:[1,0,1]
    v_pk_fma_f32 v[130:131], v[130:131], v[2:3], v[2:3] op_sel:[0,0,1] op_sel_hi:[1,0,1]
    v_pk_fma_f32 v[166:167], v[166:167], v[2:3], v[2:3] op_sel:[0,0,1] op_sel_hi:[1,0,1]
    v_cvt_pk_bf16_f32 v128, v128, v164
    v_cvt_pk_bf16_f32 v129, v129, v165
    v_cvt_pk_bf16_f32 v130, v130, v166
    v_cvt_pk_bf16_f32 v131, v131, v167
    v_accvgpr_write_b32 a52, v128
    v_accvgpr_write_b32 a53, v129
    v_accvgpr_write_b32 a54, v130
    v_accvgpr_write_b32 a55, v131
    v_pk_fma_f32 v[132:133], v[132:133], v[2:3], v[2:3] op_sel:[0,0,1] op_sel_hi:[1,0,1]
    v_pk_fma_f32 v[168:169], v[168:169], v[2:3], v[2:3] op_sel:[0,0,1] op_sel_hi:[1,0,1]
    v_pk_fma_f32 v[134:135], v[134:135], v[2:3], v[2:3] op_sel:[0,0,1] op_sel_hi:[1,0,1]
    v_pk_fma_f32 v[170:171], v[170:171], v[2:3], v[2:3] op_sel:[0,0,1] op_sel_hi:[1,0,1]
    v_cvt_pk_bf16_f32 v132, v132, v168
    v_cvt_pk_bf16_f32 v133, v133, v169
    v_cvt_pk_bf16_f32 v134, v134, v170
    v_cvt_pk_bf16_f32 v135, v135, v171
    v_accvgpr_write_b32 a56, v132
    v_accvgpr_write_b32 a57, v133
    v_accvgpr_write_b32 a58, v134
    v_accvgpr_write_b32 a59, v135
    s_cmp_eq_u32 s79, 0
    s_cbranch_scc1 L_nokv
    s_add_u32 m0, s82, 147456
    s_mov_b32 s90, 0
    buffer_load_dwordx4 v208, s[40:43], s90 offen lds
    s_add_u32 m0, s82, 151552
    s_mov_b32 s90, 4608
    buffer_load_dwordx4 v208, s[40:43], s90 offen lds
    s_add_u32 m0, s82, 155648
    s_mov_b32 s90, 9216
    buffer_load_dwordx4 v208, s[40:43], s90 offen lds
    s_add_u32 m0, s82, 159744
    s_mov_b32 s90, 13824
    buffer_load_dwordx4 v208, s[40:43], s90 offen lds
    s_add_u32 m0, s82, 69632
    s_mov_b32 s90, 18432
    buffer_load_dwordx4 v208, s[40:43], s90 offen lds
L_nokv:
    s_nop 0
    v_pk_fma_f32 v[136:137], v[136:137], v[2:3], v[2:3] op_sel:[0,0,1] op_sel_hi:[1,0,1]
    v_pk_fma_f32 v[172:173], v[172:173], v[2:3], v[2:3] op_sel:[0,0,1] op_sel_hi:[1,0,1]
    v_pk_fma_f32 v[138:139], v[138:139], v[2:3], v[2:3] op_sel:[0,0,1] op_sel_hi:[1,0,1]
    v_pk_fma_f32 v[174:175], v[174:175], v[2:3], v[2:3] op_sel:[0,0,1] op_sel_hi:[1,0,1]
    v_cvt_pk_bf16_f32 v136, v136, v172
    v_cvt_pk_bf16_f32 v137, v137, v173
    v_cvt_pk_bf16_f32 v138, v138, v174
    v_cvt_pk_bf16_f32 v139, v139, v175
    v_accvgpr_write_b32 a60, v136
    v_accvgpr_write_b32 a61, v137
    v_accvgpr_write_b32 a62, v138
    v_accvgpr_write_b32 a63, v139
    s_waitcnt vmcnt(15)
    s_nop 0
    ds_read_b128 v[76:79], v7 offset:0
    ds_read_b128 v[80:83], v27 offset:0
    ds_read_b128 v[84:87], v7 offset:4096
    ds_read_b128 v[88:91], v27 offset:4096
    v_pk_fma_f32 v[140:141], v[140:141], v[2:3], v[2:3] op_sel:[0,0,1] op_sel_hi:[1,0,1]
    v_pk_fma_f32 v[176:177], v[176:177], v[2:3], v[2:3] op_sel:[0,0,1] op_sel_hi:[1,0,1]
    v_pk_fma_f32 v[142:143], v[142:143], v[2:3], v[2:3] op_sel:[0,0,1] op_sel_hi:[1,0,1]
    v_pk_fma_f32 v[178:179], v[178:179], v[2:3], v[2:3] op_sel:[0,0,1] op_sel_hi:[1,0,1]
    v_cvt_pk_bf16_f32 v140, v140, v176
    v_cvt_pk_bf16_f32 v141, v141, v177
    v_cvt_pk_bf16_f32 v142, v142, v178
    v_cvt_pk_bf16_f32 v143, v143, v179
    v_accvgpr_write_b32 a64, v140
    v_accvgpr_write_b32 a65, v141
    v_accvgpr_write_b32 a66, v142
    v_accvgpr_write_b32 a67, v143
    v_pk_fma_f32 v[144:145], v[144:145], v[2:3], v[2:3] op_sel:[0,0,1] op_sel_hi:[1,0,1]
    v_pk_fma_f32 v[180:181], v[180:181], v[2:3], v[2:3] op_sel:[0,0,1] op_sel_hi:[1,0,1]
    v_pk_fma_f32 v[146:147], v[146:147], v[2:3], v[2:3] op_sel:[0,0,1] op_sel_hi:[1,0,1]
    v_pk_fma_f32 v[182:183], v[182:183], v[2:3], v[2:3] op_sel:[0,0,1] op_sel_hi:[1,0,1]
    v_cvt_pk_bf16_f32 v144, v144, v180
    v_cvt_pk_bf16_f32 v145, v145, v181
    v_cvt_pk_bf16_f32 v146, v146, v182
    v_cvt_pk_bf16_f32 v147, v147, v183
    v_accvgpr_write_b32 a68, v144
    v_accvgpr_write_b32 a69, v145
    v_accvgpr_write_b32 a70, v146
    v_accvgpr_write_b32 a71, v147
    s_waitcnt lgkmcnt(2)
    v_mfma_f32_16x16x32_bf16 v[32:35], a[252:255], v[76:79], 0
    s_waitcnt vmcnt(13)
    ds_read_b128 v[92:95], v7 offset:8192
    v_lshlrev_b32 v40, 16, v76
    v_lshlrev_b32 v41, 16, v77
    v_lshlrev_b32 v42, 16, v78
    v_lshlrev_b32 v43, 16, v79
    v_mfma_f32_16x16x32_bf16 v[36:39], v[76:79], v[76:79], 0
    s_add_u32 m0, s82, 0
    s_mov_b32 s83, s84
    ds_read_b128 v[96:99], v27 offset:8192
    buffer_load_dwordx4 v24, s[12:15], s83 offen lds
    v_and_b32 v76, 0xffff0000, v76
    v_and_b32 v77, 0xffff0000, v77
    v_and_b32 v78, 0xffff0000, v78
    v_and_b32 v79, 0xffff0000, v79
    v_mfma_f32_16x16x32_bf16 v[32:35], a[252:255], v[80:83], v[32:35]
    s_add_u32 m0, s82, 4096
    s_add_u32 s83, s83, s86
    buffer_load_dwordx4 v24, s[12:15], s83 offen lds
    v_lshlrev_b32 v44, 16, v80
    v_lshlrev_b32 v45, 16, v81
    v_lshlrev_b32 v46, 16, v82
    v_lshlrev_b32_e64 v47, 16, v83
    v_mfma_f32_16x16x32_bf16 v[36:39], v[80:83], v[80:83], v[36:39]
    s_waitcnt lgkmcnt(2)
    v_and_b32 v80, 0xffff0000, v80
    v_and_b32 v81, 0xffff0000, v81
    v_and_b32 v82, 0xffff0000, v82
    v_and_b32 v83, 0xffff0000, v83
    v_mfma_f32_16x16x32_bf16 v[32:35], a[252:255], v[84:87], v[32:35]
    s_waitcnt vmcnt(13)
    ds_read_b128 v[100:103], v7 offset:12288
    v_lshlrev_b32 v48, 16, v84
    v_lshlrev_b32 v49, 16, v85
    v_lshlrev_b32 v50, 16, v86
    v_lshlrev_b32 v51, 16, v87
    v_mfma_f32_16x16x32_bf16 v[36:39], v[84:87], v[84:87], v[36:39]
    s_add_u32 m0, s82, 8192
    s_add_u32 s83, s83, s86
    s_nop 0
    ds_read_b128 v[104:107], v27 offset:12288
    buffer_load_dwordx4 v24, s[12:15], s83 offen lds
    v_and_b32 v84, 0xffff0000, v84
    v_and_b32 v85, 0xffff0000, v85
    v_and_b32 v86, 0xffff0000, v86
    v_and_b32 v87, 0xffff0000, v87
L_w0:
    s_cbranch_execz L_wb
    v_mfma_f32_16x16x32_bf16 v[32:35], a[252:255], v[88:91], v[32:35]
    s_add_u32 m0, s82, 12288
    s_add_u32 s83, s83, s86
    buffer_load_dwordx4 v24, s[12:15], s83 offen lds
    v_lshlrev_b32 v52, 16, v88
    v_lshlrev_b32 v53, 16, v89
    v_lshlrev_b32 v54, 16, v90
    v_lshlrev_b32 v55, 16, v91
    v_mfma_f32_16x16x32_bf16 v[36:39], v[88:91], v[88:91], v[36:39]
    s_waitcnt lgkmcnt(2)
    v_and_b32 v88, 0xffff0000, v88
    v_and_b32 v89, 0xffff0000, v89
    v_and_b32 v90, 0xffff0000, v90
    v_and_b32 v91, 0xffff0000, v91
    v_mfma_f32_16x16x32_bf16 v[32:35], a[252:255], v[92:95], v[32:35]
    s_waitcnt vmcnt(13)
    ds_read_b128 v[108:111], v7 offset:16384
    v_lshlrev_b32 v56, 16, v92
    v_lshlrev_b32 v57, 16, v93
    v_lshlrev_b32 v58, 16, v94
    v_lshlrev_b32 v59, 16, v95
    v_mfma_f32_16x16x32_bf16 v[36:39], v[92:95], v[92:95], v[36:39]
    s_add_u32 m0, s82, 16384
    s_add_u32 s83, s83, s86
    s_nop 0
    ds_read_b128 v[148:151], v27 offset:16384
    buffer_load_dwordx4 v24, s[12:15], s83 offen lds
    v_and_b32 v92, 0xffff0000, v92
    v_and_b32 v93, 0xffff0000, v93
    v_and_b32 v94, 0xffff0000, v94
    v_and_b32 v95, 0xffff0000, v95
    v_mfma_f32_16x16x32_bf16 v[32:35], a[252:255], v[96:99], v[32:35]
    s_add_u32 m0, s82, 20480
    s_add_u32 s83, s83, s86
    buffer_load_dwordx4 v24, s[12:15], s83 offen lds
    v_lshlrev_b32 v60, 16, v96
    v_lshlrev_b32 v61, 16, v97
    v_lshlrev_b32 v62, 16, v98
    v_lshlrev_b32_e64 v63, 16, v99
    v_mfma_f32_16x16x32_bf16 v[36:39], v[96:99], v[96:99], v[36:39]
    s_waitcnt lgkmcnt(2)
    v_and_b32 v96, 0xffff0000, v96
    v_and_b32 v97, 0xffff0000, v97
    v_and_b32 v98, 0xffff0000, v98
    v_and_b32 v99, 0xffff0000, v99
    v_mfma_f32_16x16x32_bf16 v[32:35], a[252:255], v[100:103], v[32:35]
    s_waitcnt vmcnt(13)
    ds_read_b128 v[152:155], v7 offset:20480
    v_lshlrev_b32 v64, 16, v100
    v_lshlrev_b32 v65, 16, v101
    v_lshlrev_b32 v66, 16, v102
    v_lshlrev_b32 v67, 16, v103
    v_mfma_f32_16x16x32_bf16 v[36:39], v[100:103], v[100:103], v[36:39]
    s_add_u32 m0, s82, 24576
    s_add_u32 s83, s83, s86
    s_nop 0
    ds_read_b128 v[156:159], v27 offset:20480
    buffer_load_dwordx4 v24, s[12:15], s83 offen lds
    v_and_b32 v100, 0xffff0000, v100
    v_and_b32 v101, 0xffff0000, v101
    v_and_b32 v102, 0xffff0000, v102
    v_and_b32 v103, 0xffff0000, v103
    v_mfma_f32_16x16x32_bf16 v[32:35], a[252:255], v[104:107], v[32:35]
    s_add_u32 m0, s82, 28672
    s_add_u32 s83, s83, s86
    buffer_load_dwordx4 v24, s[12:15], s83 offen lds
    v_lshlrev_b32 v68, 16, v104
    v_lshlrev_b32 v69, 16, v105
    v_lshlrev_b32 v70, 16, v106
    v_lshlrev_b32_e64 v71, 16, v107
    v_mfma_f32_16x16x32_bf16 v[36:39], v[104:107], v[104:107], v[36:39]
    s_waitcnt lgkmcnt(2)
    v_and_b32 v104, 0xffff0000, v104
    v_and_b32 v105, 0xffff0000, v105
    v_and_b32 v106, 0xffff0000, v106
    v_and_b32 v107, 0xffff0000, v107
    v_mfma_f32_16x16x32_bf16 v[32:35], a[252:255], v[108:111], v[32:35]
    s_waitcnt vmcnt(12)
    ds_read_b128 v[160:163], v7 offset:24576
    v_lshlrev_b32 v72, 16, v108
    v_lshlrev_b32 v73, 16, v109
    v_lshlrev_b32 v74, 16, v110
    v_lshlrev_b32 v75, 16, v111
    v_mfma_f32_16x16x32_bf16 v[36:39], v[108:111], v[108:111], v[36:39]
    s_add_u32 m0, s82, 32768
    s_add_u32 s83, s83, s86
    ds_read_b128 v[164:167], v27 offset:24576
    buffer_load_dwordx4 v24, s[12:15], s83 offen lds
    v_and_b32 v108, 0xffff0000, v108
    v_and_b32 v109, 0xffff0000, v109
    v_and_b32 v110, 0xffff0000, v110
    v_and_b32 v111, 0xffff0000, v111
    v_mfma_f32_16x16x32_bf16 v[32:35], a[252:255], v[148:151], v[32:35]
    s_add_u32 s90, s84, 0
    buffer_load_dword v5, v25, s[72:75], s90 offen
    v_lshlrev_b32 v112, 16, v148
    v_lshlrev_b32 v113, 16, v149
    v_lshlrev_b32 v114, 16, v150
    v_lshlrev_b32 v115, 16, v151
    v_mfma_f32_16x16x32_bf16 v[36:39], v[148:151], v[148:151], v[36:39]
    s_waitcnt lgkmcnt(2)
    v_and_b32 v148, 0xffff0000, v148
    v_and_b32 v149, 0xffff0000, v149
    v_and_b32 v150, 0xffff0000, v150
    v_and_b32 v151, 0xffff0000, v151
    v_mfma_f32_16x16x32_bf16 v[32:35], a[252:255], v[152:155], v[32:35]
    s_waitcnt vmcnt(12)
    ds_read_b128 v[168:171], v7 offset:28672
    v_lshlrev_b32 v116, 16, v152
    v_lshlrev_b32 v117, 16, v153
    v_lshlrev_b32 v118, 16, v154
    v_lshlrev_b32 v119, 16, v155
    v_mfma_f32_16x16x32_bf16 v[36:39], v[152:155], v[152:155], v[36:39]
    ds_read_b128 v[172:175], v27 offset:28672
    v_and_b32 v152, 0xffff0000, v152
    v_and_b32 v153, 0xffff0000, v153
    v_and_b32 v154, 0xffff0000, v154
    v_and_b32 v155, 0xffff0000, v155
    v_mfma_f32_16x16x32_bf16 v[32:35], a[252:255], v[156:159], v[32:35]
    v_lshlrev_b32 v120, 16, v156
    v_lshlrev_b32 v121, 16, v157
    v_lshlrev_b32 v122, 16, v158
    v_lshlrev_b32 v123, 16, v159
    v_mfma_f32_16x16x32_bf16 v[36:39], v[156:159], v[156:159], v[36:39]
    s_waitcnt lgkmcnt(2)
    v_and_b32 v156, 0xffff0000, v156
    v_and_b32 v157, 0xffff0000, v157
    v_and_b32 v158, 0xffff0000, v158
    v_and_b32 v159, 0xffff0000, v159
    v_mfma_f32_16x16x32_bf16 v[32:35], a[252:255], v[160:163], v[32:35]
    s_waitcnt vmcnt(10)
    ds_read_b128 v[176:179], v7 offset:32768
    v_lshlrev_b32 v124, 16, v160
    v_lshlrev_b32 v125, 16, v161
    v_lshlrev_b32 v126, 16, v162
    v_lshlrev_b32 v127, 16, v163
    v_mfma_f32_16x16x32_bf16 v[36:39], v[160:163], v[160:163], v[36:39]
    ds_read_b128 v[180:183], v27 offset:32768
    v_and_b32 v160, 0xffff0000, v160
    v_and_b32 v161, 0xffff0000, v161
    v_and_b32 v162, 0xffff0000, v162
    v_and_b32 v163, 0xffff0000, v163
    v_mfma_f32_16x16x32_bf16 v[32:35], a[252:255], v[164:167], v[32:35]
    v_lshlrev_b32 v128, 16, v164
    v_lshlrev_b32 v129, 16, v165
    v_lshlrev_b32 v130, 16, v166
    v_lshlrev_b32 v131, 16, v167
    v_mfma_f32_16x16x32_bf16 v[36:39], v[164:167], v[164:167], v[36:39]
    s_waitcnt lgkmcnt(2)
    v_and_b32 v164, 0xffff0000, v164
    v_and_b32 v165, 0xffff0000, v165
    v_and_b32 v166, 0xffff0000, v166
    v_and_b32 v167, 0xffff0000, v167
    v_mfma_f32_16x16x32_bf16 v[32:35], a[252:255], v[168:171], v[32:35]
    v_lshlrev_b32 v132, 16, v168
    v_lshlrev_b32 v133, 16, v169
    v_lshlrev_b32 v134, 16, v170
    v_lshlrev_b32_e64 v135, 16, v171
    v_mfma_f32_16x16x32_bf16 v[36:39], v[168:171], v[168:171], v[36:39]
    v_and_b32 v168, 0xffff0000, v168
    v_and_b32 v169, 0xffff0000, v169
    v_and_b32 v170, 0xffff0000, v170
    v_and_b32 v171, 0xffff0000, v171
    v_mfma_f32_16x16x32_bf16 v[32:35], a[252:255], v[172:175], v[32:35]
    v_lshlrev_b32 v136, 16, v172
    v_lshlrev_b32 v137, 16, v173
    v_lshlrev_b32 v138, 16, v174
    v_lshlrev_b32 v139, 16, v175
    v_mfma_f32_16x16x32_bf16 v[36:39], v[172:175], v[172:175], v[36:39]
    s_waitcnt lgkmcnt(0)
    v_and_b32 v172, 0xffff0000, v172
    v_and_b32 v173, 0xffff0000, v173
    v_and_b32 v174, 0xffff0000, v174
    v_and_b32 v175, 0xffff0000, v175
    v_mfma_f32_16x16x32_bf16 v[32:35], a[252:255], v[176:179], v[32:35]
    v_lshlrev_b32 v140, 16, v176
    v_lshlrev_b32 v141, 16, v177
    v_lshlrev_b32 v142, 16, v178
    v_lshlrev_b32_e64 v143, 16, v179
    v_mfma_f32_16x16x32_bf16 v[36:39], v[176:179], v[176:179], v[36:39]
    v_and_b32 v176, 0xffff0000, v176
    v_and_b32 v177, 0xffff0000, v177
    v_and_b32 v178, 0xffff0000, v178
    v_and_b32 v179, 0xffff0000, v179
    v_mfma_f32_16x16x32_bf16 v[32:35], a[252:255], v[180:183], v[32:35]
    v_lshlrev_b32 v144, 16, v180
    v_lshlrev_b32 v145, 16, v181
    v_lshlrev_b32 v146, 16, v182
    v_lshlrev_b32 v147, 16, v183
    v_mfma_f32_16x16x32_bf16 v[36:39], v[180:183], v[180:183], v[36:39]
    v_and_b32 v180, 0xffff0000, v180
    v_and_b32 v181, 0xffff0000, v181
    v_and_b32 v182, 0xffff0000, v182
    v_and_b32 v183, 0xffff0000, v183
    s_nop 3
    v_cndmask_b32 v36, 0, v36, s[60:61]
    v_cndmask_b32 v36, v36, v37, s[62:63]
    v_cndmask_b32 v36, v36, v38, s[64:65]
    v_cndmask_b32 v36, v36, v39, s[66:67]
    v_mov_b32 v37, v36
    v_mul_f32 v32, 0x3ae38e39, v32
    s_nop 0
    v_permlane16_swap_b32 v36, v37
    v_add_f32 v36, v36, v37
    v_mov_b32 v37, v36
    v_mul_f32 v33, v32, v32
    s_nop 0
    v_permlane32_swap_b32 v36, v37
    v_add_f32 v36, v36, v37
    v_mul_f32 v36, 0x3ae38e39, v36
    v_sub_f32 v36, v36, v33
    v_max_f32 v36, 0, v36
    v_add_f32 v36, 0x3727c5ac, v36
    v_rsq_f32 v36, v36
    s_nop 0
    v_mul_f32 v2, 0x3eeff558, v36
    v_mul_f32 v3, v2, -v32
    v_pk_fma_f32 v[40:41], v[40:41], v[2:3], v[2:3] op_sel:[0,0,1] op_sel_hi:[1,0,1]
    v_pk_fma_f32 v[76:77], v[76:77], v[2:3], v[2:3] op_sel:[0,0,1] op_sel_hi:[1,0,1]
    v_pk_fma_f32 v[42:43], v[42:43], v[2:3], v[2:3] op_sel:[0,0,1] op_sel_hi:[1,0,1]
    v_pk_fma_f32 v[78:79], v[78:79], v[2:3], v[2:3] op_sel:[0,0,1] op_sel_hi:[1,0,1]
    v_cvt_pk_bf16_f32 v40, v40, v76
    v_cvt_pk_bf16_f32 v41, v41, v77
    v_cvt_pk_bf16_f32 v42, v42, v78
    v_cvt_pk_bf16_f32 v43, v43, v79
    v_accvgpr_write_b32 a72, v40
    v_accvgpr_write_b32 a73, v41
    v_accvgpr_write_b32 a74, v42
    v_accvgpr_write_b32 a75, v43
    v_pk_fma_f32 v[44:45], v[44:45], v[2:3], v[2:3] op_sel:[0,0,1] op_sel_hi:[1,0,1]
    v_pk_fma_f32 v[80:81], v[80:81], v[2:3], v[2:3] op_sel:[0,0,1] op_sel_hi:[1,0,1]
    v_pk_fma_f32 v[46:47], v[46:47], v[2:3], v[2:3] op_sel:[0,0,1] op_sel_hi:[1,0,1]
    v_pk_fma_f32 v[82:83], v[82:83], v[2:3], v[2:3] op_sel:[0,0,1] op_sel_hi:[1,0,1]
    v_cvt_pk_bf16_f32 v44, v44, v80
    v_cvt_pk_bf16_f32 v45, v45, v81
    v_cvt_pk_bf16_f32 v46, v46, v82
    v_cvt_pk_bf16_f32 v47, v47, v83
    v_accvgpr_write_b32 a76, v44
    v_accvgpr_write_b32 a77, v45
    v_accvgpr_write_b32 a78, v46
    v_accvgpr_write_b32 a79, v47
    v_pk_fma_f32 v[48:49], v[48:49], v[2:3], v[2:3] op_sel:[0,0,1] op_sel_hi:[1,0,1]
    v_pk_fma_f32 v[84:85], v[84:85], v[2:3], v[2:3] op_sel:[0,0,1] op_sel_hi:[1,0,1]
    v_pk_fma_f32 v[50:51], v[50:51], v[2:3], v[2:3] op_sel:[0,0,1] op_sel_hi:[1,0,1]
    v_pk_fma_f32 v[86:87], v[86:87], v[2:3], v[2:3] op_sel:[0,0,1] op_sel_hi:[1,0,1]
    v_cvt_pk_bf16_f32 v48, v48, v84
    v_cvt_pk_bf16_f32 v49, v49, v85
    v_cvt_pk_bf16_f32 v50, v50, v86
    v_cvt_pk_bf16_f32 v51, v51, v87
    v_accvgpr_write_b32 a80, v48
    v_accvgpr_write_b32 a81, v49
    v_accvgpr_write_b32 a82, v50
    v_accvgpr_write_b32 a83, v51
    v_pk_fma_f32 v[52:53], v[52:53], v[2:3], v[2:3] op_sel:[0,0,1] op_sel_hi:[1,0,1]
    v_pk_fma_f32 v[88:89], v[88:89], v[2:3], v[2:3] op_sel:[0,0,1] op_sel_hi:[1,0,1]
    v_pk_fma_f32 v[54:55], v[54:55], v[2:3], v[2:3] op_sel:[0,0,1] op_sel_hi:[1,0,1]
    v_pk_fma_f32 v[90:91], v[90:91], v[2:3], v[2:3] op_sel:[0,0,1] op_sel_hi:[1,0,1]
    v_cvt_pk_bf16_f32 v52, v52, v88
    v_cvt_pk_bf16_f32 v53, v53, v89
    v_cvt_pk_bf16_f32 v54, v54, v90
    v_cvt_pk_bf16_f32 v55, v55, v91
    v_accvgpr_write_b32 a84, v52
    v_accvgpr_write_b32 a85, v53
    v_accvgpr_write_b32 a86, v54
    v_accvgpr_write_b32 a87, v55
    v_pk_fma_f32 v[56:57], v[56:57], v[2:3], v[2:3] op_sel:[0,0,1] op_sel_hi:[1,0,1]
    v_pk_fma_f32 v[92:93], v[92:93], v[2:3], v[2:3] op_sel:[0,0,1] op_sel_hi:[1,0,1]
    v_pk_fma_f32 v[58:59], v[58:59], v[2:3], v[2:3] op_sel:[0,0,1] op_sel_hi:[1,0,1]
    v_pk_fma_f32 v[94:95], v[94:95], v[2:3], v[2:3] op_sel:[0,0,1] op_sel_hi:[1,0,1]
    v_cvt_pk_bf16_f32 v56, v56, v92
    v_cvt_pk_bf16_f32 v57, v57, v93
    v_cvt_pk_bf16_f32 v58, v58, v94
    v_cvt_pk_bf16_f32 v59, v59, v95
    v_accvgpr_write_b32 a88, v56
    v_accvgpr_write_b32 a89, v57
    v_accvgpr_write_b32 a90, v58
    v_accvgpr_write_b32 a91, v59
    v_pk_fma_f32 v[60:61], v[60:61], v[2:3], v[2:3] op_sel:[0,0,1] op_sel_hi:[1,0,1]
    v_pk_fma_f32 v[96:97], v[96:97], v[2:3], v[2:3] op_sel:[0,0,1] op_sel_hi:[1,0,1]
    v_pk_fma_f32 v[62:63], v[62:63], v[2:3], v[2:3] op_sel:[0,0,1] op_sel_hi:[1,0,1]
    v_pk_fma_f32 v[98:99], v[98:99], v[2:3], v[2:3] op_sel:[0,0,1] op_sel_hi:[1,0,1]
    v_cvt_pk_bf16_f32 v60, v60, v96
    v_cvt_pk_bf16_f32 v61, v61, v97
    v_cvt_pk_bf16_f32 v62, v62, v98
    v_cvt_pk_bf16_f32 v63, v63, v99
    v_accvgpr_write_b32 a92, v60
    v_accvgpr_write_b32 a93, v61
    v_accvgpr_write_b32 a94, v62
    v_accvgpr_write_b32 a95, v63
    v_pk_fma_f32 v[64:65], v[64:65], v[2:3], v[2:3] op_sel:[0,0,1] op_sel_hi:[1,0,1]
    v_pk_fma_f32 v[100:101], v[100:101], v[2:3], v[2:3] op_sel:[0,0,1] op_sel_hi:[1,0,1]
    v_pk_fma_f32 v[66:67], v[66:67], v[2:3], v[2:3] op_sel:[0,0,1] op_sel_hi:[1,0,1]
    v_pk_fma_f32 v[102:103], v[102:103], v[2:3], v[2:3] op_sel:[0,0,1] op_sel_hi:[1,0,1]
    v_cvt_pk_bf16_f32 v64, v64, v100
    v_cvt_pk_bf16_f32 v65, v65, v101
    v_cvt_pk_bf16_f32 v66, v66, v102
    v_cvt_pk_bf16_f32 v67, v67, v103
    v_accvgpr_write_b32 a96, v64
    v_accvgpr_write_b32 a97, v65
    v_accvgpr_write_b32 a98, v66
    v_accvgpr_write_b32 a99, v67
    v_pk_fma_f32 v[68:69], v[68:69], v[2:3], v[2:3] op_sel:[0,0,1] op_sel_hi:[1,0,1]
    v_pk_fma_f32 v[104:105], v[104:105], v[2:3], v[2:3] op_sel:[0,0,1] op_sel_hi:[1,0,1]
    v_pk_fma_f32 v[70:71], v[70:71], v[2:3], v[2:3] op_sel:[0,0,1] op_sel_hi:[1,0,1]
    v_pk_fma_f32 v[106:107], v[106:107], v[2:3], v[2:3] op_sel:[0,0,1] op_sel_hi:[1,0,1]
    v_cvt_pk_bf16_f32 v68, v68, v104
    v_cvt_pk_bf16_f32 v69, v69, v105
    v_cvt_pk_bf16_f32 v70, v70, v106
    v_cvt_pk_bf16_f32 v71, v71, v107
    v_accvgpr_write_b32 a100, v68
    v_accvgpr_write_b32 a101, v69
    v_accvgpr_write_b32 a102, v70
    v_accvgpr_write_b32 a103, v71
    v_pk_fma_f32 v[72:73], v[72:73], v[2:3], v[2:3] op_sel:[0,0,1] op_sel_hi:[1,0,1]
    v_pk_fma_f32 v[108:109], v[108:109], v[2:3], v[2:3] op_sel:[0,0,1] op_sel_hi:[1,0,1]
    v_pk_fma_f32 v[74:75], v[74:75], v[2:3], v[2:3] op_sel:[0,0,1] op_sel_hi:[1,0,1]
    v_pk_fma_f32 v[110:111], v[110:111], v[2:3], v[2:3] op_sel:[0,0,1] op_sel_hi:[1,0,1]
    v_cvt_pk_bf16_f32 v72, v72, v108
    v_cvt_pk_bf16_f32 v73, v73, v109
    v_cvt_pk_bf16_f32 v74, v74, v110
    v_cvt_pk_bf16_f32 v75, v75, v111
    v_accvgpr_write_b32 a104, v72
    v_accvgpr_write_b32 a105, v73
    v_accvgpr_write_b32 a106, v74
    v_accvgpr_write_b32 a107, v75
    v_pk_fma_f32 v[112:113], v[112:113], v[2:3], v[2:3] op_sel:[0,0,1] op_sel_hi:[1,0,1]
    v_pk_fma_f32 v[148:149], v[148:149], v[2:3], v[2:3] op_sel:[0,0,1] op_sel_hi:[1,0,1]
    v_pk_fma_f32 v[114:115], v[114:115], v[2:3], v[2:3] op_sel:[0,0,1] op_sel_hi:[1,0,1]
    v_pk_fma_f32 v[150:151], v[150:151], v[2:3], v[2:3] op_sel:[0,0,1] op_sel_hi:[1,0,1]
    v_cvt_pk_bf16_f32 v112, v112, v148
    v_cvt_pk_bf16_f32 v113, v113, v149
    v_cvt_pk_bf16_f32 v114, v114, v150
    v_cvt_pk_bf16_f32 v115, v115, v151
    v_accvgpr_write_b32 a108, v112
    v_accvgpr_write_b32 a109, v113
    v_accvgpr_write_b32 a110, v114
    v_accvgpr_write_b32 a111, v115
    v_pk_fma_f32 v[116:117], v[116:117], v[2:3], v[2:3] op_sel:[0,0,1] op_sel_hi:[1,0,1]
    v_pk_fma_f32 v[152:153], v[152:153], v[2:3], v[2:3] op_sel:[0,0,1] op_sel_hi:[1,0,1]
    v_pk_fma_f32 v[118:119], v[118:119], v[2:3], v[2:3] op_sel:[0,0,1] op_sel_hi:[1,0,1]
    v_pk_fma_f32 v[154:155], v[154:155], v[2:3], v[2:3] op_sel:[0,0,1] op_sel_hi:[1,0,1]
    v_cvt_pk_bf16_f32 v116, v116, v152
    v_cvt_pk_bf16_f32 v117, v117, v153
    v_cvt_pk_bf16_f32 v118, v118, v154
    v_cvt_pk_bf16_f32 v119, v119, v155
    v_accvgpr_write_b32 a112, v116
    v_accvgpr_write_b32 a113, v117
    v_accvgpr_write_b32 a114, v118
    v_accvgpr_write_b32 a115, v119
    v_pk_fma_f32 v[120:121], v[120:121], v[2:3], v[2:3] op_sel:[0,0,1] op_sel_hi:[1,0,1]
    v_pk_fma_f32 v[156:157], v[156:157], v[2:3], v[2:3] op_sel:[0,0,1] op_sel_hi:[1,0,1]
    v_pk_fma_f32 v[122:123], v[122:123], v[2:3], v[2:3] op_sel:[0,0,1] op_sel_hi:[1,0,1]
    v_pk_fma_f32 v[158:159], v[158:159], v[2:3], v[2:3] op_sel:[0,0,1] op_sel_hi:[1,0,1]
    v_pk_fma_f32 v[124:125], v[124:125], v[2:3], v[2:3] op_sel:[0,0,1] op_sel_hi:[1,0,1]
    v_pk_fma_f32 v[160:161], v[160:161], v[2:3], v[2:3] op_sel:[0,0,1] op_sel_hi:[1,0,1]
    v_pk_fma_f32 v[126:127], v[126:127], v[2:3], v[2:3] op_sel:[0,0,1] op_sel_hi:[1,0,1]
    v_pk_fma_f32 v[162:163], v[162:163], v[2:3], v[2:3] op_sel:[0,0,1] op_sel_hi:[1,0,1]
    v_pk_fma_f32 v[128:129], v[128:129], v[2:3], v[2:3] op_sel:[0,0,1] op_sel_hi:[1,0,1]
    v_pk_fma_f32 v[164:165], v[164:165], v[2:3], v[2:3] op_sel:[0,0,1] op_sel_hi:[1,0,1]
    v_pk_fma_f32 v[130:131], v[130:131], v[2:3], v[2:3] op_sel:[0,0,1] op_sel_hi:[1,0,1]
    v_pk_fma_f32 v[166:167], v[166:167], v[2:3], v[2:3] op_sel:[0,0,1] op_sel_hi:[1,0,1]
    v_pk_fma_f32 v[132:133], v[132:133], v[2:3], v[2:3] op_sel:[0,0,1] op_sel_hi:[1,0,1]
    v_pk_fma_f32 v[168:169], v[168:169], v[2:3], v[2:3] op_sel:[0,0,1] op_sel_hi:[1,0,1]
    v_pk_fma_f32 v[134:135], v[134:135], v[2:3], v[2:3] op_sel:[0,0,1] op_sel_hi:[1,0,1]
    v_pk_fma_f32 v[170:171], v[170:171], v[2:3], v[2:3] op_sel:[0,0,1] op_sel_hi:[1,0,1]
    v_pk_fma_f32 v[136:137], v[136:137], v[2:3], v[2:3] op_sel:[0,0,1] op_sel_hi:[1,0,1]
    v_pk_fma_f32 v[172:173], v[172:173], v[2:3], v[2:3] op_sel:[0,0,1] op_sel_hi:[1,0,1]
    v_pk_fma_f32 v[138:139], v[138:139], v[2:3], v[2:3] op_sel:[0,0,1] op_sel_hi:[1,0,1]
    v_pk_fma_f32 v[174:175], v[174:175], v[2:3], v[2:3] op_sel:[0,0,1] op_sel_hi:[1,0,1]
    v_pk_fma_f32 v[140:141], v[140:141], v[2:3], v[2:3] op_sel:[0,0,1] op_sel_hi:[1,0,1]
    v_pk_fma_f32 v[176:177], v[176:177], v[2:3], v[2:3] op_sel:[0,0,1] op_sel_hi:[1,0,1]
    v_pk_fma_f32 v[142:143], v[142:143], v[2:3], v[2:3] op_sel:[0,0,1] op_sel_hi:[1,0,1]
    v_pk_fma_f32 v[178:179], v[178:179], v[2:3], v[2:3] op_sel:[0,0,1] op_sel_hi:[1,0,1]
    v_pk_fma_f32 v[144:145], v[144:145], v[2:3], v[2:3] op_sel:[0,0,1] op_sel_hi:[1,0,1]
    v_pk_fma_f32 v[180:181], v[180:181], v[2:3], v[2:3] op_sel:[0,0,1] op_sel_hi:[1,0,1]
    v_pk_fma_f32 v[146:147], v[146:147], v[2:3], v[2:3] op_sel:[0,0,1] op_sel_hi:[1,0,1]
    v_pk_fma_f32 v[182:183], v[182:183], v[2:3], v[2:3] op_sel:[0,0,1] op_sel_hi:[1,0,1]
    v_mov_b32 v3, 1073741824
    v_cmp_eq_u32 vcc, 0, v1
    v_mov_b32 v27, 1
    s_nop 0
    v_cndmask_b32 v7, v3, 0, vcc
    s_cmp_lg_u32 s79, 0
    s_cbranch_scc1 L_p1
    s_add_u32 s48, s12, 384
    s_addc_u32 s49, s13, 0
    s_add_u32 s50, s16, 256
    s_addc_u32 s51, s17, 0
    s_mov_b32 s87, 1
    s_mov_b32 s88, 0
    s_mov_b32 s97, 1073741824
    s_lshl_b32 s93, s77, 2
    s_add_u32 s93, s93, 128
    s_mov_b32 s68, s86
    s_mov_b32 s69, s58
    v_mov_b32 v28, v24
    s_waitcnt vmcnt(1)
    s_barrier
    s_add_u32 m0, s82, 36864
    ds_read_b64_tr_b16 a[144:145], v8 offset:0
    s_add_u32 s56, s56, s86
    ds_read_b64_tr_b16 a[146:147], v8 offset:2048
    s_addc_u32 s57, s57, 0
    ds_read_b64_tr_b16 a[148:149], v8 offset:4096
    buffer_load_dwordx4 v24, s[56:59], 0 offen lds
    ds_read_b64_tr_b16 a[150:151], v8 offset:6144
    s_add_u32 m0, s82, 40960
    ds_read_b64_tr_b16 a[152:153], v8 offset:8192
    s_add_u32 s56, s56, s86
    ds_read_b64_tr_b16 a[154:155], v8 offset:10240
    s_addc_u32 s57, s57, 0
    ds_read_b64_tr_b16 a[156:157], v8 offset:12288
    buffer_load_dwordx4 v24, s[56:59], 0 offen lds
    ds_read_b64_tr_b16 a[158:159], v8 offset:14336
    s_add_u32 m0, s82, 45056
    ds_read_b64_tr_b16 a[160:161], v8 offset:16384
    s_add_u32 s56, s56, s86
    ds_read_b64_tr_b16 a[162:163], v8 offset:18432
    s_addc_u32 s57, s57, 0
    ds_read_b64_tr_b16 a[164:165], v8 offset:20480
    buffer_load_dwordx4 v24, s[56:59], 0 offen lds
    ds_read_b64_tr_b16 a[166:167], v8 offset:22528
    s_add_u32 m0, s82, 49152
    ds_read_b64_tr_b16 a[168:169], v8 offset:24576
    s_add_u32 s56, s56, s86
    ds_read_b64_tr_b16 a[170:171], v8 offset:26624
    s_addc_u32 s57, s57, 0
    ds_read_b64_tr_b16 a[172:173], v8 offset:28672
    buffer_load_dwordx4 v24, s[56:59], 0 offen lds
    ds_read_b64_tr_b16 a[174:175], v8 offset:30720
    s_add_u32 m0, s82, 53248
    ds_read_b64_tr_b16 a[176:177], v8 offset:32768
    s_add_u32 s56, s56, s86
    ds_read_b64_tr_b16 a[178:179], v8 offset:34816
    s_addc_u32 s57, s57, 0
    ds_read_b64_tr_b16 a[180:181], v9 offset:0
    buffer_load_dwordx4 v24, s[56:59], 0 offen lds
    s_waitcnt lgkmcnt(5)
    ds_read_b64_tr_b16 a[182:183], v9 offset:2048
    v_mfma_f32_16x16x32_bf16 v[64:67], a[144:147], a[0:3], 0
    s_add_u32 m0, s82, 57344
    ds_read_b64_tr_b16 a[184:185], v9 offset:4096
    v_cvt_pk_bf16_f32 v120, v120, v156
    v_mfma_f32_16x16x32_bf16 v[64:67], a[148:151], a[4:7], v[64:67]
    s_add_u32 s56, s56, s86
    ds_read_b64_tr_b16 a[186:187], v9 offset:6144
    v_cvt_pk_bf16_f32 v121, v121, v157
    v_mfma_f32_16x16x32_bf16 v[64:67], a[152:155], a[8:11], v[64:67]
    s_addc_u32 s57, s57, 0
    ds_read_b64_tr_b16 a[188:189], v9 offset:8192
    buffer_load_dwordx4 v24, s[56:59], 0 offen lds
    v_mfma_f32_16x16x32_bf16 v[64:67], a[156:159], a[12:15], v[64:67]
    s_waitcnt lgkmcnt(5)
    ds_read_b64_tr_b16 a[190:191], v9 offset:10240
    v_cvt_pk_bf16_f32 v122, v122, v158
    v_mfma_f32_16x16x32_bf16 v[64:67], a[160:163], a[16:19], v[64:67]
    s_add_u32 m0, s82, 61440
    ds_read_b64_tr_b16 a[192:193], v9 offset:12288
    v_cvt_pk_bf16_f32 v123, v123, v159
    v_mfma_f32_16x16x32_bf16 v[64:67], a[164:167], a[20:23], v[64:67]
    s_add_u32 s56, s56, s86
    ds_read_b64_tr_b16 a[194:195], v9 offset:14336
    v_accvgpr_write_b32 a116, v120
    v_mfma_f32_16x16x32_bf16 v[64:67], a[168:171], a[24:27], v[64:67]
    s_addc_u32 s57, s57, 0
    ds_read_b64_tr_b16 a[196:197], v9 offset:16384
    buffer_load_dwordx4 v24, s[56:59], 0 offen lds
    v_mfma_f32_16x16x32_bf16 v[64:67], a[172:175], a[28:31], v[64:67]
    ds_read_b64_tr_b16 a[198:199], v9 offset:18432
    v_accvgpr_write_b32 a117, v121
    v_mfma_f32_16x16x32_bf16 v[64:67], a[176:179], a[32:35], v[64:67]
    s_add_u32 m0, s82, 65536
    ds_read_b64_tr_b16 a[200:201], v9 offset:20480
    v_accvgpr_write_b32 a118, v122
    v_mfma_f32_16x16x32_bf16 v[68:71], a[144:147], a[72:75], 0
    s_add_u32 s56, s56, s86
    ds_read_b64_tr_b16 a[202:203], v9 offset:22528
    v_accvgpr_write_b32 a119, v123
    v_mfma_f32_16x16x32_bf16 v[68:71], a[148:151], a[76:79], v[68:71]
    s_addc_u32 s57, s57, 0
    ds_read_b64_tr_b16 a[204:205], v9 offset:24576
    buffer_load_dwordx4 v24, s[56:59], 0 offen lds
    v_mfma_f32_16x16x32_bf16 v[68:71], a[152:155], a[80:83], v[68:71]
    ds_read_b64_tr_b16 a[206:207], v9 offset:26624
    v_cvt_pk_bf16_f32 v124, v124, v160
    v_mfma_f32_16x16x32_bf16 v[68:71], a[156:159], a[84:87], v[68:71]
    s_add_u32 m0, s82, 69632
    ds_read_b64_tr_b16 a[208:209], v9 offset:28672
    v_cvt_pk_bf16_f32 v125, v125, v161
    v_mfma_f32_16x16x32_bf16 v[68:71], a[160:163], a[88:91], v[68:71]
    s_add_u32 s56, s56, s86
    ds_read_b64_tr_b16 a[210:211], v9 offset:30720
    v_cvt_pk_bf16_f32 v126, v126, v162
    v_mfma_f32_16x16x32_bf16 v[68:71], a[164:167], a[92:95], v[68:71]
    s_addc_u32 s57, s57, 0
    ds_read_b64_tr_b16 a[212:213], v9 offset:32768
    buffer_load_dwordx4 v24, s[56:59], 0 offen lds
    v_mfma_f32_16x16x32_bf16 v[68:71], a[168:171], a[96:99], v[68:71]
    s_waitcnt lgkmcnt(5)
    ds_read_b64_tr_b16 a[214:215], v9 offset:34816
    v_cvt_pk_bf16_f32 v127, v127, v163
    v_mfma_f32_16x16x32_bf16 v[68:71], a[172:175], a[100:103], v[68:71]
    s_add_u32 m0, s82, 73728
    ds_read_b64_tr_b16 a[144:145], v10 offset:0
    v_accvgpr_write_b32 a120, v124
    v_mfma_f32_16x16x32_bf16 v[68:71], a[176:179], a[104:107], v[68:71]
    s_add_u32 s56, s16, s84
    ds_read_b64_tr_b16 a[146:147], v10 offset:2048
    v_accvgpr_write_b32 a121, v125
    v_mfma_f32_16x16x32_bf16 v[72:75], a[180:183], a[0:3], 0
    s_addc_u32 s57, s17, 0
    ds_read_b64_tr_b16 a[148:149], v10 offset:4096
    buffer_load_dwordx4 v24, s[56:59], 0 offen lds
    v_mfma_f32_16x16x32_bf16 v[72:75], a[184:187], a[4:7], v[72:75]
    ds_read_b64_tr_b16 a[150:151], v10 offset:6144
    v_accvgpr_write_b32 a122, v126
    v_mfma_f32_16x16x32_bf16 v[72:75], a[188:191], a[8:11], v[72:75]
    s_add_u32 m0, s82, 77824
    ds_read_b64_tr_b16 a[152:153], v10 offset:8192
    v_accvgpr_write_b32 a123, v127
    v_mfma_f32_16x16x32_bf16 v[72:75], a[192:195], a[12:15], v[72:75]
    s_add_u32 s56, s56, s86
    ds_read_b64_tr_b16 a[154:155], v10 offset:10240
    v_cvt_pk_bf16_f32 v128, v128, v164
    v_mfma_f32_16x16x32_bf16 v[72:75], a[196:199], a[16:19], v[72:75]
    s_addc_u32 s57, s57, 0
    ds_read_b64_tr_b16 a[156:157], v10 offset:12288
    buffer_load_dwordx4 v24, s[56:59], 0 offen lds
    v_mfma_f32_16x16x32_bf16 v[72:75], a[200:203], a[20:23], v[72:75]
    s_waitcnt lgkmcnt(5)
    ds_read_b64_tr_b16 a[158:159], v10 offset:14336
    v_cvt_pk_bf16_f32 v129, v129, v165
    v_mfma_f32_16x16x32_bf16 v[72:75], a[204:207], a[24:27], v[72:75]
    s_add_u32 m0, s82, 81920
    ds_read_b64_tr_b16 a[160:161], v10 offset:16384
    v_cvt_pk_bf16_f32 v130, v130, v166
    v_mfma_f32_16x16x32_bf16 v[72:75], a[208:211], a[28:31], v[72:75]
    s_add_u32 s56, s56, s86
    ds_read_b64_tr_b16 a[162:163], v10 offset:18432
    v_mfma_f32_16x16x32_bf16 v[72:75], a[212:215], a[32:35], v[72:75]
    s_addc_u32 s57, s57, 0
    ds_read_b64_tr_b16 a[164:165], v10 offset:20480
    buffer_load_dwordx4 v24, s[56:59], 0 offen lds
    v_mfma_f32_16x16x32_bf16 v[76:79], a[180:183], a[72:75], 0
    ds_read_b64_tr_b16 a[166:167], v10 offset:22528
    v_cvt_pk_bf16_f32 v131, v131, v167
    v_mfma_f32_16x16x32_bf16 v[76:79], a[184:187], a[76:79], v[76:79]
    s_add_u32 m0, s82, 86016
    ds_read_b64_tr_b16 a[168:169], v10 offset:24576
    v_accvgpr_write_b32 a124, v128
    v_mfma_f32_16x16x32_bf16 v[76:79], a[188:191], a[80:83], v[76:79]
    s_add_u32 s56, s56, s86
    ds_read_b64_tr_b16 a[170:171], v10 offset:26624
    v_accvgpr_write_b32 a125, v129
    v_mfma_f32_16x16x32_bf16 v[76:79], a[192:195], a[84:87], v[76:79]
    s_addc_u32 s57, s57, 0
    ds_read_b64_tr_b16 a[172:173], v10 offset:28672
    buffer_load_dwordx4 v24, s[56:59], 0 offen lds
    v_mfma_f32_16x16x32_bf16 v[76:79], a[196:199], a[88:91], v[76:79]
    ds_read_b64_tr_b16 a[174:175], v10 offset:30720
    v_accvgpr_write_b32 a126, v130
    v_mfma_f32_16x16x32_bf16 v[76:79], a[200:203], a[92:95], v[76:79]
    s_add_u32 m0, s82, 90112
    ds_read_b64_tr_b16 a[176:177], v10 offset:32768
    v_accvgpr_write_b32 a127, v131
    v_mfma_f32_16x16x32_bf16 v[76:79], a[204:207], a[96:99], v[76:79]
    s_add_u32 s56, s56, s86
    ds_read_b64_tr_b16 a[178:179], v10 offset:34816
    v_cvt_pk_bf16_f32 v132, v132, v168
    v_mfma_f32_16x16x32_bf16 v[76:79], a[208:211], a[100:103], v[76:79]
    s_addc_u32 s57, s57, 0
    ds_read_b64_tr_b16 a[180:181], v11 offset:0
    buffer_load_dwordx4 v24, s[56:59], 0 offen lds
    v_mfma_f32_16x16x32_bf16 v[76:79], a[212:215], a[104:107], v[76:79]
    s_waitcnt lgkmcnt(5)
    ds_read_b64_tr_b16 a[182:183], v11 offset:2048
    v_cvt_pk_bf16_f32 v133, v133, v169
    v_mfma_f32_16x16x32_bf16 v[80:83], a[144:147], a[0:3], 0
    s_add_u32 m0, s82, 94208
    ds_read_b64_tr_b16 a[184:185], v11 offset:4096
    v_cvt_pk_bf16_f32 v134, v134, v170
    v_mfma_f32_16x16x32_bf16 v[80:83], a[148:151], a[4:7], v[80:83]
L_w1:
    s_cbranch_execz L_w5
    s_add_u32 s56, s56, s86
    ds_read_b64_tr_b16 a[186:187], v11 offset:6144
    v_cvt_pk_bf16_f32 v135, v135, v171
    v_mfma_f32_16x16x32_bf16 v[80:83], a[152:155], a[8:11], v[80:83]
    s_addc_u32 s57, s57, 0
    ds_read_b64_tr_b16 a[188:189], v11 offset:8192
    buffer_load_dwordx4 v24, s[56:59], 0 offen lds
    v_mfma_f32_16x16x32_bf16 v[80:83], a[156:159], a[12:15], v[80:83]
    s_waitcnt lgkmcnt(5)
    ds_read_b64_tr_b16 a[190:191], v11 offset:10240
    v_accvgpr_write_b32 a128, v132
    v_mfma_f32_16x16x32_bf16 v[80:83], a[160:163], a[16:19], v[80:83]
    s_add_u32 m0, s82, 98304
    ds_read_b64_tr_b16 a[192:193], v11 offset:12288
    v_accvgpr_write_b32 a129, v133
    v_mfma_f32_16x16x32_bf16 v[80:83], a[164:167], a[20:23], v[80:83]
    s_add_u32 s56, s56, s86
    ds_read_b64_tr_b16 a[194:195], v11 offset:14336
    v_accvgpr_write_b32 a130, v134
    v_mfma_f32_16x16x32_bf16 v[80:83], a[168:171], a[24:27], v[80:83]
    s_addc_u32 s57, s57, 0
    ds_read_b64_tr_b16 a[196:197], v11 offset:16384
    buffer_load_dwordx4 v24, s[56:59], 0 offen lds
    v_mfma_f32_16x16x32_bf16 v[80:83], a[172:175], a[28:31], v[80:83]
    ds_read_b64_tr_b16 a[198:199], v11 offset:18432
    v_accvgpr_write_b32 a131, v135
    v_mfma_f32_16x16x32_bf16 v[80:83], a[176:179], a[32:35], v[80:83]
    s_add_u32 m0, s82, 102400
    ds_read_b64_tr_b16 a[200:201], v11 offset:20480
    v_cvt_pk_bf16_f32 v136, v136, v172
    v_mfma_f32_16x16x32_bf16 v[84:87], a[144:147], a[72:75], 0
    s_add_u32 s56, s56, s86
    ds_read_b64_tr_b16 a[202:203], v11 offset:22528
    v_mfma_f32_16x16x32_bf16 v[84:87], a[148:151], a[76:79], v[84:87]
    s_addc_u32 s57, s57, 0
    ds_read_b64_tr_b16 a[204:205], v11 offset:24576
    buffer_load_dwordx4 v24, s[56:59], 0 offen lds
    v_mfma_f32_16x16x32_bf16 v[84:87], a[152:155], a[80:83], v[84:87]
    ds_read_b64_tr_b16 a[206:207], v11 offset:26624
    v_cvt_pk_bf16_f32 v137, v137, v173
    v_mfma_f32_16x16x32_bf16 v[84:87], a[156:159], a[84:87], v[84:87]
    s_add_u32 m0, s82, 106496
    ds_read_b64_tr_b16 a[208:209], v11 offset:28672
    v_cvt_pk_bf16_f32 v138, v138, v174
    v_mfma_f32_16x16x32_bf16 v[84:87], a[160:163], a[88:91], v[84:87]
    s_add_u32 s56, s56, s86
    ds_read_b64_tr_b16 a[210:211], v11 offset:30720
    v_cvt_pk_bf16_f32 v139, v139, v175
    v_mfma_f32_16x16x32_bf16 v[84:87], a[164:167], a[92:95], v[84:87]
    s_addc_u32 s57, s57, 0
    ds_read_b64_tr_b16 a[212:213], v11 offset:32768
    buffer_load_dwordx4 v24, s[56:59], 0 offen lds
    v_mfma_f32_16x16x32_bf16 v[84:87], a[168:171], a[96:99], v[84:87]
    ds_read_b64_tr_b16 a[214:215], v11 offset:34816
    v_accvgpr_write_b32 a132, v136
    v_mfma_f32_16x16x32_bf16 v[84:87], a[172:175], a[100:103], v[84:87]
    s_waitcnt vmcnt(9) lgkmcnt(6)
    s_barrier
    ds_read_b64_tr_b16 a[144:145], v8 offset:36864
    v_mfma_f32_16x16x32_bf16 v[84:87], a[176:179], a[104:107], v[84:87]
    ds_read_b64_tr_b16 a[146:147], v8 offset:38912
    v_accvgpr_write_b32 a133, v137
    v_mfma_f32_16x16x32_bf16 v[88:91], a[180:183], a[0:3], 0
    ds_read_b64_tr_b16 a[148:149], v8 offset:40960
    v_accvgpr_write_b32 a134, v138
    v_mfma_f32_16x16x32_bf16 v[88:91], a[184:187], a[4:7], v[88:91]
    s_add_u32 m0, s82, 110592
    ds_read_b64_tr_b16 a[150:151], v8 offset:43008
    v_accvgpr_write_b32 a135, v139
    v_mfma_f32_16x16x32_bf16 v[88:91], a[188:191], a[8:11], v[88:91]
    s_add_u32 s56, s56, s86
    ds_read_b64_tr_b16 a[152:153], v8 offset:45056
    v_cvt_pk_bf16_f32 v140, v140, v176
    v_mfma_f32_16x16x32_bf16 v[88:91], a[192:195], a[12:15], v[88:91]
    s_addc_u32 s57, s57, 0
    ds_read_b64_tr_b16 a[154:155], v8 offset:47104
    buffer_load_dwordx4 v24, s[56:59], 0 offen lds
    v_mfma_f32_16x16x32_bf16 v[88:91], a[196:199], a[16:19], v[88:91]
    ds_read_b64_tr_b16 a[156:157], v8 offset:49152
    v_cvt_pk_bf16_f32 v141, v141, v177
    v_mfma_f32_16x16x32_bf16 v[88:91], a[200:203], a[20:23], v[88:91]
    s_waitcnt lgkmcnt(5)
    ds_read_b64_tr_b16 a[158:159], v8 offset:51200
    v_cvt_pk_bf16_f32 v142, v142, v178
    v_mfma_f32_16x16x32_bf16 v[88:91], a[204:207], a[24:27], v[88:91]
    s_add_u32 m0, s82, 114688
    ds_read_b64_tr_b16 a[160:161], v8 offset:53248
    v_cvt_pk_bf16_f32 v143, v143, v179
    v_mfma_f32_16x16x32_bf16 v[88:91], a[208:211], a[28:31], v[88:91]
    s_add_u32 s56, s56, s86
    ds_read_b64_tr_b16 a[162:163], v8 offset:55296
    v_accvgpr_write_b32 a136, v140
    v_mfma_f32_16x16x32_bf16 v[88:91], a[212:215], a[32:35], v[88:91]
    s_addc_u32 s57, s57, 0
    ds_read_b64_tr_b16 a[164:165], v8 offset:57344
    buffer_load_dwordx4 v24, s[56:59], 0 offen lds
    v_mfma_f32_16x16x32_bf16 v[92:95], a[180:183], a[72:75], 0
    ds_read_b64_tr_b16 a[166:167], v8 offset:59392
    v_accvgpr_write_b32 a137, v141
    v_mfma_f32_16x16x32_bf16 v[92:95], a[184:187], a[76:79], v[92:95]
    ds_read_b64_tr_b16 a[168:169], v8 offset:61440
    v_accvgpr_write_b32 a138, v142
    v_mfma_f32_16x16x32_bf16 v[92:95], a[188:191], a[80:83], v[92:95]
    s_add_u32 m0, s82, 118784
    ds_read_b64_tr_b16 a[170:171], v8 offset:63488
    v_mfma_f32_16x16x32_bf16 v[92:95], a[192:195], a[84:87], v[92:95]
    s_add_u32 s56, s56, s86
    ds_read_b64_tr_b16 a[172:173], v12 offset:0
    v_accvgpr_write_b32 a139, v143
    v_mfma_f32_16x16x32_bf16 v[92:95], a[196:199], a[88:91], v[92:95]
    s_addc_u32 s57, s57, 0
    ds_read_b64_tr_b16 a[174:175], v12 offset:2048
    buffer_load_dwordx4 v24, s[56:59], 0 offen lds
    v_mfma_f32_16x16x32_bf16 v[92:95], a[200:203], a[92:95], v[92:95]
    ds_read_b64_tr_b16 a[176:177], v12 offset:4096
    v_cvt_pk_bf16_f32 v144, v144, v180
    v_mfma_f32_16x16x32_bf16 v[92:95], a[204:207], a[96:99], v[92:95]
    s_waitcnt lgkmcnt(5)
    ds_read_b64_tr_b16 a[178:179], v12 offset:6144
    v_cvt_pk_bf16_f32 v145, v145, v181
    v_mfma_f32_16x16x32_bf16 v[92:95], a[208:211], a[100:103], v[92:95]
    s_add_u32 m0, s82, 122880
    ds_read_b64_tr_b16 a[180:181], v9 offset:36864
    v_cvt_pk_bf16_f32 v146, v146, v182
    v_mfma_f32_16x16x32_bf16 v[92:95], a[212:215], a[104:107], v[92:95]
    s_add_u32 s56, s56, s86
    ds_read_b64_tr_b16 a[182:183], v9 offset:38912
    v_cvt_pk_bf16_f32 v147, v147, v183
    v_mfma_f32_16x16x32_bf16 v[64:67], a[144:147], a[36:39], v[64:67]
    s_addc_u32 s57, s57, 0
    ds_read_b64_tr_b16 a[184:185], v9 offset:40960
    buffer_load_dwordx4 v24, s[56:59], 0 offen lds
    v_mfma_f32_16x16x32_bf16 v[64:67], a[148:151], a[40:43], v[64:67]
    ds_read_b64_tr_b16 a[186:187], v9 offset:43008
    v_accvgpr_write_b32 a140, v144
    v_mfma_f32_16x16x32_bf16 v[64:67], a[152:155], a[44:47], v[64:67]
    s_waitcnt lgkmcnt(5)
    ds_read_b64_tr_b16 a[188:189], v9 offset:45056
    v_accvgpr_write_b32 a141, v145
    v_mfma_f32_16x16x32_bf16 v[64:67], a[156:159], a[48:51], v[64:67]
    s_add_u32 m0, s82, 126976
    ds_read_b64_tr_b16 a[190:191], v9 offset:47104
    v_mfma_f32_16x16x32_bf16 v[64:67], a[160:163], a[52:55], v[64:67]
    s_add_u32 s56, s56, s86
    ds_read_b64_tr_b16 a[192:193], v9 offset:49152
    v_accvgpr_write_b32 a142, v146
    v_mfma_f32_16x16x32_bf16 v[64:67], a[164:167], a[56:59], v[64:67]
    s_addc_u32 s57, s57, 0
    ds_read_b64_tr_b16 a[194:195], v9 offset:51200
    buffer_load_dwordx4 v24, s[56:59], 0 offen lds
    v_mfma_f32_16x16x32_bf16 v[64:67], a[168:171], a[60:63], v[64:67]
    ds_read_b64_tr_b16 a[196:197], v9 offset:53248
    v_accvgpr_write_b32 a143, v147
    v_mfma_f32_16x16x32_bf16 v[64:67], a[172:175], a[64:67], v[64:67]
    s_waitcnt lgkmcnt(5)
    ds_read_b64_tr_b16 a[198:199], v9 offset:55296
    v_mfma_f32_16x16x32_bf16 v[64:67], a[176:179], a[68:71], v[64:67]
    s_add_u32 m0, s82, 131072
    ds_read_b64_tr_b16 a[200:201], v9 offset:57344
    v_mfma_f32_16x16x32_bf16 v[68:71], a[144:147], a[108:111], v[68:71]
    s_add_u32 s56, s56, s86
    ds_read_b64_tr_b16 a[202:203], v9 offset:59392
    v_mfma_f32_16x16x32_bf16 v[68:71], a[148:151], a[112:115], v[68:71]
    s_addc_u32 s57, s57, 0
    ds_read_b64_tr_b16 a[204:205], v9 offset:61440
    buffer_load_dwordx4 v24, s[56:59], 0 offen lds
    v_mfma_f32_16x16x32_bf16 v[68:71], a[152:155], a[116:119], v[68:71]
    ds_read_b64_tr_b16 a[206:207], v9 offset:63488
    v_mfma_f32_16x16x32_bf16 v[68:71], a[156:159], a[120:123], v[68:71]
    ds_read_b64_tr_b16 a[208:209], v13 offset:0
    v_mfma_f32_16x16x32_bf16 v[68:71], a[160:163], a[124:127], v[68:71]
    s_add_u32 m0, s82, 135168
    ds_read_b64_tr_b16 a[210:211], v13 offset:2048
    v_fma_f32 v32, -v64, v64, s89
    v_mfma_f32_16x16x32_bf16 v[68:71], a[164:167], a[128:131], v[68:71]
    s_add_u32 s56, s56, s86
    ds_read_b64_tr_b16 a[212:213], v13 offset:4096
    v_fma_f32 v33, -v65, v65, s89
    v_mfma_f32_16x16x32_bf16 v[68:71], a[168:171], a[132:135], v[68:71]
    s_addc_u32 s57, s57, 0
    ds_read_b64_tr_b16 a[214:215], v13 offset:6144
    buffer_load_dwordx4 v24, s[56:59], 0 offen lds
    v_mfma_f32_16x16x32_bf16 v[68:71], a[172:175], a[136:139], v[68:71]
    ds_read_b64_tr_b16 a[144:145], v10 offset:36864
    v_fma_f32 v34, -v66, v66, s89
    v_mfma_f32_16x16x32_bf16 v[68:71], a[176:179], a[140:143], v[68:71]
    s_waitcnt lgkmcnt(5)
    ds_read_b64_tr_b16 a[146:147], v10 offset:38912
    v_fma_f32 v35, -v67, v67, s89
    v_mfma_f32_16x16x32_bf16 v[72:75], a[180:183], a[36:39], v[72:75]
    s_add_u32 m0, s82, 139264
    ds_read_b64_tr_b16 a[148:149], v10 offset:40960
    v_mul_f32 v32, v32, v64
    v_mfma_f32_16x16x32_bf16 v[72:75], a[184:187], a[40:43], v[72:75]
    s_add_u32 s56, s56, s86
    ds_read_b64_tr_b16 a[150:151], v10 offset:43008
    v_mul_f32 v33, v33, v65
    v_mfma_f32_16x16x32_bf16 v[72:75], a[188:191], a[44:47], v[72:75]
    s_addc_u32 s57, s57, 0
    ds_read_b64_tr_b16 a[152:153], v10 offset:45056
    buffer_load_dwordx4 v24, s[56:59], 0 offen lds
    v_mfma_f32_16x16x32_bf16 v[72:75], a[192:195], a[48:51], v[72:75]
    ds_read_b64_tr_b16 a[154:155], v10 offset:47104
    v_mul_f32 v34, v34, v66
    v_mfma_f32_16x16x32_bf16 v[72:75], a[196:199], a[52:55], v[72:75]
    s_waitcnt lgkmcnt(5)
    ds_read_b64_tr_b16 a[156:157], v10 offset:49152
    v_mul_f32 v35, v35, v67
    v_mfma_f32_16x16x32_bf16 v[72:75], a[200:203], a[56:59], v[72:75]
    s_add_u32 m0, s82, 143360
    ds_read_b64_tr_b16 a[158:159], v10 offset:51200
    v_exp_f32 v32, v32
    v_mfma_f32_16x16x32_bf16 v[72:75], a[204:207], a[60:63], v[72:75]
    s_add_u32 s56, s56, s86
    ds_read_b64_tr_b16 a[160:161], v10 offset:53248
    v_exp_f32 v33, v33
    v_mfma_f32_16x16x32_bf16 v[72:75], a[208:211], a[64:67], v[72:75]
    s_addc_u32 s57, s57, 0
    ds_read_b64_tr_b16 a[162:163], v10 offset:55296
    buffer_load_dwordx4 v24, s[56:59], 0 offen lds
    v_mfma_f32_16x16x32_bf16 v[72:75], a[212:215], a[68:71], v[72:75]
    ds_read_b64_tr_b16 a[164:165], v10 offset:57344
    v_exp_f32 v34, v34
    v_mfma_f32_16x16x32_bf16 v[76:79], a[180:183], a[108:111], v[76:79]
    ds_read_b64_tr_b16 a[166:167], v10 offset:59392
    v_exp_f32 v35, v35
    v_mfma_f32_16x16x32_bf16 v[76:79], a[184:187], a[112:115], v[76:79]
    ds_read_b64_tr_b16 a[168:169], v10 offset:61440
    v_add_f32 v32, 1.0, v32
    v_mfma_f32_16x16x32_bf16 v[76:79], a[188:191], a[116:119], v[76:79]
    s_add_u32 m0, s82, 0
    ds_read_b64_tr_b16 a[170:171], v10 offset:63488
    v_add_f32 v33, 1.0, v33
    v_mfma_f32_16x16x32_bf16 v[76:79], a[192:195], a[120:123], v[76:79]
    s_add_u32 s56, s12, 256
    ds_read_b64_tr_b16 a[172:173], v14 offset:0
    v_add_f32 v34, 1.0, v34
    v_mfma_f32_16x16x32_bf16 v[76:79], a[196:199], a[124:127], v[76:79]
    s_addc_u32 s57, s13, 0
    ds_read_b64_tr_b16 a[174:175], v14 offset:2048
    buffer_load_dwordx4 v24, s[56:59], 0 offen lds
    v_mfma_f32_16x16x32_bf16 v[76:79], a[200:203], a[128:131], v[76:79]
    ds_read_b64_tr_b16 a[176:177], v14 offset:4096
    v_add_f32 v35, 1.0, v35
    v_mfma_f32_16x16x32_bf16 v[76:79], a[204:207], a[132:135], v[76:79]
    s_waitcnt lgkmcnt(5)
    ds_read_b64_tr_b16 a[178:179], v14 offset:6144
    v_rcp_f32 v32, v32
    v_mfma_f32_16x16x32_bf16 v[76:79], a[208:211], a[136:139], v[76:79]
    s_add_u32 m0, s82, 4096
    ds_read_b64_tr_b16 a[180:181], v11 offset:36864
    v_rcp_f32 v33, v33
    v_mfma_f32_16x16x32_bf16 v[76:79], a[212:215], a[140:143], v[76:79]
    s_add_u32 s56, s56, s86
    ds_read_b64_tr_b16 a[182:183], v11 offset:38912
    v_rcp_f32 v34, v34
    v_mfma_f32_16x16x32_bf16 v[80:83], a[144:147], a[36:39], v[80:83]
    s_addc_u32 s57, s57, 0
    ds_read_b64_tr_b16 a[184:185], v11 offset:40960
    buffer_load_dwordx4 v24, s[56:59], 0 offen lds
    v_mfma_f32_16x16x32_bf16 v[80:83], a[148:151], a[40:43], v[80:83]
    ds_read_b64_tr_b16 a[186:187], v11 offset:43008
    v_rcp_f32 v35, v35
    v_mfma_f32_16x16x32_bf16 v[80:83], a[152:155], a[44:47], v[80:83]
    s_waitcnt lgkmcnt(5)
    ds_read_b64_tr_b16 a[188:189], v11 offset:45056
    v_mul_f32 v32, v32, v64
    v_mfma_f32_16x16x32_bf16 v[80:83], a[156:159], a[48:51], v[80:83]
    s_add_u32 m0, s82, 8192
    ds_read_b64_tr_b16 a[190:191], v11 offset:47104
    v_mul_f32 v33, v33, v65
    v_mfma_f32_16x16x32_bf16 v[80:83], a[160:163], a[52:55], v[80:83]
    s_add_u32 s56, s56, s86
    ds_read_b64_tr_b16 a[192:193], v11 offset:49152
    v_mul_f32 v34, v34, v66
    v_mfma_f32_16x16x32_bf16 v[80:83], a[164:167], a[56:59], v[80:83]
    s_addc_u32 s57, s57, 0
    ds_read_b64_tr_b16 a[194:195], v11 offset:51200
    buffer_load_dwordx4 v24, s[56:59], 0 offen lds
    v_mfma_f32_16x16x32_bf16 v[80:83], a[168:171], a[60:63], v[80:83]
    ds_read_b64_tr_b16 a[196:197], v11 offset:53248
    v_mul_f32 v35, v35, v67
    v_mfma_f32_16x16x32_bf16 v[80:83], a[172:175], a[64:67], v[80:83]
    s_waitcnt lgkmcnt(5)
    ds_read_b64_tr_b16 a[198:199], v11 offset:55296
    v_fma_f32 v36, -v68, v68, s89
    v_mfma_f32_16x16x32_bf16 v[80:83], a[176:179], a[68:71], v[80:83]
    s_add_u32 m0, s82, 12288
    ds_read_b64_tr_b16 a[200:201], v11 offset:57344
    v_fma_f32 v37, -v69, v69, s89
    v_mfma_f32_16x16x32_bf16 v[84:87], a[144:147], a[108:111], v[84:87]
    s_add_u32 s56, s56, s86
    ds_read_b64_tr_b16 a[202:203], v11 offset:59392
    v_fma_f32 v38, -v70, v70, s89
    v_mfma_f32_16x16x32_bf16 v[84:87], a[148:151], a[112:115], v[84:87]
    s_addc_u32 s57, s57, 0
    ds_read_b64_tr_b16 a[204:205], v11 offset:61440
    buffer_load_dwordx4 v24, s[56:59], 0 offen lds
    v_mfma_f32_16x16x32_bf16 v[84:87], a[152:155], a[116:119], v[84:87]
    ds_read_b64_tr_b16 a[206:207], v11 offset:63488
    v_fma_f32 v39, -v71, v71, s89
    v_mfma_f32_16x16x32_bf16 v[84:87], a[156:159], a[120:123], v[84:87]
    ds_read_b64_tr_b16 a[208:209], v15 offset:0
    v_mul_f32 v36, v36, v68
    v_mfma_f32_16x16x32_bf16 v[84:87], a[160:163], a[124:127], v[84:87]
    s_add_u32 m0, s82, 16384
    ds_read_b64_tr_b16 a[210:211], v15 offset:2048
    v_mul_f32 v37, v37, v69
    v_mfma_f32_16x16x32_bf16 v[84:87], a[164:167], a[128:131], v[84:87]
    s_add_u32 s56, s56, s86
    ds_read_b64_tr_b16 a[212:213], v15 offset:4096
    v_mul_f32 v38, v38, v70
    v_mfma_f32_16x16x32_bf16 v[84:87], a[168:171], a[132:135], v[84:87]
    s_addc_u32 s57, s57, 0
    ds_read_b64_tr_b16 a[214:215], v15 offset:6144
    buffer_load_dwordx4 v24, s[56:59], 0 offen lds
    v_mfma_f32_16x16x32_bf16 v[84:87], a[172:175], a[136:139], v[84:87]
    s_waitcnt vmcnt(14) lgkmcnt(6)
    s_barrier
    ds_read_b64_tr_b16 a[144:145], v12 offset:8192
    v_mfma_f32_16x16x32_bf16 v[84:87], a[176:179], a[140:143], v[84:87]
    ds_read_b64_tr_b16 a[146:147], v12 offset:10240
    v_mul_f32 v39, v39, v71
    v_mfma_f32_16x16x32_bf16 v[88:91], a[180:183], a[36:39], v[88:91]
    s_add_u32 m0, s82, 20480
    ds_read_b64_tr_b16 a[148:149], v12 offset:12288
    v_exp_f32 v36, v36
    v_mfma_f32_16x16x32_bf16 v[88:91], a[184:187], a[40:43], v[88:91]
    s_add_u32 s56, s56, s86
    ds_read_b64_tr_b16 a[150:151], v12 offset:14336
    v_exp_f32 v37, v37
    v_mfma_f32_16x16x32_bf16 v[88:91], a[188:191], a[44:47], v[88:91]
    s_addc_u32 s57, s57, 0
    ds_read_b64_tr_b16 a[152:153], v12 offset:16384
    buffer_load_dwordx4 v24, s[56:59], 0 offen lds
    v_mfma_f32_16x16x32_bf16 v[88:91], a[192:195], a[48:51], v[88:91]
    ds_read_b64_tr_b16 a[154:155], v12 offset:18432
    v_exp_f32 v38, v38
    v_mfma_f32_16x16x32_bf16 v[88:91], a[196:199], a[52:55], v[88:91]
    s_waitcnt lgkmcnt(5)
    ds_read_b64_tr_b16 a[156:157], v12 offset:20480
    v_exp_f32 v39, v39
    v_mfma_f32_16x16x32_bf16 v[88:91], a[200:203], a[56:59], v[88:91]
    s_add_u32 m0, s82, 24576
    ds_read_b64_tr_b16 a[158:159], v12 offset:22528
    v_add_f32 v36, 1.0, v36
    v_mfma_f32_16x16x32_bf16 v[88:91], a[204:207], a[60:63], v[88:91]
    s_add_u32 s56, s56, s86
    ds_read_b64_tr_b16 a[160:161], v12 offset:24576
    v_add_f32 v37, 1.0, v37
    v_mfma_f32_16x16x32_bf16 v[88:91], a[208:211], a[64:67], v[88:91]
    s_addc_u32 s57, s57, 0
    ds_read_b64_tr_b16 a[162:163], v12 offset:26624
    buffer_load_dwordx4 v24, s[56:59], 0 offen lds
    v_add_f32 v38, 1.0, v38
    v_mfma_f32_16x16x32_bf16 v[88:91], a[212:215], a[68:71], v[88:91]
    ds_read_b64_tr_b16 a[164:165], v12 offset:28672
    v_add_f32 v39, 1.0, v39
    v_mfma_f32_16x16x32_bf16 v[92:95], a[180:183], a[108:111], v[92:95]
    ds_read_b64_tr_b16 a[166:167], v12 offset:30720
    v_rcp_f32 v36, v36
    v_mfma_f32_16x16x32_bf16 v[92:95], a[184:187], a[112:115], v[92:95]
    s_add_u32 m0, s82, 28672
    ds_read_b64_tr_b16 a[168:169], v12 offset:32768
    v_rcp_f32 v37, v37
    v_mfma_f32_16x16x32_bf16 v[92:95], a[188:191], a[116:119], v[92:95]
    s_add_u32 s56, s56, s86
    ds_read_b64_tr_b16 a[170:171], v12 offset:34816
    v_rcp_f32 v38, v38
    v_mfma_f32_16x16x32_bf16 v[92:95], a[192:195], a[120:123], v[92:95]
    s_addc_u32 s57, s57, 0
    ds_read_b64_tr_b16 a[172:173], v12 offset:36864
    buffer_load_dwordx4 v24, s[56:59], 0 offen lds
    v_mfma_f32_16x16x32_bf16 v[92:95], a[196:199], a[124:127], v[92:95]
    ds_read_b64_tr_b16 a[174:175], v12 offset:38912
    v_rcp_f32 v39, v39
    v_mfma_f32_16x16x32_bf16 v[92:95], a[200:203], a[128:131], v[92:95]
    s_waitcnt lgkmcnt(5)
    ds_read_b64_tr_b16 a[176:177], v12 offset:40960
    v_mul_f32 v36, v36, v68
    v_mfma_f32_16x16x32_bf16 v[92:95], a[204:207], a[132:135], v[92:95]
    s_add_u32 m0, s82, 32768
    ds_read_b64_tr_b16 a[178:179], v12 offset:43008
    v_mfma_f32_16x16x32_bf16 v[92:95], a[208:211], a[136:139], v[92:95]
    s_add_u32 s56, s56, s86
    ds_read_b64_tr_b16 a[180:181], v13 offset:8192
    v_mfma_f32_16x16x32_bf16 v[92:95], a[212:215], a[140:143], v[92:95]
    s_addc_u32 s57, s57, 0
    ds_read_b64_tr_b16 a[182:183], v13 offset:10240
    buffer_load_dwordx4 v24, s[56:59], 0 offen lds
    s_waitcnt lgkmcnt(15)
.p2align 3
L_amid:
    v_mfma_f32_16x16x32_bf16 v[96:99], a[144:147], a[0:3], 0
    s_waitcnt lgkmcnt(5)
    ds_read_b64_tr_b16 a[184:185], v13 offset:12288
    v_mul_f32 v37, v37, v69
    v_mfma_f32_16x16x32_bf16 v[96:99], a[148:151], a[4:7], v[96:99]
    ds_read_b64_tr_b16 a[186:187], v13 offset:14336
    v_mul_f32 v38, v38, v70
    v_mfma_f32_16x16x32_bf16 v[96:99], a[152:155], a[8:11], v[96:99]
    ds_read_b64_tr_b16 a[188:189], v13 offset:16384
    v_mul_f32 v39, v39, v71
    v_mfma_f32_16x16x32_bf16 v[96:99], a[156:159], a[12:15], v[96:99]
    ds_read_b64_tr_b16 a[190:191], v13 offset:18432
    v_fma_f32 v40, -v72, v72, s89
    v_mfma_f32_16x16x32_bf16 v[96:99], a[160:163], a[16:19], v[96:99]
    s_waitcnt lgkmcnt(5)
    ds_read_b64_tr_b16 a[192:193], v13 offset:20480
    v_fma_f32 v41, -v73, v73, s89
    v_mfma_f32_16x16x32_bf16 v[96:99], a[164:167], a[20:23], v[96:99]
    s_add_u32 m0, s82, 36864
    ds_read_b64_tr_b16 a[194:195], v13 offset:22528
    v_fma_f32 v42, -v74, v74, s89
    v_mfma_f32_16x16x32_bf16 v[96:99], a[168:171], a[24:27], v[96:99]
    s_add_u32 s56, s56, s86
    ds_read_b64_tr_b16 a[196:197], v13 offset:24576
    v_fma_f32 v43, -v75, v75, s89
    v_mfma_f32_16x16x32_bf16 v[96:99], a[172:175], a[28:31], v[96:99]
    s_addc_u32 s57, s57, 0
    ds_read_b64_tr_b16 a[198:199], v13 offset:26624
    buffer_load_dwordx4 v24, s[56:59], 0 offen lds
    v_mfma_f32_16x16x32_bf16 v[96:99], a[176:179], a[32:35], v[96:99]
    ds_read_b64_tr_b16 a[200:201], v13 offset:28672
    v_mul_f32 v40, v40, v72
    v_mfma_f32_16x16x32_bf16 v[100:103], a[144:147], a[72:75], 0
    ds_read_b64_tr_b16 a[202:203], v13 offset:30720
    v_mul_f32 v41, v41, v73
    v_mfma_f32_16x16x32_bf16 v[100:103], a[148:151], a[76:79], v[100:103]
    ds_read_b64_tr_b16 a[204:205], v13 offset:32768
    v_mul_f32 v42, v42, v74
    v_mfma_f32_16x16x32_bf16 v[100:103], a[152:155], a[80:83], v[100:103]
    ds_read_b64_tr_b16 a[206:207], v13 offset:34816
    v_mul_f32 v43, v43, v75
    v_mfma_f32_16x16x32_bf16 v[100:103], a[156:159], a[84:87], v[100:103]
    v_exp_f32 v40, v40
    v_mfma_f32_16x16x32_bf16 v[100:103], a[160:163], a[88:91], v[100:103]
    s_add_u32 m0, s82, 40960
    ds_read_b64_tr_b16 a[208:209], v13 offset:36864
    ds_read_b64_tr_b16 a[210:211], v13 offset:38912
    v_mfma_f32_16x16x32_bf16 v[100:103], a[164:167], a[92:95], v[100:103]
    s_add_u32 s56, s56, s86
    ds_read_b64_tr_b16 a[212:213], v13 offset:40960
    v_exp_f32 v41, v41
    v_mfma_f32_16x16x32_bf16 v[100:103], a[168:171], a[96:99], v[100:103]
    s_addc_u32 s57, s57, 0
    ds_read_b64_tr_b16 a[214:215], v13 offset:43008
    buffer_load_dwordx4 v24, s[56:59], 0 offen lds
    v_mfma_f32_16x16x32_bf16 v[100:103], a[172:175], a[100:103], v[100:103]
    ds_read_b64_tr_b16 a[144:145], v14 offset:8192
    v_exp_f32 v42, v42
    v_mfma_f32_16x16x32_bf16 v[100:103], a[176:179], a[104:107], v[100:103]
    s_waitcnt lgkmcnt(5)
    ds_read_b64_tr_b16 a[146:147], v14 offset:10240
    v_exp_f32 v43, v43
    v_mfma_f32_16x16x32_bf16 v[104:107], a[180:183], a[0:3], 0
    ds_read_b64_tr_b16 a[148:149], v14 offset:12288
    v_add_f32 v40, 1.0, v40
    v_mfma_f32_16x16x32_bf16 v[104:107], a[184:187], a[4:7], v[104:107]
    ds_read_b64_tr_b16 a[150:151], v14 offset:14336
    v_add_f32 v41, 1.0, v41
    v_mfma_f32_16x16x32_bf16 v[104:107], a[188:191], a[8:11], v[104:107]
    ds_read_b64_tr_b16 a[152:153], v14 offset:16384
    v_add_f32 v42, 1.0, v42
    v_mfma_f32_16x16x32_bf16 v[104:107], a[192:195], a[12:15], v[104:107]
    s_add_u32 m0, s82, 45056
    ds_read_b64_tr_b16 a[154:155], v14 offset:18432
    v_add_f32 v43, 1.0, v43
    v_mfma_f32_16x16x32_bf16 v[104:107], a[196:199], a[16:19], v[104:107]
    s_add_u32 s56, s56, s86
    ds_read_b64_tr_b16 a[156:157], v14 offset:20480
    v_rcp_f32 v40, v40
    v_mfma_f32_16x16x32_bf16 v[104:107], a[200:203], a[20:23], v[104:107]
    s_addc_u32 s57, s57, 0
    ds_read_b64_tr_b16 a[158:159], v14 offset:22528
    buffer_load_dwordx4 v24, s[56:59], 0 offen lds
    v_mfma_f32_16x16x32_bf16 v[104:107], a[204:207], a[24:27], v[104:107]
    s_waitcnt lgkmcnt(5)
    ds_read_b64_tr_b16 a[160:161], v14 offset:24576
    v_rcp_f32 v41, v41
    v_mfma_f32_16x16x32_bf16 v[104:107], a[208:211], a[28:31], v[104:107]
    ds_read_b64_tr_b16 a[162:163], v14 offset:26624
    v_rcp_f32 v42, v42
    v_mfma_f32_16x16x32_bf16 v[104:107], a[212:215], a[32:35], v[104:107]
    ds_read_b64_tr_b16 a[164:165], v14 offset:28672
    v_rcp_f32 v43, v43
    v_mfma_f32_16x16x32_bf16 v[108:111], a[180:183], a[72:75], 0
    ds_read_b64_tr_b16 a[166:167], v14 offset:30720
    v_mul_f32 v40, v40, v72
    v_mfma_f32_16x16x32_bf16 v[108:111], a[184:187], a[76:79], v[108:111]
    ds_read_b64_tr_b16 a[168:169], v14 offset:32768
    v_mul_f32 v41, v41, v73
    v_mfma_f32_16x16x32_bf16 v[108:111], a[188:191], a[80:83], v[108:111]
    s_add_u32 m0, s82, 49152
    ds_read_b64_tr_b16 a[170:171], v14 offset:34816
    v_mul_f32 v42, v42, v74
    v_mfma_f32_16x16x32_bf16 v[108:111], a[192:195], a[84:87], v[108:111]
    s_add_u32 s56, s56, s86
    ds_read_b64_tr_b16 a[172:173], v14 offset:36864
    v_mul_f32 v43, v43, v75
    v_mfma_f32_16x16x32_bf16 v[108:111], a[196:199], a[88:91], v[108:111]
    s_addc_u32 s57, s57, 0
    ds_read_b64_tr_b16 a[174:175], v14 offset:38912
    buffer_load_dwordx4 v24, s[56:59], 0 offen lds
    v_mfma_f32_16x16x32_bf16 v[108:111], a[200:203], a[92:95], v[108:111]
    ds_read_b64_tr_b16 a[176:177], v14 offset:40960
    v_fma_f32 v44, -v76, v76, s89
    v_mfma_f32_16x16x32_bf16 v[108:111], a[204:207], a[96:99], v[108:111]
    ds_read_b64_tr_b16 a[178:179], v14 offset:43008
    v_fma_f32 v45, -v77, v77, s89
    v_mfma_f32_16x16x32_bf16 v[108:111], a[208:211], a[100:103], v[108:111]
    ds_read_b64_tr_b16 a[180:181], v15 offset:8192
    v_fma_f32 v46, -v78, v78, s89
    v_mfma_f32_16x16x32_bf16 v[108:111], a[212:215], a[104:107], v[108:111]
    ds_read_b64_tr_b16 a[182:183], v15 offset:10240
    v_fma_f32 v47, -v79, v79, s89
    v_mfma_f32_16x16x32_bf16 v[112:115], a[144:147], a[0:3], 0
    s_waitcnt lgkmcnt(5)
    ds_read_b64_tr_b16 a[184:185], v15 offset:12288
    v_mul_f32 v44, v44, v76
    v_mfma_f32_16x16x32_bf16 v[112:115], a[148:151], a[4:7], v[112:115]
    s_add_u32 m0, s82, 53248
    ds_read_b64_tr_b16 a[186:187], v15 offset:14336
    v_mul_f32 v45, v45, v77
    v_mfma_f32_16x16x32_bf16 v[112:115], a[152:155], a[8:11], v[112:115]
    s_add_u32 s56, s56, s86
    ds_read_b64_tr_b16 a[188:189], v15 offset:16384
    v_mul_f32 v46, v46, v78
    v_mfma_f32_16x16x32_bf16 v[112:115], a[156:159], a[12:15], v[112:115]
    s_addc_u32 s57, s57, 0
    ds_read_b64_tr_b16 a[190:191], v15 offset:18432
    buffer_load_dwordx4 v24, s[56:59], 0 offen lds
    v_mfma_f32_16x16x32_bf16 v[112:115], a[160:163], a[16:19], v[112:115]
    ds_read_b64_tr_b16 a[192:193], v15 offset:20480
    v_mul_f32 v47, v47, v79
    v_mfma_f32_16x16x32_bf16 v[112:115], a[164:167], a[20:23], v[112:115]
    v_exp_f32 v44, v44
    v_mfma_f32_16x16x32_bf16 v[112:115], a[168:171], a[24:27], v[112:115]
    s_waitcnt lgkmcnt(4)
    ds_read_b64_tr_b16 a[194:195], v15 offset:22528
    ds_read_b64_tr_b16 a[196:197], v15 offset:24576
    v_mfma_f32_16x16x32_bf16 v[112:115], a[172:175], a[28:31], v[112:115]
    v_exp_f32 v45, v45
    v_mfma_f32_16x16x32_bf16 v[112:115], a[176:179], a[32:35], v[112:115]
    ds_read_b64_tr_b16 a[198:199], v15 offset:26624
    ds_read_b64_tr_b16 a[200:201], v15 offset:28672
    v_mfma_f32_16x16x32_bf16 v[116:119], a[144:147], a[72:75], 0
    s_add_u32 m0, s82, 57344
    ds_read_b64_tr_b16 a[202:203], v15 offset:30720
    v_exp_f32 v46, v46
    v_mfma_f32_16x16x32_bf16 v[116:119], a[148:151], a[76:79], v[116:119]
    s_add_u32 s56, s56, s86
    ds_read_b64_tr_b16 a[204:205], v15 offset:32768
    v_exp_f32 v47, v47
    v_mfma_f32_16x16x32_bf16 v[116:119], a[152:155], a[80:83], v[116:119]
    s_addc_u32 s57, s57, 0
    ds_read_b64_tr_b16 a[206:207], v15 offset:34816
    buffer_load_dwordx4 v24, s[56:59], 0 offen lds
    v_mfma_f32_16x16x32_bf16 v[116:119], a[156:159], a[84:87], v[116:119]
    ds_read_b64_tr_b16 a[208:209], v15 offset:36864
    v_add_f32 v44, 1.0, v44
    v_mfma_f32_16x16x32_bf16 v[116:119], a[160:163], a[88:91], v[116:119]
    ds_read_b64_tr_b16 a[210:211], v15 offset:38912
    v_add_f32 v45, 1.0, v45
    v_mfma_f32_16x16x32_bf16 v[116:119], a[164:167], a[92:95], v[116:119]
    ds_read_b64_tr_b16 a[212:213], v15 offset:40960
    v_add_f32 v46, 1.0, v46
    v_mfma_f32_16x16x32_bf16 v[116:119], a[168:171], a[96:99], v[116:119]
    ds_read_b64_tr_b16 a[214:215], v15 offset:43008
    v_add_f32 v47, 1.0, v47
    v_mfma_f32_16x16x32_bf16 v[116:119], a[172:175], a[100:103], v[116:119]
    s_waitcnt vmcnt(15) lgkmcnt(6)
    s_barrier
    ds_read_b64_tr_b16 a[144:145], v12 offset:45056
    v_mfma_f32_16x16x32_bf16 v[116:119], a[176:179], a[104:107], v[116:119]
    s_add_u32 m0, s82, 61440
    ds_read_b64_tr_b16 a[146:147], v12 offset:47104
    v_rcp_f32 v44, v44
    v_mfma_f32_16x16x32_bf16 v[120:123], a[180:183], a[0:3], 0
    s_add_u32 s56, s56, s86
    ds_read_b64_tr_b16 a[148:149], v12 offset:49152
    v_rcp_f32 v45, v45
    v_mfma_f32_16x16x32_bf16 v[120:123], a[184:187], a[4:7], v[120:123]
    s_addc_u32 s57, s57, 0
    ds_read_b64_tr_b16 a[150:151], v12 offset:51200
    buffer_load_dwordx4 v24, s[56:59], 0 offen lds
    v_mfma_f32_16x16x32_bf16 v[120:123], a[188:191], a[8:11], v[120:123]
L_w2:
    s_cbranch_execz L_w6
    ds_read_b64_tr_b16 a[152:153], v12 offset:53248
    v_rcp_f32 v46, v46
    v_mfma_f32_16x16x32_bf16 v[120:123], a[192:195], a[12:15], v[120:123]
    ds_read_b64_tr_b16 a[154:155], v12 offset:55296
    v_rcp_f32 v47, v47
    v_mfma_f32_16x16x32_bf16 v[120:123], a[196:199], a[16:19], v[120:123]
    ds_read_b64_tr_b16 a[156:157], v12 offset:57344
    v_mul_f32 v44, v44, v76
    v_mfma_f32_16x16x32_bf16 v[120:123], a[200:203], a[20:23], v[120:123]
    s_waitcnt lgkmcnt(5)
    ds_read_b64_tr_b16 a[158:159], v12 offset:59392
    v_mul_f32 v45, v45, v77
    v_mfma_f32_16x16x32_bf16 v[120:123], a[204:207], a[24:27], v[120:123]
    ds_read_b64_tr_b16 a[160:161], v12 offset:61440
    v_mul_f32 v46, v46, v78
    v_mfma_f32_16x16x32_bf16 v[120:123], a[208:211], a[28:31], v[120:123]
    s_add_u32 m0, s82, 65536
    ds_read_b64_tr_b16 a[162:163], v12 offset:63488
    v_mul_f32 v47, v47, v79
    v_mfma_f32_16x16x32_bf16 v[120:123], a[212:215], a[32:35], v[120:123]
    s_add_u32 s56, s56, s86
    ds_read_b64_tr_b16 a[164:165], v16 offset:0
    v_fma_f32 v48, -v80, v80, s89
    v_mfma_f32_16x16x32_bf16 v[124:127], a[180:183], a[72:75], 0
    s_addc_u32 s57, s57, 0
    ds_read_b64_tr_b16 a[166:167], v16 offset:2048
    buffer_load_dwordx4 v24, s[56:59], 0 offen lds
    v_mfma_f32_16x16x32_bf16 v[124:127], a[184:187], a[76:79], v[124:127]
    ds_read_b64_tr_b16 a[168:169], v16 offset:4096
    v_fma_f32 v49, -v81, v81, s89
    v_mfma_f32_16x16x32_bf16 v[124:127], a[188:191], a[80:83], v[124:127]
    ds_read_b64_tr_b16 a[170:171], v16 offset:6144
    v_fma_f32 v50, -v82, v82, s89
    v_mfma_f32_16x16x32_bf16 v[124:127], a[192:195], a[84:87], v[124:127]
    ds_read_b64_tr_b16 a[172:173], v16 offset:8192
    v_fma_f32 v51, -v83, v83, s89
    v_mfma_f32_16x16x32_bf16 v[124:127], a[196:199], a[88:91], v[124:127]
    ds_read_b64_tr_b16 a[174:175], v16 offset:10240
    v_mul_f32 v48, v48, v80
    v_mfma_f32_16x16x32_bf16 v[124:127], a[200:203], a[92:95], v[124:127]
    ds_read_b64_tr_b16 a[176:177], v16 offset:12288
    v_mul_f32 v49, v49, v81
    v_mfma_f32_16x16x32_bf16 v[124:127], a[204:207], a[96:99], v[124:127]
    s_add_u32 m0, s82, 69632
    ds_read_b64_tr_b16 a[178:179], v16 offset:14336
    v_mul_f32 v50, v50, v82
    v_mfma_f32_16x16x32_bf16 v[124:127], a[208:211], a[100:103], v[124:127]
    s_add_u32 s56, s56, s86
    ds_read_b64_tr_b16 a[180:181], v13 offset:45056
    v_mul_f32 v51, v51, v83
    v_mfma_f32_16x16x32_bf16 v[124:127], a[212:215], a[104:107], v[124:127]
    s_addc_u32 s57, s57, 0
    ds_read_b64_tr_b16 a[182:183], v13 offset:47104
    buffer_load_dwordx4 v24, s[56:59], 0 offen lds
    v_mfma_f32_16x16x32_bf16 v[96:99], a[144:147], a[36:39], v[96:99]
    s_waitcnt lgkmcnt(5)
    ds_read_b64_tr_b16 a[184:185], v13 offset:49152
    v_exp_f32 v48, v48
    v_mfma_f32_16x16x32_bf16 v[96:99], a[148:151], a[40:43], v[96:99]
    ds_read_b64_tr_b16 a[186:187], v13 offset:51200
    v_exp_f32 v49, v49
    v_mfma_f32_16x16x32_bf16 v[96:99], a[152:155], a[44:47], v[96:99]
    ds_read_b64_tr_b16 a[188:189], v13 offset:53248
    v_exp_f32 v50, v50
    v_mfma_f32_16x16x32_bf16 v[96:99], a[156:159], a[48:51], v[96:99]
    v_exp_f32 v51, v51
    v_mfma_f32_16x16x32_bf16 v[96:99], a[160:163], a[52:55], v[96:99]
    s_waitcnt lgkmcnt(4)
    ds_read_b64_tr_b16 a[190:191], v13 offset:55296
    ds_read_b64_tr_b16 a[192:193], v13 offset:57344
    v_mfma_f32_16x16x32_bf16 v[96:99], a[164:167], a[56:59], v[96:99]
    s_add_u32 m0, s82, 73728
    ds_read_b64_tr_b16 a[194:195], v13 offset:59392
    v_add_f32 v48, 1.0, v48
    v_mfma_f32_16x16x32_bf16 v[96:99], a[168:171], a[60:63], v[96:99]
    s_mov_b32 s56, s50
    ds_read_b64_tr_b16 a[196:197], v13 offset:61440
    v_add_f32 v49, 1.0, v49
    v_mfma_f32_16x16x32_bf16 v[96:99], a[172:175], a[64:67], v[96:99]
    s_mov_b32 s57, s51
    ds_read_b64_tr_b16 a[198:199], v13 offset:63488
    buffer_load_dwordx4 v24, s[56:59], 0 offen lds
    v_mfma_f32_16x16x32_bf16 v[96:99], a[176:179], a[68:71], v[96:99]
    s_add_u32 s50, s50, 128
    ds_read_b64_tr_b16 a[200:201], v17 offset:0
    v_add_f32 v50, 1.0, v50
    v_mfma_f32_16x16x32_bf16 v[100:103], a[144:147], a[108:111], v[100:103]
    s_addc_u32 s51, s51, 0
    ds_read_b64_tr_b16 a[202:203], v17 offset:2048
    v_add_f32 v51, 1.0, v51
    v_mfma_f32_16x16x32_bf16 v[100:103], a[148:151], a[112:115], v[100:103]
    ds_read_b64_tr_b16 a[204:205], v17 offset:4096
    v_rcp_f32 v48, v48
    v_mfma_f32_16x16x32_bf16 v[100:103], a[152:155], a[116:119], v[100:103]
    ds_read_b64_tr_b16 a[206:207], v17 offset:6144
    v_rcp_f32 v49, v49
    v_mfma_f32_16x16x32_bf16 v[100:103], a[156:159], a[120:123], v[100:103]
    ds_read_b64_tr_b16 a[208:209], v17 offset:8192
    v_rcp_f32 v50, v50
    v_mfma_f32_16x16x32_bf16 v[100:103], a[160:163], a[124:127], v[100:103]
    s_add_u32 m0, s82, 77824
    ds_read_b64_tr_b16 a[210:211], v17 offset:10240
    v_rcp_f32 v51, v51
    v_mfma_f32_16x16x32_bf16 v[100:103], a[164:167], a[128:131], v[100:103]
    s_add_u32 s56, s56, s86
    ds_read_b64_tr_b16 a[212:213], v17 offset:12288
    v_mul_f32 v48, v48, v80
    v_mfma_f32_16x16x32_bf16 v[100:103], a[168:171], a[132:135], v[100:103]
    s_addc_u32 s57, s57, 0
    ds_read_b64_tr_b16 a[214:215], v17 offset:14336
    buffer_load_dwordx4 v24, s[56:59], 0 offen lds
    v_mfma_f32_16x16x32_bf16 v[100:103], a[172:175], a[136:139], v[100:103]
    ds_read_b64_tr_b16 a[144:145], v14 offset:45056
    v_mul_f32 v49, v49, v81
    v_mfma_f32_16x16x32_bf16 v[100:103], a[176:179], a[140:143], v[100:103]
    s_waitcnt lgkmcnt(5)
    ds_read_b64_tr_b16 a[146:147], v14 offset:47104
    v_mul_f32 v50, v50, v82
    v_mfma_f32_16x16x32_bf16 v[104:107], a[180:183], a[36:39], v[104:107]
    ds_read_b64_tr_b16 a[148:149], v14 offset:49152
    v_mul_f32 v51, v51, v83
    v_mfma_f32_16x16x32_bf16 v[104:107], a[184:187], a[40:43], v[104:107]
    ds_read_b64_tr_b16 a[150:151], v14 offset:51200
    v_fma_f32 v52, -v84, v84, s89
    v_mfma_f32_16x16x32_bf16 v[104:107], a[188:191], a[44:47], v[104:107]
    ds_read_b64_tr_b16 a[152:153], v14 offset:53248
    v_fma_f32 v53, -v85, v85, s89
    v_mfma_f32_16x16x32_bf16 v[104:107], a[192:195], a[48:51], v[104:107]
    s_add_u32 m0, s82, 81920
    ds_read_b64_tr_b16 a[154:155], v14 offset:55296
    v_fma_f32 v54, -v86, v86, s89
    v_mfma_f32_16x16x32_bf16 v[104:107], a[196:199], a[52:55], v[104:107]
    s_add_u32 s56, s56, s86
    ds_read_b64_tr_b16 a[156:157], v14 offset:57344
    v_fma_f32 v55, -v87, v87, s89
    v_mfma_f32_16x16x32_bf16 v[104:107], a[200:203], a[56:59], v[104:107]
    s_addc_u32 s57, s57, 0
    ds_read_b64_tr_b16 a[158:159], v14 offset:59392
    buffer_load_dwordx4 v24, s[56:59], 0 offen lds
    v_mfma_f32_16x16x32_bf16 v[104:107], a[204:207], a[60:63], v[104:107]
    s_waitcnt lgkmcnt(5)
    ds_read_b64_tr_b16 a[160:161], v14 offset:61440
    v_mul_f32 v52, v52, v84
    v_mfma_f32_16x16x32_bf16 v[104:107], a[208:211], a[64:67], v[104:107]
    ds_read_b64_tr_b16 a[162:163], v14 offset:63488
    v_mul_f32 v53, v53, v85
    v_mfma_f32_16x16x32_bf16 v[104:107], a[212:215], a[68:71], v[104:107]
    ds_read_b64_tr_b16 a[164:165], v18 offset:0
    v_mul_f32 v54, v54, v86
    v_mfma_f32_16x16x32_bf16 v[108:111], a[180:183], a[108:111], v[108:111]
    ds_read_b64_tr_b16 a[166:167], v18 offset:2048
    v_mul_f32 v55, v55, v87
    v_mfma_f32_16x16x32_bf16 v[108:111], a[184:187], a[112:115], v[108:111]
    v_exp_f32 v52, v52
    v_mfma_f32_16x16x32_bf16 v[108:111], a[188:191], a[116:119], v[108:111]
    s_add_u32 m0, s82, 86016
    ds_read_b64_tr_b16 a[168:169], v18 offset:4096
    ds_read_b64_tr_b16 a[170:171], v18 offset:6144
    v_mfma_f32_16x16x32_bf16 v[108:111], a[192:195], a[120:123], v[108:111]
    s_add_u32 s56, s56, s86
    ds_read_b64_tr_b16 a[172:173], v18 offset:8192
    v_exp_f32 v53, v53
    v_mfma_f32_16x16x32_bf16 v[108:111], a[196:199], a[124:127], v[108:111]
    s_addc_u32 s57, s57, 0
    ds_read_b64_tr_b16 a[174:175], v18 offset:10240
    buffer_load_dwordx4 v24, s[56:59], 0 offen lds
    v_mfma_f32_16x16x32_bf16 v[108:111], a[200:203], a[128:131], v[108:111]
    ds_read_b64_tr_b16 a[176:177], v18 offset:12288
    v_exp_f32 v54, v54
    v_mfma_f32_16x16x32_bf16 v[108:111], a[204:207], a[132:135], v[108:111]
    ds_read_b64_tr_b16 a[178:179], v18 offset:14336
    v_exp_f32 v55, v55
    v_mfma_f32_16x16x32_bf16 v[108:111], a[208:211], a[136:139], v[108:111]
    ds_read_b64_tr_b16 a[180:181], v15 offset:45056
    v_add_f32 v52, 1.0, v52
    v_mfma_f32_16x16x32_bf16 v[108:111], a[212:215], a[140:143], v[108:111]
    ds_read_b64_tr_b16 a[182:183], v15 offset:47104
    v_add_f32 v53, 1.0, v53
    v_mfma_f32_16x16x32_bf16 v[112:115], a[144:147], a[36:39], v[112:115]
    s_waitcnt lgkmcnt(5)
    ds_read_b64_tr_b16 a[184:185], v15 offset:49152
    v_add_f32 v54, 1.0, v54
    v_mfma_f32_16x16x32_bf16 v[112:115], a[148:151], a[40:43], v[112:115]
    s_add_u32 m0, s82, 90112
    ds_read_b64_tr_b16 a[186:187], v15 offset:51200
    v_add_f32 v55, 1.0, v55
    v_mfma_f32_16x16x32_bf16 v[112:115], a[152:155], a[44:47], v[112:115]
    s_add_u32 s56, s56, s86
    ds_read_b64_tr_b16 a[188:189], v15 offset:53248
    v_rcp_f32 v52, v52
    v_mfma_f32_16x16x32_bf16 v[112:115], a[156:159], a[48:51], v[112:115]
    s_addc_u32 s57, s57, 0
    ds_read_b64_tr_b16 a[190:191], v15 offset:55296
    buffer_load_dwordx4 v24, s[56:59], 0 offen lds
    v_mfma_f32_16x16x32_bf16 v[112:115], a[160:163], a[52:55], v[112:115]
    v_rcp_f32 v53, v53
    v_mfma_f32_16x16x32_bf16 v[112:115], a[164:167], a[56:59], v[112:115]
    ds_read_b64_tr_b16 a[192:193], v15 offset:57344
    ds_read_b64_tr_b16 a[194:195], v15 offset:59392
    v_mfma_f32_16x16x32_bf16 v[112:115], a[168:171], a[60:63], v[112:115]
    s_waitcnt lgkmcnt(5)
    ds_read_b64_tr_b16 a[196:197], v15 offset:61440
    v_rcp_f32 v54, v54
    v_mfma_f32_16x16x32_bf16 v[112:115], a[172:175], a[64:67], v[112:115]
    ds_read_b64_tr_b16 a[198:199], v15 offset:63488
    v_rcp_f32 v55, v55
    v_mfma_f32_16x16x32_bf16 v[112:115], a[176:179], a[68:71], v[112:115]
    ds_read_b64_tr_b16 a[200:201], v19 offset:0
    v_mul_f32 v52, v52, v84
    v_mfma_f32_16x16x32_bf16 v[116:119], a[144:147], a[108:111], v[116:119]
    s_add_u32 m0, s82, 94208
    ds_read_b64_tr_b16 a[202:203], v19 offset:2048
    v_mul_f32 v53, v53, v85
    v_mfma_f32_16x16x32_bf16 v[116:119], a[148:151], a[112:115], v[116:119]
    s_add_u32 s56, s56, s86
    ds_read_b64_tr_b16 a[204:205], v19 offset:4096
    v_mul_f32 v54, v54, v86
    v_mfma_f32_16x16x32_bf16 v[116:119], a[152:155], a[116:119], v[116:119]
    s_addc_u32 s57, s57, 0
    ds_read_b64_tr_b16 a[206:207], v19 offset:6144
    buffer_load_dwordx4 v24, s[56:59], 0 offen lds
    v_mfma_f32_16x16x32_bf16 v[116:119], a[156:159], a[120:123], v[116:119]
    ds_read_b64_tr_b16 a[208:209], v19 offset:8192
    v_mul_f32 v55, v55, v87
    v_mfma_f32_16x16x32_bf16 v[116:119], a[160:163], a[124:127], v[116:119]
    ds_read_b64_tr_b16 a[210:211], v19 offset:10240
    v_fma_f32 v56, -v88, v88, s89
    v_mfma_f32_16x16x32_bf16 v[116:119], a[164:167], a[128:131], v[116:119]
    ds_read_b64_tr_b16 a[212:213], v19 offset:12288
    v_fma_f32 v57, -v89, v89, s89
    v_mfma_f32_16x16x32_bf16 v[116:119], a[168:171], a[132:135], v[116:119]
    ds_read_b64_tr_b16 a[214:215], v19 offset:14336
    v_fma_f32 v58, -v90, v90, s89
    v_mfma_f32_16x16x32_bf16 v[116:119], a[172:175], a[136:139], v[116:119]
    s_waitcnt vmcnt(15) lgkmcnt(6)
    s_barrier
    ds_read_b64_tr_b16 a[144:145], v8 offset:0
    v_mfma_f32_16x16x32_bf16 v[116:119], a[176:179], a[140:143], v[116:119]
    s_add_u32 m0, s82, 98304
    ds_read_b64_tr_b16 a[146:147], v8 offset:2048
    v_fma_f32 v59, -v91, v91, s89
    v_mfma_f32_16x16x32_bf16 v[120:123], a[180:183], a[36:39], v[120:123]
    s_add_u32 s56, s56, s86
    ds_read_b64_tr_b16 a[148:149], v8 offset:4096
    v_mul_f32 v56, v56, v88
    v_mfma_f32_16x16x32_bf16 v[120:123], a[184:187], a[40:43], v[120:123]
    s_addc_u32 s57, s57, 0
    ds_read_b64_tr_b16 a[150:151], v8 offset:6144
    buffer_load_dwordx4 v24, s[56:59], 0 offen lds
    v_mfma_f32_16x16x32_bf16 v[120:123], a[188:191], a[44:47], v[120:123]
    ds_read_b64_tr_b16 a[152:153], v8 offset:8192
    v_mul_f32 v57, v57, v89
    v_mfma_f32_16x16x32_bf16 v[120:123], a[192:195], a[48:51], v[120:123]
    ds_read_b64_tr_b16 a[154:155], v8 offset:10240
    v_mul_f32 v58, v58, v90
    v_mfma_f32_16x16x32_bf16 v[120:123], a[196:199], a[52:55], v[120:123]
    ds_read_b64_tr_b16 a[156:157], v8 offset:12288
    v_mul_f32 v59, v59, v91
    v_mfma_f32_16x16x32_bf16 v[120:123], a[200:203], a[56:59], v[120:123]
    s_waitcnt lgkmcnt(5)
    ds_read_b64_tr_b16 a[158:159], v8 offset:14336
    v_exp_f32 v56, v56
    v_mfma_f32_16x16x32_bf16 v[120:123], a[204:207], a[60:63], v[120:123]
    ds_read_b64_tr_b16 a[160:161], v8 offset:16384
    v_exp_f32 v57, v57
    v_mfma_f32_16x16x32_bf16 v[120:123], a[208:211], a[64:67], v[120:123]
    s_add_u32 m0, s82, 102400
    v_exp_f32 v58, v58
    v_mfma_f32_16x16x32_bf16 v[120:123], a[212:215], a[68:71], v[120:123]
    s_add_u32 s56, s56, s86
    ds_read_b64_tr_b16 a[162:163], v8 offset:18432
    ds_read_b64_tr_b16 a[164:165], v8 offset:20480
    v_mfma_f32_16x16x32_bf16 v[124:127], a[180:183], a[108:111], v[124:127]
    s_addc_u32 s57, s57, 0
    ds_read_b64_tr_b16 a[166:167], v8 offset:22528
    buffer_load_dwordx4 v24, s[56:59], 0 offen lds
    v_mfma_f32_16x16x32_bf16 v[124:127], a[184:187], a[112:115], v[124:127]
    ds_read_b64_tr_b16 a[168:169], v8 offset:24576
    v_exp_f32 v59, v59
    v_mfma_f32_16x16x32_bf16 v[124:127], a[188:191], a[116:119], v[124:127]
    ds_read_b64_tr_b16 a[170:171], v8 offset:26624
    v_add_f32 v56, 1.0, v56
    v_mfma_f32_16x16x32_bf16 v[124:127], a[192:195], a[120:123], v[124:127]
    ds_read_b64_tr_b16 a[172:173], v8 offset:28672
    v_add_f32 v57, 1.0, v57
    v_mfma_f32_16x16x32_bf16 v[124:127], a[196:199], a[124:127], v[124:127]
    ds_read_b64_tr_b16 a[174:175], v8 offset:30720
    v_add_f32 v58, 1.0, v58
    v_mfma_f32_16x16x32_bf16 v[124:127], a[200:203], a[128:131], v[124:127]
    ds_read_b64_tr_b16 a[176:177], v8 offset:32768
    v_add_f32 v59, 1.0, v59
    v_mfma_f32_16x16x32_bf16 v[124:127], a[204:207], a[132:135], v[124:127]
    s_add_u32 m0, s82, 106496
    ds_read_b64_tr_b16 a[178:179], v8 offset:34816
    v_rcp_f32 v56, v56
    v_mfma_f32_16x16x32_bf16 v[124:127], a[208:211], a[136:139], v[124:127]
    s_add_u32 s56, s56, s86
    ds_read_b64_tr_b16 a[180:181], v9 offset:0
    v_rcp_f32 v57, v57
    v_mfma_f32_16x16x32_bf16 v[124:127], a[212:215], a[140:143], v[124:127]
    s_addc_u32 s57, s57, 0
    s_cmp_lt_u32 s87, 7
    ds_read_b64_tr_b16 a[182:183], v9 offset:2048
    buffer_load_dwordx4 v24, s[56:59], 0 offen lds
    s_cbranch_scc0 L_aexit
L_aloop:
    v_mfma_f32_16x16x32_bf16 v[64:67], a[144:147], a[0:3], 0
    s_waitcnt lgkmcnt(5)
    ds_read_b64_tr_b16 a[184:185], v9 offset:4096
    v_rcp_f32 v58, v58
    v_mfma_f32_16x16x32_bf16 v[64:67], a[148:151], a[4:7], v[64:67]
    ds_read_b64_tr_b16 a[186:187], v9 offset:6144
    v_rcp_f32 v59, v59
    v_mfma_f32_16x16x32_bf16 v[64:67], a[152:155], a[8:11], v[64:67]
    ds_read_b64_tr_b16 a[188:189], v9 offset:8192
    v_mul_f32 v56, v56, v88
    v_mfma_f32_16x16x32_bf16 v[64:67], a[156:159], a[12:15], v[64:67]
    ds_read_b64_tr_b16 a[190:191], v9 offset:10240
    v_mul_f32 v57, v57, v89
    v_mfma_f32_16x16x32_bf16 v[64:67], a[160:163], a[16:19], v[64:67]
    s_waitcnt lgkmcnt(5)
    ds_read_b64_tr_b16 a[192:193], v9 offset:12288
    v_mul_f32 v58, v58, v90
    v_mfma_f32_16x16x32_bf16 v[64:67], a[164:167], a[20:23], v[64:67]
    s_add_u32 m0, s82, 110592
    ds_read_b64_tr_b16 a[194:195], v9 offset:14336
    v_mul_f32 v59, v59, v91
    v_mfma_f32_16x16x32_bf16 v[64:67], a[168:171], a[24:27], v[64:67]
    s_add_u32 s56, s56, s86
    ds_read_b64_tr_b16 a[196:197], v9 offset:16384
    v_fma_f32 v60, -v92, v92, s89
    v_mfma_f32_16x16x32_bf16 v[64:67], a[172:175], a[28:31], v[64:67]
    s_addc_u32 s57, s57, 0
    ds_read_b64_tr_b16 a[198:199], v9 offset:18432
    buffer_load_dwordx4 v24, s[56:59], 0 offen lds
    v_mfma_f32_16x16x32_bf16 v[64:67], a[176:179], a[32:35], v[64:67]
    ds_read_b64_tr_b16 a[200:201], v9 offset:20480
    v_fma_f32 v61, -v93, v93, s89
    v_mfma_f32_16x16x32_bf16 v[68:71], a[144:147], a[72:75], 0
    ds_read_b64_tr_b16 a[202:203], v9 offset:22528
    v_fma_f32 v62, -v94, v94, s89
    v_mfma_f32_16x16x32_bf16 v[68:71], a[148:151], a[76:79], v[68:71]
    ds_read_b64_tr_b16 a[204:205], v9 offset:24576
    v_fma_f32 v63, -v95, v95, s89
    v_mfma_f32_16x16x32_bf16 v[68:71], a[152:155], a[80:83], v[68:71]
    ds_read_b64_tr_b16 a[206:207], v9 offset:26624
    v_mul_f32 v60, v60, v92
    v_mfma_f32_16x16x32_bf16 v[68:71], a[156:159], a[84:87], v[68:71]
    ds_read_b64_tr_b16 a[208:209], v9 offset:28672
    v_mul_f32 v61, v61, v93
    v_mfma_f32_16x16x32_bf16 v[68:71], a[160:163], a[88:91], v[68:71]
    s_add_u32 m0, s82, 114688
    ds_read_b64_tr_b16 a[210:211], v9 offset:30720
    v_mul_f32 v62, v62, v94
    v_mfma_f32_16x16x32_bf16 v[68:71], a[164:167], a[92:95], v[68:71]
    s_add_u32 s56, s56, s86
    ds_read_b64_tr_b16 a[212:213], v9 offset:32768
    v_mul_f32 v63, v63, v95
    v_mfma_f32_16x16x32_bf16 v[68:71], a[168:171], a[96:99], v[68:71]
    s_addc_u32 s57, s57, 0
    ds_read_b64_tr_b16 a[214:215], v9 offset:34816
    buffer_load_dwordx4 v24, s[56:59], 0 offen lds
    v_mfma_f32_16x16x32_bf16 v[68:71], a[172:175], a[100:103], v[68:71]
    v_exp_f32 v60, v60
    v_mfma_f32_16x16x32_bf16 v[68:71], a[176:179], a[104:107], v[68:71]
    s_waitcnt lgkmcnt(4)
    ds_read_b64_tr_b16 a[144:145], v10 offset:0
    ds_read_b64_tr_b16 a[146:147], v10 offset:2048
    v_mfma_f32_16x16x32_bf16 v[72:75], a[180:183], a[0:3], 0
    ds_read_b64_tr_b16 a[148:149], v10 offset:4096
    buffer_load_dword v26, off, s[32:35], s97 sc1
    v_mfma_f32_16x16x32_bf16 v[72:75], a[184:187], a[4:7], v[72:75]
    ds_read_b64_tr_b16 a[150:151], v10 offset:6144
    v_exp_f32 v61, v61
    v_mfma_f32_16x16x32_bf16 v[72:75], a[188:191], a[8:11], v[72:75]
    ds_read_b64_tr_b16 a[152:153], v10 offset:8192
    v_exp_f32 v62, v62
    v_mfma_f32_16x16x32_bf16 v[72:75], a[192:195], a[12:15], v[72:75]
    s_add_u32 m0, s82, 118784
    ds_read_b64_tr_b16 a[154:155], v10 offset:10240
    v_exp_f32 v63, v63
    v_mfma_f32_16x16x32_bf16 v[72:75], a[196:199], a[16:19], v[72:75]
    s_add_u32 s56, s56, s86
    ds_read_b64_tr_b16 a[156:157], v10 offset:12288
    v_add_f32 v60, 1.0, v60
    v_mfma_f32_16x16x32_bf16 v[72:75], a[200:203], a[20:23], v[72:75]
    s_addc_u32 s57, s57, 0
    ds_read_b64_tr_b16 a[158:159], v10 offset:14336
    buffer_load_dwordx4 v24, s[56:59], 0 offen lds
    v_mfma_f32_16x16x32_bf16 v[72:75], a[204:207], a[24:27], v[72:75]
    s_waitcnt lgkmcnt(5)
    ds_read_b64_tr_b16 a[160:161], v10 offset:16384
    v_add_f32 v61, 1.0, v61
    v_mfma_f32_16x16x32_bf16 v[72:75], a[208:211], a[28:31], v[72:75]
    ds_read_b64_tr_b16 a[162:163], v10 offset:18432
    v_add_f32 v62, 1.0, v62
    v_mfma_f32_16x16x32_bf16 v[72:75], a[212:215], a[32:35], v[72:75]
    ds_read_b64_tr_b16 a[164:165], v10 offset:20480
    v_add_f32 v63, 1.0, v63
    v_mfma_f32_16x16x32_bf16 v[76:79], a[180:183], a[72:75], 0
    ds_read_b64_tr_b16 a[166:167], v10 offset:22528
    v_rcp_f32 v60, v60
    v_mfma_f32_16x16x32_bf16 v[76:79], a[184:187], a[76:79], v[76:79]
    ds_read_b64_tr_b16 a[168:169], v10 offset:24576
    v_rcp_f32 v61, v61
    v_mfma_f32_16x16x32_bf16 v[76:79], a[188:191], a[80:83], v[76:79]
    s_add_u32 m0, s82, 122880
    ds_read_b64_tr_b16 a[170:171], v10 offset:26624
    v_rcp_f32 v62, v62
    v_mfma_f32_16x16x32_bf16 v[76:79], a[192:195], a[84:87], v[76:79]
    s_add_u32 s56, s56, s86
    ds_read_b64_tr_b16 a[172:173], v10 offset:28672
    v_rcp_f32 v63, v63
    v_mfma_f32_16x16x32_bf16 v[76:79], a[196:199], a[88:91], v[76:79]
    s_addc_u32 s57, s57, 0
    ds_read_b64_tr_b16 a[174:175], v10 offset:30720
    buffer_load_dwordx4 v24, s[56:59], 0 offen lds
    v_mfma_f32_16x16x32_bf16 v[76:79], a[200:203], a[92:95], v[76:79]
    ds_read_b64_tr_b16 a[176:177], v10 offset:32768
    v_mul_f32 v60, v60, v92
    v_mfma_f32_16x16x32_bf16 v[76:79], a[204:207], a[96:99], v[76:79]
    ds_read_b64_tr_b16 a[178:179], v10 offset:34816
    v_mul_f32 v61, v61, v93
    v_mfma_f32_16x16x32_bf16 v[76:79], a[208:211], a[100:103], v[76:79]
    ds_read_b64_tr_b16 a[180:181], v11 offset:0
    v_mul_f32 v62, v62, v94
    v_mfma_f32_16x16x32_bf16 v[76:79], a[212:215], a[104:107], v[76:79]
    ds_read_b64_tr_b16 a[182:183], v11 offset:2048
    v_mul_f32 v63, v63, v95
    v_mfma_f32_16x16x32_bf16 v[80:83], a[144:147], a[0:3], 0
    s_waitcnt lgkmcnt(5)
    ds_read_b64_tr_b16 a[184:185], v11 offset:4096
    v_mul_f32 v32, v32, v96
    v_mfma_f32_16x16x32_bf16 v[80:83], a[148:151], a[4:7], v[80:83]
    s_add_u32 m0, s82, 126976
    ds_read_b64_tr_b16 a[186:187], v11 offset:6144
    v_mul_f32 v33, v33, v97
    v_mfma_f32_16x16x32_bf16 v[80:83], a[152:155], a[8:11], v[80:83]
    s_add_u32 s56, s56, s86
    ds_read_b64_tr_b16 a[188:189], v11 offset:8192
    v_mul_f32 v34, v34, v98
    v_mfma_f32_16x16x32_bf16 v[80:83], a[156:159], a[12:15], v[80:83]
    s_addc_u32 s57, s57, 0
    ds_read_b64_tr_b16 a[190:191], v11 offset:10240
    buffer_load_dwordx4 v24, s[56:59], 0 offen lds
    v_mfma_f32_16x16x32_bf16 v[80:83], a[160:163], a[16:19], v[80:83]
    ds_read_b64_tr_b16 a[192:193], v11 offset:12288
    v_mul_f32 v35, v35, v99
    v_mfma_f32_16x16x32_bf16 v[80:83], a[164:167], a[20:23], v[80:83]
    s_set_gpr_idx_on s88, 8
    ds_read_b64_tr_b16 a[194:195], v11 offset:14336
    v_cvt_pk_bf16_f32 v128, v32, v33
    v_cvt_pk_bf16_f32 v129, v34, v35
    s_set_gpr_idx_off
    v_mfma_f32_16x16x32_bf16 v[80:83], a[168:171], a[24:27], v[80:83]
    s_waitcnt lgkmcnt(5)
    ds_read_b64_tr_b16 a[196:197], v11 offset:16384
    v_mul_f32 v40, v40, v104
    v_mfma_f32_16x16x32_bf16 v[80:83], a[172:175], a[28:31], v[80:83]
    ds_read_b64_tr_b16 a[198:199], v11 offset:18432
    v_mul_f32 v41, v41, v105
    v_mfma_f32_16x16x32_bf16 v[80:83], a[176:179], a[32:35], v[80:83]
    ds_read_b64_tr_b16 a[200:201], v11 offset:20480
    v_mul_f32 v42, v42, v106
    v_mfma_f32_16x16x32_bf16 v[84:87], a[144:147], a[72:75], 0
    s_add_u32 m0, s82, 131072
    ds_read_b64_tr_b16 a[202:203], v11 offset:22528
    v_mul_f32 v43, v43, v107
    v_mfma_f32_16x16x32_bf16 v[84:87], a[148:151], a[76:79], v[84:87]
    s_add_u32 s56, s56, s86
    ds_read_b64_tr_b16 a[204:205], v11 offset:24576
    v_mul_f32 v48, v48, v112
    v_mfma_f32_16x16x32_bf16 v[84:87], a[152:155], a[80:83], v[84:87]
    s_addc_u32 s57, s57, 0
    ds_read_b64_tr_b16 a[206:207], v11 offset:26624
    buffer_load_dwordx4 v24, s[56:59], 0 offen lds
    v_mfma_f32_16x16x32_bf16 v[84:87], a[156:159], a[84:87], v[84:87]
    s_set_gpr_idx_on s88, 8
    ds_read_b64_tr_b16 a[208:209], v11 offset:28672
    v_cvt_pk_bf16_f32 v130, v40, v41
    v_cvt_pk_bf16_f32 v131, v42, v43
    s_set_gpr_idx_off
    v_mfma_f32_16x16x32_bf16 v[84:87], a[160:163], a[88:91], v[84:87]
    ds_read_b64_tr_b16 a[210:211], v11 offset:30720
    v_mul_f32 v49, v49, v113
    v_mfma_f32_16x16x32_bf16 v[84:87], a[164:167], a[92:95], v[84:87]
    ds_read_b64_tr_b16 a[212:213], v11 offset:32768
    v_mul_f32 v50, v50, v114
    v_mfma_f32_16x16x32_bf16 v[84:87], a[168:171], a[96:99], v[84:87]
    ds_read_b64_tr_b16 a[214:215], v11 offset:34816
    v_mul_f32 v51, v51, v115
    v_mfma_f32_16x16x32_bf16 v[84:87], a[172:175], a[100:103], v[84:87]
    s_waitcnt vmcnt(16) lgkmcnt(6)
    s_barrier
    ds_read_b64_tr_b16 a[144:145], v8 offset:36864
    v_mfma_f32_16x16x32_bf16 v[84:87], a[176:179], a[104:107], v[84:87]
    s_add_u32 m0, s82, 135168
    ds_read_b64_tr_b16 a[146:147], v8 offset:38912
    v_mul_f32 v56, v56, v120
    v_mfma_f32_16x16x32_bf16 v[88:91], a[180:183], a[0:3], 0
    s_add_u32 s56, s56, s86
    ds_read_b64_tr_b16 a[148:149], v8 offset:40960
    v_mul_f32 v57, v57, v121
    v_mfma_f32_16x16x32_bf16 v[88:91], a[184:187], a[4:7], v[88:91]
    s_addc_u32 s57, s57, 0
    ds_read_b64_tr_b16 a[150:151], v8 offset:43008
    buffer_load_dwordx4 v24, s[56:59], 0 offen lds
    v_mfma_f32_16x16x32_bf16 v[88:91], a[188:191], a[8:11], v[88:91]
    s_set_gpr_idx_on s88, 8
    ds_read_b64_tr_b16 a[152:153], v8 offset:45056
    v_cvt_pk_bf16_f32 v136, v48, v49
    v_cvt_pk_bf16_f32 v137, v50, v51
    s_set_gpr_idx_off
    v_mfma_f32_16x16x32_bf16 v[88:91], a[192:195], a[12:15], v[88:91]
    ds_read_b64_tr_b16 a[154:155], v8 offset:47104
    v_mul_f32 v58, v58, v122
    v_mfma_f32_16x16x32_bf16 v[88:91], a[196:199], a[16:19], v[88:91]
    s_waitcnt lgkmcnt(5)
    ds_read_b64_tr_b16 a[156:157], v8 offset:49152
    v_mul_f32 v59, v59, v123
    v_mfma_f32_16x16x32_bf16 v[88:91], a[200:203], a[20:23], v[88:91]
    s_set_gpr_idx_on s88, 8
    ds_read_b64_tr_b16 a[158:159], v8 offset:51200
    v_cvt_pk_bf16_f32 v138, v56, v57
    v_cvt_pk_bf16_f32 v139, v58, v59
    s_set_gpr_idx_off
    v_mfma_f32_16x16x32_bf16 v[88:91], a[204:207], a[24:27], v[88:91]
    ds_read_b64_tr_b16 a[160:161], v8 offset:53248
    v_mul_f32 v36, v36, v100
    v_mfma_f32_16x16x32_bf16 v[88:91], a[208:211], a[28:31], v[88:91]
    s_add_u32 m0, s82, 139264
    ds_read_b64_tr_b16 a[162:163], v8 offset:55296
    v_mul_f32 v37, v37, v101
    v_mfma_f32_16x16x32_bf16 v[88:91], a[212:215], a[32:35], v[88:91]
    s_add_u32 s56, s56, s86
    ds_read_b64_tr_b16 a[164:165], v8 offset:57344
    v_mul_f32 v38, v38, v102
    v_mfma_f32_16x16x32_bf16 v[92:95], a[180:183], a[72:75], 0
    s_addc_u32 s57, s57, 0
    ds_read_b64_tr_b16 a[166:167], v8 offset:59392
    buffer_load_dwordx4 v24, s[56:59], 0 offen lds
    v_mfma_f32_16x16x32_bf16 v[92:95], a[184:187], a[76:79], v[92:95]
    ds_read_b64_tr_b16 a[168:169], v8 offset:61440
    v_mul_f32 v39, v39, v103
    v_mfma_f32_16x16x32_bf16 v[92:95], a[188:191], a[80:83], v[92:95]
    s_set_gpr_idx_on s88, 8
    ds_read_b64_tr_b16 a[170:171], v8 offset:63488
    v_cvt_pk_bf16_f32 v132, v36, v37
    v_cvt_pk_bf16_f32 v133, v38, v39
    s_set_gpr_idx_off
    v_mfma_f32_16x16x32_bf16 v[92:95], a[192:195], a[84:87], v[92:95]
    ds_read_b64_tr_b16 a[172:173], v12 offset:0
    v_mul_f32 v44, v44, v108
    v_mfma_f32_16x16x32_bf16 v[92:95], a[196:199], a[88:91], v[92:95]
    ds_read_b64_tr_b16 a[174:175], v12 offset:2048
    v_mul_f32 v45, v45, v109
    v_mfma_f32_16x16x32_bf16 v[92:95], a[200:203], a[92:95], v[92:95]
    s_waitcnt lgkmcnt(5)
    ds_read_b64_tr_b16 a[176:177], v12 offset:4096
    v_mul_f32 v46, v46, v110
    v_mfma_f32_16x16x32_bf16 v[92:95], a[204:207], a[96:99], v[92:95]
    s_add_u32 m0, s82, 143360
    ds_read_b64_tr_b16 a[178:179], v12 offset:6144
    v_mul_f32 v47, v47, v111
    v_mfma_f32_16x16x32_bf16 v[92:95], a[208:211], a[100:103], v[92:95]
    s_add_u32 s56, s56, s86
    ds_read_b64_tr_b16 a[180:181], v9 offset:36864
    v_mul_f32 v52, v52, v116
    v_mfma_f32_16x16x32_bf16 v[92:95], a[212:215], a[104:107], v[92:95]
    s_addc_u32 s57, s57, 0
    ds_read_b64_tr_b16 a[182:183], v9 offset:38912
    buffer_load_dwordx4 v24, s[56:59], 0 offen lds
    v_mfma_f32_16x16x32_bf16 v[64:67], a[144:147], a[36:39], v[64:67]
    s_mov_b32 s86, s68
    ds_read_b64_tr_b16 a[184:185], v9 offset:40960
    v_mul_f32 v53, v53, v117
    v_mfma_f32_16x16x32_bf16 v[64:67], a[148:151], a[40:43], v[64:67]
    s_mov_b32 s58, s69
    ds_read_b64_tr_b16 a[186:187], v9 offset:43008
    v_mul_f32 v54, v54, v118
    v_mfma_f32_16x16x32_bf16 v[64:67], a[152:155], a[44:47], v[64:67]
    ds_read_b64_tr_b16 a[188:189], v9 offset:45056
    v_mov_b32 v24, v28
    v_mfma_f32_16x16x32_bf16 v[64:67], a[156:159], a[48:51], v[64:67]
    s_set_gpr_idx_on s88, 8
    ds_read_b64_tr_b16 a[190:191], v9 offset:47104
    v_cvt_pk_bf16_f32 v134, v44, v45
    v_cvt_pk_bf16_f32 v135, v46, v47
    s_set_gpr_idx_off
    v_mfma_f32_16x16x32_bf16 v[64:67], a[160:163], a[52:55], v[64:67]
    s_waitcnt lgkmcnt(5)
    ds_read_b64_tr_b16 a[192:193], v9 offset:49152
    v_mul_f32 v55, v55, v119
    v_mfma_f32_16x16x32_bf16 v[64:67], a[164:167], a[56:59], v[64:67]
    s_add_u32 m0, s82, 0
    ds_read_b64_tr_b16 a[194:195], v9 offset:51200
    v_mul_f32 v60, v60, v124
    v_mfma_f32_16x16x32_bf16 v[64:67], a[168:171], a[60:63], v[64:67]
    s_mov_b32 s56, s48
    ds_read_b64_tr_b16 a[196:197], v9 offset:53248
    v_mul_f32 v61, v61, v125
    v_mfma_f32_16x16x32_bf16 v[64:67], a[172:175], a[64:67], v[64:67]
    s_mov_b32 s57, s49
    ds_read_b64_tr_b16 a[198:199], v9 offset:55296
    buffer_load_dwordx4 v24, s[56:59], 0 offen lds
    v_mfma_f32_16x16x32_bf16 v[64:67], a[176:179], a[68:71], v[64:67]
    s_set_gpr_idx_on s88, 8
    ds_read_b64_tr_b16 a[200:201], v9 offset:57344
    v_cvt_pk_bf16_f32 v140, v52, v53
    v_cvt_pk_bf16_f32 v141, v54, v55
    s_set_gpr_idx_off
    v_mfma_f32_16x16x32_bf16 v[68:71], a[144:147], a[108:111], v[68:71]
L_w3:
    s_cbranch_execz L_w7
    ds_read_b64_tr_b16 a[202:203], v9 offset:59392
    v_mul_f32 v62, v62, v126
    v_mfma_f32_16x16x32_bf16 v[68:71], a[148:151], a[112:115], v[68:71]
    ds_read_b64_tr_b16 a[204:205], v9 offset:61440
    v_mul_f32 v63, v63, v127
    v_mfma_f32_16x16x32_bf16 v[68:71], a[152:155], a[116:119], v[68:71]
    s_set_gpr_idx_on s88, 8
    ds_read_b64_tr_b16 a[206:207], v9 offset:63488
    v_cvt_pk_bf16_f32 v142, v60, v61
    v_cvt_pk_bf16_f32 v143, v62, v63
    s_set_gpr_idx_off
    v_mfma_f32_16x16x32_bf16 v[68:71], a[156:159], a[120:123], v[68:71]
    ds_read_b64_tr_b16 a[208:209], v13 offset:0
    v_mfma_f32_16x16x32_bf16 v[68:71], a[160:163], a[124:127], v[68:71]
    s_add_u32 m0, s82, 4096
    ds_read_b64_tr_b16 a[210:211], v13 offset:2048
    v_fma_f32 v32, -v64, v64, s89
    v_mfma_f32_16x16x32_bf16 v[68:71], a[164:167], a[128:131], v[68:71]
    s_add_u32 s56, s56, s86
    ds_read_b64_tr_b16 a[212:213], v13 offset:4096
    v_fma_f32 v33, -v65, v65, s89
    v_mfma_f32_16x16x32_bf16 v[68:71], a[168:171], a[132:135], v[68:71]
    s_addc_u32 s57, s57, 0
    ds_read_b64_tr_b16 a[214:215], v13 offset:6144
    buffer_load_dwordx4 v24, s[56:59], 0 offen lds
    v_mfma_f32_16x16x32_bf16 v[68:71], a[172:175], a[136:139], v[68:71]
    ds_read_b64_tr_b16 a[144:145], v10 offset:36864
    v_fma_f32 v34, -v66, v66, s89
    v_mfma_f32_16x16x32_bf16 v[68:71], a[176:179], a[140:143], v[68:71]
    s_waitcnt lgkmcnt(5)
    ds_read_b64_tr_b16 a[146:147], v10 offset:38912
    v_fma_f32 v35, -v67, v67, s89
    v_mfma_f32_16x16x32_bf16 v[72:75], a[180:183], a[36:39], v[72:75]
    ds_read_b64_tr_b16 a[148:149], v10 offset:40960
    v_mul_f32 v32, v32, v64
    v_mfma_f32_16x16x32_bf16 v[72:75], a[184:187], a[40:43], v[72:75]
    ds_read_b64_tr_b16 a[150:151], v10 offset:43008
    v_mul_f32 v33, v33, v65
    v_mfma_f32_16x16x32_bf16 v[72:75], a[188:191], a[44:47], v[72:75]
    ds_read_b64_tr_b16 a[152:153], v10 offset:45056
    v_mul_f32 v34, v34, v66
    v_mfma_f32_16x16x32_bf16 v[72:75], a[192:195], a[48:51], v[72:75]
    s_add_u32 m0, s82, 8192
    ds_read_b64_tr_b16 a[154:155], v10 offset:47104
    v_mul_f32 v35, v35, v67
    v_mfma_f32_16x16x32_bf16 v[72:75], a[196:199], a[52:55], v[72:75]
    s_add_u32 s56, s56, s86
    ds_read_b64_tr_b16 a[156:157], v10 offset:49152
    v_exp_f32 v32, v32
    v_mfma_f32_16x16x32_bf16 v[72:75], a[200:203], a[56:59], v[72:75]
    s_addc_u32 s57, s57, 0
    ds_read_b64_tr_b16 a[158:159], v10 offset:51200
    buffer_load_dwordx4 v24, s[56:59], 0 offen lds
    v_mfma_f32_16x16x32_bf16 v[72:75], a[204:207], a[60:63], v[72:75]
    s_waitcnt lgkmcnt(5)
    v_exp_f32 v33, v33
    v_mfma_f32_16x16x32_bf16 v[72:75], a[208:211], a[64:67], v[72:75]
    ds_read_b64_tr_b16 a[160:161], v10 offset:53248
    ds_read_b64_tr_b16 a[162:163], v10 offset:55296
    v_mfma_f32_16x16x32_bf16 v[72:75], a[212:215], a[68:71], v[72:75]
    v_exp_f32 v34, v34
    v_mfma_f32_16x16x32_bf16 v[76:79], a[180:183], a[108:111], v[76:79]
    ds_read_b64_tr_b16 a[164:165], v10 offset:57344
    ds_read_b64_tr_b16 a[166:167], v10 offset:59392
    v_mfma_f32_16x16x32_bf16 v[76:79], a[184:187], a[112:115], v[76:79]
    v_exp_f32 v35, v35
    v_mfma_f32_16x16x32_bf16 v[76:79], a[188:191], a[116:119], v[76:79]
    s_add_u32 m0, s82, 12288
    ds_read_b64_tr_b16 a[168:169], v10 offset:61440
    ds_read_b64_tr_b16 a[170:171], v10 offset:63488
    v_mfma_f32_16x16x32_bf16 v[76:79], a[192:195], a[120:123], v[76:79]
    s_add_u32 s56, s56, s86
    ds_read_b64_tr_b16 a[172:173], v14 offset:0
    v_add_f32 v32, 1.0, v32
    v_mfma_f32_16x16x32_bf16 v[76:79], a[196:199], a[124:127], v[76:79]
    s_addc_u32 s57, s57, 0
    ds_read_b64_tr_b16 a[174:175], v14 offset:2048
    buffer_load_dwordx4 v24, s[56:59], 0 offen lds
    v_mfma_f32_16x16x32_bf16 v[76:79], a[200:203], a[128:131], v[76:79]
    ds_read_b64_tr_b16 a[176:177], v14 offset:4096
    v_add_f32 v33, 1.0, v33
    v_mfma_f32_16x16x32_bf16 v[76:79], a[204:207], a[132:135], v[76:79]
    ds_read_b64_tr_b16 a[178:179], v14 offset:6144
    v_add_f32 v34, 1.0, v34
    v_mfma_f32_16x16x32_bf16 v[76:79], a[208:211], a[136:139], v[76:79]
    ds_read_b64_tr_b16 a[180:181], v11 offset:36864
    v_add_f32 v35, 1.0, v35
    v_mfma_f32_16x16x32_bf16 v[76:79], a[212:215], a[140:143], v[76:79]
    ds_read_b64_tr_b16 a[182:183], v11 offset:38912
    v_rcp_f32 v32, v32
    v_mfma_f32_16x16x32_bf16 v[80:83], a[144:147], a[36:39], v[80:83]
    s_waitcnt lgkmcnt(5)
    v_rcp_f32 v33, v33
    v_mfma_f32_16x16x32_bf16 v[80:83], a[148:151], a[40:43], v[80:83]
    s_add_u32 m0, s82, 16384
    ds_read_b64_tr_b16 a[184:185], v11 offset:40960
    ds_read_b64_tr_b16 a[186:187], v11 offset:43008
    v_mfma_f32_16x16x32_bf16 v[80:83], a[152:155], a[44:47], v[80:83]
    s_add_u32 s56, s56, s86
    ds_read_b64_tr_b16 a[188:189], v11 offset:45056
    v_rcp_f32 v34, v34
    v_mfma_f32_16x16x32_bf16 v[80:83], a[156:159], a[48:51], v[80:83]
    s_addc_u32 s57, s57, 0
    ds_read_b64_tr_b16 a[190:191], v11 offset:47104
    buffer_load_dwordx4 v24, s[56:59], 0 offen lds
    v_mfma_f32_16x16x32_bf16 v[80:83], a[160:163], a[52:55], v[80:83]
    ds_read_b64_tr_b16 a[192:193], v11 offset:49152
    v_rcp_f32 v35, v35
    v_mfma_f32_16x16x32_bf16 v[80:83], a[164:167], a[56:59], v[80:83]
    ds_read_b64_tr_b16 a[194:195], v11 offset:51200
    v_mul_f32 v32, v32, v64
    v_mfma_f32_16x16x32_bf16 v[80:83], a[168:171], a[60:63], v[80:83]
    s_waitcnt lgkmcnt(6)
    ds_read_b64_tr_b16 a[196:197], v11 offset:53248
    v_mul_f32 v33, v33, v65
    v_mfma_f32_16x16x32_bf16 v[80:83], a[172:175], a[64:67], v[80:83]
    ds_read_b64_tr_b16 a[198:199], v11 offset:55296
    v_mul_f32 v34, v34, v66
    v_mfma_f32_16x16x32_bf16 v[80:83], a[176:179], a[68:71], v[80:83]
    ds_read_b64_tr_b16 a[200:201], v11 offset:57344
    v_mul_f32 v35, v35, v67
    v_mfma_f32_16x16x32_bf16 v[84:87], a[144:147], a[108:111], v[84:87]
    s_add_u32 m0, s82, 20480
    ds_read_b64_tr_b16 a[202:203], v11 offset:59392
    v_fma_f32 v36, -v68, v68, s89
    v_mfma_f32_16x16x32_bf16 v[84:87], a[148:151], a[112:115], v[84:87]
    s_add_u32 s56, s56, s86
    ds_read_b64_tr_b16 a[204:205], v11 offset:61440
    v_fma_f32 v37, -v69, v69, s89
    v_mfma_f32_16x16x32_bf16 v[84:87], a[152:155], a[116:119], v[84:87]
    s_addc_u32 s57, s57, 0
    ds_read_b64_tr_b16 a[206:207], v11 offset:63488
    buffer_load_dwordx4 v24, s[56:59], 0 offen lds
    v_mfma_f32_16x16x32_bf16 v[84:87], a[156:159], a[120:123], v[84:87]
    s_add_u32 s88, s88, 16
    ds_read_b64_tr_b16 a[208:209], v15 offset:0
    v_fma_f32 v38, -v70, v70, s89
    v_mfma_f32_16x16x32_bf16 v[84:87], a[160:163], a[124:127], v[84:87]
    s_and_b32 s88, s88, 127
    ds_read_b64_tr_b16 a[210:211], v15 offset:2048
    v_fma_f32 v39, -v71, v71, s89
    v_mfma_f32_16x16x32_bf16 v[84:87], a[164:167], a[128:131], v[84:87]
    s_add_u32 s87, s87, 1
    ds_read_b64_tr_b16 a[212:213], v15 offset:4096
    v_mul_f32 v36, v36, v68
    v_mfma_f32_16x16x32_bf16 v[84:87], a[168:171], a[132:135], v[84:87]
    ds_read_b64_tr_b16 a[214:215], v15 offset:6144
    v_mul_f32 v37, v37, v69
    v_mfma_f32_16x16x32_bf16 v[84:87], a[172:175], a[136:139], v[84:87]
    s_waitcnt vmcnt(16) lgkmcnt(6)
    s_barrier
    ds_read_b64_tr_b16 a[144:145], v12 offset:8192
    v_mfma_f32_16x16x32_bf16 v[84:87], a[176:179], a[140:143], v[84:87]
    s_add_u32 m0, s82, 24576
    ds_read_b64_tr_b16 a[146:147], v12 offset:10240
    v_mul_f32 v38, v38, v70
    v_mfma_f32_16x16x32_bf16 v[88:91], a[180:183], a[36:39], v[88:91]
    s_add_u32 s56, s56, s86
    ds_read_b64_tr_b16 a[148:149], v12 offset:12288
    v_mul_f32 v39, v39, v71
    v_mfma_f32_16x16x32_bf16 v[88:91], a[184:187], a[40:43], v[88:91]
    s_addc_u32 s57, s57, 0
    ds_read_b64_tr_b16 a[150:151], v12 offset:14336
    buffer_load_dwordx4 v24, s[56:59], 0 offen lds
    v_mfma_f32_16x16x32_bf16 v[88:91], a[188:191], a[44:47], v[88:91]
    s_add_u32 s48, s48, 128
    ds_read_b64_tr_b16 a[152:153], v12 offset:16384
    v_exp_f32 v36, v36
    v_mfma_f32_16x16x32_bf16 v[88:91], a[192:195], a[48:51], v[88:91]
    s_addc_u32 s49, s49, 0
    ds_read_b64_tr_b16 a[154:155], v12 offset:18432
    v_exp_f32 v37, v37
    v_mfma_f32_16x16x32_bf16 v[88:91], a[196:199], a[52:55], v[88:91]
    s_cmp_eq_u32 s87, 6
    ds_read_b64_tr_b16 a[156:157], v12 offset:20480
    v_exp_f32 v38, v38
    v_mfma_f32_16x16x32_bf16 v[88:91], a[200:203], a[56:59], v[88:91]
    s_waitcnt lgkmcnt(5)
    s_cselect_b32 s97, s93, 1073741824
    ds_read_b64_tr_b16 a[158:159], v12 offset:22528
    v_exp_f32 v39, v39
    v_mfma_f32_16x16x32_bf16 v[88:91], a[204:207], a[60:63], v[88:91]
    ds_read_b64_tr_b16 a[160:161], v12 offset:24576
    v_add_f32 v36, 1.0, v36
    v_mfma_f32_16x16x32_bf16 v[88:91], a[208:211], a[64:67], v[88:91]
    s_add_u32 m0, s82, 28672
    ds_read_b64_tr_b16 a[162:163], v12 offset:26624
    v_add_f32 v37, 1.0, v37
    v_mfma_f32_16x16x32_bf16 v[88:91], a[212:215], a[68:71], v[88:91]
    s_add_u32 s56, s56, s86
    ds_read_b64_tr_b16 a[164:165], v12 offset:28672
    v_add_f32 v38, 1.0, v38
    v_mfma_f32_16x16x32_bf16 v[92:95], a[180:183], a[108:111], v[92:95]
    s_addc_u32 s57, s57, 0
    ds_read_b64_tr_b16 a[166:167], v12 offset:30720
    buffer_load_dwordx4 v24, s[56:59], 0 offen lds
    v_mfma_f32_16x16x32_bf16 v[92:95], a[184:187], a[112:115], v[92:95]
    ds_read_b64_tr_b16 a[168:169], v12 offset:32768
    v_add_f32 v39, 1.0, v39
    v_mfma_f32_16x16x32_bf16 v[92:95], a[188:191], a[116:119], v[92:95]
    ds_read_b64_tr_b16 a[170:171], v12 offset:34816
    v_rcp_f32 v36, v36
    v_mfma_f32_16x16x32_bf16 v[92:95], a[192:195], a[120:123], v[92:95]
    ds_read_b64_tr_b16 a[172:173], v12 offset:36864
    v_rcp_f32 v37, v37
    v_mfma_f32_16x16x32_bf16 v[92:95], a[196:199], a[124:127], v[92:95]
    v_rcp_f32 v38, v38
    v_mfma_f32_16x16x32_bf16 v[92:95], a[200:203], a[128:131], v[92:95]
    ds_read_b64_tr_b16 a[174:175], v12 offset:38912
    ds_read_b64_tr_b16 a[176:177], v12 offset:40960
    v_mfma_f32_16x16x32_bf16 v[92:95], a[204:207], a[132:135], v[92:95]
    s_add_u32 m0, s82, 32768
    ds_read_b64_tr_b16 a[178:179], v12 offset:43008
    v_rcp_f32 v39, v39
    v_mfma_f32_16x16x32_bf16 v[92:95], a[208:211], a[136:139], v[92:95]
    s_add_u32 s56, s56, s86
    ds_read_b64_tr_b16 a[180:181], v13 offset:8192
    v_mul_f32 v36, v36, v68
    v_mfma_f32_16x16x32_bf16 v[92:95], a[212:215], a[140:143], v[92:95]
    s_addc_u32 s57, s57, 0
    ds_read_b64_tr_b16 a[182:183], v13 offset:10240
    buffer_load_dwordx4 v24, s[56:59], 0 offen lds
    s_branch L_amid
L_aexit:
    s_cmp_eq_u32 s87, 7
L_w4:
    s_cbranch_execz L_w8
    s_cbranch_scc0 L_bstart
    v_readfirstlane_b32 s90, v26
    s_mov_b32 s91, 0
    s_cmp_ge_u32 s90, 8
    s_cbranch_scc1 L_hready
L_hspin:
    buffer_load_dword v26, off, s[32:35], s93 sc1
    s_add_u32 s91, s91, 1
    s_waitcnt vmcnt(0)
    v_readfirstlane_b32 s90, v26
    s_cmp_gt_u32 s91, 0x100000
    s_cbranch_scc1 L_end
    s_cmp_ge_u32 s90, 8
    s_cbranch_scc0 L_hspin
L_hready:
    s_lshl_b32 s90, s77, 3
    s_add_u32 s90, s90, s78
    s_lshl_b32 s91, s90, 2
    s_add_u32 s91, s91, s76
    s_lshl_b32 s91, s91, 12
    s_add_u32 s91, s91, 524288
    buffer_load_dwordx4 a[216:219], v6, s[24:27], s91 offen offset:0 sc1
    s_mov_b32 s68, 36864
    s_mov_b32 s69, 35840
    s_lshl_b32 s84, s78, 7
    s_add_u32 s48, s20, s84
    s_addc_u32 s49, s21, 0
    s_add_u32 s84, s84, 128
    s_and_b32 s84, s84, 1023
    s_add_u32 s50, s20, s84
    s_addc_u32 s51, s21, 0
    v_lshrrev_b32 v2, 3, v1
    s_lshl_b32 s85, s76, 3
    buffer_load_dwordx4 a[220:223], v6, s[24:27], s91 offen offset:1024 sc1
    v_add_u32 v2, s85, v2
    v_mul_u32_u24 v2, 1152, v2
    v_add_u32 v28, v2, v21
    v_lshlrev_b32 v2, 9, v1
    v_mov_b32 v3, 1073741824
    v_cmp_gt_u32 vcc, 8, v1
    v_lshlrev_b32 v4, 3, v1
    s_mul_i32 s92, s77, 1179648
    v_cndmask_b32 v2, v3, v2, vcc
    s_lshl_b32 s85, s76, 12
    s_add_u32 s92, s92, s85
    buffer_load_dwordx4 a[224:227], v6, s[24:27], s91 offen offset:2048 sc1
    s_add_u32 s92, s92, 6291456
    s_lshl_b32 s98, s78, 9
    s_add_u32 s98, s92, s98
    s_mul_i32 s85, s78, 147456
    s_add_u32 s92, s92, s85
    s_lshl_b32 s93, s77, 12
    s_lshl_b32 s85, s76, 7
    s_add_u32 s93, s93, s85
    s_lshl_b32 s85, s78, 2
    s_add_u32 s93, s93, s85
    s_add_u32 s93, s93, 262176
    buffer_load_dwordx4 a[228:231], v6, s[24:27], s91 offen offset:3072 sc1
    s_branch L_aloop
L_bstart:
    s_mov_b32 s87, 0
    s_mov_b32 s99, 1073741824
    v_mfma_f32_16x16x32_bf16 v[64:67], a[144:147], a[216:219], 0
    s_waitcnt lgkmcnt(5)
L_w5:
    s_cbranch_execz L_w9
    ds_read_b64_tr_b16 a[184:185], v9 offset:4096
    v_rcp_f32 v58, v58
    v_mfma_f32_16x16x32_bf16 v[64:67], a[148:151], a[224:227], v[64:67]
    ds_read_b64_tr_b16 a[186:187], v9 offset:6144
    v_rcp_f32 v59, v59
    v_mfma_f32_16x16x32_bf16 v[64:67], a[152:155], v[128:131], v[64:67]
    ds_read_b64_tr_b16 a[188:189], v9 offset:8192
    v_mul_f32 v56, v56, v88
    v_mfma_f32_16x16x32_bf16 v[64:67], a[156:159], v[136:139], v[64:67]
    ds_read_b64_tr_b16 a[190:191], v9 offset:10240
    v_mul_f32 v57, v57, v89
    v_mfma_f32_16x16x32_bf16 v[64:67], a[160:163], v[144:147], v[64:67]
    s_waitcnt lgkmcnt(5)
    ds_read_b64_tr_b16 a[192:193], v9 offset:12288
    v_mul_f32 v58, v58, v90
    v_mfma_f32_16x16x32_bf16 v[64:67], a[164:167], v[152:155], v[64:67]
    s_add_u32 m0, s82, 110592
    ds_read_b64_tr_b16 a[194:195], v9 offset:14336
    v_mul_f32 v59, v59, v91
    v_mfma_f32_16x16x32_bf16 v[64:67], a[168:171], v[160:163], v[64:67]
    s_add_u32 s56, s56, s86
    ds_read_b64_tr_b16 a[196:197], v9 offset:16384
    v_fma_f32 v60, -v92, v92, s89
    v_mfma_f32_16x16x32_bf16 v[64:67], a[172:175], v[168:171], v[64:67]
    s_addc_u32 s57, s57, 0
    ds_read_b64_tr_b16 a[198:199], v9 offset:18432
    buffer_load_dwordx4 v24, s[56:59], 0 offen lds
    v_mfma_f32_16x16x32_bf16 v[64:67], a[176:179], v[176:179], v[64:67]
    ds_read_b64_tr_b16 a[200:201], v9 offset:20480
    v_fma_f32 v61, -v93, v93, s89
    v_mfma_f32_16x16x32_bf16 v[68:71], a[144:147], a[220:223], 0
    ds_read_b64_tr_b16 a[202:203], v9 offset:22528
    v_fma_f32 v62, -v94, v94, s89
    v_mfma_f32_16x16x32_bf16 v[68:71], a[148:151], a[228:231], v[68:71]
    ds_read_b64_tr_b16 a[204:205], v9 offset:24576
    v_fma_f32 v63, -v95, v95, s89
    v_mfma_f32_16x16x32_bf16 v[68:71], a[152:155], v[132:135], v[68:71]
    ds_read_b64_tr_b16 a[206:207], v9 offset:26624
    v_mul_f32 v60, v60, v92
    v_mfma_f32_16x16x32_bf16 v[68:71], a[156:159], v[140:143], v[68:71]
    ds_read_b64_tr_b16 a[208:209], v9 offset:28672
    v_mul_f32 v61, v61, v93
    v_mfma_f32_16x16x32_bf16 v[68:71], a[160:163], v[148:151], v[68:71]
    s_add_u32 m0, s82, 114688
    ds_read_b64_tr_b16 a[210:211], v9 offset:30720
    v_mul_f32 v62, v62, v94
    v_mfma_f32_16x16x32_bf16 v[68:71], a[164:167], v[156:159], v[68:71]
    s_add_u32 s56, s56, s86
    ds_read_b64_tr_b16 a[212:213], v9 offset:32768
    v_mul_f32 v63, v63, v95
    v_mfma_f32_16x16x32_bf16 v[68:71], a[168:171], v[164:167], v[68:71]
    s_addc_u32 s57, s57, 0
    ds_read_b64_tr_b16 a[214:215], v9 offset:34816
    buffer_load_dwordx4 v24, s[56:59], 0 offen lds
    v_mfma_f32_16x16x32_bf16 v[68:71], a[172:175], v[172:175], v[68:71]
    ds_read_b64_tr_b16 a[144:145], v10 offset:0
    v_exp_f32 v60, v60
    v_mfma_f32_16x16x32_bf16 v[68:71], a[176:179], v[180:183], v[68:71]
    s_waitcnt lgkmcnt(5)
    ds_read_b64_tr_b16 a[146:147], v10 offset:2048
    v_exp_f32 v61, v61
    v_mfma_f32_16x16x32_bf16 v[72:75], a[180:183], a[216:219], 0
    ds_read_b64_tr_b16 a[148:149], v10 offset:4096
    v_exp_f32 v62, v62
    v_mfma_f32_16x16x32_bf16 v[72:75], a[184:187], a[224:227], v[72:75]
    ds_read_b64_tr_b16 a[150:151], v10 offset:6144
    v_exp_f32 v63, v63
    v_mfma_f32_16x16x32_bf16 v[72:75], a[188:191], v[128:131], v[72:75]
    s_waitcnt lgkmcnt(5)
    ds_read_b64_tr_b16 a[152:153], v10 offset:8192
    v_add_f32 v60, 1.0, v60
    v_mfma_f32_16x16x32_bf16 v[72:75], a[192:195], v[136:139], v[72:75]
    s_add_u32 m0, s82, 118784
    ds_read_b64_tr_b16 a[154:155], v10 offset:10240
    v_add_f32 v61, 1.0, v61
    v_mfma_f32_16x16x32_bf16 v[72:75], a[196:199], v[144:147], v[72:75]
    s_add_u32 s56, s56, s86
    ds_read_b64_tr_b16 a[156:157], v10 offset:12288
    v_add_f32 v62, 1.0, v62
    v_mfma_f32_16x16x32_bf16 v[72:75], a[200:203], v[152:155], v[72:75]
    s_addc_u32 s57, s57, 0
    ds_read_b64_tr_b16 a[158:159], v10 offset:14336
    buffer_load_dwordx4 v24, s[56:59], 0 offen lds
    v_mfma_f32_16x16x32_bf16 v[72:75], a[204:207], v[160:163], v[72:75]
    s_add_u32 s90, s87, s78
    ds_read_b64_tr_b16 a[160:161], v10 offset:16384
    v_add_f32 v63, 1.0, v63
    v_mfma_f32_16x16x32_bf16 v[72:75], a[208:211], v[168:171], v[72:75]
    s_waitcnt lgkmcnt(5)
    s_and_b32 s91, s90, 7
    ds_read_b64_tr_b16 a[162:163], v10 offset:18432
    v_rcp_f32 v60, v60
    v_mfma_f32_16x16x32_bf16 v[72:75], a[212:215], v[176:179], v[72:75]
    s_add_u32 s90, s90, 2
    ds_read_b64_tr_b16 a[164:165], v10 offset:20480
    v_rcp_f32 v61, v61
    v_mfma_f32_16x16x32_bf16 v[76:79], a[180:183], a[220:223], 0
    s_and_b32 s90, s90, 7
    ds_read_b64_tr_b16 a[166:167], v10 offset:22528
    v_rcp_f32 v62, v62
    v_mfma_f32_16x16x32_bf16 v[76:79], a[184:187], a[228:231], v[76:79]
    s_waitcnt lgkmcnt(5)
    ds_read_b64_tr_b16 a[168:169], v10 offset:24576
    v_rcp_f32 v63, v63
    v_mfma_f32_16x16x32_bf16 v[76:79], a[188:191], v[132:135], v[76:79]
    s_add_u32 m0, s82, 122880
    ds_read_b64_tr_b16 a[170:171], v10 offset:26624
    v_mul_f32 v60, v60, v92
    v_mfma_f32_16x16x32_bf16 v[76:79], a[192:195], v[140:143], v[76:79]
    s_add_u32 s56, s56, s86
    ds_read_b64_tr_b16 a[172:173], v10 offset:28672
    v_mul_f32 v61, v61, v93
    v_mfma_f32_16x16x32_bf16 v[76:79], a[196:199], v[148:151], v[76:79]
    s_addc_u32 s57, s57, 0
    ds_read_b64_tr_b16 a[174:175], v10 offset:30720
    buffer_load_dwordx4 v24, s[56:59], 0 offen lds
    v_mul_f32 v62, v62, v94
    v_mfma_f32_16x16x32_bf16 v[76:79], a[200:203], v[156:159], v[76:79]
    s_cmp_lt_u32 s87, 6
    ds_read_b64_tr_b16 a[176:177], v10 offset:32768
    v_mul_f32 v63, v63, v95
    v_mfma_f32_16x16x32_bf16 v[76:79], a[204:207], v[164:167], v[76:79]
    s_cselect_b32 s90, s90, 8
    ds_read_b64_tr_b16 a[178:179], v10 offset:34816
    v_mul_f32 v32, v32, v96
    v_mfma_f32_16x16x32_bf16 v[76:79], a[208:211], v[172:175], v[76:79]
    s_lshl_b32 s84, s90, 7
    ds_read_b64_tr_b16 a[180:181], v11 offset:0
    v_mul_f32 v33, v33, v97
    v_mfma_f32_16x16x32_bf16 v[76:79], a[212:215], v[180:183], v[76:79]
    s_cmp_lt_u32 s87, 7
    ds_read_b64_tr_b16 a[182:183], v11 offset:2048
    v_mul_f32 v34, v34, v98
    v_mfma_f32_16x16x32_bf16 v[80:83], a[144:147], a[216:219], 0
    s_cselect_b32 s69, s69, 0
    ds_read_b64_tr_b16 a[184:185], v11 offset:4096
    v_mul_f32 v35, v35, v99
    v_mfma_f32_16x16x32_bf16 v[80:83], a[148:151], a[224:227], v[80:83]
    s_add_u32 m0, s82, 126976
    ds_read_b64_tr_b16 a[186:187], v11 offset:6144
    v_cvt_pk_bf16_f32 v240, v32, v33
    v_mfma_f32_16x16x32_bf16 v[80:83], a[152:155], v[128:131], v[80:83]
    s_waitcnt lgkmcnt(5)
    s_add_u32 s56, s56, s86
    ds_read_b64_tr_b16 a[188:189], v11 offset:8192
    v_cvt_pk_bf16_f32 v241, v34, v35
    v_mfma_f32_16x16x32_bf16 v[80:83], a[156:159], v[136:139], v[80:83]
    s_addc_u32 s57, s57, 0
    ds_read_b64_tr_b16 a[190:191], v11 offset:10240
    buffer_load_dwordx4 v24, s[56:59], 0 offen lds
    v_mul_f32 v40, v40, v104
    v_mfma_f32_16x16x32_bf16 v[80:83], a[160:163], v[144:147], v[80:83]
    s_lshl_b32 s94, s91, 14
    ds_read_b64_tr_b16 a[192:193], v11 offset:12288
    v_mul_f32 v41, v41, v105
    v_mfma_f32_16x16x32_bf16 v[80:83], a[164:167], v[152:155], v[80:83]
    s_add_u32 s94, s94, s92
    ds_read_b64_tr_b16 a[194:195], v11 offset:14336
    v_mul_f32 v42, v42, v106
    v_mfma_f32_16x16x32_bf16 v[80:83], a[168:171], v[160:163], v[80:83]
    s_mov_b32 s95, s99
    ds_read_b64_tr_b16 a[196:197], v11 offset:16384
    v_mul_f32 v43, v43, v107
    v_mfma_f32_16x16x32_bf16 v[80:83], a[172:175], v[168:171], v[80:83]
    s_waitcnt lgkmcnt(5)
    s_lshl_b32 s99, s91, 9
    ds_read_b64_tr_b16 a[198:199], v11 offset:18432
    v_cvt_pk_bf16_f32 v242, v40, v41
    v_mfma_f32_16x16x32_bf16 v[80:83], a[176:179], v[176:179], v[80:83]
    s_add_u32 s99, s99, s93
    ds_read_b64_tr_b16 a[200:201], v11 offset:20480
    v_cvt_pk_bf16_f32 v243, v42, v43
    v_mfma_f32_16x16x32_bf16 v[84:87], a[144:147], a[220:223], 0
    s_add_u32 m0, s82, 131072
    ds_read_b64_tr_b16 a[202:203], v11 offset:22528
    v_mul_f32 v48, v48, v112
    v_mfma_f32_16x16x32_bf16 v[84:87], a[148:151], a[228:231], v[84:87]
    s_add_u32 s56, s56, s86
    ds_read_b64_tr_b16 a[204:205], v11 offset:24576
    v_mul_f32 v49, v49, v113
    v_mfma_f32_16x16x32_bf16 v[84:87], a[152:155], v[132:135], v[84:87]
    s_addc_u32 s57, s57, 0
    ds_read_b64_tr_b16 a[206:207], v11 offset:26624
    buffer_load_dwordx4 v24, s[56:59], 0 offen lds
    v_mfma_f32_16x16x32_bf16 v[84:87], a[156:159], v[140:143], v[84:87]
    s_add_u32 s87, s87, 1
    ds_read_b64_tr_b16 a[208:209], v11 offset:28672
    v_mul_f32 v50, v50, v114
    v_mfma_f32_16x16x32_bf16 v[84:87], a[160:163], v[148:151], v[84:87]
    ds_read_b64_tr_b16 a[210:211], v11 offset:30720
    v_mul_f32 v51, v51, v115
    v_mfma_f32_16x16x32_bf16 v[84:87], a[164:167], v[156:159], v[84:87]
    ds_read_b64_tr_b16 a[212:213], v11 offset:32768
    v_cvt_pk_bf16_f32 v248, v48, v49
    v_mfma_f32_16x16x32_bf16 v[84:87], a[168:171], v[164:167], v[84:87]
    ds_read_b64_tr_b16 a[214:215], v11 offset:34816
    v_cvt_pk_bf16_f32 v249, v50, v51
    v_mfma_f32_16x16x32_bf16 v[84:87], a[172:175], v[172:175], v[84:87]
    s_waitcnt vmcnt(15) lgkmcnt(6)
    s_barrier
    ds_read_b64_tr_b16 a[144:145], v8 offset:36864
    v_mfma_f32_16x16x32_bf16 v[84:87], a[176:179], v[180:183], v[84:87]
    s_add_u32 m0, s82, 135168
    ds_read_b64_tr_b16 a[146:147], v8 offset:38912
    v_mul_f32 v56, v56, v120
    v_mul_f32 v57, v57, v121
    v_mfma_f32_16x16x32_bf16 v[88:91], a[180:183], a[216:219], 0
    s_add_u32 s56, s56, s86
    ds_read_b64_tr_b16 a[148:149], v8 offset:40960
    v_mul_f32 v58, v58, v122
    v_mfma_f32_16x16x32_bf16 v[88:91], a[184:187], a[224:227], v[88:91]
    s_addc_u32 s57, s57, 0
    ds_read_b64_tr_b16 a[150:151], v8 offset:43008
    buffer_load_dwordx4 v24, s[56:59], 0 offen lds
    v_mul_f32 v59, v59, v123
    v_mfma_f32_16x16x32_bf16 v[88:91], a[188:191], v[128:131], v[88:91]
    ds_read_b64_tr_b16 a[152:153], v8 offset:45056
    v_cvt_pk_bf16_f32 v250, v56, v57
    v_mfma_f32_16x16x32_bf16 v[88:91], a[192:195], v[136:139], v[88:91]
    ds_read_b64_tr_b16 a[154:155], v8 offset:47104
    v_cvt_pk_bf16_f32 v251, v58, v59
    v_mfma_f32_16x16x32_bf16 v[88:91], a[196:199], v[144:147], v[88:91]
    ds_read_b64_tr_b16 a[156:157], v8 offset:49152
    v_mul_f32 v36, v36, v100
    v_mfma_f32_16x16x32_bf16 v[88:91], a[200:203], v[152:155], v[88:91]
    s_waitcnt lgkmcnt(5)
    ds_read_b64_tr_b16 a[158:159], v8 offset:51200
    v_mul_f32 v37, v37, v101
    v_mfma_f32_16x16x32_bf16 v[88:91], a[204:207], v[160:163], v[88:91]
    ds_read_b64_tr_b16 a[160:161], v8 offset:53248
    v_mul_f32 v38, v38, v102
    v_mfma_f32_16x16x32_bf16 v[88:91], a[208:211], v[168:171], v[88:91]
    s_add_u32 m0, s82, 139264
    ds_read_b64_tr_b16 a[162:163], v8 offset:55296
    v_mul_f32 v39, v39, v103
    v_mfma_f32_16x16x32_bf16 v[88:91], a[212:215], v[176:179], v[88:91]
    s_add_u32 s56, s56, s86
    ds_read_b64_tr_b16 a[164:165], v8 offset:57344
    v_cvt_pk_bf16_f32 v244, v36, v37
    v_mfma_f32_16x16x32_bf16 v[92:95], a[180:183], a[220:223], 0
    s_addc_u32 s57, s57, 0
    ds_read_b64_tr_b16 a[166:167], v8 offset:59392
    buffer_load_dwordx4 v24, s[56:59], 0 offen lds
    v_mfma_f32_16x16x32_bf16 v[92:95], a[184:187], a[228:231], v[92:95]
    ds_read_b64_tr_b16 a[168:169], v8 offset:61440
    v_cvt_pk_bf16_f32 v245, v38, v39
    v_mfma_f32_16x16x32_bf16 v[92:95], a[188:191], v[132:135], v[92:95]
    ds_read_b64_tr_b16 a[170:171], v8 offset:63488
    v_mul_f32 v44, v44, v108
    v_mfma_f32_16x16x32_bf16 v[92:95], a[192:195], v[140:143], v[92:95]
    s_waitcnt vmcnt(63)
    ds_read_b64_tr_b16 a[172:173], v12 offset:0
    buffer_store_dword v27, v7, s[24:27], s95 offen sc1
    v_mul_f32 v45, v45, v109
    v_mfma_f32_16x16x32_bf16 v[92:95], a[196:199], v[148:151], v[92:95]
    ds_read_b64_tr_b16 a[174:175], v12 offset:2048
    v_mul_f32 v46, v46, v110
    v_mfma_f32_16x16x32_bf16 v[92:95], a[200:203], v[156:159], v[92:95]
    ds_read_b64_tr_b16 a[176:177], v12 offset:4096
    v_mul_f32 v47, v47, v111
    v_mfma_f32_16x16x32_bf16 v[92:95], a[204:207], v[164:167], v[92:95]
    s_add_u32 m0, s82, 143360
    ds_read_b64_tr_b16 a[178:179], v12 offset:6144
    v_cvt_pk_bf16_f32 v246, v44, v45
    v_mfma_f32_16x16x32_bf16 v[92:95], a[208:211], v[172:175], v[92:95]
    s_add_u32 s56, s56, s86
    ds_read_b64_tr_b16 a[180:181], v9 offset:36864
    v_cvt_pk_bf16_f32 v247, v46, v47
    v_mfma_f32_16x16x32_bf16 v[92:95], a[212:215], v[180:183], v[92:95]
    s_addc_u32 s57, s57, 0
    ds_read_b64_tr_b16 a[182:183], v9 offset:38912
    buffer_load_dwordx4 v24, s[56:59], 0 offen lds
    v_mul_f32 v52, v52, v116
    v_mfma_f32_16x16x32_bf16 v[64:67], a[144:147], v[184:187], v[64:67]
    s_waitcnt lgkmcnt(5)
    ds_read_b64_tr_b16 a[184:185], v9 offset:40960
    v_mul_f32 v53, v53, v117
    v_mfma_f32_16x16x32_bf16 v[64:67], a[148:151], v[192:195], v[64:67]
    ds_read_b64_tr_b16 a[186:187], v9 offset:43008
    v_mul_f32 v54, v54, v118
    v_mfma_f32_16x16x32_bf16 v[64:67], a[152:155], v[200:203], v[64:67]
    ds_read_b64_tr_b16 a[188:189], v9 offset:45056
    v_mul_f32 v55, v55, v119
    v_mfma_f32_16x16x32_bf16 v[64:67], a[156:159], v[208:211], v[64:67]
    s_waitcnt lgkmcnt(5)
    ds_read_b64_tr_b16 a[190:191], v9 offset:47104
    v_cvt_pk_bf16_f32 v252, v52, v53
    v_mfma_f32_16x16x32_bf16 v[64:67], a[160:163], v[216:219], v[64:67]
    s_add_u32 m0, s82, 0
    ds_read_b64_tr_b16 a[192:193], v9 offset:49152
    v_cvt_pk_bf16_f32 v253, v54, v55
    v_mfma_f32_16x16x32_bf16 v[64:67], a[164:167], v[224:227], v[64:67]
    s_mov_b32 s58, s69
    ds_read_b64_tr_b16 a[194:195], v9 offset:51200
    v_mul_f32 v60, v60, v124
    v_mfma_f32_16x16x32_bf16 v[64:67], a[168:171], v[232:235], v[64:67]
    s_add_u32 s56, s20, s84
    ds_read_b64_tr_b16 a[196:197], v9 offset:53248
    v_mul_f32 v61, v61, v125
    v_mfma_f32_16x16x32_bf16 v[64:67], a[172:175], v[240:243], v[64:67]
    s_addc_u32 s57, s21, 0
    ds_read_b64_tr_b16 a[198:199], v9 offset:55296
    buffer_load_dwordx4 v24, s[56:59], 0 offen lds
    v_mul_f32 v62, v62, v126
    v_mfma_f32_16x16x32_bf16 v[64:67], a[176:179], v[248:251], v[64:67]
    ds_read_b64_tr_b16 a[200:201], v9 offset:57344
    v_mul_f32 v63, v63, v127
    v_mfma_f32_16x16x32_bf16 v[68:71], a[144:147], v[188:191], v[68:71]
    ds_read_b64_tr_b16 a[202:203], v9 offset:59392
    v_cvt_pk_bf16_f32 v254, v60, v61
    v_mfma_f32_16x16x32_bf16 v[68:71], a[148:151], v[196:199], v[68:71]
    ds_read_b64_tr_b16 a[204:205], v9 offset:61440
    v_cvt_pk_bf16_f32 v255, v62, v63
    v_mfma_f32_16x16x32_bf16 v[68:71], a[152:155], v[204:207], v[68:71]
    ds_read_b64_tr_b16 a[206:207], v9 offset:63488
    v_mfma_f32_16x16x32_bf16 v[68:71], a[156:159], v[212:215], v[68:71]
    ds_read_b64_tr_b16 a[208:209], v13 offset:0
    v_mfma_f32_16x16x32_bf16 v[68:71], a[160:163], v[220:223], v[68:71]
    s_add_u32 m0, s82, 4096
    ds_read_b64_tr_b16 a[210:211], v13 offset:2048
    v_mfma_f32_16x16x32_bf16 v[68:71], a[164:167], v[228:231], v[68:71]
    s_add_u32 s56, s56, s86
    ds_read_b64_tr_b16 a[212:213], v13 offset:4096
    v_mfma_f32_16x16x32_bf16 v[68:71], a[168:171], v[236:239], v[68:71]
    s_addc_u32 s57, s57, 0
    ds_read_b64_tr_b16 a[214:215], v13 offset:6144
    buffer_load_dwordx4 v24, s[56:59], 0 offen lds
    v_mfma_f32_16x16x32_bf16 v[68:71], a[172:175], v[244:247], v[68:71]
    ds_read_b64_tr_b16 a[144:145], v10 offset:36864
    v_cvt_pk_bf16_f32 v96, v64, v65
    v_mfma_f32_16x16x32_bf16 v[68:71], a[176:179], v[252:255], v[68:71]
    s_waitcnt lgkmcnt(5)
    ds_read_b64_tr_b16 a[146:147], v10 offset:38912
    v_cvt_pk_bf16_f32 v97, v66, v67
    v_mfma_f32_16x16x32_bf16 v[72:75], a[180:183], v[184:187], v[72:75]
    ds_read_b64_tr_b16 a[148:149], v10 offset:40960
    v_mfma_f32_16x16x32_bf16 v[72:75], a[184:187], v[192:195], v[72:75]
L_w6:
    s_cbranch_execz L_wb
    ds_read_b64_tr_b16 a[150:151], v10 offset:43008
    v_mfma_f32_16x16x32_bf16 v[72:75], a[188:191], v[200:203], v[72:75]
    ds_read_b64_tr_b16 a[152:153], v10 offset:45056
    v_mfma_f32_16x16x32_bf16 v[72:75], a[192:195], v[208:211], v[72:75]
    s_add_u32 m0, s82, 8192
    ds_read_b64_tr_b16 a[154:155], v10 offset:47104
    v_mfma_f32_16x16x32_bf16 v[72:75], a[196:199], v[216:219], v[72:75]
    s_add_u32 s56, s56, s86
    ds_read_b64_tr_b16 a[156:157], v10 offset:49152
    v_mfma_f32_16x16x32_bf16 v[72:75], a[200:203], v[224:227], v[72:75]
    s_addc_u32 s57, s57, 0
    ds_read_b64_tr_b16 a[158:159], v10 offset:51200
    buffer_load_dwordx4 v24, s[56:59], 0 offen lds
    v_mfma_f32_16x16x32_bf16 v[72:75], a[204:207], v[232:235], v[72:75]
    s_waitcnt lgkmcnt(5)
    ds_read_b64_tr_b16 a[160:161], v10 offset:53248
    v_mfma_f32_16x16x32_bf16 v[72:75], a[208:211], v[240:243], v[72:75]
    ds_read_b64_tr_b16 a[162:163], v10 offset:55296
    v_cvt_pk_bf16_f32 v100, v68, v69
    v_mfma_f32_16x16x32_bf16 v[72:75], a[212:215], v[248:251], v[72:75]
    ds_read_b64_tr_b16 a[164:165], v10 offset:57344
    v_cvt_pk_bf16_f32 v101, v70, v71
    v_mfma_f32_16x16x32_bf16 v[76:79], a[180:183], v[188:191], v[76:79]
    ds_read_b64_tr_b16 a[166:167], v10 offset:59392
    v_mfma_f32_16x16x32_bf16 v[76:79], a[184:187], v[196:199], v[76:79]
    ds_read_b64_tr_b16 a[168:169], v10 offset:61440
    v_mfma_f32_16x16x32_bf16 v[76:79], a[188:191], v[204:207], v[76:79]
    s_add_u32 m0, s82, 12288
    ds_read_b64_tr_b16 a[170:171], v10 offset:63488
    v_mfma_f32_16x16x32_bf16 v[76:79], a[192:195], v[212:215], v[76:79]
    s_add_u32 s56, s56, s86
    ds_read_b64_tr_b16 a[172:173], v14 offset:0
    v_mfma_f32_16x16x32_bf16 v[76:79], a[196:199], v[220:223], v[76:79]
    s_addc_u32 s57, s57, 0
    ds_read_b64_tr_b16 a[174:175], v14 offset:2048
    buffer_load_dwordx4 v24, s[56:59], 0 offen lds
    v_mfma_f32_16x16x32_bf16 v[76:79], a[200:203], v[228:231], v[76:79]
    ds_read_b64_tr_b16 a[176:177], v14 offset:4096
    v_mfma_f32_16x16x32_bf16 v[76:79], a[204:207], v[236:239], v[76:79]
    ds_read_b64_tr_b16 a[178:179], v14 offset:6144
    v_mfma_f32_16x16x32_bf16 v[76:79], a[208:211], v[244:247], v[76:79]
    ds_read_b64_tr_b16 a[180:181], v11 offset:36864
    v_cvt_pk_bf16_f32 v98, v72, v73
    v_mfma_f32_16x16x32_bf16 v[76:79], a[212:215], v[252:255], v[76:79]
    ds_read_b64_tr_b16 a[182:183], v11 offset:38912
    v_cvt_pk_bf16_f32 v99, v74, v75
    v_mfma_f32_16x16x32_bf16 v[80:83], a[144:147], v[184:187], v[80:83]
    s_waitcnt lgkmcnt(5)
    ds_read_b64_tr_b16 a[184:185], v11 offset:40960
    v_mfma_f32_16x16x32_bf16 v[80:83], a[148:151], v[192:195], v[80:83]
    s_add_u32 m0, s82, 16384
    ds_read_b64_tr_b16 a[186:187], v11 offset:43008
    v_mfma_f32_16x16x32_bf16 v[80:83], a[152:155], v[200:203], v[80:83]
    s_add_u32 s56, s56, s86
    ds_read_b64_tr_b16 a[188:189], v11 offset:45056
    v_mfma_f32_16x16x32_bf16 v[80:83], a[156:159], v[208:211], v[80:83]
    s_addc_u32 s57, s57, 0
    ds_read_b64_tr_b16 a[190:191], v11 offset:47104
    buffer_load_dwordx4 v24, s[56:59], 0 offen lds
    v_mfma_f32_16x16x32_bf16 v[80:83], a[160:163], v[216:219], v[80:83]
    ds_read_b64_tr_b16 a[192:193], v11 offset:49152
    v_mfma_f32_16x16x32_bf16 v[80:83], a[164:167], v[224:227], v[80:83]
    ds_read_b64_tr_b16 a[194:195], v11 offset:51200
    v_mfma_f32_16x16x32_bf16 v[80:83], a[168:171], v[232:235], v[80:83]
    s_waitcnt lgkmcnt(5)
    ds_read_b64_tr_b16 a[196:197], v11 offset:53248
    v_mfma_f32_16x16x32_bf16 v[80:83], a[172:175], v[240:243], v[80:83]
    ds_read_b64_tr_b16 a[198:199], v11 offset:55296
    v_cvt_pk_bf16_f32 v102, v76, v77
    v_mfma_f32_16x16x32_bf16 v[80:83], a[176:179], v[248:251], v[80:83]
    ds_read_b64_tr_b16 a[200:201], v11 offset:57344
    v_cvt_pk_bf16_f32 v103, v78, v79
    v_mfma_f32_16x16x32_bf16 v[84:87], a[144:147], v[188:191], v[84:87]
    s_add_u32 m0, s82, 20480
    ds_read_b64_tr_b16 a[202:203], v11 offset:59392
    v_mfma_f32_16x16x32_bf16 v[84:87], a[148:151], v[196:199], v[84:87]
    s_add_u32 s56, s56, s86
    ds_read_b64_tr_b16 a[204:205], v11 offset:61440
    v_mfma_f32_16x16x32_bf16 v[84:87], a[152:155], v[204:207], v[84:87]
    s_addc_u32 s57, s57, 0
    ds_read_b64_tr_b16 a[206:207], v11 offset:63488
    buffer_load_dwordx4 v24, s[56:59], 0 offen lds
    v_mfma_f32_16x16x32_bf16 v[84:87], a[156:159], v[212:215], v[84:87]
    ds_read_b64_tr_b16 a[208:209], v15 offset:0
    v_mfma_f32_16x16x32_bf16 v[84:87], a[160:163], v[220:223], v[84:87]
    ds_read_b64_tr_b16 a[210:211], v15 offset:2048
    v_mfma_f32_16x16x32_bf16 v[84:87], a[164:167], v[228:231], v[84:87]
    ds_read_b64_tr_b16 a[212:213], v15 offset:4096
    v_mfma_f32_16x16x32_bf16 v[84:87], a[168:171], v[236:239], v[84:87]
    ds_read_b64_tr_b16 a[214:215], v15 offset:6144
    v_mfma_f32_16x16x32_bf16 v[84:87], a[172:175], v[244:247], v[84:87]
    s_waitcnt vmcnt(16) lgkmcnt(6)
    s_barrier
    ds_read_b64_tr_b16 a[144:145], v12 offset:8192
    v_mfma_f32_16x16x32_bf16 v[84:87], a[176:179], v[252:255], v[84:87]
    s_add_u32 m0, s82, 24576
    ds_read_b64_tr_b16 a[146:147], v12 offset:10240
    v_cvt_pk_bf16_f32 v104, v80, v81
    v_mfma_f32_16x16x32_bf16 v[88:91], a[180:183], v[184:187], v[88:91]
    s_add_u32 s56, s56, s86
    ds_read_b64_tr_b16 a[148:149], v12 offset:12288
    v_cvt_pk_bf16_f32 v105, v82, v83
    v_mfma_f32_16x16x32_bf16 v[88:91], a[184:187], v[192:195], v[88:91]
    s_addc_u32 s57, s57, 0
    ds_read_b64_tr_b16 a[150:151], v12 offset:14336
    buffer_load_dwordx4 v24, s[56:59], 0 offen lds
    v_mfma_f32_16x16x32_bf16 v[88:91], a[188:191], v[200:203], v[88:91]
    ds_read_b64_tr_b16 a[152:153], v12 offset:16384
    buffer_store_dwordx4 v[96:99], v6, s[24:27], s94 offen offset:0 sc1
    v_mfma_f32_16x16x32_bf16 v[88:91], a[192:195], v[208:211], v[88:91]
    ds_read_b64_tr_b16 a[154:155], v12 offset:18432
    v_mfma_f32_16x16x32_bf16 v[88:91], a[196:199], v[216:219], v[88:91]
    ds_read_b64_tr_b16 a[156:157], v12 offset:20480
    v_mfma_f32_16x16x32_bf16 v[88:91], a[200:203], v[224:227], v[88:91]
    s_waitcnt lgkmcnt(5)
    ds_read_b64_tr_b16 a[158:159], v12 offset:22528
    v_mfma_f32_16x16x32_bf16 v[88:91], a[204:207], v[232:235], v[88:91]
    ds_read_b64_tr_b16 a[160:161], v12 offset:24576
    v_mfma_f32_16x16x32_bf16 v[88:91], a[208:211], v[240:243], v[88:91]
    s_add_u32 m0, s82, 28672
    ds_read_b64_tr_b16 a[162:163], v12 offset:26624
    v_cvt_pk_bf16_f32 v108, v84, v85
    v_mfma_f32_16x16x32_bf16 v[88:91], a[212:215], v[248:251], v[88:91]
    s_add_u32 s56, s56, s86
    ds_read_b64_tr_b16 a[164:165], v12 offset:28672
    v_cvt_pk_bf16_f32 v109, v86, v87
    v_mfma_f32_16x16x32_bf16 v[92:95], a[180:183], v[188:191], v[92:95]
    s_addc_u32 s57, s57, 0
    ds_read_b64_tr_b16 a[166:167], v12 offset:30720
    buffer_load_dwordx4 v24, s[56:59], 0 offen lds
    v_mfma_f32_16x16x32_bf16 v[92:95], a[184:187], v[196:199], v[92:95]
    ds_read_b64_tr_b16 a[168:169], v12 offset:32768
    v_mfma_f32_16x16x32_bf16 v[92:95], a[188:191], v[204:207], v[92:95]
    ds_read_b64_tr_b16 a[170:171], v12 offset:34816
    buffer_store_dwordx4 v[100:103], v6, s[24:27], s94 offen offset:1024 sc1
    v_mfma_f32_16x16x32_bf16 v[92:95], a[192:195], v[212:215], v[92:95]
    ds_read_b64_tr_b16 a[172:173], v12 offset:36864
    v_mfma_f32_16x16x32_bf16 v[92:95], a[196:199], v[220:223], v[92:95]
    ds_read_b64_tr_b16 a[174:175], v12 offset:38912
    v_mfma_f32_16x16x32_bf16 v[92:95], a[200:203], v[228:231], v[92:95]
    ds_read_b64_tr_b16 a[176:177], v12 offset:40960
    v_mfma_f32_16x16x32_bf16 v[92:95], a[204:207], v[236:239], v[92:95]
    s_add_u32 m0, s82, 32768
    ds_read_b64_tr_b16 a[178:179], v12 offset:43008
    v_mfma_f32_16x16x32_bf16 v[92:95], a[208:211], v[244:247], v[92:95]
    s_add_u32 s56, s56, s86
    ds_read_b64_tr_b16 a[180:181], v13 offset:8192
    v_cvt_pk_bf16_f32 v106, v88, v89
    v_mfma_f32_16x16x32_bf16 v[92:95], a[212:215], v[252:255], v[92:95]
    s_addc_u32 s57, s57, 0
    ds_read_b64_tr_b16 a[182:183], v13 offset:10240
    buffer_load_dwordx4 v24, s[56:59], 0 offen lds
.p2align 3
L_bloop:
    v_mfma_f32_16x16x32_bf16 v[64:67], a[144:147], a[216:219], 0
    s_waitcnt lgkmcnt(5)
    ds_read_b64_tr_b16 a[184:185], v13 offset:12288
    v_cvt_pk_bf16_f32 v107, v90, v91
    v_mfma_f32_16x16x32_bf16 v[64:67], a[148:151], a[224:227], v[64:67]
    ds_read_b64_tr_b16 a[186:187], v13 offset:14336
    buffer_store_dwordx4 v[104:107], v6, s[24:27], s94 offen offset:2048 sc1
    v_mfma_f32_16x16x32_bf16 v[64:67], a[152:155], v[128:131], v[64:67]
    ds_read_b64_tr_b16 a[188:189], v13 offset:16384
    v_mfma_f32_16x16x32_bf16 v[64:67], a[156:159], v[136:139], v[64:67]
    ds_read_b64_tr_b16 a[190:191], v13 offset:18432
    v_mfma_f32_16x16x32_bf16 v[64:67], a[160:163], v[144:147], v[64:67]
    s_waitcnt lgkmcnt(5)
    ds_read_b64_tr_b16 a[192:193], v13 offset:20480
    v_mfma_f32_16x16x32_bf16 v[64:67], a[164:167], v[152:155], v[64:67]
    s_add_u32 m0, s82, 36864
    ds_read_b64_tr_b16 a[194:195], v13 offset:22528
    v_mfma_f32_16x16x32_bf16 v[64:67], a[168:171], v[160:163], v[64:67]
    s_add_u32 s56, s56, s86
    ds_read_b64_tr_b16 a[196:197], v13 offset:24576
    v_mfma_f32_16x16x32_bf16 v[64:67], a[172:175], v[168:171], v[64:67]
    s_addc_u32 s57, s57, 0
    ds_read_b64_tr_b16 a[198:199], v13 offset:26624
    buffer_load_dwordx4 v24, s[56:59], 0 offen lds
    v_mfma_f32_16x16x32_bf16 v[64:67], a[176:179], v[176:179], v[64:67]
    ds_read_b64_tr_b16 a[200:201], v13 offset:28672
    v_cvt_pk_bf16_f32 v110, v92, v93
    v_mfma_f32_16x16x32_bf16 v[68:71], a[144:147], a[220:223], 0
    ds_read_b64_tr_b16 a[202:203], v13 offset:30720
    v_cvt_pk_bf16_f32 v111, v94, v95
    v_mfma_f32_16x16x32_bf16 v[68:71], a[148:151], a[228:231], v[68:71]
    ds_read_b64_tr_b16 a[204:205], v13 offset:32768
    buffer_store_dwordx4 v[108:111], v6, s[24:27], s94 offen offset:3072 sc1
    v_mfma_f32_16x16x32_bf16 v[68:71], a[152:155], v[132:135], v[68:71]
    ds_read_b64_tr_b16 a[206:207], v13 offset:34816
    v_mfma_f32_16x16x32_bf16 v[68:71], a[156:159], v[140:143], v[68:71]
    ds_read_b64_tr_b16 a[208:209], v13 offset:36864
    v_mfma_f32_16x16x32_bf16 v[68:71], a[160:163], v[148:151], v[68:71]
    s_add_u32 m0, s82, 40960
    ds_read_b64_tr_b16 a[210:211], v13 offset:38912
    v_mfma_f32_16x16x32_bf16 v[68:71], a[164:167], v[156:159], v[68:71]
    s_add_u32 s56, s56, s86
    ds_read_b64_tr_b16 a[212:213], v13 offset:40960
    v_mfma_f32_16x16x32_bf16 v[68:71], a[168:171], v[164:167], v[68:71]
    s_addc_u32 s57, s57, 0
    ds_read_b64_tr_b16 a[214:215], v13 offset:43008
    buffer_load_dwordx4 v24, s[56:59], 0 offen lds
    v_mfma_f32_16x16x32_bf16 v[68:71], a[172:175], v[172:175], v[68:71]
    ds_read_b64_tr_b16 a[144:145], v14 offset:8192
    v_mfma_f32_16x16x32_bf16 v[68:71], a[176:179], v[180:183], v[68:71]
    s_waitcnt lgkmcnt(5)
    ds_read_b64_tr_b16 a[146:147], v14 offset:10240
    v_mfma_f32_16x16x32_bf16 v[72:75], a[180:183], a[216:219], 0
    ds_read_b64_tr_b16 a[148:149], v14 offset:12288
    v_mfma_f32_16x16x32_bf16 v[72:75], a[184:187], a[224:227], v[72:75]
    ds_read_b64_tr_b16 a[150:151], v14 offset:14336
    v_mfma_f32_16x16x32_bf16 v[72:75], a[188:191], v[128:131], v[72:75]
    s_waitcnt lgkmcnt(5)
    ds_read_b64_tr_b16 a[152:153], v14 offset:16384
    v_mfma_f32_16x16x32_bf16 v[72:75], a[192:195], v[136:139], v[72:75]
    s_add_u32 m0, s82, 45056
    ds_read_b64_tr_b16 a[154:155], v14 offset:18432
    v_mfma_f32_16x16x32_bf16 v[72:75], a[196:199], v[144:147], v[72:75]
    s_add_u32 s56, s56, s86
    ds_read_b64_tr_b16 a[156:157], v14 offset:20480
    v_mfma_f32_16x16x32_bf16 v[72:75], a[200:203], v[152:155], v[72:75]
    s_addc_u32 s57, s57, 0
    ds_read_b64_tr_b16 a[158:159], v14 offset:22528
    buffer_load_dwordx4 v24, s[56:59], 0 offen lds
    v_mfma_f32_16x16x32_bf16 v[72:75], a[204:207], v[160:163], v[72:75]
    s_add_u32 s90, s87, s78
    ds_read_b64_tr_b16 a[160:161], v14 offset:24576
    v_mfma_f32_16x16x32_bf16 v[72:75], a[208:211], v[168:171], v[72:75]
    s_waitcnt lgkmcnt(5)
    s_and_b32 s91, s90, 7
    ds_read_b64_tr_b16 a[162:163], v14 offset:26624
    v_mfma_f32_16x16x32_bf16 v[72:75], a[212:215], v[176:179], v[72:75]
    s_add_u32 s90, s90, 2
    ds_read_b64_tr_b16 a[164:165], v14 offset:28672
    v_mfma_f32_16x16x32_bf16 v[76:79], a[180:183], a[220:223], 0
    s_and_b32 s90, s90, 7
    ds_read_b64_tr_b16 a[166:167], v14 offset:30720
    v_mfma_f32_16x16x32_bf16 v[76:79], a[184:187], a[228:231], v[76:79]
    s_waitcnt lgkmcnt(5)
    ds_read_b64_tr_b16 a[168:169], v14 offset:32768
    v_mfma_f32_16x16x32_bf16 v[76:79], a[188:191], v[132:135], v[76:79]
    s_add_u32 m0, s82, 49152
    ds_read_b64_tr_b16 a[170:171], v14 offset:34816
    v_mfma_f32_16x16x32_bf16 v[76:79], a[192:195], v[140:143], v[76:79]
    s_add_u32 s56, s56, s86
    ds_read_b64_tr_b16 a[172:173], v14 offset:36864
    v_mfma_f32_16x16x32_bf16 v[76:79], a[196:199], v[148:151], v[76:79]
    s_addc_u32 s57, s57, 0
    ds_read_b64_tr_b16 a[174:175], v14 offset:38912
    buffer_load_dwordx4 v24, s[56:59], 0 offen lds
    v_mfma_f32_16x16x32_bf16 v[76:79], a[200:203], v[156:159], v[76:79]
    s_cmp_lt_u32 s87, 6
    ds_read_b64_tr_b16 a[176:177], v14 offset:40960
    v_mfma_f32_16x16x32_bf16 v[76:79], a[204:207], v[164:167], v[76:79]
    s_cselect_b32 s90, s90, 8
    ds_read_b64_tr_b16 a[178:179], v14 offset:43008
    v_mfma_f32_16x16x32_bf16 v[76:79], a[208:211], v[172:175], v[76:79]
    s_lshl_b32 s84, s90, 7
    ds_read_b64_tr_b16 a[180:181], v15 offset:8192
    v_mfma_f32_16x16x32_bf16 v[76:79], a[212:215], v[180:183], v[76:79]
    s_cmp_lt_u32 s87, 7
    ds_read_b64_tr_b16 a[182:183], v15 offset:10240
    v_mfma_f32_16x16x32_bf16 v[80:83], a[144:147], a[216:219], 0
    s_cselect_b32 s69, s69, 0
    ds_read_b64_tr_b16 a[184:185], v15 offset:12288
    v_mfma_f32_16x16x32_bf16 v[80:83], a[148:151], a[224:227], v[80:83]
    s_add_u32 m0, s82, 53248
    ds_read_b64_tr_b16 a[186:187], v15 offset:14336
    v_mfma_f32_16x16x32_bf16 v[80:83], a[152:155], v[128:131], v[80:83]
    s_waitcnt lgkmcnt(5)
    s_add_u32 s56, s56, s86
    ds_read_b64_tr_b16 a[188:189], v15 offset:16384
    v_mfma_f32_16x16x32_bf16 v[80:83], a[156:159], v[136:139], v[80:83]
    s_addc_u32 s57, s57, 0
    ds_read_b64_tr_b16 a[190:191], v15 offset:18432
    buffer_load_dwordx4 v24, s[56:59], 0 offen lds
    v_mfma_f32_16x16x32_bf16 v[80:83], a[160:163], v[144:147], v[80:83]
    s_lshl_b32 s94, s91, 14
    ds_read_b64_tr_b16 a[192:193], v15 offset:20480
    v_mfma_f32_16x16x32_bf16 v[80:83], a[164:167], v[152:155], v[80:83]
    s_add_u32 s94, s94, s92
    ds_read_b64_tr_b16 a[194:195], v15 offset:22528
    v_mfma_f32_16x16x32_bf16 v[80:83], a[168:171], v[160:163], v[80:83]
    s_mov_b32 s95, s99
    ds_read_b64_tr_b16 a[196:197], v15 offset:24576
    v_mfma_f32_16x16x32_bf16 v[80:83], a[172:175], v[168:171], v[80:83]
    s_waitcnt lgkmcnt(5)
    s_lshl_b32 s99, s91, 9
    ds_read_b64_tr_b16 a[198:199], v15 offset:26624
    v_mfma_f32_16x16x32_bf16 v[80:83], a[176:179], v[176:179], v[80:83]
    s_add_u32 s99, s99, s93
    ds_read_b64_tr_b16 a[200:201], v15 offset:28672
    v_mfma_f32_16x16x32_bf16 v[84:87], a[144:147], a[220:223], 0
    s_add_u32 m0, s82, 57344
    ds_read_b64_tr_b16 a[202:203], v15 offset:30720
    v_mfma_f32_16x16x32_bf16 v[84:87], a[148:151], a[228:231], v[84:87]
    s_add_u32 s56, s56, s86
    ds_read_b64_tr_b16 a[204:205], v15 offset:32768
    v_mfma_f32_16x16x32_bf16 v[84:87], a[152:155], v[132:135], v[84:87]
    s_addc_u32 s57, s57, 0
    ds_read_b64_tr_b16 a[206:207], v15 offset:34816
    buffer_load_dwordx4 v24, s[56:59], 0 offen lds
    v_mfma_f32_16x16x32_bf16 v[84:87], a[156:159], v[140:143], v[84:87]
    s_add_u32 s87, s87, 1
    ds_read_b64_tr_b16 a[208:209], v15 offset:36864
    v_mfma_f32_16x16x32_bf16 v[84:87], a[160:163], v[148:151], v[84:87]
    ds_read_b64_tr_b16 a[210:211], v15 offset:38912
    v_mfma_f32_16x16x32_bf16 v[84:87], a[164:167], v[156:159], v[84:87]
    ds_read_b64_tr_b16 a[212:213], v15 offset:40960
    v_mfma_f32_16x16x32_bf16 v[84:87], a[168:171], v[164:167], v[84:87]
    ds_read_b64_tr_b16 a[214:215], v15 offset:43008
    v_mfma_f32_16x16x32_bf16 v[84:87], a[172:175], v[172:175], v[84:87]
    s_waitcnt vmcnt(19) lgkmcnt(6)
    s_barrier
    ds_read_b64_tr_b16 a[144:145], v12 offset:45056
    v_mfma_f32_16x16x32_bf16 v[84:87], a[176:179], v[180:183], v[84:87]
    s_add_u32 m0, s82, 61440
    ds_read_b64_tr_b16 a[146:147], v12 offset:47104
    v_mfma_f32_16x16x32_bf16 v[88:91], a[180:183], a[216:219], 0
    s_add_u32 s56, s56, s86
    ds_read_b64_tr_b16 a[148:149], v12 offset:49152
    v_mfma_f32_16x16x32_bf16 v[88:91], a[184:187], a[224:227], v[88:91]
    s_addc_u32 s57, s57, 0
    ds_read_b64_tr_b16 a[150:151], v12 offset:51200
    buffer_load_dwordx4 v24, s[56:59], 0 offen lds
    v_mfma_f32_16x16x32_bf16 v[88:91], a[188:191], v[128:131], v[88:91]
    ds_read_b64_tr_b16 a[152:153], v12 offset:53248
    v_mfma_f32_16x16x32_bf16 v[88:91], a[192:195], v[136:139], v[88:91]
    ds_read_b64_tr_b16 a[154:155], v12 offset:55296
    v_mfma_f32_16x16x32_bf16 v[88:91], a[196:199], v[144:147], v[88:91]
    ds_read_b64_tr_b16 a[156:157], v12 offset:57344
    v_mfma_f32_16x16x32_bf16 v[88:91], a[200:203], v[152:155], v[88:91]
    s_waitcnt lgkmcnt(5)
    ds_read_b64_tr_b16 a[158:159], v12 offset:59392
    v_mfma_f32_16x16x32_bf16 v[88:91], a[204:207], v[160:163], v[88:91]
    ds_read_b64_tr_b16 a[160:161], v12 offset:61440
    v_mfma_f32_16x16x32_bf16 v[88:91], a[208:211], v[168:171], v[88:91]
    s_add_u32 m0, s82, 65536
    ds_read_b64_tr_b16 a[162:163], v12 offset:63488
    v_mfma_f32_16x16x32_bf16 v[88:91], a[212:215], v[176:179], v[88:91]
    s_add_u32 s56, s56, s86
    ds_read_b64_tr_b16 a[164:165], v16 offset:0
    v_mfma_f32_16x16x32_bf16 v[92:95], a[180:183], a[220:223], 0
    s_addc_u32 s57, s57, 0
    ds_read_b64_tr_b16 a[166:167], v16 offset:2048
    buffer_load_dwordx4 v24, s[56:59], 0 offen lds
    v_mfma_f32_16x16x32_bf16 v[92:95], a[184:187], a[228:231], v[92:95]
    ds_read_b64_tr_b16 a[168:169], v16 offset:4096
    v_mfma_f32_16x16x32_bf16 v[92:95], a[188:191], v[132:135], v[92:95]
    ds_read_b64_tr_b16 a[170:171], v16 offset:6144
    v_mfma_f32_16x16x32_bf16 v[92:95], a[192:195], v[140:143], v[92:95]
    s_waitcnt vmcnt(7)
    ds_read_b64_tr_b16 a[172:173], v16 offset:8192
    buffer_store_dword v27, v7, s[24:27], s95 offen sc1
    v_mfma_f32_16x16x32_bf16 v[92:95], a[196:199], v[148:151], v[92:95]
    ds_read_b64_tr_b16 a[174:175], v16 offset:10240
    v_mfma_f32_16x16x32_bf16 v[92:95], a[200:203], v[156:159], v[92:95]
    ds_read_b64_tr_b16 a[176:177], v16 offset:12288
    v_mfma_f32_16x16x32_bf16 v[92:95], a[204:207], v[164:167], v[92:95]
    s_add_u32 m0, s82, 69632
    ds_read_b64_tr_b16 a[178:179], v16 offset:14336
    v_mfma_f32_16x16x32_bf16 v[92:95], a[208:211], v[172:175], v[92:95]
    s_add_u32 s56, s56, s86
    ds_read_b64_tr_b16 a[180:181], v13 offset:45056
    v_mfma_f32_16x16x32_bf16 v[92:95], a[212:215], v[180:183], v[92:95]
    s_addc_u32 s57, s57, 0
    ds_read_b64_tr_b16 a[182:183], v13 offset:47104
    buffer_load_dwordx4 v24, s[56:59], 0 offen lds
    v_mfma_f32_16x16x32_bf16 v[64:67], a[144:147], v[184:187], v[64:67]
    s_waitcnt lgkmcnt(5)
    ds_read_b64_tr_b16 a[184:185], v13 offset:49152
    v_mfma_f32_16x16x32_bf16 v[64:67], a[148:151], v[192:195], v[64:67]
    ds_read_b64_tr_b16 a[186:187], v13 offset:51200
    v_mfma_f32_16x16x32_bf16 v[64:67], a[152:155], v[200:203], v[64:67]
    ds_read_b64_tr_b16 a[188:189], v13 offset:53248
    v_mfma_f32_16x16x32_bf16 v[64:67], a[156:159], v[208:211], v[64:67]
    s_waitcnt lgkmcnt(5)
    ds_read_b64_tr_b16 a[190:191], v13 offset:55296
    v_mfma_f32_16x16x32_bf16 v[64:67], a[160:163], v[216:219], v[64:67]
    s_add_u32 m0, s82, 73728
    ds_read_b64_tr_b16 a[192:193], v13 offset:57344
    v_mfma_f32_16x16x32_bf16 v[64:67], a[164:167], v[224:227], v[64:67]
    s_mov_b32 s58, s69
    ds_read_b64_tr_b16 a[194:195], v13 offset:59392
    v_mfma_f32_16x16x32_bf16 v[64:67], a[168:171], v[232:235], v[64:67]
    s_add_u32 s56, s20, s84
    ds_read_b64_tr_b16 a[196:197], v13 offset:61440
    v_mfma_f32_16x16x32_bf16 v[64:67], a[172:175], v[240:243], v[64:67]
    s_addc_u32 s57, s21, 0
    ds_read_b64_tr_b16 a[198:199], v13 offset:63488
    buffer_load_dwordx4 v24, s[56:59], 0 offen lds
    v_mfma_f32_16x16x32_bf16 v[64:67], a[176:179], v[248:251], v[64:67]
    ds_read_b64_tr_b16 a[200:201], v17 offset:0
    v_mfma_f32_16x16x32_bf16 v[68:71], a[144:147], v[188:191], v[68:71]
    ds_read_b64_tr_b16 a[202:203], v17 offset:2048
    v_mfma_f32_16x16x32_bf16 v[68:71], a[148:151], v[196:199], v[68:71]
    ds_read_b64_tr_b16 a[204:205], v17 offset:4096
    v_mfma_f32_16x16x32_bf16 v[68:71], a[152:155], v[204:207], v[68:71]
    ds_read_b64_tr_b16 a[206:207], v17 offset:6144
    v_mfma_f32_16x16x32_bf16 v[68:71], a[156:159], v[212:215], v[68:71]
    ds_read_b64_tr_b16 a[208:209], v17 offset:8192
    v_mfma_f32_16x16x32_bf16 v[68:71], a[160:163], v[220:223], v[68:71]
    s_add_u32 m0, s82, 77824
    ds_read_b64_tr_b16 a[210:211], v17 offset:10240
    v_mfma_f32_16x16x32_bf16 v[68:71], a[164:167], v[228:231], v[68:71]
    s_add_u32 s56, s56, s86
    ds_read_b64_tr_b16 a[212:213], v17 offset:12288
    v_mfma_f32_16x16x32_bf16 v[68:71], a[168:171], v[236:239], v[68:71]
    s_addc_u32 s57, s57, 0
    ds_read_b64_tr_b16 a[214:215], v17 offset:14336
    buffer_load_dwordx4 v24, s[56:59], 0 offen lds
    v_mfma_f32_16x16x32_bf16 v[68:71], a[172:175], v[244:247], v[68:71]
    ds_read_b64_tr_b16 a[144:145], v14 offset:45056
    v_cvt_pk_bf16_f32 v96, v64, v65
    v_mfma_f32_16x16x32_bf16 v[68:71], a[176:179], v[252:255], v[68:71]
    s_waitcnt lgkmcnt(5)
    ds_read_b64_tr_b16 a[146:147], v14 offset:47104
    v_cvt_pk_bf16_f32 v97, v66, v67
    v_mfma_f32_16x16x32_bf16 v[72:75], a[180:183], v[184:187], v[72:75]
    ds_read_b64_tr_b16 a[148:149], v14 offset:49152
    v_mfma_f32_16x16x32_bf16 v[72:75], a[184:187], v[192:195], v[72:75]
    ds_read_b64_tr_b16 a[150:151], v14 offset:51200
    v_mfma_f32_16x16x32_bf16 v[72:75], a[188:191], v[200:203], v[72:75]
    ds_read_b64_tr_b16 a[152:153], v14 offset:53248
    v_mfma_f32_16x16x32_bf16 v[72:75], a[192:195], v[208:211], v[72:75]
    s_add_u32 m0, s82, 81920
    ds_read_b64_tr_b16 a[154:155], v14 offset:55296
    v_mfma_f32_16x16x32_bf16 v[72:75], a[196:199], v[216:219], v[72:75]
    s_add_u32 s56, s56, s86
    ds_read_b64_tr_b16 a[156:157], v14 offset:57344
    v_mfma_f32_16x16x32_bf16 v[72:75], a[200:203], v[224:227], v[72:75]
    s_addc_u32 s57, s57, 0
    ds_read_b64_tr_b16 a[158:159], v14 offset:59392
    buffer_load_dwordx4 v24, s[56:59], 0 offen lds
    v_mfma_f32_16x16x32_bf16 v[72:75], a[204:207], v[232:235], v[72:75]
    s_waitcnt lgkmcnt(5)
    ds_read_b64_tr_b16 a[160:161], v14 offset:61440
    v_mfma_f32_16x16x32_bf16 v[72:75], a[208:211], v[240:243], v[72:75]
    ds_read_b64_tr_b16 a[162:163], v14 offset:63488
    v_cvt_pk_bf16_f32 v100, v68, v69
    v_mfma_f32_16x16x32_bf16 v[72:75], a[212:215], v[248:251], v[72:75]
    ds_read_b64_tr_b16 a[164:165], v18 offset:0
    v_cvt_pk_bf16_f32 v101, v70, v71
    v_mfma_f32_16x16x32_bf16 v[76:79], a[180:183], v[188:191], v[76:79]
    ds_read_b64_tr_b16 a[166:167], v18 offset:2048
    v_mfma_f32_16x16x32_bf16 v[76:79], a[184:187], v[196:199], v[76:79]
    ds_read_b64_tr_b16 a[168:169], v18 offset:4096
    v_mfma_f32_16x16x32_bf16 v[76:79], a[188:191], v[204:207], v[76:79]
    s_add_u32 m0, s82, 86016
    ds_read_b64_tr_b16 a[170:171], v18 offset:6144
    v_mfma_f32_16x16x32_bf16 v[76:79], a[192:195], v[212:215], v[76:79]
    s_add_u32 s56, s56, s86
    ds_read_b64_tr_b16 a[172:173], v18 offset:8192
    v_mfma_f32_16x16x32_bf16 v[76:79], a[196:199], v[220:223], v[76:79]
    s_addc_u32 s57, s57, 0
    ds_read_b64_tr_b16 a[174:175], v18 offset:10240
    buffer_load_dwordx4 v24, s[56:59], 0 offen lds
    v_mfma_f32_16x16x32_bf16 v[76:79], a[200:203], v[228:231], v[76:79]
    ds_read_b64_tr_b16 a[176:177], v18 offset:12288
    v_mfma_f32_16x16x32_bf16 v[76:79], a[204:207], v[236:239], v[76:79]
    ds_read_b64_tr_b16 a[178:179], v18 offset:14336
    v_mfma_f32_16x16x32_bf16 v[76:79], a[208:211], v[244:247], v[76:79]
    ds_read_b64_tr_b16 a[180:181], v15 offset:45056
    v_cvt_pk_bf16_f32 v98, v72, v73
    v_mfma_f32_16x16x32_bf16 v[76:79], a[212:215], v[252:255], v[76:79]
    ds_read_b64_tr_b16 a[182:183], v15 offset:47104
    v_cvt_pk_bf16_f32 v99, v74, v75
    v_mfma_f32_16x16x32_bf16 v[80:83], a[144:147], v[184:187], v[80:83]
    s_waitcnt lgkmcnt(5)
    ds_read_b64_tr_b16 a[184:185], v15 offset:49152
    v_mfma_f32_16x16x32_bf16 v[80:83], a[148:151], v[192:195], v[80:83]
    s_add_u32 m0, s82, 90112
    ds_read_b64_tr_b16 a[186:187], v15 offset:51200
    v_mfma_f32_16x16x32_bf16 v[80:83], a[152:155], v[200:203], v[80:83]
    s_add_u32 s56, s56, s86
    ds_read_b64_tr_b16 a[188:189], v15 offset:53248
    v_mfma_f32_16x16x32_bf16 v[80:83], a[156:159], v[208:211], v[80:83]
    s_addc_u32 s57, s57, 0
    ds_read_b64_tr_b16 a[190:191], v15 offset:55296
    buffer_load_dwordx4 v24, s[56:59], 0 offen lds
    v_mfma_f32_16x16x32_bf16 v[80:83], a[160:163], v[216:219], v[80:83]
    ds_read_b64_tr_b16 a[192:193], v15 offset:57344
    v_mfma_f32_16x16x32_bf16 v[80:83], a[164:167], v[224:227], v[80:83]
    ds_read_b64_tr_b16 a[194:195], v15 offset:59392
    v_mfma_f32_16x16x32_bf16 v[80:83], a[168:171], v[232:235], v[80:83]
    s_waitcnt lgkmcnt(5)
    ds_read_b64_tr_b16 a[196:197], v15 offset:61440
    v_mfma_f32_16x16x32_bf16 v[80:83], a[172:175], v[240:243], v[80:83]
    ds_read_b64_tr_b16 a[198:199], v15 offset:63488
    v_cvt_pk_bf16_f32 v102, v76, v77
    v_mfma_f32_16x16x32_bf16 v[80:83], a[176:179], v[248:251], v[80:83]
    ds_read_b64_tr_b16 a[200:201], v19 offset:0
    v_cvt_pk_bf16_f32 v103, v78, v79
    v_mfma_f32_16x16x32_bf16 v[84:87], a[144:147], v[188:191], v[84:87]
    s_add_u32 m0, s82, 94208
    ds_read_b64_tr_b16 a[202:203], v19 offset:2048
    v_mfma_f32_16x16x32_bf16 v[84:87], a[148:151], v[196:199], v[84:87]
    s_add_u32 s56, s56, s86
    ds_read_b64_tr_b16 a[204:205], v19 offset:4096
    v_mfma_f32_16x16x32_bf16 v[84:87], a[152:155], v[204:207], v[84:87]
    s_addc_u32 s57, s57, 0
    ds_read_b64_tr_b16 a[206:207], v19 offset:6144
    buffer_load_dwordx4 v24, s[56:59], 0 offen lds
    v_mfma_f32_16x16x32_bf16 v[84:87], a[156:159], v[212:215], v[84:87]
    ds_read_b64_tr_b16 a[208:209], v19 offset:8192
    v_mfma_f32_16x16x32_bf16 v[84:87], a[160:163], v[220:223], v[84:87]
    ds_read_b64_tr_b16 a[210:211], v19 offset:10240
    v_mfma_f32_16x16x32_bf16 v[84:87], a[164:167], v[228:231], v[84:87]
    ds_read_b64_tr_b16 a[212:213], v19 offset:12288
    v_mfma_f32_16x16x32_bf16 v[84:87], a[168:171], v[236:239], v[84:87]
    ds_read_b64_tr_b16 a[214:215], v19 offset:14336
    v_mfma_f32_16x16x32_bf16 v[84:87], a[172:175], v[244:247], v[84:87]
    s_waitcnt vmcnt(18) lgkmcnt(6)
    s_barrier
    ds_read_b64_tr_b16 a[144:145], v8 offset:0
    v_mfma_f32_16x16x32_bf16 v[84:87], a[176:179], v[252:255], v[84:87]
    s_add_u32 m0, s82, 98304
    ds_read_b64_tr_b16 a[146:147], v8 offset:2048
    v_cvt_pk_bf16_f32 v104, v80, v81
    v_mfma_f32_16x16x32_bf16 v[88:91], a[180:183], v[184:187], v[88:91]
    s_add_u32 s56, s56, s86
    ds_read_b64_tr_b16 a[148:149], v8 offset:4096
    v_cvt_pk_bf16_f32 v105, v82, v83
    v_mfma_f32_16x16x32_bf16 v[88:91], a[184:187], v[192:195], v[88:91]
    s_addc_u32 s57, s57, 0
    ds_read_b64_tr_b16 a[150:151], v8 offset:6144
    buffer_load_dwordx4 v24, s[56:59], 0 offen lds
    v_mfma_f32_16x16x32_bf16 v[88:91], a[188:191], v[200:203], v[88:91]
    ds_read_b64_tr_b16 a[152:153], v8 offset:8192
    buffer_store_dwordx4 v[96:99], v6, s[24:27], s94 offen offset:0 sc1
    v_mfma_f32_16x16x32_bf16 v[88:91], a[192:195], v[208:211], v[88:91]
    ds_read_b64_tr_b16 a[154:155], v8 offset:10240
    v_mfma_f32_16x16x32_bf16 v[88:91], a[196:199], v[216:219], v[88:91]
    ds_read_b64_tr_b16 a[156:157], v8 offset:12288
    v_mfma_f32_16x16x32_bf16 v[88:91], a[200:203], v[224:227], v[88:91]
    s_waitcnt lgkmcnt(5)
    ds_read_b64_tr_b16 a[158:159], v8 offset:14336
    v_mfma_f32_16x16x32_bf16 v[88:91], a[204:207], v[232:235], v[88:91]
    ds_read_b64_tr_b16 a[160:161], v8 offset:16384
    v_mfma_f32_16x16x32_bf16 v[88:91], a[208:211], v[240:243], v[88:91]
    s_add_u32 m0, s82, 102400
    ds_read_b64_tr_b16 a[162:163], v8 offset:18432
    v_cvt_pk_bf16_f32 v108, v84, v85
    v_mfma_f32_16x16x32_bf16 v[88:91], a[212:215], v[248:251], v[88:91]
    s_add_u32 s56, s56, s86
    ds_read_b64_tr_b16 a[164:165], v8 offset:20480
    v_cvt_pk_bf16_f32 v109, v86, v87
    v_mfma_f32_16x16x32_bf16 v[92:95], a[180:183], v[188:191], v[92:95]
    s_addc_u32 s57, s57, 0
    ds_read_b64_tr_b16 a[166:167], v8 offset:22528
    buffer_load_dwordx4 v24, s[56:59], 0 offen lds
    v_mfma_f32_16x16x32_bf16 v[92:95], a[184:187], v[196:199], v[92:95]
    ds_read_b64_tr_b16 a[168:169], v8 offset:24576
    v_mfma_f32_16x16x32_bf16 v[92:95], a[188:191], v[204:207], v[92:95]
    ds_read_b64_tr_b16 a[170:171], v8 offset:26624
    buffer_store_dwordx4 v[100:103], v6, s[24:27], s94 offen offset:1024 sc1
    v_mfma_f32_16x16x32_bf16 v[92:95], a[192:195], v[212:215], v[92:95]
    ds_read_b64_tr_b16 a[172:173], v8 offset:28672
    v_mfma_f32_16x16x32_bf16 v[92:95], a[196:199], v[220:223], v[92:95]
    ds_read_b64_tr_b16 a[174:175], v8 offset:30720
    v_mfma_f32_16x16x32_bf16 v[92:95], a[200:203], v[228:231], v[92:95]
L_w7:
    s_cbranch_execz L_wb
    ds_read_b64_tr_b16 a[176:177], v8 offset:32768
    v_mfma_f32_16x16x32_bf16 v[92:95], a[204:207], v[236:239], v[92:95]
    s_add_u32 m0, s82, 106496
    ds_read_b64_tr_b16 a[178:179], v8 offset:34816
    v_mfma_f32_16x16x32_bf16 v[92:95], a[208:211], v[244:247], v[92:95]
    s_add_u32 s56, s56, s86
    ds_read_b64_tr_b16 a[180:181], v9 offset:0
    v_cvt_pk_bf16_f32 v106, v88, v89
    v_mfma_f32_16x16x32_bf16 v[92:95], a[212:215], v[252:255], v[92:95]
    s_addc_u32 s57, s57, 0
    s_cmp_eq_u32 s87, 8
    ds_read_b64_tr_b16 a[182:183], v9 offset:2048
    buffer_load_dwordx4 v24, s[56:59], 0 offen lds
    s_cbranch_scc1 L_blast
    v_mfma_f32_16x16x32_bf16 v[64:67], a[144:147], a[216:219], 0
    s_waitcnt lgkmcnt(5)
    ds_read_b64_tr_b16 a[184:185], v9 offset:4096
    v_cvt_pk_bf16_f32 v107, v90, v91
    v_mfma_f32_16x16x32_bf16 v[64:67], a[148:151], a[224:227], v[64:67]
    ds_read_b64_tr_b16 a[186:187], v9 offset:6144
    buffer_store_dwordx4 v[104:107], v6, s[24:27], s94 offen offset:2048 sc1
    v_mfma_f32_16x16x32_bf16 v[64:67], a[152:155], v[128:131], v[64:67]
    ds_read_b64_tr_b16 a[188:189], v9 offset:8192
    v_mfma_f32_16x16x32_bf16 v[64:67], a[156:159], v[136:139], v[64:67]
    ds_read_b64_tr_b16 a[190:191], v9 offset:10240
    v_mfma_f32_16x16x32_bf16 v[64:67], a[160:163], v[144:147], v[64:67]
    s_waitcnt lgkmcnt(5)
    ds_read_b64_tr_b16 a[192:193], v9 offset:12288
    v_mfma_f32_16x16x32_bf16 v[64:67], a[164:167], v[152:155], v[64:67]
    s_add_u32 m0, s82, 110592
    ds_read_b64_tr_b16 a[194:195], v9 offset:14336
    v_mfma_f32_16x16x32_bf16 v[64:67], a[168:171], v[160:163], v[64:67]
    s_add_u32 s56, s56, s86
    ds_read_b64_tr_b16 a[196:197], v9 offset:16384
    v_mfma_f32_16x16x32_bf16 v[64:67], a[172:175], v[168:171], v[64:67]
    s_addc_u32 s57, s57, 0
    ds_read_b64_tr_b16 a[198:199], v9 offset:18432
    buffer_load_dwordx4 v24, s[56:59], 0 offen lds
    v_mfma_f32_16x16x32_bf16 v[64:67], a[176:179], v[176:179], v[64:67]
    ds_read_b64_tr_b16 a[200:201], v9 offset:20480
    v_cvt_pk_bf16_f32 v110, v92, v93
    v_mfma_f32_16x16x32_bf16 v[68:71], a[144:147], a[220:223], 0
    ds_read_b64_tr_b16 a[202:203], v9 offset:22528
    v_cvt_pk_bf16_f32 v111, v94, v95
    v_mfma_f32_16x16x32_bf16 v[68:71], a[148:151], a[228:231], v[68:71]
    ds_read_b64_tr_b16 a[204:205], v9 offset:24576
    buffer_store_dwordx4 v[108:111], v6, s[24:27], s94 offen offset:3072 sc1
    v_mfma_f32_16x16x32_bf16 v[68:71], a[152:155], v[132:135], v[68:71]
    ds_read_b64_tr_b16 a[206:207], v9 offset:26624
    v_mfma_f32_16x16x32_bf16 v[68:71], a[156:159], v[140:143], v[68:71]
    ds_read_b64_tr_b16 a[208:209], v9 offset:28672
    v_mfma_f32_16x16x32_bf16 v[68:71], a[160:163], v[148:151], v[68:71]
    s_add_u32 m0, s82, 114688
    ds_read_b64_tr_b16 a[210:211], v9 offset:30720
    v_mfma_f32_16x16x32_bf16 v[68:71], a[164:167], v[156:159], v[68:71]
    s_add_u32 s56, s56, s86
    ds_read_b64_tr_b16 a[212:213], v9 offset:32768
    v_mfma_f32_16x16x32_bf16 v[68:71], a[168:171], v[164:167], v[68:71]
    s_addc_u32 s57, s57, 0
    ds_read_b64_tr_b16 a[214:215], v9 offset:34816
    buffer_load_dwordx4 v24, s[56:59], 0 offen lds
    v_mfma_f32_16x16x32_bf16 v[68:71], a[172:175], v[172:175], v[68:71]
    ds_read_b64_tr_b16 a[144:145], v10 offset:0
    v_mfma_f32_16x16x32_bf16 v[68:71], a[176:179], v[180:183], v[68:71]
    s_waitcnt lgkmcnt(5)
    ds_read_b64_tr_b16 a[146:147], v10 offset:2048
    v_mfma_f32_16x16x32_bf16 v[72:75], a[180:183], a[216:219], 0
    ds_read_b64_tr_b16 a[148:149], v10 offset:4096
    v_mfma_f32_16x16x32_bf16 v[72:75], a[184:187], a[224:227], v[72:75]
    ds_read_b64_tr_b16 a[150:151], v10 offset:6144
    v_mfma_f32_16x16x32_bf16 v[72:75], a[188:191], v[128:131], v[72:75]
    s_waitcnt lgkmcnt(5)
    ds_read_b64_tr_b16 a[152:153], v10 offset:8192
    v_mfma_f32_16x16x32_bf16 v[72:75], a[192:195], v[136:139], v[72:75]
    s_add_u32 m0, s82, 118784
    ds_read_b64_tr_b16 a[154:155], v10 offset:10240
    v_mfma_f32_16x16x32_bf16 v[72:75], a[196:199], v[144:147], v[72:75]
    s_add_u32 s56, s56, s86
    ds_read_b64_tr_b16 a[156:157], v10 offset:12288
    v_mfma_f32_16x16x32_bf16 v[72:75], a[200:203], v[152:155], v[72:75]
    s_addc_u32 s57, s57, 0
    ds_read_b64_tr_b16 a[158:159], v10 offset:14336
    buffer_load_dwordx4 v24, s[56:59], 0 offen lds
    v_mfma_f32_16x16x32_bf16 v[72:75], a[204:207], v[160:163], v[72:75]
    s_add_u32 s90, s87, s78
    ds_read_b64_tr_b16 a[160:161], v10 offset:16384
    v_mfma_f32_16x16x32_bf16 v[72:75], a[208:211], v[168:171], v[72:75]
    s_waitcnt lgkmcnt(5)
    s_and_b32 s91, s90, 7
    ds_read_b64_tr_b16 a[162:163], v10 offset:18432
    v_mfma_f32_16x16x32_bf16 v[72:75], a[212:215], v[176:179], v[72:75]
    s_add_u32 s90, s90, 2
    ds_read_b64_tr_b16 a[164:165], v10 offset:20480
    v_mfma_f32_16x16x32_bf16 v[76:79], a[180:183], a[220:223], 0
    s_and_b32 s90, s90, 7
    ds_read_b64_tr_b16 a[166:167], v10 offset:22528
    v_mfma_f32_16x16x32_bf16 v[76:79], a[184:187], a[228:231], v[76:79]
    s_waitcnt lgkmcnt(5)
    ds_read_b64_tr_b16 a[168:169], v10 offset:24576
    v_mfma_f32_16x16x32_bf16 v[76:79], a[188:191], v[132:135], v[76:79]
    s_add_u32 m0, s82, 122880
    ds_read_b64_tr_b16 a[170:171], v10 offset:26624
    v_mfma_f32_16x16x32_bf16 v[76:79], a[192:195], v[140:143], v[76:79]
    s_add_u32 s56, s56, s86
    ds_read_b64_tr_b16 a[172:173], v10 offset:28672
    v_mfma_f32_16x16x32_bf16 v[76:79], a[196:199], v[148:151], v[76:79]
    s_addc_u32 s57, s57, 0
    ds_read_b64_tr_b16 a[174:175], v10 offset:30720
    buffer_load_dwordx4 v24, s[56:59], 0 offen lds
    v_mfma_f32_16x16x32_bf16 v[76:79], a[200:203], v[156:159], v[76:79]
    s_cmp_lt_u32 s87, 6
    ds_read_b64_tr_b16 a[176:177], v10 offset:32768
    v_mfma_f32_16x16x32_bf16 v[76:79], a[204:207], v[164:167], v[76:79]
    s_cselect_b32 s90, s90, 8
    ds_read_b64_tr_b16 a[178:179], v10 offset:34816
    v_mfma_f32_16x16x32_bf16 v[76:79], a[208:211], v[172:175], v[76:79]
    s_lshl_b32 s84, s90, 7
    ds_read_b64_tr_b16 a[180:181], v11 offset:0
    v_mfma_f32_16x16x32_bf16 v[76:79], a[212:215], v[180:183], v[76:79]
    s_cmp_lt_u32 s87, 7
    ds_read_b64_tr_b16 a[182:183], v11 offset:2048
    v_mfma_f32_16x16x32_bf16 v[80:83], a[144:147], a[216:219], 0
    s_cselect_b32 s69, s69, 0
    ds_read_b64_tr_b16 a[184:185], v11 offset:4096
    v_mfma_f32_16x16x32_bf16 v[80:83], a[148:151], a[224:227], v[80:83]
    s_add_u32 m0, s82, 126976
    ds_read_b64_tr_b16 a[186:187], v11 offset:6144
    v_mfma_f32_16x16x32_bf16 v[80:83], a[152:155], v[128:131], v[80:83]
    s_waitcnt lgkmcnt(5)
    s_add_u32 s56, s56, s86
    ds_read_b64_tr_b16 a[188:189], v11 offset:8192
    v_mfma_f32_16x16x32_bf16 v[80:83], a[156:159], v[136:139], v[80:83]
    s_addc_u32 s57, s57, 0
    ds_read_b64_tr_b16 a[190:191], v11 offset:10240
    buffer_load_dwordx4 v24, s[56:59], 0 offen lds
    v_mfma_f32_16x16x32_bf16 v[80:83], a[160:163], v[144:147], v[80:83]
    s_lshl_b32 s94, s91, 14
    ds_read_b64_tr_b16 a[192:193], v11 offset:12288
    v_mfma_f32_16x16x32_bf16 v[80:83], a[164:167], v[152:155], v[80:83]
    s_add_u32 s94, s94, s92
    ds_read_b64_tr_b16 a[194:195], v11 offset:14336
    v_mfma_f32_16x16x32_bf16 v[80:83], a[168:171], v[160:163], v[80:83]
    s_mov_b32 s95, s99
    ds_read_b64_tr_b16 a[196:197], v11 offset:16384
    v_mfma_f32_16x16x32_bf16 v[80:83], a[172:175], v[168:171], v[80:83]
    s_waitcnt lgkmcnt(5)
    s_lshl_b32 s99, s91, 9
    ds_read_b64_tr_b16 a[198:199], v11 offset:18432
    v_mfma_f32_16x16x32_bf16 v[80:83], a[176:179], v[176:179], v[80:83]
    s_add_u32 s99, s99, s93
    ds_read_b64_tr_b16 a[200:201], v11 offset:20480
    v_mfma_f32_16x16x32_bf16 v[84:87], a[144:147], a[220:223], 0
    s_add_u32 m0, s82, 131072
    ds_read_b64_tr_b16 a[202:203], v11 offset:22528
    v_mfma_f32_16x16x32_bf16 v[84:87], a[148:151], a[228:231], v[84:87]
    s_add_u32 s56, s56, s86
    ds_read_b64_tr_b16 a[204:205], v11 offset:24576
    v_mfma_f32_16x16x32_bf16 v[84:87], a[152:155], v[132:135], v[84:87]
    s_addc_u32 s57, s57, 0
    ds_read_b64_tr_b16 a[206:207], v11 offset:26624
    buffer_load_dwordx4 v24, s[56:59], 0 offen lds
    v_mfma_f32_16x16x32_bf16 v[84:87], a[156:159], v[140:143], v[84:87]
    s_add_u32 s87, s87, 1
    ds_read_b64_tr_b16 a[208:209], v11 offset:28672
    v_mfma_f32_16x16x32_bf16 v[84:87], a[160:163], v[148:151], v[84:87]
    ds_read_b64_tr_b16 a[210:211], v11 offset:30720
    v_mfma_f32_16x16x32_bf16 v[84:87], a[164:167], v[156:159], v[84:87]
    ds_read_b64_tr_b16 a[212:213], v11 offset:32768
    v_mfma_f32_16x16x32_bf16 v[84:87], a[168:171], v[164:167], v[84:87]
    ds_read_b64_tr_b16 a[214:215], v11 offset:34816
    v_mfma_f32_16x16x32_bf16 v[84:87], a[172:175], v[172:175], v[84:87]
    s_waitcnt vmcnt(19) lgkmcnt(6)
    s_barrier
    ds_read_b64_tr_b16 a[144:145], v8 offset:36864
    v_mfma_f32_16x16x32_bf16 v[84:87], a[176:179], v[180:183], v[84:87]
    s_add_u32 m0, s82, 135168
    ds_read_b64_tr_b16 a[146:147], v8 offset:38912
    v_mfma_f32_16x16x32_bf16 v[88:91], a[180:183], a[216:219], 0
    s_add_u32 s56, s56, s86
    ds_read_b64_tr_b16 a[148:149], v8 offset:40960
    v_mfma_f32_16x16x32_bf16 v[88:91], a[184:187], a[224:227], v[88:91]
    s_addc_u32 s57, s57, 0
    ds_read_b64_tr_b16 a[150:151], v8 offset:43008
    buffer_load_dwordx4 v24, s[56:59], 0 offen lds
    v_mfma_f32_16x16x32_bf16 v[88:91], a[188:191], v[128:131], v[88:91]
    ds_read_b64_tr_b16 a[152:153], v8 offset:45056
    v_mfma_f32_16x16x32_bf16 v[88:91], a[192:195], v[136:139], v[88:91]
    ds_read_b64_tr_b16 a[154:155], v8 offset:47104
    v_mfma_f32_16x16x32_bf16 v[88:91], a[196:199], v[144:147], v[88:91]
    ds_read_b64_tr_b16 a[156:157], v8 offset:49152
    v_mfma_f32_16x16x32_bf16 v[88:91], a[200:203], v[152:155], v[88:91]
    s_waitcnt lgkmcnt(5)
    ds_read_b64_tr_b16 a[158:159], v8 offset:51200
    v_mfma_f32_16x16x32_bf16 v[88:91], a[204:207], v[160:163], v[88:91]
    ds_read_b64_tr_b16 a[160:161], v8 offset:53248
    v_mfma_f32_16x16x32_bf16 v[88:91], a[208:211], v[168:171], v[88:91]
    s_add_u32 m0, s82, 139264
    ds_read_b64_tr_b16 a[162:163], v8 offset:55296
    v_mfma_f32_16x16x32_bf16 v[88:91], a[212:215], v[176:179], v[88:91]
    s_add_u32 s56, s56, s86
    ds_read_b64_tr_b16 a[164:165], v8 offset:57344
    v_mfma_f32_16x16x32_bf16 v[92:95], a[180:183], a[220:223], 0
    s_addc_u32 s57, s57, 0
    ds_read_b64_tr_b16 a[166:167], v8 offset:59392
    buffer_load_dwordx4 v24, s[56:59], 0 offen lds
    v_mfma_f32_16x16x32_bf16 v[92:95], a[184:187], a[228:231], v[92:95]
    ds_read_b64_tr_b16 a[168:169], v8 offset:61440
    v_mfma_f32_16x16x32_bf16 v[92:95], a[188:191], v[132:135], v[92:95]
    ds_read_b64_tr_b16 a[170:171], v8 offset:63488
    v_mfma_f32_16x16x32_bf16 v[92:95], a[192:195], v[140:143], v[92:95]
    s_waitcnt vmcnt(7)
    ds_read_b64_tr_b16 a[172:173], v12 offset:0
    buffer_store_dword v27, v7, s[24:27], s95 offen sc1
    v_mfma_f32_16x16x32_bf16 v[92:95], a[196:199], v[148:151], v[92:95]
    ds_read_b64_tr_b16 a[174:175], v12 offset:2048
    v_mfma_f32_16x16x32_bf16 v[92:95], a[200:203], v[156:159], v[92:95]
    ds_read_b64_tr_b16 a[176:177], v12 offset:4096
    v_mfma_f32_16x16x32_bf16 v[92:95], a[204:207], v[164:167], v[92:95]
    s_add_u32 m0, s82, 143360
    ds_read_b64_tr_b16 a[178:179], v12 offset:6144
    v_mfma_f32_16x16x32_bf16 v[92:95], a[208:211], v[172:175], v[92:95]
    s_add_u32 s56, s56, s86
    ds_read_b64_tr_b16 a[180:181], v9 offset:36864
    v_mfma_f32_16x16x32_bf16 v[92:95], a[212:215], v[180:183], v[92:95]
    s_addc_u32 s57, s57, 0
    ds_read_b64_tr_b16 a[182:183], v9 offset:38912
    buffer_load_dwordx4 v24, s[56:59], 0 offen lds
    v_mfma_f32_16x16x32_bf16 v[64:67], a[144:147], v[184:187], v[64:67]
    s_waitcnt lgkmcnt(5)
    ds_read_b64_tr_b16 a[184:185], v9 offset:40960
    v_mfma_f32_16x16x32_bf16 v[64:67], a[148:151], v[192:195], v[64:67]
    ds_read_b64_tr_b16 a[186:187], v9 offset:43008
    v_mfma_f32_16x16x32_bf16 v[64:67], a[152:155], v[200:203], v[64:67]
    ds_read_b64_tr_b16 a[188:189], v9 offset:45056
    v_mfma_f32_16x16x32_bf16 v[64:67], a[156:159], v[208:211], v[64:67]
    s_waitcnt lgkmcnt(5)
    ds_read_b64_tr_b16 a[190:191], v9 offset:47104
    v_mfma_f32_16x16x32_bf16 v[64:67], a[160:163], v[216:219], v[64:67]
    s_add_u32 m0, s82, 0
    ds_read_b64_tr_b16 a[192:193], v9 offset:49152
    v_mfma_f32_16x16x32_bf16 v[64:67], a[164:167], v[224:227], v[64:67]
    s_mov_b32 s58, s69
    ds_read_b64_tr_b16 a[194:195], v9 offset:51200
    v_mfma_f32_16x16x32_bf16 v[64:67], a[168:171], v[232:235], v[64:67]
    s_add_u32 s56, s20, s84
    ds_read_b64_tr_b16 a[196:197], v9 offset:53248
    v_mfma_f32_16x16x32_bf16 v[64:67], a[172:175], v[240:243], v[64:67]
    s_addc_u32 s57, s21, 0
    ds_read_b64_tr_b16 a[198:199], v9 offset:55296
    buffer_load_dwordx4 v24, s[56:59], 0 offen lds
    v_mfma_f32_16x16x32_bf16 v[64:67], a[176:179], v[248:251], v[64:67]
    ds_read_b64_tr_b16 a[200:201], v9 offset:57344
    v_mfma_f32_16x16x32_bf16 v[68:71], a[144:147], v[188:191], v[68:71]
    ds_read_b64_tr_b16 a[202:203], v9 offset:59392
    v_mfma_f32_16x16x32_bf16 v[68:71], a[148:151], v[196:199], v[68:71]
    ds_read_b64_tr_b16 a[204:205], v9 offset:61440
    v_mfma_f32_16x16x32_bf16 v[68:71], a[152:155], v[204:207], v[68:71]
    ds_read_b64_tr_b16 a[206:207], v9 offset:63488
    v_mfma_f32_16x16x32_bf16 v[68:71], a[156:159], v[212:215], v[68:71]
    ds_read_b64_tr_b16 a[208:209], v13 offset:0
    v_mfma_f32_16x16x32_bf16 v[68:71], a[160:163], v[220:223], v[68:71]
    s_add_u32 m0, s82, 4096
    ds_read_b64_tr_b16 a[210:211], v13 offset:2048
    v_mfma_f32_16x16x32_bf16 v[68:71], a[164:167], v[228:231], v[68:71]
    s_add_u32 s56, s56, s86
    ds_read_b64_tr_b16 a[212:213], v13 offset:4096
    v_mfma_f32_16x16x32_bf16 v[68:71], a[168:171], v[236:239], v[68:71]
    s_addc_u32 s57, s57, 0
    ds_read_b64_tr_b16 a[214:215], v13 offset:6144
    buffer_load_dwordx4 v24, s[56:59], 0 offen lds
    v_mfma_f32_16x16x32_bf16 v[68:71], a[172:175], v[244:247], v[68:71]
    ds_read_b64_tr_b16 a[144:145], v10 offset:36864
    v_cvt_pk_bf16_f32 v96, v64, v65
    v_mfma_f32_16x16x32_bf16 v[68:71], a[176:179], v[252:255], v[68:71]
    s_waitcnt lgkmcnt(5)
    ds_read_b64_tr_b16 a[146:147], v10 offset:38912
    v_cvt_pk_bf16_f32 v97, v66, v67
    v_mfma_f32_16x16x32_bf16 v[72:75], a[180:183], v[184:187], v[72:75]
    ds_read_b64_tr_b16 a[148:149], v10 offset:40960
    v_mfma_f32_16x16x32_bf16 v[72:75], a[184:187], v[192:195], v[72:75]
    ds_read_b64_tr_b16 a[150:151], v10 offset:43008
    v_mfma_f32_16x16x32_bf16 v[72:75], a[188:191], v[200:203], v[72:75]
    ds_read_b64_tr_b16 a[152:153], v10 offset:45056
    v_mfma_f32_16x16x32_bf16 v[72:75], a[192:195], v[208:211], v[72:75]
    s_add_u32 m0, s82, 8192
    ds_read_b64_tr_b16 a[154:155], v10 offset:47104
    v_mfma_f32_16x16x32_bf16 v[72:75], a[196:199], v[216:219], v[72:75]
    s_add_u32 s56, s56, s86
    ds_read_b64_tr_b16 a[156:157], v10 offset:49152
    v_mfma_f32_16x16x32_bf16 v[72:75], a[200:203], v[224:227], v[72:75]
    s_addc_u32 s57, s57, 0
    ds_read_b64_tr_b16 a[158:159], v10 offset:51200
    buffer_load_dwordx4 v24, s[56:59], 0 offen lds
    v_mfma_f32_16x16x32_bf16 v[72:75], a[204:207], v[232:235], v[72:75]
    s_waitcnt lgkmcnt(5)
    ds_read_b64_tr_b16 a[160:161], v10 offset:53248
    v_mfma_f32_16x16x32_bf16 v[72:75], a[208:211], v[240:243], v[72:75]
    ds_read_b64_tr_b16 a[162:163], v10 offset:55296
    v_cvt_pk_bf16_f32 v100, v68, v69
    v_mfma_f32_16x16x32_bf16 v[72:75], a[212:215], v[248:251], v[72:75]
    ds_read_b64_tr_b16 a[164:165], v10 offset:57344
    v_cvt_pk_bf16_f32 v101, v70, v71
    v_mfma_f32_16x16x32_bf16 v[76:79], a[180:183], v[188:191], v[76:79]
    ds_read_b64_tr_b16 a[166:167], v10 offset:59392
    v_mfma_f32_16x16x32_bf16 v[76:79], a[184:187], v[196:199], v[76:79]
    ds_read_b64_tr_b16 a[168:169], v10 offset:61440
    v_mfma_f32_16x16x32_bf16 v[76:79], a[188:191], v[204:207], v[76:79]
    s_add_u32 m0, s82, 12288
    ds_read_b64_tr_b16 a[170:171], v10 offset:63488
    v_mfma_f32_16x16x32_bf16 v[76:79], a[192:195], v[212:215], v[76:79]
    s_add_u32 s56, s56, s86
    ds_read_b64_tr_b16 a[172:173], v14 offset:0
    v_mfma_f32_16x16x32_bf16 v[76:79], a[196:199], v[220:223], v[76:79]
    s_addc_u32 s57, s57, 0
    ds_read_b64_tr_b16 a[174:175], v14 offset:2048
    buffer_load_dwordx4 v24, s[56:59], 0 offen lds
    v_mfma_f32_16x16x32_bf16 v[76:79], a[200:203], v[228:231], v[76:79]
    ds_read_b64_tr_b16 a[176:177], v14 offset:4096
    v_mfma_f32_16x16x32_bf16 v[76:79], a[204:207], v[236:239], v[76:79]
    ds_read_b64_tr_b16 a[178:179], v14 offset:6144
    v_mfma_f32_16x16x32_bf16 v[76:79], a[208:211], v[244:247], v[76:79]
    ds_read_b64_tr_b16 a[180:181], v11 offset:36864
    v_cvt_pk_bf16_f32 v98, v72, v73
    v_mfma_f32_16x16x32_bf16 v[76:79], a[212:215], v[252:255], v[76:79]
    ds_read_b64_tr_b16 a[182:183], v11 offset:38912
    v_cvt_pk_bf16_f32 v99, v74, v75
    v_mfma_f32_16x16x32_bf16 v[80:83], a[144:147], v[184:187], v[80:83]
    s_waitcnt lgkmcnt(5)
    ds_read_b64_tr_b16 a[184:185], v11 offset:40960
    v_mfma_f32_16x16x32_bf16 v[80:83], a[148:151], v[192:195], v[80:83]
    s_add_u32 m0, s82, 16384
    ds_read_b64_tr_b16 a[186:187], v11 offset:43008
    v_mfma_f32_16x16x32_bf16 v[80:83], a[152:155], v[200:203], v[80:83]
    s_add_u32 s56, s56, s86
    ds_read_b64_tr_b16 a[188:189], v11 offset:45056
    v_mfma_f32_16x16x32_bf16 v[80:83], a[156:159], v[208:211], v[80:83]
    s_addc_u32 s57, s57, 0
    ds_read_b64_tr_b16 a[190:191], v11 offset:47104
    buffer_load_dwordx4 v24, s[56:59], 0 offen lds
    v_mfma_f32_16x16x32_bf16 v[80:83], a[160:163], v[216:219], v[80:83]
    ds_read_b64_tr_b16 a[192:193], v11 offset:49152
    v_mfma_f32_16x16x32_bf16 v[80:83], a[164:167], v[224:227], v[80:83]
    ds_read_b64_tr_b16 a[194:195], v11 offset:51200
    v_mfma_f32_16x16x32_bf16 v[80:83], a[168:171], v[232:235], v[80:83]
    s_waitcnt lgkmcnt(5)
    ds_read_b64_tr_b16 a[196:197], v11 offset:53248
    v_mfma_f32_16x16x32_bf16 v[80:83], a[172:175], v[240:243], v[80:83]
    ds_read_b64_tr_b16 a[198:199], v11 offset:55296
    v_cvt_pk_bf16_f32 v102, v76, v77
    v_mfma_f32_16x16x32_bf16 v[80:83], a[176:179], v[248:251], v[80:83]
    ds_read_b64_tr_b16 a[200:201], v11 offset:57344
    v_cvt_pk_bf16_f32 v103, v78, v79
    v_mfma_f32_16x16x32_bf16 v[84:87], a[144:147], v[188:191], v[84:87]
    s_add_u32 m0, s82, 20480
    ds_read_b64_tr_b16 a[202:203], v11 offset:59392
    v_mfma_f32_16x16x32_bf16 v[84:87], a[148:151], v[196:199], v[84:87]
    s_add_u32 s56, s56, s86
    ds_read_b64_tr_b16 a[204:205], v11 offset:61440
    v_mfma_f32_16x16x32_bf16 v[84:87], a[152:155], v[204:207], v[84:87]
    s_addc_u32 s57, s57, 0
    ds_read_b64_tr_b16 a[206:207], v11 offset:63488
    buffer_load_dwordx4 v24, s[56:59], 0 offen lds
    v_mfma_f32_16x16x32_bf16 v[84:87], a[156:159], v[212:215], v[84:87]
    ds_read_b64_tr_b16 a[208:209], v15 offset:0
    v_mfma_f32_16x16x32_bf16 v[84:87], a[160:163], v[220:223], v[84:87]
    ds_read_b64_tr_b16 a[210:211], v15 offset:2048
    v_mfma_f32_16x16x32_bf16 v[84:87], a[164:167], v[228:231], v[84:87]
    ds_read_b64_tr_b16 a[212:213], v15 offset:4096
    v_mfma_f32_16x16x32_bf16 v[84:87], a[168:171], v[236:239], v[84:87]
    ds_read_b64_tr_b16 a[214:215], v15 offset:6144
    v_mfma_f32_16x16x32_bf16 v[84:87], a[172:175], v[244:247], v[84:87]
    s_waitcnt vmcnt(18) lgkmcnt(6)
    s_barrier
    ds_read_b64_tr_b16 a[144:145], v12 offset:8192
    v_mfma_f32_16x16x32_bf16 v[84:87], a[176:179], v[252:255], v[84:87]
    s_add_u32 m0, s82, 24576
    ds_read_b64_tr_b16 a[146:147], v12 offset:10240
    v_cvt_pk_bf16_f32 v104, v80, v81
    v_mfma_f32_16x16x32_bf16 v[88:91], a[180:183], v[184:187], v[88:91]
    s_add_u32 s56, s56, s86
    ds_read_b64_tr_b16 a[148:149], v12 offset:12288
    v_cvt_pk_bf16_f32 v105, v82, v83
    v_mfma_f32_16x16x32_bf16 v[88:91], a[184:187], v[192:195], v[88:91]
    s_addc_u32 s57, s57, 0
    ds_read_b64_tr_b16 a[150:151], v12 offset:14336
    buffer_load_dwordx4 v24, s[56:59], 0 offen lds
    v_mfma_f32_16x16x32_bf16 v[88:91], a[188:191], v[200:203], v[88:91]
    ds_read_b64_tr_b16 a[152:153], v12 offset:16384
    buffer_store_dwordx4 v[96:99], v6, s[24:27], s94 offen offset:0 sc1
    v_mfma_f32_16x16x32_bf16 v[88:91], a[192:195], v[208:211], v[88:91]
    ds_read_b64_tr_b16 a[154:155], v12 offset:18432
    v_mfma_f32_16x16x32_bf16 v[88:91], a[196:199], v[216:219], v[88:91]
    ds_read_b64_tr_b16 a[156:157], v12 offset:20480
    v_mfma_f32_16x16x32_bf16 v[88:91], a[200:203], v[224:227], v[88:91]
    s_waitcnt lgkmcnt(5)
    ds_read_b64_tr_b16 a[158:159], v12 offset:22528
    v_mfma_f32_16x16x32_bf16 v[88:91], a[204:207], v[232:235], v[88:91]
    ds_read_b64_tr_b16 a[160:161], v12 offset:24576
    v_mfma_f32_16x16x32_bf16 v[88:91], a[208:211], v[240:243], v[88:91]
    s_add_u32 m0, s82, 28672
    ds_read_b64_tr_b16 a[162:163], v12 offset:26624
    v_cvt_pk_bf16_f32 v108, v84, v85
    v_mfma_f32_16x16x32_bf16 v[88:91], a[212:215], v[248:251], v[88:91]
    s_add_u32 s56, s56, s86
    ds_read_b64_tr_b16 a[164:165], v12 offset:28672
    v_cvt_pk_bf16_f32 v109, v86, v87
    v_mfma_f32_16x16x32_bf16 v[92:95], a[180:183], v[188:191], v[92:95]
    s_addc_u32 s57, s57, 0
    ds_read_b64_tr_b16 a[166:167], v12 offset:30720
    buffer_load_dwordx4 v24, s[56:59], 0 offen lds
    v_mfma_f32_16x16x32_bf16 v[92:95], a[184:187], v[196:199], v[92:95]
    ds_read_b64_tr_b16 a[168:169], v12 offset:32768
    v_mfma_f32_16x16x32_bf16 v[92:95], a[188:191], v[204:207], v[92:95]
    ds_read_b64_tr_b16 a[170:171], v12 offset:34816
    buffer_store_dwordx4 v[100:103], v6, s[24:27], s94 offen offset:1024 sc1
    v_mfma_f32_16x16x32_bf16 v[92:95], a[192:195], v[212:215], v[92:95]
    ds_read_b64_tr_b16 a[172:173], v12 offset:36864
    v_mfma_f32_16x16x32_bf16 v[92:95], a[196:199], v[220:223], v[92:95]
    ds_read_b64_tr_b16 a[174:175], v12 offset:38912
    v_mfma_f32_16x16x32_bf16 v[92:95], a[200:203], v[228:231], v[92:95]
    ds_read_b64_tr_b16 a[176:177], v12 offset:40960
    v_mfma_f32_16x16x32_bf16 v[92:95], a[204:207], v[236:239], v[92:95]
    s_add_u32 m0, s82, 32768
    ds_read_b64_tr_b16 a[178:179], v12 offset:43008
    v_mfma_f32_16x16x32_bf16 v[92:95], a[208:211], v[244:247], v[92:95]
    s_add_u32 s56, s56, s86
    ds_read_b64_tr_b16 a[180:181], v13 offset:8192
    v_cvt_pk_bf16_f32 v106, v88, v89
    v_mfma_f32_16x16x32_bf16 v[92:95], a[212:215], v[252:255], v[92:95]
    s_addc_u32 s57, s57, 0
    ds_read_b64_tr_b16 a[182:183], v13 offset:10240
    buffer_load_dwordx4 v24, s[56:59], 0 offen lds
    s_branch L_bloop
.p2align 3
L_blast:
    v_mfma_f32_16x16x32_bf16 v[64:67], a[144:147], a[216:219], 0
    s_waitcnt lgkmcnt(5)
    ds_read_b64_tr_b16 a[184:185], v9 offset:4096
L_w8:
    s_cbranch_execz L_w0
    v_cvt_pk_bf16_f32 v107, v90, v91
    v_mfma_f32_16x16x32_bf16 v[64:67], a[148:151], a[224:227], v[64:67]
    ds_read_b64_tr_b16 a[186:187], v9 offset:6144
    buffer_store_dwordx4 v[104:107], v6, s[24:27], s94 offen offset:2048 sc1
    v_mfma_f32_16x16x32_bf16 v[64:67], a[152:155], v[128:131], v[64:67]
    ds_read_b64_tr_b16 a[188:189], v9 offset:8192
    v_mfma_f32_16x16x32_bf16 v[64:67], a[156:159], v[136:139], v[64:67]
    ds_read_b64_tr_b16 a[190:191], v9 offset:10240
    v_mfma_f32_16x16x32_bf16 v[64:67], a[160:163], v[144:147], v[64:67]
    ds_read_b64_tr_b16 a[192:193], v9 offset:12288
    v_mfma_f32_16x16x32_bf16 v[64:67], a[164:167], v[152:155], v[64:67]
    ds_read_b64_tr_b16 a[194:195], v9 offset:14336
    v_mfma_f32_16x16x32_bf16 v[64:67], a[168:171], v[160:163], v[64:67]
    s_waitcnt lgkmcnt(5)
    ds_read_b64_tr_b16 a[196:197], v9 offset:16384
    v_mfma_f32_16x16x32_bf16 v[64:67], a[172:175], v[168:171], v[64:67]
    ds_read_b64_tr_b16 a[198:199], v9 offset:18432
    v_cvt_pk_bf16_f32 v110, v92, v93
    v_mfma_f32_16x16x32_bf16 v[64:67], a[176:179], v[176:179], v[64:67]
    ds_read_b64_tr_b16 a[200:201], v9 offset:20480
    v_cvt_pk_bf16_f32 v111, v94, v95
    v_mfma_f32_16x16x32_bf16 v[68:71], a[144:147], a[220:223], 0
    ds_read_b64_tr_b16 a[202:203], v9 offset:22528
    buffer_store_dwordx4 v[108:111], v6, s[24:27], s94 offen offset:3072 sc1
    v_mfma_f32_16x16x32_bf16 v[68:71], a[148:151], a[228:231], v[68:71]
    ds_read_b64_tr_b16 a[204:205], v9 offset:24576
    v_mfma_f32_16x16x32_bf16 v[68:71], a[152:155], v[132:135], v[68:71]
    ds_read_b64_tr_b16 a[206:207], v9 offset:26624
    v_mfma_f32_16x16x32_bf16 v[68:71], a[156:159], v[140:143], v[68:71]
    s_add_u32 s93, s93, 32
    ds_read_b64_tr_b16 a[208:209], v9 offset:28672
    v_mfma_f32_16x16x32_bf16 v[68:71], a[160:163], v[148:151], v[68:71]
    ds_read_b64_tr_b16 a[210:211], v9 offset:30720
    v_mfma_f32_16x16x32_bf16 v[68:71], a[164:167], v[156:159], v[68:71]
    ds_read_b64_tr_b16 a[212:213], v9 offset:32768
    v_mfma_f32_16x16x32_bf16 v[68:71], a[168:171], v[164:167], v[68:71]
    ds_read_b64_tr_b16 a[214:215], v9 offset:34816
    v_mfma_f32_16x16x32_bf16 v[68:71], a[172:175], v[172:175], v[68:71]
    ds_read_b64_tr_b16 a[144:145], v10 offset:0
    v_mfma_f32_16x16x32_bf16 v[68:71], a[176:179], v[180:183], v[68:71]
    ds_read_b64_tr_b16 a[146:147], v10 offset:2048
    v_mfma_f32_16x16x32_bf16 v[72:75], a[180:183], a[216:219], 0
    s_waitcnt lgkmcnt(5)
    ds_read_b64_tr_b16 a[148:149], v10 offset:4096
    v_mfma_f32_16x16x32_bf16 v[72:75], a[184:187], a[224:227], v[72:75]
    ds_read_b64_tr_b16 a[150:151], v10 offset:6144
    v_mfma_f32_16x16x32_bf16 v[72:75], a[188:191], v[128:131], v[72:75]
    ds_read_b64_tr_b16 a[152:153], v10 offset:8192
    v_mfma_f32_16x16x32_bf16 v[72:75], a[192:195], v[136:139], v[72:75]
    ds_read_b64_tr_b16 a[154:155], v10 offset:10240
    v_mfma_f32_16x16x32_bf16 v[72:75], a[196:199], v[144:147], v[72:75]
    ds_read_b64_tr_b16 a[156:157], v10 offset:12288
    v_mfma_f32_16x16x32_bf16 v[72:75], a[200:203], v[152:155], v[72:75]
    ds_read_b64_tr_b16 a[158:159], v10 offset:14336
    v_mfma_f32_16x16x32_bf16 v[72:75], a[204:207], v[160:163], v[72:75]
    s_waitcnt lgkmcnt(5)
    ds_read_b64_tr_b16 a[160:161], v10 offset:16384
    v_mfma_f32_16x16x32_bf16 v[72:75], a[208:211], v[168:171], v[72:75]
    ds_read_b64_tr_b16 a[162:163], v10 offset:18432
    v_mfma_f32_16x16x32_bf16 v[72:75], a[212:215], v[176:179], v[72:75]
    ds_read_b64_tr_b16 a[164:165], v10 offset:20480
    v_mfma_f32_16x16x32_bf16 v[76:79], a[180:183], a[220:223], 0
    ds_read_b64_tr_b16 a[166:167], v10 offset:22528
    v_mfma_f32_16x16x32_bf16 v[76:79], a[184:187], a[228:231], v[76:79]
    ds_read_b64_tr_b16 a[168:169], v10 offset:24576
    v_mfma_f32_16x16x32_bf16 v[76:79], a[188:191], v[132:135], v[76:79]
    ds_read_b64_tr_b16 a[170:171], v10 offset:26624
    v_mfma_f32_16x16x32_bf16 v[76:79], a[192:195], v[140:143], v[76:79]
    ds_read_b64_tr_b16 a[172:173], v10 offset:28672
    v_mfma_f32_16x16x32_bf16 v[76:79], a[196:199], v[148:151], v[76:79]
    ds_read_b64_tr_b16 a[174:175], v10 offset:30720
    v_mfma_f32_16x16x32_bf16 v[76:79], a[200:203], v[156:159], v[76:79]
    ds_read_b64_tr_b16 a[176:177], v10 offset:32768
    v_mfma_f32_16x16x32_bf16 v[76:79], a[204:207], v[164:167], v[76:79]
    ds_read_b64_tr_b16 a[178:179], v10 offset:34816
    v_mfma_f32_16x16x32_bf16 v[76:79], a[208:211], v[172:175], v[76:79]
    ds_read_b64_tr_b16 a[180:181], v11 offset:0
    v_mfma_f32_16x16x32_bf16 v[76:79], a[212:215], v[180:183], v[76:79]
    ds_read_b64_tr_b16 a[182:183], v11 offset:2048
    v_mfma_f32_16x16x32_bf16 v[80:83], a[144:147], a[216:219], 0
    s_waitcnt lgkmcnt(5)
    ds_read_b64_tr_b16 a[184:185], v11 offset:4096
    v_mfma_f32_16x16x32_bf16 v[80:83], a[148:151], a[224:227], v[80:83]
    ds_read_b64_tr_b16 a[186:187], v11 offset:6144
    v_mfma_f32_16x16x32_bf16 v[80:83], a[152:155], v[128:131], v[80:83]
    ds_read_b64_tr_b16 a[188:189], v11 offset:8192
    v_mfma_f32_16x16x32_bf16 v[80:83], a[156:159], v[136:139], v[80:83]
    ds_read_b64_tr_b16 a[190:191], v11 offset:10240
    v_mfma_f32_16x16x32_bf16 v[80:83], a[160:163], v[144:147], v[80:83]
    ds_read_b64_tr_b16 a[192:193], v11 offset:12288
    v_mfma_f32_16x16x32_bf16 v[80:83], a[164:167], v[152:155], v[80:83]
    ds_read_b64_tr_b16 a[194:195], v11 offset:14336
    v_mfma_f32_16x16x32_bf16 v[80:83], a[168:171], v[160:163], v[80:83]
    s_waitcnt lgkmcnt(5)
    ds_read_b64_tr_b16 a[196:197], v11 offset:16384
    v_mfma_f32_16x16x32_bf16 v[80:83], a[172:175], v[168:171], v[80:83]
    ds_read_b64_tr_b16 a[198:199], v11 offset:18432
    v_mfma_f32_16x16x32_bf16 v[80:83], a[176:179], v[176:179], v[80:83]
    ds_read_b64_tr_b16 a[200:201], v11 offset:20480
    v_mfma_f32_16x16x32_bf16 v[84:87], a[144:147], a[220:223], 0
    ds_read_b64_tr_b16 a[202:203], v11 offset:22528
    v_mfma_f32_16x16x32_bf16 v[84:87], a[148:151], a[228:231], v[84:87]
    ds_read_b64_tr_b16 a[204:205], v11 offset:24576
    v_mfma_f32_16x16x32_bf16 v[84:87], a[152:155], v[132:135], v[84:87]
    ds_read_b64_tr_b16 a[206:207], v11 offset:26624
    v_mfma_f32_16x16x32_bf16 v[84:87], a[156:159], v[140:143], v[84:87]
    ds_read_b64_tr_b16 a[208:209], v11 offset:28672
    v_mfma_f32_16x16x32_bf16 v[84:87], a[160:163], v[148:151], v[84:87]
    ds_read_b64_tr_b16 a[210:211], v11 offset:30720
    v_mfma_f32_16x16x32_bf16 v[84:87], a[164:167], v[156:159], v[84:87]
    ds_read_b64_tr_b16 a[212:213], v11 offset:32768
    v_mfma_f32_16x16x32_bf16 v[84:87], a[168:171], v[164:167], v[84:87]
    ds_read_b64_tr_b16 a[214:215], v11 offset:34816
    v_mfma_f32_16x16x32_bf16 v[84:87], a[172:175], v[172:175], v[84:87]
    s_waitcnt vmcnt(13) lgkmcnt(6)
    s_barrier
    ds_read_b64_tr_b16 a[144:145], v8 offset:36864
    v_mfma_f32_16x16x32_bf16 v[84:87], a[176:179], v[180:183], v[84:87]
L_w9:
    s_cbranch_execz L_wb
    ds_read_b64_tr_b16 a[146:147], v8 offset:38912
    v_mfma_f32_16x16x32_bf16 v[88:91], a[180:183], a[216:219], 0
    ds_read_b64_tr_b16 a[148:149], v8 offset:40960
    v_mfma_f32_16x16x32_bf16 v[88:91], a[184:187], a[224:227], v[88:91]
    ds_read_b64_tr_b16 a[150:151], v8 offset:43008
    v_mfma_f32_16x16x32_bf16 v[88:91], a[188:191], v[128:131], v[88:91]
    ds_read_b64_tr_b16 a[152:153], v8 offset:45056
    v_mfma_f32_16x16x32_bf16 v[88:91], a[192:195], v[136:139], v[88:91]
    ds_read_b64_tr_b16 a[154:155], v8 offset:47104
    v_mfma_f32_16x16x32_bf16 v[88:91], a[196:199], v[144:147], v[88:91]
    ds_read_b64_tr_b16 a[156:157], v8 offset:49152
    v_mfma_f32_16x16x32_bf16 v[88:91], a[200:203], v[152:155], v[88:91]
    s_waitcnt lgkmcnt(5)
    ds_read_b64_tr_b16 a[158:159], v8 offset:51200
    v_mfma_f32_16x16x32_bf16 v[88:91], a[204:207], v[160:163], v[88:91]
    ds_read_b64_tr_b16 a[160:161], v8 offset:53248
    v_mfma_f32_16x16x32_bf16 v[88:91], a[208:211], v[168:171], v[88:91]
    ds_read_b64_tr_b16 a[162:163], v8 offset:55296
    v_mfma_f32_16x16x32_bf16 v[88:91], a[212:215], v[176:179], v[88:91]
    ds_read_b64_tr_b16 a[164:165], v8 offset:57344
    v_mfma_f32_16x16x32_bf16 v[92:95], a[180:183], a[220:223], 0
    ds_read_b64_tr_b16 a[166:167], v8 offset:59392
    v_mfma_f32_16x16x32_bf16 v[92:95], a[184:187], a[228:231], v[92:95]
    ds_read_b64_tr_b16 a[168:169], v8 offset:61440
    v_mfma_f32_16x16x32_bf16 v[92:95], a[188:191], v[132:135], v[92:95]
    ds_read_b64_tr_b16 a[170:171], v8 offset:63488
    v_mfma_f32_16x16x32_bf16 v[92:95], a[192:195], v[140:143], v[92:95]
    s_waitcnt vmcnt(0)
    ds_read_b64_tr_b16 a[172:173], v12 offset:0
    buffer_store_dword v27, v7, s[24:27], s99 offen sc1
    v_mfma_f32_16x16x32_bf16 v[92:95], a[196:199], v[148:151], v[92:95]
    ds_read_b64_tr_b16 a[174:175], v12 offset:2048
    v_mfma_f32_16x16x32_bf16 v[92:95], a[200:203], v[156:159], v[92:95]
    ds_read_b64_tr_b16 a[176:177], v12 offset:4096
    v_mfma_f32_16x16x32_bf16 v[92:95], a[204:207], v[164:167], v[92:95]
    ds_read_b64_tr_b16 a[178:179], v12 offset:6144
    v_mfma_f32_16x16x32_bf16 v[92:95], a[208:211], v[172:175], v[92:95]
    ds_read_b64_tr_b16 a[180:181], v9 offset:36864
    v_mfma_f32_16x16x32_bf16 v[92:95], a[212:215], v[180:183], v[92:95]
    ds_read_b64_tr_b16 a[182:183], v9 offset:38912
    v_mfma_f32_16x16x32_bf16 v[64:67], a[144:147], v[184:187], v[64:67]
    s_waitcnt lgkmcnt(5)
    ds_read_b64_tr_b16 a[184:185], v9 offset:40960
    v_mfma_f32_16x16x32_bf16 v[64:67], a[148:151], v[192:195], v[64:67]
    ds_read_b64_tr_b16 a[186:187], v9 offset:43008
    v_mfma_f32_16x16x32_bf16 v[64:67], a[152:155], v[200:203], v[64:67]
    ds_read_b64_tr_b16 a[188:189], v9 offset:45056
    v_mfma_f32_16x16x32_bf16 v[64:67], a[156:159], v[208:211], v[64:67]
    ds_read_b64_tr_b16 a[190:191], v9 offset:47104
    v_mfma_f32_16x16x32_bf16 v[64:67], a[160:163], v[216:219], v[64:67]
    ds_read_b64_tr_b16 a[192:193], v9 offset:49152
    v_mfma_f32_16x16x32_bf16 v[64:67], a[164:167], v[224:227], v[64:67]
    ds_read_b64_tr_b16 a[194:195], v9 offset:51200
    v_mfma_f32_16x16x32_bf16 v[64:67], a[168:171], v[232:235], v[64:67]
    s_waitcnt lgkmcnt(5)
    ds_read_b64_tr_b16 a[196:197], v9 offset:53248
    v_mfma_f32_16x16x32_bf16 v[64:67], a[172:175], v[240:243], v[64:67]
    s_add_u32 s83, s98, 131072
    ds_read_b64_tr_b16 a[198:199], v9 offset:55296
    v_mfma_f32_16x16x32_bf16 v[64:67], a[176:179], v[248:251], v[64:67]
    ds_read_b64_tr_b16 a[200:201], v9 offset:57344
    v_mfma_f32_16x16x32_bf16 v[68:71], a[144:147], v[188:191], v[68:71]
    ds_read_b64_tr_b16 a[202:203], v9 offset:59392
    v_mfma_f32_16x16x32_bf16 v[68:71], a[148:151], v[196:199], v[68:71]
    ds_read_b64_tr_b16 a[204:205], v9 offset:61440
    v_mfma_f32_16x16x32_bf16 v[68:71], a[152:155], v[204:207], v[68:71]
    ds_read_b64_tr_b16 a[206:207], v9 offset:63488
    v_mfma_f32_16x16x32_bf16 v[68:71], a[156:159], v[212:215], v[68:71]
    ds_read_b64_tr_b16 a[208:209], v13 offset:0
    v_cvt_pk_bf16_f32 v32, v64, v65
    v_mfma_f32_16x16x32_bf16 v[68:71], a[160:163], v[220:223], v[68:71]
    ds_read_b64_tr_b16 a[210:211], v13 offset:2048
    v_cvt_pk_bf16_f32 v33, v66, v67
    v_mfma_f32_16x16x32_bf16 v[68:71], a[164:167], v[228:231], v[68:71]
    ds_read_b64_tr_b16 a[212:213], v13 offset:4096
    buffer_store_dwordx2 v[32:33], v4, s[24:27], s83 offen sc1
    v_mfma_f32_16x16x32_bf16 v[68:71], a[168:171], v[236:239], v[68:71]
    ds_read_b64_tr_b16 a[214:215], v13 offset:6144
    v_mfma_f32_16x16x32_bf16 v[68:71], a[172:175], v[244:247], v[68:71]
    s_add_u32 s84, s98, 720896
    ds_read_b64_tr_b16 a[144:145], v10 offset:36864
    v_mfma_f32_16x16x32_bf16 v[68:71], a[176:179], v[252:255], v[68:71]
    ds_read_b64_tr_b16 a[146:147], v10 offset:38912
    v_mfma_f32_16x16x32_bf16 v[72:75], a[180:183], v[184:187], v[72:75]
    s_waitcnt lgkmcnt(5)
    ds_read_b64_tr_b16 a[148:149], v10 offset:40960
    v_mfma_f32_16x16x32_bf16 v[72:75], a[184:187], v[192:195], v[72:75]
    ds_read_b64_tr_b16 a[150:151], v10 offset:43008
    v_mfma_f32_16x16x32_bf16 v[72:75], a[188:191], v[200:203], v[72:75]
    ds_read_b64_tr_b16 a[152:153], v10 offset:45056
    v_mfma_f32_16x16x32_bf16 v[72:75], a[192:195], v[208:211], v[72:75]
    ds_read_b64_tr_b16 a[154:155], v10 offset:47104
    v_cvt_pk_bf16_f32 v34, v68, v69
    v_mfma_f32_16x16x32_bf16 v[72:75], a[196:199], v[216:219], v[72:75]
    ds_read_b64_tr_b16 a[156:157], v10 offset:49152
    v_cvt_pk_bf16_f32 v35, v70, v71
    v_mfma_f32_16x16x32_bf16 v[72:75], a[200:203], v[224:227], v[72:75]
    ds_read_b64_tr_b16 a[158:159], v10 offset:51200
    buffer_store_dwordx2 v[34:35], v4, s[24:27], s84 offen sc1
    v_mfma_f32_16x16x32_bf16 v[72:75], a[204:207], v[232:235], v[72:75]
    s_waitcnt lgkmcnt(5)
    ds_read_b64_tr_b16 a[160:161], v10 offset:53248
    v_mfma_f32_16x16x32_bf16 v[72:75], a[208:211], v[240:243], v[72:75]
    s_add_u32 s83, s98, 278528
    ds_read_b64_tr_b16 a[162:163], v10 offset:55296
    v_mfma_f32_16x16x32_bf16 v[72:75], a[212:215], v[248:251], v[72:75]
    ds_read_b64_tr_b16 a[164:165], v10 offset:57344
    v_mfma_f32_16x16x32_bf16 v[76:79], a[180:183], v[188:191], v[76:79]
    ds_read_b64_tr_b16 a[166:167], v10 offset:59392
    v_mfma_f32_16x16x32_bf16 v[76:79], a[184:187], v[196:199], v[76:79]
    ds_read_b64_tr_b16 a[168:169], v10 offset:61440
    v_mfma_f32_16x16x32_bf16 v[76:79], a[188:191], v[204:207], v[76:79]
    ds_read_b64_tr_b16 a[170:171], v10 offset:63488
    v_mfma_f32_16x16x32_bf16 v[76:79], a[192:195], v[212:215], v[76:79]
    ds_read_b64_tr_b16 a[172:173], v14 offset:0
    v_cvt_pk_bf16_f32 v36, v72, v73
    v_mfma_f32_16x16x32_bf16 v[76:79], a[196:199], v[220:223], v[76:79]
    ds_read_b64_tr_b16 a[174:175], v14 offset:2048
    v_cvt_pk_bf16_f32 v37, v74, v75
    v_mfma_f32_16x16x32_bf16 v[76:79], a[200:203], v[228:231], v[76:79]
    ds_read_b64_tr_b16 a[176:177], v14 offset:4096
    buffer_store_dwordx2 v[36:37], v4, s[24:27], s83 offen sc1
    v_mfma_f32_16x16x32_bf16 v[76:79], a[204:207], v[236:239], v[76:79]
    ds_read_b64_tr_b16 a[178:179], v14 offset:6144
    v_mfma_f32_16x16x32_bf16 v[76:79], a[208:211], v[244:247], v[76:79]
    s_add_u32 s84, s98, 868352
    ds_read_b64_tr_b16 a[180:181], v11 offset:36864
    v_mfma_f32_16x16x32_bf16 v[76:79], a[212:215], v[252:255], v[76:79]
    ds_read_b64_tr_b16 a[182:183], v11 offset:38912
    v_mfma_f32_16x16x32_bf16 v[80:83], a[144:147], v[184:187], v[80:83]
    s_waitcnt lgkmcnt(5)
    ds_read_b64_tr_b16 a[184:185], v11 offset:40960
    v_mfma_f32_16x16x32_bf16 v[80:83], a[148:151], v[192:195], v[80:83]
    ds_read_b64_tr_b16 a[186:187], v11 offset:43008
    v_mfma_f32_16x16x32_bf16 v[80:83], a[152:155], v[200:203], v[80:83]
    ds_read_b64_tr_b16 a[188:189], v11 offset:45056
    v_mfma_f32_16x16x32_bf16 v[80:83], a[156:159], v[208:211], v[80:83]
    ds_read_b64_tr_b16 a[190:191], v11 offset:47104
    v_cvt_pk_bf16_f32 v38, v76, v77
    v_mfma_f32_16x16x32_bf16 v[80:83], a[160:163], v[216:219], v[80:83]
    ds_read_b64_tr_b16 a[192:193], v11 offset:49152
    v_cvt_pk_bf16_f32 v39, v78, v79
    v_mfma_f32_16x16x32_bf16 v[80:83], a[164:167], v[224:227], v[80:83]
    ds_read_b64_tr_b16 a[194:195], v11 offset:51200
    buffer_store_dwordx2 v[38:39], v4, s[24:27], s84 offen sc1
    v_mfma_f32_16x16x32_bf16 v[80:83], a[168:171], v[232:235], v[80:83]
    s_waitcnt lgkmcnt(5)
    ds_read_b64_tr_b16 a[196:197], v11 offset:53248
    v_mfma_f32_16x16x32_bf16 v[80:83], a[172:175], v[240:243], v[80:83]
    s_add_u32 s83, s98, 425984
    ds_read_b64_tr_b16 a[198:199], v11 offset:55296
    v_mfma_f32_16x16x32_bf16 v[80:83], a[176:179], v[248:251], v[80:83]
    ds_read_b64_tr_b16 a[200:201], v11 offset:57344
    v_mfma_f32_16x16x32_bf16 v[84:87], a[144:147], v[188:191], v[84:87]
    ds_read_b64_tr_b16 a[202:203], v11 offset:59392
    v_mfma_f32_16x16x32_bf16 v[84:87], a[148:151], v[196:199], v[84:87]
    ds_read_b64_tr_b16 a[204:205], v11 offset:61440
    v_mfma_f32_16x16x32_bf16 v[84:87], a[152:155], v[204:207], v[84:87]
    ds_read_b64_tr_b16 a[206:207], v11 offset:63488
    v_mfma_f32_16x16x32_bf16 v[84:87], a[156:159], v[212:215], v[84:87]
    ds_read_b64_tr_b16 a[208:209], v15 offset:0
    v_mfma_f32_16x16x32_bf16 v[84:87], a[160:163], v[220:223], v[84:87]
    ds_read_b64_tr_b16 a[210:211], v15 offset:2048
    v_mfma_f32_16x16x32_bf16 v[84:87], a[164:167], v[228:231], v[84:87]
    ds_read_b64_tr_b16 a[212:213], v15 offset:4096
    v_mfma_f32_16x16x32_bf16 v[84:87], a[168:171], v[236:239], v[84:87]
    ds_read_b64_tr_b16 a[214:215], v15 offset:6144
    v_mfma_f32_16x16x32_bf16 v[84:87], a[172:175], v[244:247], v[84:87]
    s_add_u32 s84, s98, 1015808
    v_cvt_pk_bf16_f32 v40, v80, v81
    v_cvt_pk_bf16_f32 v41, v82, v83
    v_mfma_f32_16x16x32_bf16 v[84:87], a[176:179], v[252:255], v[84:87]
    buffer_store_dwordx2 v[40:41], v4, s[24:27], s83 offen sc1
    v_mfma_f32_16x16x32_bf16 v[88:91], a[180:183], v[184:187], v[88:91]
    s_waitcnt lgkmcnt(3)
    v_mfma_f32_16x16x32_bf16 v[88:91], a[184:187], v[192:195], v[88:91]
    v_mfma_f32_16x16x32_bf16 v[88:91], a[188:191], v[200:203], v[88:91]
    v_mfma_f32_16x16x32_bf16 v[88:91], a[192:195], v[208:211], v[88:91]
    v_mfma_f32_16x16x32_bf16 v[88:91], a[196:199], v[216:219], v[88:91]
    v_mfma_f32_16x16x32_bf16 v[88:91], a[200:203], v[224:227], v[88:91]
    v_mfma_f32_16x16x32_bf16 v[88:91], a[204:207], v[232:235], v[88:91]
    s_waitcnt lgkmcnt(0)
    v_mfma_f32_16x16x32_bf16 v[88:91], a[208:211], v[240:243], v[88:91]
    s_add_u32 s83, s98, 573440
    v_cvt_pk_bf16_f32 v42, v84, v85
    v_cvt_pk_bf16_f32 v43, v86, v87
    v_mfma_f32_16x16x32_bf16 v[88:91], a[212:215], v[248:251], v[88:91]
    buffer_store_dwordx2 v[42:43], v4, s[24:27], s84 offen sc1
    v_mfma_f32_16x16x32_bf16 v[92:95], a[180:183], v[188:191], v[92:95]
    v_mfma_f32_16x16x32_bf16 v[92:95], a[184:187], v[196:199], v[92:95]
    v_mfma_f32_16x16x32_bf16 v[92:95], a[188:191], v[204:207], v[92:95]
    v_mfma_f32_16x16x32_bf16 v[92:95], a[192:195], v[212:215], v[92:95]
    v_mfma_f32_16x16x32_bf16 v[92:95], a[196:199], v[220:223], v[92:95]
    v_mfma_f32_16x16x32_bf16 v[92:95], a[200:203], v[228:231], v[92:95]
    v_mfma_f32_16x16x32_bf16 v[92:95], a[204:207], v[236:239], v[92:95]
    v_mfma_f32_16x16x32_bf16 v[92:95], a[208:211], v[244:247], v[92:95]
    s_add_u32 s84, s98, 1163264
    v_cvt_pk_bf16_f32 v44, v88, v89
    v_cvt_pk_bf16_f32 v45, v90, v91
    v_mfma_f32_16x16x32_bf16 v[92:95], a[212:215], v[252:255], v[92:95]
    buffer_store_dwordx2 v[44:45], v4, s[24:27], s83 offen sc1
    s_nop 6
    v_cvt_pk_bf16_f32 v46, v92, v93
    v_cvt_pk_bf16_f32 v47, v94, v95
    buffer_store_dwordx2 v[46:47], v4, s[24:27], s84 offen sc1
    s_waitcnt vmcnt(0)
    buffer_store_dword v27, v2, s[24:27], s93 offen sc1
    s_endpgm
L_p1:
    s_lshr_b32 s91, s76, 1
    s_mul_i32 s91, s91, 140
    s_add_u32 s91, s91, 0
    buffer_load_dword v5, v26, s[36:39], s91 offen
    v_subrev_u32 v2, 94208, v210
L_w10:
    s_cbranch_execz L_w14
    s_waitcnt vmcnt(2)
    s_barrier
    s_nop 0
    ds_read_b64_tr_b16 a[216:217], v210 offset:0
    ds_read_b64_tr_b16 a[218:219], v210 offset:128
    ds_read_b64_tr_b16 a[220:221], v210 offset:1024
    ds_read_b64_tr_b16 a[222:223], v210 offset:1152
    ds_read_b64_tr_b16 a[224:225], v210 offset:2048
    ds_read_b64_tr_b16 a[226:227], v210 offset:2176
    ds_read_b64_tr_b16 a[228:229], v210 offset:3072
    ds_read_b64_tr_b16 a[230:231], v210 offset:3200
    ds_read_b64_tr_b16 a[232:233], v210 offset:4096
    ds_read_b64_tr_b16 a[234:235], v210 offset:4224
    ds_read_b64_tr_b16 a[236:237], v210 offset:5120
    ds_read_b64_tr_b16 a[238:239], v210 offset:5248
    ds_read_b64_tr_b16 a[240:241], v210 offset:6144
    ds_read_b64_tr_b16 a[242:243], v210 offset:6272
    ds_read_b64_tr_b16 a[244:245], v210 offset:7168
    ds_read_b64_tr_b16 a[246:247], v210 offset:7296
    ds_read_b64_tr_b16 a[248:249], v210 offset:8192
    ds_read_b64_tr_b16 a[250:251], v210 offset:8320
    v_cvt_pk_bf16_f32 v120, v120, v156
    v_cvt_pk_bf16_f32 v121, v121, v157
    v_cvt_pk_bf16_f32 v122, v122, v158
    v_cvt_pk_bf16_f32 v123, v123, v159
    v_accvgpr_write_b32 a116, v120
    v_accvgpr_write_b32 a117, v121
    v_accvgpr_write_b32 a118, v122
    v_accvgpr_write_b32 a119, v123
    v_cvt_pk_bf16_f32 v124, v124, v160
    v_cvt_pk_bf16_f32 v125, v125, v161
    v_cvt_pk_bf16_f32 v126, v126, v162
    v_cvt_pk_bf16_f32 v127, v127, v163
    v_accvgpr_write_b32 a120, v124
    v_accvgpr_write_b32 a121, v125
    v_accvgpr_write_b32 a122, v126
    v_accvgpr_write_b32 a123, v127
    v_cvt_pk_bf16_f32 v128, v128, v164
    v_cvt_pk_bf16_f32 v129, v129, v165
    v_cvt_pk_bf16_f32 v130, v130, v166
    v_cvt_pk_bf16_f32 v131, v131, v167
    v_accvgpr_write_b32 a124, v128
    v_accvgpr_write_b32 a125, v129
    v_accvgpr_write_b32 a126, v130
    v_accvgpr_write_b32 a127, v131
    v_cvt_pk_bf16_f32 v132, v132, v168
    v_cvt_pk_bf16_f32 v133, v133, v169
    v_cvt_pk_bf16_f32 v134, v134, v170
    v_cvt_pk_bf16_f32 v135, v135, v171
    v_accvgpr_write_b32 a128, v132
    v_accvgpr_write_b32 a129, v133
    v_accvgpr_write_b32 a130, v134
    v_accvgpr_write_b32 a131, v135
    v_cvt_pk_bf16_f32 v136, v136, v172
    v_cvt_pk_bf16_f32 v137, v137, v173
    v_cvt_pk_bf16_f32 v138, v138, v174
    v_cvt_pk_bf16_f32 v139, v139, v175
    v_accvgpr_write_b32 a132, v136
    v_accvgpr_write_b32 a133, v137
    v_accvgpr_write_b32 a134, v138
    v_accvgpr_write_b32 a135, v139
    v_cvt_pk_bf16_f32 v140, v140, v176
    v_cvt_pk_bf16_f32 v141, v141, v177
    v_cvt_pk_bf16_f32 v142, v142, v178
    v_cvt_pk_bf16_f32 v143, v143, v179
    v_accvgpr_write_b32 a136, v140
    v_accvgpr_write_b32 a137, v141
    v_accvgpr_write_b32 a138, v142
    v_accvgpr_write_b32 a139, v143
    v_cvt_pk_bf16_f32 v144, v144, v180
    v_cvt_pk_bf16_f32 v145, v145, v181
    v_cvt_pk_bf16_f32 v146, v146, v182
    v_cvt_pk_bf16_f32 v147, v147, v183
    v_accvgpr_write_b32 a140, v144
    v_accvgpr_write_b32 a141, v145
    v_accvgpr_write_b32 a142, v146
    v_accvgpr_write_b32 a143, v147
    s_bitcmp1_b32 s78, 2
    s_cbranch_scc1 L_kvu1
    s_bitcmp1_b32 s78, 1
    s_cbranch_scc1 L_kv01
    s_waitcnt lgkmcnt(12)
    v_mfma_f32_16x16x32_bf16 v[192:195], a[216:219], a[0:3], 0
    s_add_u32 m0, s82, 36864
    ds_read_b64_tr_b16 a[180:181], v210 offset:9216
    ds_read_b64_tr_b16 a[182:183], v210 offset:9344
    v_mfma_f32_16x16x32_bf16 v[192:195], a[220:223], a[4:7], v[192:195]
    s_add_u32 s83, s83, s86
    ds_read_b64_tr_b16 a[184:185], v210 offset:10240
    ds_read_b64_tr_b16 a[186:187], v210 offset:10368
    buffer_load_dwordx4 v24, s[12:15], s83 offen lds
    v_mfma_f32_16x16x32_bf16 v[192:195], a[224:227], a[8:11], v[192:195]
    s_waitcnt lgkmcnt(10)
    s_add_u32 m0, s82, 40960
    ds_read_b64_tr_b16 a[188:189], v210 offset:11264
    ds_read_b64_tr_b16 a[190:191], v210 offset:11392
    v_mfma_f32_16x16x32_bf16 v[192:195], a[228:231], a[12:15], v[192:195]
    s_add_u32 s83, s83, s86
    ds_read_b64_tr_b16 a[192:193], v210 offset:12288
    ds_read_b64_tr_b16 a[194:195], v210 offset:12416
    buffer_load_dwordx4 v24, s[12:15], s83 offen lds
    v_mfma_f32_16x16x32_bf16 v[192:195], a[232:235], a[16:19], v[192:195]
    s_add_u32 m0, s82, 45056
    ds_read_b64_tr_b16 a[196:197], v210 offset:13312
    ds_read_b64_tr_b16 a[198:199], v210 offset:13440
    v_mfma_f32_16x16x32_bf16 v[192:195], a[236:239], a[20:23], v[192:195]
    s_waitcnt lgkmcnt(10)
    s_add_u32 s83, s83, s86
    ds_read_b64_tr_b16 a[200:201], v210 offset:14336
    ds_read_b64_tr_b16 a[202:203], v210 offset:14464
    buffer_load_dwordx4 v24, s[12:15], s83 offen lds
    v_mfma_f32_16x16x32_bf16 v[192:195], a[240:243], a[24:27], v[192:195]
    s_add_u32 m0, s82, 49152
    ds_read_b64_tr_b16 a[204:205], v210 offset:15360
    ds_read_b64_tr_b16 a[206:207], v210 offset:15488
    v_mfma_f32_16x16x32_bf16 v[192:195], a[244:247], a[28:31], v[192:195]
    s_add_u32 s83, s83, s86
    ds_read_b64_tr_b16 a[208:209], v2 offset:16384
    ds_read_b64_tr_b16 a[210:211], v2 offset:16512
    buffer_load_dwordx4 v24, s[12:15], s83 offen lds
    v_mfma_f32_16x16x32_bf16 v[192:195], a[248:251], a[32:35], v[192:195]
    s_waitcnt lgkmcnt(10)
    s_add_u32 m0, s82, 53248
    ds_read_b64_tr_b16 a[212:213], v2 offset:17408
    ds_read_b64_tr_b16 a[214:215], v2 offset:17536
    v_mfma_f32_16x16x32_bf16 v[192:195], a[180:183], a[36:39], v[192:195]
    s_add_u32 s83, s83, s86
    ds_read_b64_tr_b16 a[144:145], v8 offset:0
    ds_read_b64_tr_b16 a[146:147], v8 offset:2048
    buffer_load_dwordx4 v24, s[12:15], s83 offen lds
    v_mfma_f32_16x16x32_bf16 v[192:195], a[184:187], a[40:43], v[192:195]
    s_add_u32 m0, s82, 57344
    ds_read_b64_tr_b16 a[148:149], v8 offset:4096
    ds_read_b64_tr_b16 a[150:151], v8 offset:6144
    v_mfma_f32_16x16x32_bf16 v[192:195], a[188:191], a[44:47], v[192:195]
    s_waitcnt lgkmcnt(10)
    s_add_u32 s83, s83, s86
    ds_read_b64_tr_b16 a[152:153], v8 offset:8192
    ds_read_b64_tr_b16 a[154:155], v8 offset:10240
    buffer_load_dwordx4 v24, s[12:15], s83 offen lds
    v_mfma_f32_16x16x32_bf16 v[192:195], a[192:195], a[48:51], v[192:195]
    s_add_u32 m0, s82, 61440
    ds_read_b64_tr_b16 a[156:157], v8 offset:12288
    ds_read_b64_tr_b16 a[158:159], v8 offset:14336
    v_mfma_f32_16x16x32_bf16 v[192:195], a[196:199], a[52:55], v[192:195]
    s_add_u32 s83, s83, s86
    ds_read_b64_tr_b16 a[160:161], v8 offset:16384
    ds_read_b64_tr_b16 a[162:163], v8 offset:18432
    buffer_load_dwordx4 v24, s[12:15], s83 offen lds
    v_mfma_f32_16x16x32_bf16 v[192:195], a[200:203], a[56:59], v[192:195]
    s_waitcnt lgkmcnt(10)
    s_add_u32 m0, s82, 65536
    ds_read_b64_tr_b16 a[164:165], v8 offset:20480
    ds_read_b64_tr_b16 a[166:167], v8 offset:22528
    v_mfma_f32_16x16x32_bf16 v[192:195], a[204:207], a[60:63], v[192:195]
    s_add_u32 s83, s83, s86
    ds_read_b64_tr_b16 a[168:169], v8 offset:24576
    ds_read_b64_tr_b16 a[170:171], v8 offset:26624
    buffer_load_dwordx4 v24, s[12:15], s83 offen lds
    v_mfma_f32_16x16x32_bf16 v[192:195], a[208:211], a[64:67], v[192:195]
    s_add_u32 m0, s82, 69632
    ds_read_b64_tr_b16 a[172:173], v8 offset:28672
    ds_read_b64_tr_b16 a[174:175], v8 offset:30720
    v_mfma_f32_16x16x32_bf16 v[192:195], a[212:215], a[68:71], v[192:195]
    s_add_u32 s83, s83, s86
    ds_read_b64_tr_b16 a[176:177], v8 offset:32768
    ds_read_b64_tr_b16 a[178:179], v8 offset:34816
    ds_read_b64_tr_b16 a[180:181], v9 offset:0
    ds_read_b64_tr_b16 a[182:183], v9 offset:2048
    s_branch L_kvdone
L_kv01:
    s_waitcnt lgkmcnt(12)
    v_mfma_f32_16x16x32_bf16 v[192:195], a[0:3], a[216:219], 0
    s_add_u32 m0, s82, 36864
    ds_read_b64_tr_b16 a[180:181], v210 offset:9216
    ds_read_b64_tr_b16 a[182:183], v210 offset:9344
    v_mfma_f32_16x16x32_bf16 v[192:195], a[4:7], a[220:223], v[192:195]
    s_add_u32 s83, s83, s86
    ds_read_b64_tr_b16 a[184:185], v210 offset:10240
    ds_read_b64_tr_b16 a[186:187], v210 offset:10368
    buffer_load_dwordx4 v24, s[12:15], s83 offen lds
    v_mfma_f32_16x16x32_bf16 v[192:195], a[8:11], a[224:227], v[192:195]
    s_waitcnt lgkmcnt(10)
    s_add_u32 m0, s82, 40960
    ds_read_b64_tr_b16 a[188:189], v210 offset:11264
    ds_read_b64_tr_b16 a[190:191], v210 offset:11392
    v_mfma_f32_16x16x32_bf16 v[192:195], a[12:15], a[228:231], v[192:195]
    s_add_u32 s83, s83, s86
    ds_read_b64_tr_b16 a[192:193], v210 offset:12288
    ds_read_b64_tr_b16 a[194:195], v210 offset:12416
    buffer_load_dwordx4 v24, s[12:15], s83 offen lds
    v_mfma_f32_16x16x32_bf16 v[192:195], a[16:19], a[232:235], v[192:195]
    s_add_u32 m0, s82, 45056
    ds_read_b64_tr_b16 a[196:197], v210 offset:13312
    ds_read_b64_tr_b16 a[198:199], v210 offset:13440
    v_mfma_f32_16x16x32_bf16 v[192:195], a[20:23], a[236:239], v[192:195]
    s_waitcnt lgkmcnt(10)
    s_add_u32 s83, s83, s86
    ds_read_b64_tr_b16 a[200:201], v210 offset:14336
    ds_read_b64_tr_b16 a[202:203], v210 offset:14464
    buffer_load_dwordx4 v24, s[12:15], s83 offen lds
    v_mfma_f32_16x16x32_bf16 v[192:195], a[24:27], a[240:243], v[192:195]
    s_add_u32 m0, s82, 49152
    ds_read_b64_tr_b16 a[204:205], v210 offset:15360
    ds_read_b64_tr_b16 a[206:207], v210 offset:15488
    v_mfma_f32_16x16x32_bf16 v[192:195], a[28:31], a[244:247], v[192:195]
    s_add_u32 s83, s83, s86
    ds_read_b64_tr_b16 a[208:209], v2 offset:16384
    ds_read_b64_tr_b16 a[210:211], v2 offset:16512
    buffer_load_dwordx4 v24, s[12:15], s83 offen lds
    v_mfma_f32_16x16x32_bf16 v[192:195], a[32:35], a[248:251], v[192:195]
    s_waitcnt lgkmcnt(10)
    s_add_u32 m0, s82, 53248
    ds_read_b64_tr_b16 a[212:213], v2 offset:17408
    ds_read_b64_tr_b16 a[214:215], v2 offset:17536
    v_mfma_f32_16x16x32_bf16 v[192:195], a[36:39], a[180:183], v[192:195]
    s_add_u32 s83, s83, s86
    ds_read_b64_tr_b16 a[144:145], v8 offset:0
    ds_read_b64_tr_b16 a[146:147], v8 offset:2048
    buffer_load_dwordx4 v24, s[12:15], s83 offen lds
    v_mfma_f32_16x16x32_bf16 v[192:195], a[40:43], a[184:187], v[192:195]
    s_add_u32 m0, s82, 57344
    ds_read_b64_tr_b16 a[148:149], v8 offset:4096
    ds_read_b64_tr_b16 a[150:151], v8 offset:6144
    v_mfma_f32_16x16x32_bf16 v[192:195], a[44:47], a[188:191], v[192:195]
    s_waitcnt lgkmcnt(10)
    s_add_u32 s83, s83, s86
    ds_read_b64_tr_b16 a[152:153], v8 offset:8192
    ds_read_b64_tr_b16 a[154:155], v8 offset:10240
    buffer_load_dwordx4 v24, s[12:15], s83 offen lds
    v_mfma_f32_16x16x32_bf16 v[192:195], a[48:51], a[192:195], v[192:195]
    s_add_u32 m0, s82, 61440
    ds_read_b64_tr_b16 a[156:157], v8 offset:12288
    ds_read_b64_tr_b16 a[158:159], v8 offset:14336
    v_mfma_f32_16x16x32_bf16 v[192:195], a[52:55], a[196:199], v[192:195]
    s_add_u32 s83, s83, s86
    ds_read_b64_tr_b16 a[160:161], v8 offset:16384
    ds_read_b64_tr_b16 a[162:163], v8 offset:18432
    buffer_load_dwordx4 v24, s[12:15], s83 offen lds
    v_mfma_f32_16x16x32_bf16 v[192:195], a[56:59], a[200:203], v[192:195]
    s_waitcnt lgkmcnt(10)
    s_add_u32 m0, s82, 65536
    ds_read_b64_tr_b16 a[164:165], v8 offset:20480
    ds_read_b64_tr_b16 a[166:167], v8 offset:22528
    v_mfma_f32_16x16x32_bf16 v[192:195], a[60:63], a[204:207], v[192:195]
    s_add_u32 s83, s83, s86
    ds_read_b64_tr_b16 a[168:169], v8 offset:24576
    ds_read_b64_tr_b16 a[170:171], v8 offset:26624
    buffer_load_dwordx4 v24, s[12:15], s83 offen lds
    v_mfma_f32_16x16x32_bf16 v[192:195], a[64:67], a[208:211], v[192:195]
    s_add_u32 m0, s82, 69632
    ds_read_b64_tr_b16 a[172:173], v8 offset:28672
    ds_read_b64_tr_b16 a[174:175], v8 offset:30720
    v_mfma_f32_16x16x32_bf16 v[192:195], a[68:71], a[212:215], v[192:195]
    s_add_u32 s83, s83, s86
    ds_read_b64_tr_b16 a[176:177], v8 offset:32768
    ds_read_b64_tr_b16 a[178:179], v8 offset:34816
    ds_read_b64_tr_b16 a[180:181], v9 offset:0
    ds_read_b64_tr_b16 a[182:183], v9 offset:2048
    s_branch L_kvdone
L_kvu1:
L_w11:
    s_cbranch_execz L_w15
    s_bitcmp1_b32 s78, 1
    s_cbranch_scc1 L_kv11
    s_waitcnt lgkmcnt(12)
    v_mfma_f32_16x16x32_bf16 v[192:195], a[216:219], a[72:75], 0
    s_add_u32 m0, s82, 36864
    ds_read_b64_tr_b16 a[180:181], v210 offset:9216
    ds_read_b64_tr_b16 a[182:183], v210 offset:9344
    v_mfma_f32_16x16x32_bf16 v[192:195], a[220:223], a[76:79], v[192:195]
    s_add_u32 s83, s83, s86
    ds_read_b64_tr_b16 a[184:185], v210 offset:10240
    ds_read_b64_tr_b16 a[186:187], v210 offset:10368
    buffer_load_dwordx4 v24, s[12:15], s83 offen lds
    v_mfma_f32_16x16x32_bf16 v[192:195], a[224:227], a[80:83], v[192:195]
    s_waitcnt lgkmcnt(10)
    s_add_u32 m0, s82, 40960
    ds_read_b64_tr_b16 a[188:189], v210 offset:11264
    ds_read_b64_tr_b16 a[190:191], v210 offset:11392
    v_mfma_f32_16x16x32_bf16 v[192:195], a[228:231], a[84:87], v[192:195]
    s_add_u32 s83, s83, s86
    ds_read_b64_tr_b16 a[192:193], v210 offset:12288
    ds_read_b64_tr_b16 a[194:195], v210 offset:12416
    buffer_load_dwordx4 v24, s[12:15], s83 offen lds
    v_mfma_f32_16x16x32_bf16 v[192:195], a[232:235], a[88:91], v[192:195]
    s_add_u32 m0, s82, 45056
    ds_read_b64_tr_b16 a[196:197], v210 offset:13312
    ds_read_b64_tr_b16 a[198:199], v210 offset:13440
    v_mfma_f32_16x16x32_bf16 v[192:195], a[236:239], a[92:95], v[192:195]
    s_waitcnt lgkmcnt(10)
    s_add_u32 s83, s83, s86
    ds_read_b64_tr_b16 a[200:201], v210 offset:14336
    ds_read_b64_tr_b16 a[202:203], v210 offset:14464
    buffer_load_dwordx4 v24, s[12:15], s83 offen lds
    v_mfma_f32_16x16x32_bf16 v[192:195], a[240:243], a[96:99], v[192:195]
    s_add_u32 m0, s82, 49152
    ds_read_b64_tr_b16 a[204:205], v210 offset:15360
    ds_read_b64_tr_b16 a[206:207], v210 offset:15488
    v_mfma_f32_16x16x32_bf16 v[192:195], a[244:247], a[100:103], v[192:195]
    s_add_u32 s83, s83, s86
    ds_read_b64_tr_b16 a[208:209], v2 offset:16384
    ds_read_b64_tr_b16 a[210:211], v2 offset:16512
    buffer_load_dwordx4 v24, s[12:15], s83 offen lds
    v_mfma_f32_16x16x32_bf16 v[192:195], a[248:251], a[104:107], v[192:195]
    s_waitcnt lgkmcnt(10)
    s_add_u32 m0, s82, 53248
    ds_read_b64_tr_b16 a[212:213], v2 offset:17408
    ds_read_b64_tr_b16 a[214:215], v2 offset:17536
    v_mfma_f32_16x16x32_bf16 v[192:195], a[180:183], a[108:111], v[192:195]
    s_add_u32 s83, s83, s86
    ds_read_b64_tr_b16 a[144:145], v8 offset:0
    ds_read_b64_tr_b16 a[146:147], v8 offset:2048
    buffer_load_dwordx4 v24, s[12:15], s83 offen lds
    v_mfma_f32_16x16x32_bf16 v[192:195], a[184:187], a[112:115], v[192:195]
    s_add_u32 m0, s82, 57344
    ds_read_b64_tr_b16 a[148:149], v8 offset:4096
    ds_read_b64_tr_b16 a[150:151], v8 offset:6144
    v_mfma_f32_16x16x32_bf16 v[192:195], a[188:191], a[116:119], v[192:195]
    s_waitcnt lgkmcnt(10)
    s_add_u32 s83, s83, s86
    ds_read_b64_tr_b16 a[152:153], v8 offset:8192
    ds_read_b64_tr_b16 a[154:155], v8 offset:10240
    buffer_load_dwordx4 v24, s[12:15], s83 offen lds
    v_mfma_f32_16x16x32_bf16 v[192:195], a[192:195], a[120:123], v[192:195]
    s_add_u32 m0, s82, 61440
    ds_read_b64_tr_b16 a[156:157], v8 offset:12288
    ds_read_b64_tr_b16 a[158:159], v8 offset:14336
    v_mfma_f32_16x16x32_bf16 v[192:195], a[196:199], a[124:127], v[192:195]
    s_add_u32 s83, s83, s86
    ds_read_b64_tr_b16 a[160:161], v8 offset:16384
    ds_read_b64_tr_b16 a[162:163], v8 offset:18432
    buffer_load_dwordx4 v24, s[12:15], s83 offen lds
    v_mfma_f32_16x16x32_bf16 v[192:195], a[200:203], a[128:131], v[192:195]
    s_waitcnt lgkmcnt(10)
    s_add_u32 m0, s82, 65536
    ds_read_b64_tr_b16 a[164:165], v8 offset:20480
    ds_read_b64_tr_b16 a[166:167], v8 offset:22528
    v_mfma_f32_16x16x32_bf16 v[192:195], a[204:207], a[132:135], v[192:195]
    s_add_u32 s83, s83, s86
    ds_read_b64_tr_b16 a[168:169], v8 offset:24576
    ds_read_b64_tr_b16 a[170:171], v8 offset:26624
L_w12:
    s_cbranch_execz L_w16
    buffer_load_dwordx4 v24, s[12:15], s83 offen lds
    v_mfma_f32_16x16x32_bf16 v[192:195], a[208:211], a[136:139], v[192:195]
    s_add_u32 m0, s82, 69632
    ds_read_b64_tr_b16 a[172:173], v8 offset:28672
    ds_read_b64_tr_b16 a[174:175], v8 offset:30720
    v_mfma_f32_16x16x32_bf16 v[192:195], a[212:215], a[140:143], v[192:195]
    s_add_u32 s83, s83, s86
    ds_read_b64_tr_b16 a[176:177], v8 offset:32768
    ds_read_b64_tr_b16 a[178:179], v8 offset:34816
    ds_read_b64_tr_b16 a[180:181], v9 offset:0
    ds_read_b64_tr_b16 a[182:183], v9 offset:2048
    s_branch L_kvdone
L_kv11:
    s_waitcnt lgkmcnt(12)
    v_mfma_f32_16x16x32_bf16 v[192:195], a[72:75], a[216:219], 0
    s_add_u32 m0, s82, 36864
    ds_read_b64_tr_b16 a[180:181], v210 offset:9216
    ds_read_b64_tr_b16 a[182:183], v210 offset:9344
    v_mfma_f32_16x16x32_bf16 v[192:195], a[76:79], a[220:223], v[192:195]
    s_add_u32 s83, s83, s86
    ds_read_b64_tr_b16 a[184:185], v210 offset:10240
    ds_read_b64_tr_b16 a[186:187], v210 offset:10368
    buffer_load_dwordx4 v24, s[12:15], s83 offen lds
    v_mfma_f32_16x16x32_bf16 v[192:195], a[80:83], a[224:227], v[192:195]
    s_waitcnt lgkmcnt(10)
    s_add_u32 m0, s82, 40960
    ds_read_b64_tr_b16 a[188:189], v210 offset:11264
    ds_read_b64_tr_b16 a[190:191], v210 offset:11392
    v_mfma_f32_16x16x32_bf16 v[192:195], a[84:87], a[228:231], v[192:195]
    s_add_u32 s83, s83, s86
    ds_read_b64_tr_b16 a[192:193], v210 offset:12288
    ds_read_b64_tr_b16 a[194:195], v210 offset:12416
    buffer_load_dwordx4 v24, s[12:15], s83 offen lds
    v_mfma_f32_16x16x32_bf16 v[192:195], a[88:91], a[232:235], v[192:195]
    s_add_u32 m0, s82, 45056
    ds_read_b64_tr_b16 a[196:197], v210 offset:13312
    ds_read_b64_tr_b16 a[198:199], v210 offset:13440
    v_mfma_f32_16x16x32_bf16 v[192:195], a[92:95], a[236:239], v[192:195]
    s_waitcnt lgkmcnt(10)
    s_add_u32 s83, s83, s86
    ds_read_b64_tr_b16 a[200:201], v210 offset:14336
    ds_read_b64_tr_b16 a[202:203], v210 offset:14464
    buffer_load_dwordx4 v24, s[12:15], s83 offen lds
    v_mfma_f32_16x16x32_bf16 v[192:195], a[96:99], a[240:243], v[192:195]
    s_add_u32 m0, s82, 49152
    ds_read_b64_tr_b16 a[204:205], v210 offset:15360
    ds_read_b64_tr_b16 a[206:207], v210 offset:15488
    v_mfma_f32_16x16x32_bf16 v[192:195], a[100:103], a[244:247], v[192:195]
    s_add_u32 s83, s83, s86
    ds_read_b64_tr_b16 a[208:209], v2 offset:16384
    ds_read_b64_tr_b16 a[210:211], v2 offset:16512
    buffer_load_dwordx4 v24, s[12:15], s83 offen lds
    v_mfma_f32_16x16x32_bf16 v[192:195], a[104:107], a[248:251], v[192:195]
    s_waitcnt lgkmcnt(10)
    s_add_u32 m0, s82, 53248
    ds_read_b64_tr_b16 a[212:213], v2 offset:17408
    ds_read_b64_tr_b16 a[214:215], v2 offset:17536
    v_mfma_f32_16x16x32_bf16 v[192:195], a[108:111], a[180:183], v[192:195]
    s_add_u32 s83, s83, s86
    ds_read_b64_tr_b16 a[144:145], v8 offset:0
    ds_read_b64_tr_b16 a[146:147], v8 offset:2048
    buffer_load_dwordx4 v24, s[12:15], s83 offen lds
    v_mfma_f32_16x16x32_bf16 v[192:195], a[112:115], a[184:187], v[192:195]
    s_add_u32 m0, s82, 57344
    ds_read_b64_tr_b16 a[148:149], v8 offset:4096
    ds_read_b64_tr_b16 a[150:151], v8 offset:6144
    v_mfma_f32_16x16x32_bf16 v[192:195], a[116:119], a[188:191], v[192:195]
    s_waitcnt lgkmcnt(10)
    s_add_u32 s83, s83, s86
    ds_read_b64_tr_b16 a[152:153], v8 offset:8192
    ds_read_b64_tr_b16 a[154:155], v8 offset:10240
    buffer_load_dwordx4 v24, s[12:15], s83 offen lds
    v_mfma_f32_16x16x32_bf16 v[192:195], a[120:123], a[192:195], v[192:195]
    s_add_u32 m0, s82, 61440
    ds_read_b64_tr_b16 a[156:157], v8 offset:12288
    ds_read_b64_tr_b16 a[158:159], v8 offset:14336
    v_mfma_f32_16x16x32_bf16 v[192:195], a[124:127], a[196:199], v[192:195]
    s_add_u32 s83, s83, s86
    ds_read_b64_tr_b16 a[160:161], v8 offset:16384
    ds_read_b64_tr_b16 a[162:163], v8 offset:18432
    buffer_load_dwordx4 v24, s[12:15], s83 offen lds
    v_mfma_f32_16x16x32_bf16 v[192:195], a[128:131], a[200:203], v[192:195]
    s_waitcnt lgkmcnt(10)
    s_add_u32 m0, s82, 65536
    ds_read_b64_tr_b16 a[164:165], v8 offset:20480
    ds_read_b64_tr_b16 a[166:167], v8 offset:22528
    v_mfma_f32_16x16x32_bf16 v[192:195], a[132:135], a[204:207], v[192:195]
    s_add_u32 s83, s83, s86
    ds_read_b64_tr_b16 a[168:169], v8 offset:24576
    ds_read_b64_tr_b16 a[170:171], v8 offset:26624
    buffer_load_dwordx4 v24, s[12:15], s83 offen lds
    v_mfma_f32_16x16x32_bf16 v[192:195], a[136:139], a[208:211], v[192:195]
    s_add_u32 m0, s82, 69632
    ds_read_b64_tr_b16 a[172:173], v8 offset:28672
    ds_read_b64_tr_b16 a[174:175], v8 offset:30720
    v_mfma_f32_16x16x32_bf16 v[192:195], a[140:143], a[212:215], v[192:195]
    s_add_u32 s83, s83, s86
    ds_read_b64_tr_b16 a[176:177], v8 offset:32768
    ds_read_b64_tr_b16 a[178:179], v8 offset:34816
    ds_read_b64_tr_b16 a[180:181], v9 offset:0
    ds_read_b64_tr_b16 a[182:183], v9 offset:2048
L_kvdone:
    s_waitcnt lgkmcnt(12)
    v_mfma_f32_16x16x32_bf16 v[64:67], a[144:147], a[0:3], 0
L_w13:
    s_cbranch_execz L_w17
    ds_read_b64_tr_b16 a[184:185], v9 offset:4096
    v_mfma_f32_16x16x32_bf16 v[64:67], a[148:151], a[4:7], v[64:67]
    s_barrier
    ds_read_b64_tr_b16 a[186:187], v9 offset:6144
    buffer_load_dwordx4 v24, s[12:15], s83 offen lds
    v_mfma_f32_16x16x32_bf16 v[64:67], a[152:155], a[8:11], v[64:67]
    s_waitcnt lgkmcnt(8)
    ds_read_b64_tr_b16 a[188:189], v9 offset:8192
    v_mul_f32 v192, s70, v192
    v_mfma_f32_16x16x32_bf16 v[64:67], a[156:159], a[12:15], v[64:67]
    s_add_u32 m0, s82, 73728
    ds_read_b64_tr_b16 a[190:191], v9 offset:10240
    v_mul_f32 v193, s70, v193
    v_mfma_f32_16x16x32_bf16 v[64:67], a[160:163], a[16:19], v[64:67]
    s_add_u32 s56, s16, s84
    ds_read_b64_tr_b16 a[192:193], v9 offset:12288
    v_mul_f32 v194, s70, v194
    v_mfma_f32_16x16x32_bf16 v[64:67], a[164:167], a[20:23], v[64:67]
    s_addc_u32 s57, s17, 0
    ds_read_b64_tr_b16 a[194:195], v9 offset:14336
    buffer_load_dwordx4 v24, s[56:59], 0 offen lds
    v_mul_f32 v195, s70, v195
    v_mfma_f32_16x16x32_bf16 v[64:67], a[168:171], a[24:27], v[64:67]
    s_waitcnt lgkmcnt(5)
    ds_read_b64_tr_b16 a[196:197], v9 offset:16384
    v_cvt_pk_bf16_f32 v192, v192, v193
    v_cvt_pk_bf16_f32 v193, v194, v195
    v_mfma_f32_16x16x32_bf16 v[64:67], a[172:175], a[28:31], v[64:67]
    s_add_u32 m0, s82, 77824
    ds_read_b64_tr_b16 a[198:199], v9 offset:18432
    v_and_or_b32 v194, v192, v233, v234
    v_and_or_b32 v195, v193, v233, v234
    v_mfma_f32_16x16x32_bf16 v[64:67], a[176:179], a[32:35], v[64:67]
    s_add_u32 s56, s56, s86
    ds_read_b64_tr_b16 a[200:201], v9 offset:20480
    v_and_or_b32 v192, v192, v233, v234
    v_and_or_b32 v193, v193, v233, v234
    v_mfma_f32_16x16x32_bf16 v[68:71], a[144:147], a[72:75], 0
    s_addc_u32 s57, s57, 0
    ds_read_b64_tr_b16 a[202:203], v9 offset:22528
    buffer_load_dwordx4 v24, s[56:59], 0 offen lds
    v_mfma_f32_16x16x32_bf16 v[68:71], a[148:151], a[76:79], v[68:71]
    ds_read_b64_tr_b16 a[204:205], v9 offset:24576
    v_mfma_f32_16x16x32_bf16 v[68:71], a[152:155], a[80:83], v[68:71]
    s_add_u32 m0, s82, 81920
    ds_read_b64_tr_b16 a[206:207], v9 offset:26624
    v_permlane16_swap_b32 v192, v194
    v_mfma_f32_16x16x32_bf16 v[68:71], a[156:159], a[84:87], v[68:71]
    s_add_u32 s56, s56, s86
    ds_read_b64_tr_b16 a[208:209], v9 offset:28672
    v_permlane16_swap_b32 v193, v195
    v_mfma_f32_16x16x32_bf16 v[68:71], a[160:163], a[88:91], v[68:71]
    s_addc_u32 s57, s57, 0
    ds_read_b64_tr_b16 a[210:211], v9 offset:30720
    buffer_load_dwordx4 v24, s[56:59], 0 offen lds
    v_mfma_f32_16x16x32_bf16 v[68:71], a[164:167], a[92:95], v[68:71]
    ds_read_b64_tr_b16 a[212:213], v9 offset:32768
    buffer_store_dwordx4 v[192:195], v209, s[24:27], s68 offen sc1
    v_mfma_f32_16x16x32_bf16 v[68:71], a[168:171], a[96:99], v[68:71]
    s_add_u32 m0, s82, 86016
    ds_read_b64_tr_b16 a[214:215], v9 offset:34816
    buffer_store_dword v192, v209, s[24:27], s69 offen sc1
    v_mfma_f32_16x16x32_bf16 v[68:71], a[172:175], a[100:103], v[68:71]
    s_add_u32 s56, s56, s86
    ds_read_b64_tr_b16 a[144:145], v10 offset:0
    v_mfma_f32_16x16x32_bf16 v[68:71], a[176:179], a[104:107], v[68:71]
    s_addc_u32 s57, s57, 0
    ds_read_b64_tr_b16 a[146:147], v10 offset:2048
    buffer_load_dwordx4 v24, s[56:59], 0 offen lds
    v_mfma_f32_16x16x32_bf16 v[72:75], a[180:183], a[0:3], 0
    s_waitcnt lgkmcnt(5)
    ds_read_b64_tr_b16 a[148:149], v10 offset:4096
    v_lshlrev_b32 v192, 2, v197
    v_mfma_f32_16x16x32_bf16 v[72:75], a[184:187], a[4:7], v[72:75]
    s_add_u32 m0, s82, 90112
    ds_read_b64_tr_b16 a[150:151], v10 offset:6144
    v_xor_b32 v193, 0, v197
    v_mfma_f32_16x16x32_bf16 v[72:75], a[188:191], a[8:11], v[72:75]
    s_add_u32 s56, s56, s86
    ds_read_b64_tr_b16 a[152:153], v10 offset:8192
    v_mul_u32_u24 v193, 18432, v193
    v_mfma_f32_16x16x32_bf16 v[72:75], a[192:195], a[12:15], v[72:75]
    s_addc_u32 s57, s57, 0
    ds_read_b64_tr_b16 a[154:155], v10 offset:10240
    buffer_load_dwordx4 v24, s[56:59], 0 offen lds
    v_mfma_f32_16x16x32_bf16 v[72:75], a[196:199], a[16:19], v[72:75]
    s_waitcnt lgkmcnt(5)
    ds_read_b64_tr_b16 a[156:157], v10 offset:12288
    v_lshl_add_u32 v193, v196, 4, v193
    v_mfma_f32_16x16x32_bf16 v[72:75], a[200:203], a[20:23], v[72:75]
    s_add_u32 m0, s82, 94208
    ds_read_b64_tr_b16 a[158:159], v10 offset:14336
    v_cndmask_b32 v226, v193, v198, s[4:5]
    v_mfma_f32_16x16x32_bf16 v[72:75], a[204:207], a[24:27], v[72:75]
    s_add_u32 s56, s56, s86
    ds_read_b64_tr_b16 a[160:161], v10 offset:16384
    v_lshlrev_b32 v246, 3, v1
    v_mfma_f32_16x16x32_bf16 v[72:75], a[208:211], a[28:31], v[72:75]
    s_addc_u32 s57, s57, 0
    ds_read_b64_tr_b16 a[162:163], v10 offset:18432
    buffer_load_dwordx4 v24, s[56:59], 0 offen lds
    v_mfma_f32_16x16x32_bf16 v[72:75], a[212:215], a[32:35], v[72:75]
    ds_read_b64_tr_b16 a[164:165], v10 offset:20480
    v_add_u32 v247, 4096, v6
    v_mfma_f32_16x16x32_bf16 v[76:79], a[180:183], a[72:75], 0
    s_add_u32 m0, s82, 98304
    ds_read_b64_tr_b16 a[166:167], v10 offset:22528
    v_mov_b32 v248, -1
    v_mfma_f32_16x16x32_bf16 v[76:79], a[184:187], a[76:79], v[76:79]
    s_add_u32 s56, s56, s86
    ds_read_b64_tr_b16 a[168:169], v10 offset:24576
    v_mov_b32 v249, -1
    v_mfma_f32_16x16x32_bf16 v[76:79], a[188:191], a[80:83], v[76:79]
    s_addc_u32 s57, s57, 0
    ds_read_b64_tr_b16 a[170:171], v10 offset:26624
    buffer_load_dwordx4 v24, s[56:59], 0 offen lds
    v_mfma_f32_16x16x32_bf16 v[76:79], a[192:195], a[84:87], v[76:79]
    ds_read_b64_tr_b16 a[172:173], v10 offset:28672
    v_mov_b32 v250, -1
    v_mfma_f32_16x16x32_bf16 v[76:79], a[196:199], a[88:91], v[76:79]
    s_add_u32 m0, s82, 102400
    ds_read_b64_tr_b16 a[174:175], v10 offset:30720
    v_mov_b32 v251, -1
    v_mfma_f32_16x16x32_bf16 v[76:79], a[200:203], a[92:95], v[76:79]
    s_add_u32 s56, s56, s86
    ds_read_b64_tr_b16 a[176:177], v10 offset:32768
    v_lshlrev_b32 v193, 9, v1
    v_mfma_f32_16x16x32_bf16 v[76:79], a[204:207], a[96:99], v[76:79]
    s_addc_u32 s57, s57, 0
    ds_read_b64_tr_b16 a[178:179], v10 offset:34816
    buffer_load_dwordx4 v24, s[56:59], 0 offen lds
    v_mfma_f32_16x16x32_bf16 v[76:79], a[208:211], a[100:103], v[76:79]
    s_waitcnt lgkmcnt(5)
    ds_read_b64_tr_b16 a[180:181], v11 offset:0
    v_cmp_gt_u32 vcc, 8, v1
    v_mfma_f32_16x16x32_bf16 v[76:79], a[212:215], a[104:107], v[76:79]
    s_add_u32 m0, s82, 106496
    ds_read_b64_tr_b16 a[182:183], v11 offset:2048
    v_lshlrev_b32 v194, 3, v197
    v_mfma_f32_16x16x32_bf16 v[80:83], a[144:147], a[0:3], 0
    s_add_u32 s56, s56, s86
    ds_read_b64_tr_b16 a[184:185], v11 offset:4096
    v_add_u32 v232, s48, v6
    v_mfma_f32_16x16x32_bf16 v[80:83], a[148:151], a[4:7], v[80:83]
    s_addc_u32 s57, s57, 0
    ds_read_b64_tr_b16 a[186:187], v11 offset:6144
    buffer_load_dwordx4 v24, s[56:59], 0 offen lds
    v_mfma_f32_16x16x32_bf16 v[80:83], a[152:155], a[8:11], v[80:83]
    s_waitcnt lgkmcnt(5)
    ds_read_b64_tr_b16 a[188:189], v11 offset:8192
    v_cndmask_b32 v227, v198, v193, vcc
    v_mfma_f32_16x16x32_bf16 v[80:83], a[156:159], a[12:15], v[80:83]
    s_add_u32 m0, s82, 110592
    ds_read_b64_tr_b16 a[190:191], v11 offset:10240
    v_lshl_add_u32 v193, v196, 7, v194
    v_mfma_f32_16x16x32_bf16 v[80:83], a[160:163], a[16:19], v[80:83]
    s_add_u32 s56, s56, s86
    ds_read_b64_tr_b16 a[192:193], v11 offset:12288
    v_and_b32 v195, 7, v1
    v_mfma_f32_16x16x32_bf16 v[80:83], a[164:167], a[20:23], v[80:83]
    s_addc_u32 s57, s57, 0
    ds_read_b64_tr_b16 a[194:195], v11 offset:14336
    buffer_load_dwordx4 v24, s[56:59], 0 offen lds
    v_mfma_f32_16x16x32_bf16 v[80:83], a[168:171], a[24:27], v[80:83]
    s_waitcnt lgkmcnt(5)
    ds_read_b64_tr_b16 a[196:197], v11 offset:16384
    v_lshlrev_b32 v195, 4, v195
    v_mfma_f32_16x16x32_bf16 v[80:83], a[172:175], a[28:31], v[80:83]
    s_add_u32 m0, s82, 114688
    ds_read_b64_tr_b16 a[198:199], v11 offset:18432
    v_xor_b32 v193, v193, v195
    v_mfma_f32_16x16x32_bf16 v[80:83], a[176:179], a[32:35], v[80:83]
    s_add_u32 s56, s56, s86
    ds_read_b64_tr_b16 a[200:201], v11 offset:20480
    v_add_u32 v228, s48, v193
    v_mfma_f32_16x16x32_bf16 v[84:87], a[144:147], a[72:75], 0
    s_addc_u32 s57, s57, 0
    ds_read_b64_tr_b16 a[202:203], v11 offset:22528
    buffer_load_dwordx4 v24, s[56:59], 0 offen lds
    v_mfma_f32_16x16x32_bf16 v[84:87], a[148:151], a[76:79], v[84:87]
    ds_read_b64_tr_b16 a[204:205], v11 offset:24576
    v_xor_b32 v21, 32, v228
    v_mfma_f32_16x16x32_bf16 v[84:87], a[152:155], a[80:83], v[84:87]
    s_add_u32 m0, s82, 118784
    ds_read_b64_tr_b16 a[206:207], v11 offset:26624
    v_xor_b32 v22, 64, v228
    v_mfma_f32_16x16x32_bf16 v[84:87], a[156:159], a[84:87], v[84:87]
    s_add_u32 s56, s56, s86
    ds_read_b64_tr_b16 a[208:209], v11 offset:28672
    v_xor_b32 v23, 96, v228
    v_mfma_f32_16x16x32_bf16 v[84:87], a[160:163], a[88:91], v[84:87]
    s_addc_u32 s57, s57, 0
    ds_read_b64_tr_b16 a[210:211], v11 offset:30720
    buffer_load_dwordx4 v24, s[56:59], 0 offen lds
    v_mfma_f32_16x16x32_bf16 v[84:87], a[164:167], a[92:95], v[84:87]
    ds_read_b64_tr_b16 a[212:213], v11 offset:32768
    v_lshrrev_b32 v195, 3, v1
    v_mfma_f32_16x16x32_bf16 v[84:87], a[168:171], a[96:99], v[84:87]
    s_add_u32 m0, s82, 122880
    ds_read_b64_tr_b16 a[214:215], v11 offset:34816
    v_lshlrev_b32 v195, 4, v195
    v_mfma_f32_16x16x32_bf16 v[84:87], a[172:175], a[100:103], v[84:87]
    s_waitcnt vmcnt(14) lgkmcnt(6)
    s_add_u32 s56, s56, s86
    s_barrier
    ds_read_b64_tr_b16 a[144:145], v8 offset:36864
    v_mfma_f32_16x16x32_bf16 v[84:87], a[176:179], a[104:107], v[84:87]
    s_addc_u32 s57, s57, 0
    ds_read_b64_tr_b16 a[146:147], v8 offset:38912
    buffer_load_dwordx4 v24, s[56:59], 0 offen lds
    v_xor_b32 v20, v20, v195
    v_mfma_f32_16x16x32_bf16 v[88:91], a[180:183], a[0:3], 0
    ds_read_b64_tr_b16 a[148:149], v8 offset:40960
    v_lshl_add_u32 v193, v196, 5, v194
    v_mfma_f32_16x16x32_bf16 v[88:91], a[184:187], a[4:7], v[88:91]
    s_add_u32 m0, s82, 126976
    ds_read_b64_tr_b16 a[150:151], v8 offset:43008
    v_add_u32 v193, 151552, v193
    v_mfma_f32_16x16x32_bf16 v[88:91], a[188:191], a[8:11], v[88:91]
    s_add_u32 s56, s56, s86
    ds_read_b64_tr_b16 a[152:153], v8 offset:45056
    v_add_u32 v229, s82, v193
    v_mfma_f32_16x16x32_bf16 v[88:91], a[192:195], a[12:15], v[88:91]
    s_addc_u32 s57, s57, 0
    ds_read_b64_tr_b16 a[154:155], v8 offset:47104
    buffer_load_dwordx4 v24, s[56:59], 0 offen lds
    v_mfma_f32_16x16x32_bf16 v[88:91], a[196:199], a[16:19], v[88:91]
    s_waitcnt lgkmcnt(5)
    ds_read_b64_tr_b16 a[156:157], v8 offset:49152
    v_mul_u32_u24 v193, 1152, v196
    v_mfma_f32_16x16x32_bf16 v[88:91], a[200:203], a[20:23], v[88:91]
    s_add_u32 m0, s82, 131072
    ds_read_b64_tr_b16 a[158:159], v8 offset:51200
    v_add_u32 v230, v193, v194
    v_mfma_f32_16x16x32_bf16 v[88:91], a[204:207], a[24:27], v[88:91]
    s_add_u32 s56, s56, s86
    ds_read_b64_tr_b16 a[160:161], v8 offset:53248
    v_sub_u32 v192, v196, v192
    v_mfma_f32_16x16x32_bf16 v[88:91], a[208:211], a[28:31], v[88:91]
    s_addc_u32 s57, s57, 0
    ds_read_b64_tr_b16 a[162:163], v8 offset:55296
    buffer_load_dwordx4 v24, s[56:59], 0 offen lds
    v_mfma_f32_16x16x32_bf16 v[88:91], a[212:215], a[32:35], v[88:91]
    ds_read_b64_tr_b16 a[164:165], v8 offset:57344
    v_and_b32 v193, 1, v192
    v_mfma_f32_16x16x32_bf16 v[92:95], a[180:183], a[72:75], 0
    s_add_u32 m0, s82, 135168
    ds_read_b64_tr_b16 a[166:167], v8 offset:59392
    v_lshlrev_b32 v193, 4, v193
    v_mfma_f32_16x16x32_bf16 v[92:95], a[184:187], a[76:79], v[92:95]
    s_add_u32 s56, s56, s86
    ds_read_b64_tr_b16 a[168:169], v8 offset:61440
    v_mov_b32 v194, 0x3f80
    v_mfma_f32_16x16x32_bf16 v[92:95], a[188:191], a[80:83], v[92:95]
    s_addc_u32 s57, s57, 0
    ds_read_b64_tr_b16 a[170:171], v8 offset:63488
    buffer_load_dwordx4 v24, s[56:59], 0 offen lds
    v_mfma_f32_16x16x32_bf16 v[92:95], a[192:195], a[84:87], v[92:95]
    ds_read_b64_tr_b16 a[172:173], v12 offset:0
    v_lshlrev_b32 v194, v193, v194
    v_mfma_f32_16x16x32_bf16 v[92:95], a[196:199], a[88:91], v[92:95]
    s_add_u32 m0, s82, 139264
    ds_read_b64_tr_b16 a[174:175], v12 offset:2048
    v_lshrrev_b32 v192, 1, v192
    v_mfma_f32_16x16x32_bf16 v[92:95], a[200:203], a[92:95], v[92:95]
    s_add_u32 s56, s56, s86
    ds_read_b64_tr_b16 a[176:177], v12 offset:4096
    v_cmp_eq_u32 vcc, 0, v192
    v_mfma_f32_16x16x32_bf16 v[92:95], a[204:207], a[96:99], v[92:95]
    s_addc_u32 s57, s57, 0
    ds_read_b64_tr_b16 a[178:179], v12 offset:6144
    buffer_load_dwordx4 v24, s[56:59], 0 offen lds
    v_mfma_f32_16x16x32_bf16 v[92:95], a[208:211], a[100:103], v[92:95]
    s_waitcnt lgkmcnt(5)
    ds_read_b64_tr_b16 a[180:181], v9 offset:36864
    v_mov_b32 v236, 0
    v_mfma_f32_16x16x32_bf16 v[92:95], a[212:215], a[104:107], v[92:95]
    s_add_u32 m0, s82, 143360
    ds_read_b64_tr_b16 a[182:183], v9 offset:38912
    v_mov_b32 v237, 0
    v_mfma_f32_16x16x32_bf16 v[64:67], a[144:147], a[36:39], v[64:67]
    s_add_u32 s56, s56, s86
    ds_read_b64_tr_b16 a[184:185], v9 offset:40960
    v_cndmask_b32 v238, 0, v194, vcc
    v_mfma_f32_16x16x32_bf16 v[64:67], a[148:151], a[40:43], v[64:67]
    s_addc_u32 s57, s57, 0
    ds_read_b64_tr_b16 a[186:187], v9 offset:43008
    buffer_load_dwordx4 v24, s[56:59], 0 offen lds
    v_mfma_f32_16x16x32_bf16 v[64:67], a[152:155], a[44:47], v[64:67]
    ds_read_b64_tr_b16 a[188:189], v9 offset:45056
    v_cndmask_b32 v242, 0, v194, vcc
    v_mfma_f32_16x16x32_bf16 v[64:67], a[156:159], a[48:51], v[64:67]
    s_waitcnt lgkmcnt(5)
    ds_read_b64_tr_b16 a[190:191], v9 offset:47104
    v_cndmask_b32 v244, 0, v194, vcc
    v_mfma_f32_16x16x32_bf16 v[64:67], a[160:163], a[52:55], v[64:67]
    s_add_u32 m0, s82, 0
    ds_read_b64_tr_b16 a[192:193], v9 offset:49152
    v_cmp_eq_u32 vcc, 1, v192
    v_mfma_f32_16x16x32_bf16 v[64:67], a[164:167], a[56:59], v[64:67]
    s_mov_b32 s58, 35852
    ds_read_b64_tr_b16 a[194:195], v9 offset:51200
    v_mov_b32 v240, 0
    v_mfma_f32_16x16x32_bf16 v[64:67], a[168:171], a[60:63], v[64:67]
    s_mov_b32 s56, s36
    ds_read_b64_tr_b16 a[196:197], v9 offset:53248
    v_mov_b32 v241, 0
    v_mfma_f32_16x16x32_bf16 v[64:67], a[172:175], a[64:67], v[64:67]
    s_mov_b32 s57, s37
    ds_read_b64_tr_b16 a[198:199], v9 offset:55296
    buffer_load_dwordx4 v212, s[56:59], 0 offen lds
    v_mfma_f32_16x16x32_bf16 v[64:67], a[176:179], a[68:71], v[64:67]
    ds_read_b64_tr_b16 a[200:201], v9 offset:57344
    v_cndmask_b32 v239, 0, v194, vcc
    v_mfma_f32_16x16x32_bf16 v[68:71], a[144:147], a[108:111], v[68:71]
    ds_read_b64_tr_b16 a[202:203], v9 offset:59392
    v_cndmask_b32 v243, 0, v194, vcc
    v_mfma_f32_16x16x32_bf16 v[68:71], a[148:151], a[112:115], v[68:71]
    ds_read_b64_tr_b16 a[204:205], v9 offset:61440
    v_cndmask_b32 v245, 0, v194, vcc
    v_mfma_f32_16x16x32_bf16 v[68:71], a[152:155], a[116:119], v[68:71]
    ds_read_b64_tr_b16 a[206:207], v9 offset:63488
    v_mfma_f32_16x16x32_bf16 v[68:71], a[156:159], a[120:123], v[68:71]
    ds_read_b64_tr_b16 a[208:209], v13 offset:0
    v_fma_f32 v32, -v64, v64, s89
    v_mfma_f32_16x16x32_bf16 v[68:71], a[160:163], a[124:127], v[68:71]
    s_add_u32 m0, s82, 4096
    ds_read_b64_tr_b16 a[210:211], v13 offset:2048
    v_fma_f32 v33, -v65, v65, s89
    v_mfma_f32_16x16x32_bf16 v[68:71], a[164:167], a[128:131], v[68:71]
    s_add_u32 s56, s56, 36864
    ds_read_b64_tr_b16 a[212:213], v13 offset:4096
    v_fma_f32 v34, -v66, v66, s89
    v_mfma_f32_16x16x32_bf16 v[68:71], a[168:171], a[132:135], v[68:71]
    s_addc_u32 s57, s57, 0
    ds_read_b64_tr_b16 a[214:215], v13 offset:6144
    buffer_load_dwordx4 v212, s[56:59], 0 offen lds
    v_mfma_f32_16x16x32_bf16 v[68:71], a[172:175], a[136:139], v[68:71]
    ds_read_b64_tr_b16 a[144:145], v10 offset:36864
    v_fma_f32 v35, -v67, v67, s89
    v_mfma_f32_16x16x32_bf16 v[68:71], a[176:179], a[140:143], v[68:71]
    s_waitcnt lgkmcnt(5)
    ds_read_b64_tr_b16 a[146:147], v10 offset:38912
    v_mul_f32 v32, v32, v64
    v_mfma_f32_16x16x32_bf16 v[72:75], a[180:183], a[36:39], v[72:75]
    ds_read_b64_tr_b16 a[148:149], v10 offset:40960
    v_mul_f32 v33, v33, v65
    v_mfma_f32_16x16x32_bf16 v[72:75], a[184:187], a[40:43], v[72:75]
    ds_read_b64_tr_b16 a[150:151], v10 offset:43008
    v_mul_f32 v34, v34, v66
    v_mfma_f32_16x16x32_bf16 v[72:75], a[188:191], a[44:47], v[72:75]
    ds_read_b64_tr_b16 a[152:153], v10 offset:45056
    v_mul_f32 v35, v35, v67
    v_mfma_f32_16x16x32_bf16 v[72:75], a[192:195], a[48:51], v[72:75]
    s_add_u32 m0, s82, 8192
    v_exp_f32 v32, v32
    v_mfma_f32_16x16x32_bf16 v[72:75], a[196:199], a[52:55], v[72:75]
    s_add_u32 s56, s56, 36864
    ds_read_b64_tr_b16 a[154:155], v10 offset:47104
    ds_read_b64_tr_b16 a[156:157], v10 offset:49152
    v_mfma_f32_16x16x32_bf16 v[72:75], a[200:203], a[56:59], v[72:75]
    s_addc_u32 s57, s57, 0
    ds_read_b64_tr_b16 a[158:159], v10 offset:51200
    buffer_load_dwordx4 v212, s[56:59], 0 offen lds
    v_mfma_f32_16x16x32_bf16 v[72:75], a[204:207], a[60:63], v[72:75]
    s_waitcnt lgkmcnt(5)
    v_exp_f32 v33, v33
    v_mfma_f32_16x16x32_bf16 v[72:75], a[208:211], a[64:67], v[72:75]
    ds_read_b64_tr_b16 a[160:161], v10 offset:53248
    ds_read_b64_tr_b16 a[162:163], v10 offset:55296
    v_mfma_f32_16x16x32_bf16 v[72:75], a[212:215], a[68:71], v[72:75]
    v_exp_f32 v34, v34
    v_mfma_f32_16x16x32_bf16 v[76:79], a[180:183], a[108:111], v[76:79]
    ds_read_b64_tr_b16 a[164:165], v10 offset:57344
    ds_read_b64_tr_b16 a[166:167], v10 offset:59392
    v_mfma_f32_16x16x32_bf16 v[76:79], a[184:187], a[112:115], v[76:79]
    v_exp_f32 v35, v35
    v_mfma_f32_16x16x32_bf16 v[76:79], a[188:191], a[116:119], v[76:79]
    s_add_u32 m0, s82, 12288
    ds_read_b64_tr_b16 a[168:169], v10 offset:61440
    ds_read_b64_tr_b16 a[170:171], v10 offset:63488
    v_mfma_f32_16x16x32_bf16 v[76:79], a[192:195], a[120:123], v[76:79]
    s_add_u32 s56, s56, 36864
    ds_read_b64_tr_b16 a[172:173], v14 offset:0
    v_add_f32 v32, 1.0, v32
    v_mfma_f32_16x16x32_bf16 v[76:79], a[196:199], a[124:127], v[76:79]
    s_addc_u32 s57, s57, 0
    ds_read_b64_tr_b16 a[174:175], v14 offset:2048
    buffer_load_dwordx4 v212, s[56:59], 0 offen lds
    v_mfma_f32_16x16x32_bf16 v[76:79], a[200:203], a[128:131], v[76:79]
    ds_read_b64_tr_b16 a[176:177], v14 offset:4096
    v_add_f32 v33, 1.0, v33
    v_mfma_f32_16x16x32_bf16 v[76:79], a[204:207], a[132:135], v[76:79]
    ds_read_b64_tr_b16 a[178:179], v14 offset:6144
    v_add_f32 v34, 1.0, v34
    v_mfma_f32_16x16x32_bf16 v[76:79], a[208:211], a[136:139], v[76:79]
    ds_read_b64_tr_b16 a[180:181], v11 offset:36864
    v_add_f32 v35, 1.0, v35
    v_mfma_f32_16x16x32_bf16 v[76:79], a[212:215], a[140:143], v[76:79]
    v_rcp_f32 v32, v32
    v_mfma_f32_16x16x32_bf16 v[80:83], a[144:147], a[36:39], v[80:83]
    s_waitcnt lgkmcnt(4)
    ds_read_b64_tr_b16 a[182:183], v11 offset:38912
    ds_read_b64_tr_b16 a[184:185], v11 offset:40960
    v_mfma_f32_16x16x32_bf16 v[80:83], a[148:151], a[40:43], v[80:83]
    s_add_u32 m0, s82, 16384
    v_rcp_f32 v33, v33
    v_mfma_f32_16x16x32_bf16 v[80:83], a[152:155], a[44:47], v[80:83]
    s_add_u32 s56, s56, 36864
    ds_read_b64_tr_b16 a[186:187], v11 offset:43008
    ds_read_b64_tr_b16 a[188:189], v11 offset:45056
    v_mfma_f32_16x16x32_bf16 v[80:83], a[156:159], a[48:51], v[80:83]
    s_addc_u32 s57, s57, 0
    ds_read_b64_tr_b16 a[190:191], v11 offset:47104
    buffer_load_dwordx4 v212, s[56:59], 0 offen lds
    v_mfma_f32_16x16x32_bf16 v[80:83], a[160:163], a[52:55], v[80:83]
    ds_read_b64_tr_b16 a[192:193], v11 offset:49152
    v_rcp_f32 v34, v34
    v_mfma_f32_16x16x32_bf16 v[80:83], a[164:167], a[56:59], v[80:83]
    ds_read_b64_tr_b16 a[194:195], v11 offset:51200
    v_rcp_f32 v35, v35
    v_mfma_f32_16x16x32_bf16 v[80:83], a[168:171], a[60:63], v[80:83]
    s_waitcnt lgkmcnt(5)
    ds_read_b64_tr_b16 a[196:197], v11 offset:53248
    v_mul_f32 v32, v32, v64
    v_mfma_f32_16x16x32_bf16 v[80:83], a[172:175], a[64:67], v[80:83]
    ds_read_b64_tr_b16 a[198:199], v11 offset:55296
    v_mul_f32 v33, v33, v65
    v_mfma_f32_16x16x32_bf16 v[80:83], a[176:179], a[68:71], v[80:83]
    ds_read_b64_tr_b16 a[200:201], v11 offset:57344
    v_mul_f32 v34, v34, v66
    v_mfma_f32_16x16x32_bf16 v[84:87], a[144:147], a[108:111], v[84:87]
    s_add_u32 m0, s82, 20480
    ds_read_b64_tr_b16 a[202:203], v11 offset:59392
    v_mul_f32 v35, v35, v67
    v_mfma_f32_16x16x32_bf16 v[84:87], a[148:151], a[112:115], v[84:87]
    s_add_u32 s56, s56, 36864
    ds_read_b64_tr_b16 a[204:205], v11 offset:61440
    v_fma_f32 v36, -v68, v68, s89
    v_mfma_f32_16x16x32_bf16 v[84:87], a[152:155], a[116:119], v[84:87]
    s_addc_u32 s57, s57, 0
    ds_read_b64_tr_b16 a[206:207], v11 offset:63488
    buffer_load_dwordx4 v212, s[56:59], 0 offen lds
    v_mfma_f32_16x16x32_bf16 v[84:87], a[156:159], a[120:123], v[84:87]
    ds_read_b64_tr_b16 a[208:209], v15 offset:0
    v_fma_f32 v37, -v69, v69, s89
    v_mfma_f32_16x16x32_bf16 v[84:87], a[160:163], a[124:127], v[84:87]
    ds_read_b64_tr_b16 a[210:211], v15 offset:2048
    v_fma_f32 v38, -v70, v70, s89
    v_mfma_f32_16x16x32_bf16 v[84:87], a[164:167], a[128:131], v[84:87]
    ds_read_b64_tr_b16 a[212:213], v15 offset:4096
    v_fma_f32 v39, -v71, v71, s89
    v_mfma_f32_16x16x32_bf16 v[84:87], a[168:171], a[132:135], v[84:87]
    ds_read_b64_tr_b16 a[214:215], v15 offset:6144
    v_mul_f32 v36, v36, v68
    v_mfma_f32_16x16x32_bf16 v[84:87], a[172:175], a[136:139], v[84:87]
    s_waitcnt vmcnt(15) lgkmcnt(6)
    s_barrier
    ds_read_b64_tr_b16 a[144:145], v12 offset:8192
    buffer_atomic_add v27, v7, s[32:35], s97 offen sc1
    v_mfma_f32_16x16x32_bf16 v[84:87], a[176:179], a[140:143], v[84:87]
    s_add_u32 m0, s82, 24576
    ds_read_b64_tr_b16 a[146:147], v12 offset:10240
    v_mul_f32 v37, v37, v69
    v_mfma_f32_16x16x32_bf16 v[88:91], a[180:183], a[36:39], v[88:91]
    s_add_u32 s56, s56, 36864
    ds_read_b64_tr_b16 a[148:149], v12 offset:12288
    v_mul_f32 v38, v38, v70
    v_mfma_f32_16x16x32_bf16 v[88:91], a[184:187], a[40:43], v[88:91]
    s_addc_u32 s57, s57, 0
    ds_read_b64_tr_b16 a[150:151], v12 offset:14336
    buffer_load_dwordx4 v212, s[56:59], 0 offen lds
    v_mfma_f32_16x16x32_bf16 v[88:91], a[188:191], a[44:47], v[88:91]
    ds_read_b64_tr_b16 a[152:153], v12 offset:16384
    v_mul_f32 v39, v39, v71
    v_mfma_f32_16x16x32_bf16 v[88:91], a[192:195], a[48:51], v[88:91]
    v_exp_f32 v36, v36
    v_mfma_f32_16x16x32_bf16 v[88:91], a[196:199], a[52:55], v[88:91]
    ds_read_b64_tr_b16 a[154:155], v12 offset:18432
    ds_read_b64_tr_b16 a[156:157], v12 offset:20480
    v_mfma_f32_16x16x32_bf16 v[88:91], a[200:203], a[56:59], v[88:91]
    s_waitcnt lgkmcnt(5)
    ds_read_b64_tr_b16 a[158:159], v12 offset:22528
    v_exp_f32 v37, v37
    v_mfma_f32_16x16x32_bf16 v[88:91], a[204:207], a[60:63], v[88:91]
L_w14:
    s_cbranch_execz L_w18
    ds_read_b64_tr_b16 a[160:161], v12 offset:24576
    v_exp_f32 v38, v38
    v_mfma_f32_16x16x32_bf16 v[88:91], a[208:211], a[64:67], v[88:91]
    s_add_u32 m0, s82, 28672
    v_exp_f32 v39, v39
    v_mfma_f32_16x16x32_bf16 v[88:91], a[212:215], a[68:71], v[88:91]
    s_add_u32 s56, s56, 36864
    ds_read_b64_tr_b16 a[162:163], v12 offset:26624
    ds_read_b64_tr_b16 a[164:165], v12 offset:28672
    v_mfma_f32_16x16x32_bf16 v[92:95], a[180:183], a[108:111], v[92:95]
    s_addc_u32 s57, s57, 0
    ds_read_b64_tr_b16 a[166:167], v12 offset:30720
    buffer_load_dwordx4 v212, s[56:59], 0 offen lds
    v_mfma_f32_16x16x32_bf16 v[92:95], a[184:187], a[112:115], v[92:95]
    ds_read_b64_tr_b16 a[168:169], v12 offset:32768
    v_add_f32 v36, 1.0, v36
    v_mfma_f32_16x16x32_bf16 v[92:95], a[188:191], a[116:119], v[92:95]
    ds_read_b64_tr_b16 a[170:171], v12 offset:34816
    v_add_f32 v37, 1.0, v37
    v_mfma_f32_16x16x32_bf16 v[92:95], a[192:195], a[120:123], v[92:95]
    ds_read_b64_tr_b16 a[172:173], v12 offset:36864
    v_add_f32 v38, 1.0, v38
    v_mfma_f32_16x16x32_bf16 v[92:95], a[196:199], a[124:127], v[92:95]
    ds_read_b64_tr_b16 a[174:175], v12 offset:38912
    v_add_f32 v39, 1.0, v39
    v_mfma_f32_16x16x32_bf16 v[92:95], a[200:203], a[128:131], v[92:95]
    ds_read_b64_tr_b16 a[176:177], v12 offset:40960
    v_rcp_f32 v36, v36
    v_mfma_f32_16x16x32_bf16 v[92:95], a[204:207], a[132:135], v[92:95]
    s_add_u32 m0, s82, 32768
    v_rcp_f32 v37, v37
    v_mfma_f32_16x16x32_bf16 v[92:95], a[208:211], a[136:139], v[92:95]
    s_add_u32 s56, s56, 36864
    ds_read_b64_tr_b16 a[178:179], v12 offset:43008
    ds_read_b64_tr_b16 a[180:181], v13 offset:8192
    v_mfma_f32_16x16x32_bf16 v[92:95], a[212:215], a[140:143], v[92:95]
    s_addc_u32 s57, s57, 0
    ds_read_b64_tr_b16 a[182:183], v13 offset:10240
    buffer_load_dwordx4 v212, s[56:59], 0 offen lds
    v_mfma_f32_16x16x32_bf16 v[96:99], a[144:147], a[0:3], 0
    s_waitcnt lgkmcnt(5)
    ds_read_b64_tr_b16 a[184:185], v13 offset:12288
    v_rcp_f32 v38, v38
    v_mfma_f32_16x16x32_bf16 v[96:99], a[148:151], a[4:7], v[96:99]
    ds_read_b64_tr_b16 a[186:187], v13 offset:14336
    v_rcp_f32 v39, v39
    v_mfma_f32_16x16x32_bf16 v[96:99], a[152:155], a[8:11], v[96:99]
    ds_read_b64_tr_b16 a[188:189], v13 offset:16384
    v_mul_f32 v36, v36, v68
    v_mfma_f32_16x16x32_bf16 v[96:99], a[156:159], a[12:15], v[96:99]
    ds_read_b64_tr_b16 a[190:191], v13 offset:18432
    v_mul_f32 v37, v37, v69
    v_mfma_f32_16x16x32_bf16 v[96:99], a[160:163], a[16:19], v[96:99]
    s_waitcnt lgkmcnt(5)
    ds_read_b64_tr_b16 a[192:193], v13 offset:20480
    v_mul_f32 v38, v38, v70
    v_mfma_f32_16x16x32_bf16 v[96:99], a[164:167], a[20:23], v[96:99]
    s_add_u32 m0, s82, 36864
    ds_read_b64_tr_b16 a[194:195], v13 offset:22528
    v_mul_f32 v39, v39, v71
    v_mfma_f32_16x16x32_bf16 v[96:99], a[168:171], a[24:27], v[96:99]
    s_add_u32 s56, s56, 36864
    ds_read_b64_tr_b16 a[196:197], v13 offset:24576
    v_fma_f32 v40, -v72, v72, s89
    v_mfma_f32_16x16x32_bf16 v[96:99], a[172:175], a[28:31], v[96:99]
    s_addc_u32 s57, s57, 0
    ds_read_b64_tr_b16 a[198:199], v13 offset:26624
    buffer_load_dwordx4 v212, s[56:59], 0 offen lds
    v_mfma_f32_16x16x32_bf16 v[96:99], a[176:179], a[32:35], v[96:99]
    ds_read_b64_tr_b16 a[200:201], v13 offset:28672
    v_fma_f32 v41, -v73, v73, s89
    v_mfma_f32_16x16x32_bf16 v[100:103], a[144:147], a[72:75], 0
    ds_read_b64_tr_b16 a[202:203], v13 offset:30720
    v_fma_f32 v42, -v74, v74, s89
    v_mfma_f32_16x16x32_bf16 v[100:103], a[148:151], a[76:79], v[100:103]
    ds_read_b64_tr_b16 a[204:205], v13 offset:32768
    v_fma_f32 v43, -v75, v75, s89
    v_mfma_f32_16x16x32_bf16 v[100:103], a[152:155], a[80:83], v[100:103]
    ds_read_b64_tr_b16 a[206:207], v13 offset:34816
    v_mul_f32 v40, v40, v72
    v_mfma_f32_16x16x32_bf16 v[100:103], a[156:159], a[84:87], v[100:103]
    ds_read_b64_tr_b16 a[208:209], v13 offset:36864
    v_mul_f32 v41, v41, v73
    v_mfma_f32_16x16x32_bf16 v[100:103], a[160:163], a[88:91], v[100:103]
    s_add_u32 m0, s82, 40960
    ds_read_b64_tr_b16 a[210:211], v13 offset:38912
    v_mul_f32 v42, v42, v74
    v_mfma_f32_16x16x32_bf16 v[100:103], a[164:167], a[92:95], v[100:103]
    s_add_u32 s56, s56, 36864
    ds_read_b64_tr_b16 a[212:213], v13 offset:40960
    v_mul_f32 v43, v43, v75
    v_mfma_f32_16x16x32_bf16 v[100:103], a[168:171], a[96:99], v[100:103]
    s_addc_u32 s57, s57, 0
    ds_read_b64_tr_b16 a[214:215], v13 offset:43008
    buffer_load_dwordx4 v212, s[56:59], 0 offen lds
    v_mfma_f32_16x16x32_bf16 v[100:103], a[172:175], a[100:103], v[100:103]
    v_exp_f32 v40, v40
    v_mfma_f32_16x16x32_bf16 v[100:103], a[176:179], a[104:107], v[100:103]
    s_waitcnt lgkmcnt(4)
    ds_read_b64_tr_b16 a[144:145], v14 offset:8192
    ds_read_b64_tr_b16 a[146:147], v14 offset:10240
    v_mfma_f32_16x16x32_bf16 v[104:107], a[180:183], a[0:3], 0
    v_exp_f32 v41, v41
    v_mfma_f32_16x16x32_bf16 v[104:107], a[184:187], a[4:7], v[104:107]
    ds_read_b64_tr_b16 a[148:149], v14 offset:12288
    ds_read_b64_tr_b16 a[150:151], v14 offset:14336
    v_mfma_f32_16x16x32_bf16 v[104:107], a[188:191], a[8:11], v[104:107]
    ds_read_b64_tr_b16 a[152:153], v14 offset:16384
    v_exp_f32 v42, v42
    v_mfma_f32_16x16x32_bf16 v[104:107], a[192:195], a[12:15], v[104:107]
    s_add_u32 m0, s82, 45056
    ds_read_b64_tr_b16 a[154:155], v14 offset:18432
    v_exp_f32 v43, v43
    v_mfma_f32_16x16x32_bf16 v[104:107], a[196:199], a[16:19], v[104:107]
    s_add_u32 s56, s56, 36864
    ds_read_b64_tr_b16 a[156:157], v14 offset:20480
    v_add_f32 v40, 1.0, v40
    v_mfma_f32_16x16x32_bf16 v[104:107], a[200:203], a[20:23], v[104:107]
    s_addc_u32 s57, s57, 0
    ds_read_b64_tr_b16 a[158:159], v14 offset:22528
    buffer_load_dwordx4 v212, s[56:59], 0 offen lds
    v_mfma_f32_16x16x32_bf16 v[104:107], a[204:207], a[24:27], v[104:107]
    s_waitcnt lgkmcnt(6)
    ds_read_b64_tr_b16 a[160:161], v14 offset:24576
    v_add_f32 v41, 1.0, v41
    v_mfma_f32_16x16x32_bf16 v[104:107], a[208:211], a[28:31], v[104:107]
    ds_read_b64_tr_b16 a[162:163], v14 offset:26624
    v_add_f32 v42, 1.0, v42
    v_mfma_f32_16x16x32_bf16 v[104:107], a[212:215], a[32:35], v[104:107]
    ds_read_b64_tr_b16 a[164:165], v14 offset:28672
    v_add_f32 v43, 1.0, v43
    v_mfma_f32_16x16x32_bf16 v[108:111], a[180:183], a[72:75], 0
    v_rcp_f32 v40, v40
    v_mfma_f32_16x16x32_bf16 v[108:111], a[184:187], a[76:79], v[108:111]
    ds_read_b64_tr_b16 a[166:167], v14 offset:30720
    ds_read_b64_tr_b16 a[168:169], v14 offset:32768
    v_mfma_f32_16x16x32_bf16 v[108:111], a[188:191], a[80:83], v[108:111]
    s_add_u32 m0, s82, 49152
    ds_read_b64_tr_b16 a[170:171], v14 offset:34816
    v_rcp_f32 v41, v41
    v_mfma_f32_16x16x32_bf16 v[108:111], a[192:195], a[84:87], v[108:111]
    s_add_u32 s56, s56, 36864
    ds_read_b64_tr_b16 a[172:173], v14 offset:36864
    v_rcp_f32 v42, v42
    v_mfma_f32_16x16x32_bf16 v[108:111], a[196:199], a[88:91], v[108:111]
    s_addc_u32 s57, s57, 0
    ds_read_b64_tr_b16 a[174:175], v14 offset:38912
    buffer_load_dwordx4 v212, s[56:59], 0 offen lds
    v_mfma_f32_16x16x32_bf16 v[108:111], a[200:203], a[92:95], v[108:111]
    ds_read_b64_tr_b16 a[176:177], v14 offset:40960
    v_rcp_f32 v43, v43
    v_mfma_f32_16x16x32_bf16 v[108:111], a[204:207], a[96:99], v[108:111]
    ds_read_b64_tr_b16 a[178:179], v14 offset:43008
    v_mul_f32 v40, v40, v72
    v_mfma_f32_16x16x32_bf16 v[108:111], a[208:211], a[100:103], v[108:111]
    ds_read_b64_tr_b16 a[180:181], v15 offset:8192
    v_mul_f32 v41, v41, v73
    v_mfma_f32_16x16x32_bf16 v[108:111], a[212:215], a[104:107], v[108:111]
    ds_read_b64_tr_b16 a[182:183], v15 offset:10240
    v_mul_f32 v42, v42, v74
    v_mfma_f32_16x16x32_bf16 v[112:115], a[144:147], a[0:3], 0
    s_waitcnt lgkmcnt(5)
    ds_read_b64_tr_b16 a[184:185], v15 offset:12288
    v_mul_f32 v43, v43, v75
    v_mfma_f32_16x16x32_bf16 v[112:115], a[148:151], a[4:7], v[112:115]
    s_add_u32 m0, s82, 53248
    ds_read_b64_tr_b16 a[186:187], v15 offset:14336
    v_fma_f32 v44, -v76, v76, s89
    v_mfma_f32_16x16x32_bf16 v[112:115], a[152:155], a[8:11], v[112:115]
    s_add_u32 s56, s56, 36864
    ds_read_b64_tr_b16 a[188:189], v15 offset:16384
    v_fma_f32 v45, -v77, v77, s89
    v_mfma_f32_16x16x32_bf16 v[112:115], a[156:159], a[12:15], v[112:115]
    s_addc_u32 s57, s57, 0
    ds_read_b64_tr_b16 a[190:191], v15 offset:18432
    buffer_load_dwordx4 v212, s[56:59], 0 offen lds
    v_mfma_f32_16x16x32_bf16 v[112:115], a[160:163], a[16:19], v[112:115]
    ds_read_b64_tr_b16 a[192:193], v15 offset:20480
    v_fma_f32 v46, -v78, v78, s89
    v_mfma_f32_16x16x32_bf16 v[112:115], a[164:167], a[20:23], v[112:115]
    ds_read_b64_tr_b16 a[194:195], v15 offset:22528
    v_fma_f32 v47, -v79, v79, s89
    v_mfma_f32_16x16x32_bf16 v[112:115], a[168:171], a[24:27], v[112:115]
    s_waitcnt lgkmcnt(5)
    ds_read_b64_tr_b16 a[196:197], v15 offset:24576
    v_mul_f32 v44, v44, v76
    v_mfma_f32_16x16x32_bf16 v[112:115], a[172:175], a[28:31], v[112:115]
    ds_read_b64_tr_b16 a[198:199], v15 offset:26624
    v_mul_f32 v45, v45, v77
    v_mfma_f32_16x16x32_bf16 v[112:115], a[176:179], a[32:35], v[112:115]
    ds_read_b64_tr_b16 a[200:201], v15 offset:28672
    v_mul_f32 v46, v46, v78
    v_mfma_f32_16x16x32_bf16 v[116:119], a[144:147], a[72:75], 0
    s_add_u32 m0, s82, 57344
    ds_read_b64_tr_b16 a[202:203], v15 offset:30720
    v_mul_f32 v47, v47, v79
    v_mfma_f32_16x16x32_bf16 v[116:119], a[148:151], a[76:79], v[116:119]
    s_add_u32 s56, s56, 36864
    ds_read_b64_tr_b16 a[204:205], v15 offset:32768
    v_exp_f32 v44, v44
    v_mfma_f32_16x16x32_bf16 v[116:119], a[152:155], a[80:83], v[116:119]
    s_addc_u32 s57, s57, 0
    ds_read_b64_tr_b16 a[206:207], v15 offset:34816
    buffer_load_dwordx4 v212, s[56:59], 0 offen lds
    v_mfma_f32_16x16x32_bf16 v[116:119], a[156:159], a[84:87], v[116:119]
    v_exp_f32 v45, v45
    v_mfma_f32_16x16x32_bf16 v[116:119], a[160:163], a[88:91], v[116:119]
    ds_read_b64_tr_b16 a[208:209], v15 offset:36864
    ds_read_b64_tr_b16 a[210:211], v15 offset:38912
    v_mfma_f32_16x16x32_bf16 v[116:119], a[164:167], a[92:95], v[116:119]
    v_exp_f32 v46, v46
    v_mfma_f32_16x16x32_bf16 v[116:119], a[168:171], a[96:99], v[116:119]
    ds_read_b64_tr_b16 a[212:213], v15 offset:40960
    ds_read_b64_tr_b16 a[214:215], v15 offset:43008
    v_mfma_f32_16x16x32_bf16 v[116:119], a[172:175], a[100:103], v[116:119]
    s_waitcnt vmcnt(16) lgkmcnt(6)
    s_barrier
    ds_read_b64_tr_b16 a[144:145], v12 offset:45056
    v_mfma_f32_16x16x32_bf16 v[116:119], a[176:179], a[104:107], v[116:119]
    s_add_u32 m0, s82, 61440
    ds_read_b64_tr_b16 a[146:147], v12 offset:47104
    v_exp_f32 v47, v47
    v_mfma_f32_16x16x32_bf16 v[120:123], a[180:183], a[0:3], 0
    s_add_u32 s56, s56, 36864
    ds_read_b64_tr_b16 a[148:149], v12 offset:49152
    v_add_f32 v44, 1.0, v44
    v_mfma_f32_16x16x32_bf16 v[120:123], a[184:187], a[4:7], v[120:123]
    s_addc_u32 s57, s57, 0
    ds_read_b64_tr_b16 a[150:151], v12 offset:51200
    buffer_load_dwordx4 v212, s[56:59], 0 offen lds
    v_mfma_f32_16x16x32_bf16 v[120:123], a[188:191], a[8:11], v[120:123]
    ds_read_b64_tr_b16 a[152:153], v12 offset:53248
    v_add_f32 v45, 1.0, v45
    v_mfma_f32_16x16x32_bf16 v[120:123], a[192:195], a[12:15], v[120:123]
    ds_read_b64_tr_b16 a[154:155], v12 offset:55296
    v_add_f32 v46, 1.0, v46
    v_mfma_f32_16x16x32_bf16 v[120:123], a[196:199], a[16:19], v[120:123]
    ds_read_b64_tr_b16 a[156:157], v12 offset:57344
    v_add_f32 v47, 1.0, v47
    v_mfma_f32_16x16x32_bf16 v[120:123], a[200:203], a[20:23], v[120:123]
    s_waitcnt lgkmcnt(5)
    ds_read_b64_tr_b16 a[158:159], v12 offset:59392
    v_rcp_f32 v44, v44
    v_mfma_f32_16x16x32_bf16 v[120:123], a[204:207], a[24:27], v[120:123]
    v_rcp_f32 v45, v45
    v_mfma_f32_16x16x32_bf16 v[120:123], a[208:211], a[28:31], v[120:123]
    s_add_u32 m0, s82, 65536
    ds_read_b64_tr_b16 a[160:161], v12 offset:61440
    ds_read_b64_tr_b16 a[162:163], v12 offset:63488
    v_mfma_f32_16x16x32_bf16 v[120:123], a[212:215], a[32:35], v[120:123]
    s_add_u32 s56, s56, 36864
    ds_read_b64_tr_b16 a[164:165], v16 offset:0
    v_rcp_f32 v46, v46
    v_mfma_f32_16x16x32_bf16 v[124:127], a[180:183], a[72:75], 0
    s_addc_u32 s57, s57, 0
    ds_read_b64_tr_b16 a[166:167], v16 offset:2048
    buffer_load_dwordx4 v212, s[56:59], 0 offen lds
    v_mfma_f32_16x16x32_bf16 v[124:127], a[184:187], a[76:79], v[124:127]
    ds_read_b64_tr_b16 a[168:169], v16 offset:4096
    v_rcp_f32 v47, v47
    v_mfma_f32_16x16x32_bf16 v[124:127], a[188:191], a[80:83], v[124:127]
    ds_read_b64_tr_b16 a[170:171], v16 offset:6144
    v_mul_f32 v44, v44, v76
    v_mfma_f32_16x16x32_bf16 v[124:127], a[192:195], a[84:87], v[124:127]
    ds_read_b64_tr_b16 a[172:173], v16 offset:8192
    v_mul_f32 v45, v45, v77
    v_mfma_f32_16x16x32_bf16 v[124:127], a[196:199], a[88:91], v[124:127]
    ds_read_b64_tr_b16 a[174:175], v16 offset:10240
    v_mul_f32 v46, v46, v78
    v_mfma_f32_16x16x32_bf16 v[124:127], a[200:203], a[92:95], v[124:127]
    ds_read_b64_tr_b16 a[176:177], v16 offset:12288
    v_mul_f32 v47, v47, v79
    v_mfma_f32_16x16x32_bf16 v[124:127], a[204:207], a[96:99], v[124:127]
    s_add_u32 m0, s82, 69632
    ds_read_b64_tr_b16 a[178:179], v16 offset:14336
    v_fma_f32 v48, -v80, v80, s89
    v_mfma_f32_16x16x32_bf16 v[124:127], a[208:211], a[100:103], v[124:127]
    s_add_u32 s56, s56, 36864
    ds_read_b64_tr_b16 a[180:181], v13 offset:45056
    v_fma_f32 v49, -v81, v81, s89
    v_mfma_f32_16x16x32_bf16 v[124:127], a[212:215], a[104:107], v[124:127]
    s_addc_u32 s57, s57, 0
    ds_read_b64_tr_b16 a[182:183], v13 offset:47104
    buffer_load_dwordx4 v212, s[56:59], 0 offen lds
    v_mfma_f32_16x16x32_bf16 v[96:99], a[144:147], a[36:39], v[96:99]
    s_waitcnt lgkmcnt(5)
    ds_read_b64_tr_b16 a[184:185], v13 offset:49152
    v_fma_f32 v50, -v82, v82, s89
    v_mfma_f32_16x16x32_bf16 v[96:99], a[148:151], a[40:43], v[96:99]
    ds_read_b64_tr_b16 a[186:187], v13 offset:51200
    v_fma_f32 v51, -v83, v83, s89
    v_mfma_f32_16x16x32_bf16 v[96:99], a[152:155], a[44:47], v[96:99]
    ds_read_b64_tr_b16 a[188:189], v13 offset:53248
    v_mul_f32 v48, v48, v80
    v_mfma_f32_16x16x32_bf16 v[96:99], a[156:159], a[48:51], v[96:99]
    ds_read_b64_tr_b16 a[190:191], v13 offset:55296
    v_mul_f32 v49, v49, v81
    v_mfma_f32_16x16x32_bf16 v[96:99], a[160:163], a[52:55], v[96:99]
    ds_read_b64_tr_b16 a[192:193], v13 offset:57344
    v_mul_f32 v50, v50, v82
    v_mfma_f32_16x16x32_bf16 v[96:99], a[164:167], a[56:59], v[96:99]
    s_waitcnt lgkmcnt(5)
    ds_read_b64_tr_b16 a[194:195], v13 offset:59392
    v_mul_f32 v51, v51, v83
    v_mfma_f32_16x16x32_bf16 v[96:99], a[168:171], a[60:63], v[96:99]
    s_add_u32 m0, s82, 73728
    ds_read_b64_tr_b16 a[196:197], v13 offset:61440
    v_exp_f32 v48, v48
    v_mfma_f32_16x16x32_bf16 v[96:99], a[172:175], a[64:67], v[96:99]
    s_mov_b32 s83, 0
    ds_read_b64_tr_b16 a[198:199], v13 offset:63488
    buffer_load_dwordx4 v213, s[36:39], s83 offen lds
    v_mfma_f32_16x16x32_bf16 v[96:99], a[176:179], a[68:71], v[96:99]
    v_exp_f32 v49, v49
    v_mfma_f32_16x16x32_bf16 v[100:103], a[144:147], a[108:111], v[100:103]
    ds_read_b64_tr_b16 a[200:201], v17 offset:0
    ds_read_b64_tr_b16 a[202:203], v17 offset:2048
    v_mfma_f32_16x16x32_bf16 v[100:103], a[148:151], a[112:115], v[100:103]
    v_exp_f32 v50, v50
    v_mfma_f32_16x16x32_bf16 v[100:103], a[152:155], a[116:119], v[100:103]
    ds_read_b64_tr_b16 a[204:205], v17 offset:4096
    ds_read_b64_tr_b16 a[206:207], v17 offset:6144
    v_mfma_f32_16x16x32_bf16 v[100:103], a[156:159], a[120:123], v[100:103]
    ds_read_b64_tr_b16 a[208:209], v17 offset:8192
    v_exp_f32 v51, v51
    v_mfma_f32_16x16x32_bf16 v[100:103], a[160:163], a[124:127], v[100:103]
    ds_read_b64_tr_b16 a[210:211], v17 offset:10240
    v_add_f32 v48, 1.0, v48
    v_mfma_f32_16x16x32_bf16 v[100:103], a[164:167], a[128:131], v[100:103]
    s_add_u32 m0, s82, 77824
    ds_read_b64_tr_b16 a[212:213], v17 offset:12288
    v_add_f32 v49, 1.0, v49
    v_mfma_f32_16x16x32_bf16 v[100:103], a[168:171], a[132:135], v[100:103]
    s_add_u32 s83, s83, 73728
    ds_read_b64_tr_b16 a[214:215], v17 offset:14336
    buffer_load_dwordx4 v213, s[36:39], s83 offen lds
    v_mfma_f32_16x16x32_bf16 v[100:103], a[172:175], a[136:139], v[100:103]
    ds_read_b64_tr_b16 a[144:145], v14 offset:45056
    v_add_f32 v50, 1.0, v50
    v_mfma_f32_16x16x32_bf16 v[100:103], a[176:179], a[140:143], v[100:103]
    ds_read_b64_tr_b16 a[146:147], v14 offset:47104
    v_add_f32 v51, 1.0, v51
    v_mfma_f32_16x16x32_bf16 v[104:107], a[180:183], a[36:39], v[104:107]
    s_waitcnt lgkmcnt(5)
    v_rcp_f32 v48, v48
    v_mfma_f32_16x16x32_bf16 v[104:107], a[184:187], a[40:43], v[104:107]
    ds_read_b64_tr_b16 a[148:149], v14 offset:49152
    ds_read_b64_tr_b16 a[150:151], v14 offset:51200
    v_mfma_f32_16x16x32_bf16 v[104:107], a[188:191], a[44:47], v[104:107]
    ds_read_b64_tr_b16 a[152:153], v14 offset:53248
    v_rcp_f32 v49, v49
    v_mfma_f32_16x16x32_bf16 v[104:107], a[192:195], a[48:51], v[104:107]
    ds_read_b64_tr_b16 a[154:155], v14 offset:55296
    v_rcp_f32 v50, v50
    v_mfma_f32_16x16x32_bf16 v[104:107], a[196:199], a[52:55], v[104:107]
    s_add_u32 m0, s82, 81920
    ds_read_b64_tr_b16 a[156:157], v14 offset:57344
    v_rcp_f32 v51, v51
    v_mfma_f32_16x16x32_bf16 v[104:107], a[200:203], a[56:59], v[104:107]
    s_add_u32 s83, s83, 73728
    ds_read_b64_tr_b16 a[158:159], v14 offset:59392
    buffer_load_dwordx4 v213, s[36:39], s83 offen lds
    v_mfma_f32_16x16x32_bf16 v[104:107], a[204:207], a[60:63], v[104:107]
    s_waitcnt lgkmcnt(6)
    ds_read_b64_tr_b16 a[160:161], v14 offset:61440
    v_mul_f32 v48, v48, v80
    v_mfma_f32_16x16x32_bf16 v[104:107], a[208:211], a[64:67], v[104:107]
    ds_read_b64_tr_b16 a[162:163], v14 offset:63488
    v_mul_f32 v49, v49, v81
    v_mfma_f32_16x16x32_bf16 v[104:107], a[212:215], a[68:71], v[104:107]
    ds_read_b64_tr_b16 a[164:165], v18 offset:0
    v_mul_f32 v50, v50, v82
    v_mfma_f32_16x16x32_bf16 v[108:111], a[180:183], a[108:111], v[108:111]
    ds_read_b64_tr_b16 a[166:167], v18 offset:2048
    v_mul_f32 v51, v51, v83
    v_mfma_f32_16x16x32_bf16 v[108:111], a[184:187], a[112:115], v[108:111]
    ds_read_b64_tr_b16 a[168:169], v18 offset:4096
    v_fma_f32 v52, -v84, v84, s89
    v_mfma_f32_16x16x32_bf16 v[108:111], a[188:191], a[116:119], v[108:111]
    ds_read_b64_tr_b16 a[170:171], v18 offset:6144
    v_fma_f32 v53, -v85, v85, s89
    v_mfma_f32_16x16x32_bf16 v[108:111], a[192:195], a[120:123], v[108:111]
    s_add_u32 m0, s82, 86016
    ds_read_b64_tr_b16 a[172:173], v18 offset:8192
    v_fma_f32 v54, -v86, v86, s89
    v_mfma_f32_16x16x32_bf16 v[108:111], a[196:199], a[124:127], v[108:111]
    s_add_u32 s83, s83, 73728
    ds_read_b64_tr_b16 a[174:175], v18 offset:10240
    buffer_load_dwordx4 v213, s[36:39], s83 offen lds
    v_mfma_f32_16x16x32_bf16 v[108:111], a[200:203], a[128:131], v[108:111]
    ds_read_b64_tr_b16 a[176:177], v18 offset:12288
    v_fma_f32 v55, -v87, v87, s89
    v_mfma_f32_16x16x32_bf16 v[108:111], a[204:207], a[132:135], v[108:111]
    ds_read_b64_tr_b16 a[178:179], v18 offset:14336
    v_mul_f32 v52, v52, v84
    v_mfma_f32_16x16x32_bf16 v[108:111], a[208:211], a[136:139], v[108:111]
    ds_read_b64_tr_b16 a[180:181], v15 offset:45056
    v_mul_f32 v53, v53, v85
    v_mfma_f32_16x16x32_bf16 v[108:111], a[212:215], a[140:143], v[108:111]
    ds_read_b64_tr_b16 a[182:183], v15 offset:47104
    v_mul_f32 v54, v54, v86
    v_mfma_f32_16x16x32_bf16 v[112:115], a[144:147], a[36:39], v[112:115]
    s_waitcnt lgkmcnt(5)
    ds_read_b64_tr_b16 a[184:185], v15 offset:49152
    v_mul_f32 v55, v55, v87
    v_mfma_f32_16x16x32_bf16 v[112:115], a[148:151], a[40:43], v[112:115]
    v_exp_f32 v52, v52
    v_mfma_f32_16x16x32_bf16 v[112:115], a[152:155], a[44:47], v[112:115]
    s_add_u32 m0, s82, 90112
    ds_read_b64_tr_b16 a[186:187], v15 offset:51200
    ds_read_b64_tr_b16 a[188:189], v15 offset:53248
    v_mfma_f32_16x16x32_bf16 v[112:115], a[156:159], a[48:51], v[112:115]
    s_add_u32 s83, s83, 73728
    ds_read_b64_tr_b16 a[190:191], v15 offset:55296
    buffer_load_dwordx4 v213, s[36:39], s83 offen lds
    v_mfma_f32_16x16x32_bf16 v[112:115], a[160:163], a[52:55], v[112:115]
    v_exp_f32 v53, v53
    v_mfma_f32_16x16x32_bf16 v[112:115], a[164:167], a[56:59], v[112:115]
    ds_read_b64_tr_b16 a[192:193], v15 offset:57344
    ds_read_b64_tr_b16 a[194:195], v15 offset:59392
    v_mfma_f32_16x16x32_bf16 v[112:115], a[168:171], a[60:63], v[112:115]
    s_waitcnt lgkmcnt(5)
    ds_read_b64_tr_b16 a[196:197], v15 offset:61440
    v_exp_f32 v54, v54
    v_mfma_f32_16x16x32_bf16 v[112:115], a[172:175], a[64:67], v[112:115]
    v_exp_f32 v55, v55
    v_mfma_f32_16x16x32_bf16 v[112:115], a[176:179], a[68:71], v[112:115]
    ds_read_b64_tr_b16 a[198:199], v15 offset:63488
    ds_read_b64_tr_b16 a[200:201], v19 offset:0
    v_mfma_f32_16x16x32_bf16 v[116:119], a[144:147], a[108:111], v[116:119]
    ds_read_b64_tr_b16 a[202:203], v19 offset:2048
    v_add_f32 v52, 1.0, v52
    v_mfma_f32_16x16x32_bf16 v[116:119], a[148:151], a[112:115], v[116:119]
    s_add_u32 m0, s82, 94208
    ds_read_b64_tr_b16 a[204:205], v19 offset:4096
    v_add_f32 v53, 1.0, v53
    v_mfma_f32_16x16x32_bf16 v[116:119], a[152:155], a[116:119], v[116:119]
    s_add_u32 s83, s83, 73728
    ds_read_b64_tr_b16 a[206:207], v19 offset:6144
    buffer_load_dwordx4 v213, s[36:39], s83 offen lds
    v_mfma_f32_16x16x32_bf16 v[116:119], a[156:159], a[120:123], v[116:119]
    ds_read_b64_tr_b16 a[208:209], v19 offset:8192
    v_add_f32 v54, 1.0, v54
    v_mfma_f32_16x16x32_bf16 v[116:119], a[160:163], a[124:127], v[116:119]
    ds_read_b64_tr_b16 a[210:211], v19 offset:10240
    v_add_f32 v55, 1.0, v55
    v_mfma_f32_16x16x32_bf16 v[116:119], a[164:167], a[128:131], v[116:119]
    ds_read_b64_tr_b16 a[212:213], v19 offset:12288
    v_rcp_f32 v52, v52
    v_mfma_f32_16x16x32_bf16 v[116:119], a[168:171], a[132:135], v[116:119]
    ds_read_b64_tr_b16 a[214:215], v19 offset:14336
    v_rcp_f32 v53, v53
    v_mfma_f32_16x16x32_bf16 v[116:119], a[172:175], a[136:139], v[116:119]
    s_waitcnt vmcnt(15) lgkmcnt(6)
    s_barrier
    ds_read_b64_tr_b16 a[144:145], v8 offset:0
    v_mfma_f32_16x16x32_bf16 v[116:119], a[176:179], a[140:143], v[116:119]
    ds_read_b64_tr_b16 a[146:147], v8 offset:2048
    v_rcp_f32 v54, v54
    v_mfma_f32_16x16x32_bf16 v[120:123], a[180:183], a[36:39], v[120:123]
    s_add_u32 m0, s82, 98304
    ds_read_b64_tr_b16 a[148:149], v8 offset:4096
    v_rcp_f32 v55, v55
    v_mfma_f32_16x16x32_bf16 v[120:123], a[184:187], a[40:43], v[120:123]
    s_add_u32 s83, s83, 73728
    ds_read_b64_tr_b16 a[150:151], v8 offset:6144
    buffer_load_dwordx4 v213, s[36:39], s83 offen lds
    v_mfma_f32_16x16x32_bf16 v[120:123], a[188:191], a[44:47], v[120:123]
    ds_read_b64_tr_b16 a[152:153], v8 offset:8192
    v_mul_f32 v52, v52, v84
    v_mfma_f32_16x16x32_bf16 v[120:123], a[192:195], a[48:51], v[120:123]
    ds_read_b64_tr_b16 a[154:155], v8 offset:10240
    v_mul_f32 v53, v53, v85
    v_mfma_f32_16x16x32_bf16 v[120:123], a[196:199], a[52:55], v[120:123]
    ds_read_b64_tr_b16 a[156:157], v8 offset:12288
    v_mul_f32 v54, v54, v86
    v_mfma_f32_16x16x32_bf16 v[120:123], a[200:203], a[56:59], v[120:123]
    s_waitcnt lgkmcnt(5)
    ds_read_b64_tr_b16 a[158:159], v8 offset:14336
    v_mul_f32 v55, v55, v87
    v_mfma_f32_16x16x32_bf16 v[120:123], a[204:207], a[60:63], v[120:123]
    ds_read_b64_tr_b16 a[160:161], v8 offset:16384
    v_fma_f32 v56, -v88, v88, s89
    v_mfma_f32_16x16x32_bf16 v[120:123], a[208:211], a[64:67], v[120:123]
    ds_read_b64_tr_b16 a[162:163], v8 offset:18432
    v_fma_f32 v57, -v89, v89, s89
    v_mfma_f32_16x16x32_bf16 v[120:123], a[212:215], a[68:71], v[120:123]
    s_add_u32 m0, s82, 102400
    ds_read_b64_tr_b16 a[164:165], v8 offset:20480
    v_fma_f32 v58, -v90, v90, s89
    v_mfma_f32_16x16x32_bf16 v[124:127], a[180:183], a[108:111], v[124:127]
    s_add_u32 s83, s83, 73728
    ds_read_b64_tr_b16 a[166:167], v8 offset:22528
    buffer_load_dwordx4 v213, s[36:39], s83 offen lds
    v_mfma_f32_16x16x32_bf16 v[124:127], a[184:187], a[112:115], v[124:127]
    ds_read_b64_tr_b16 a[168:169], v8 offset:24576
    v_fma_f32 v59, -v91, v91, s89
    v_mfma_f32_16x16x32_bf16 v[124:127], a[188:191], a[116:119], v[124:127]
    ds_read_b64_tr_b16 a[170:171], v8 offset:26624
    v_mul_f32 v56, v56, v88
    v_mfma_f32_16x16x32_bf16 v[124:127], a[192:195], a[120:123], v[124:127]
    ds_read_b64_tr_b16 a[172:173], v8 offset:28672
    v_mul_f32 v57, v57, v89
    v_mfma_f32_16x16x32_bf16 v[124:127], a[196:199], a[124:127], v[124:127]
    ds_read_b64_tr_b16 a[174:175], v8 offset:30720
    v_mul_f32 v58, v58, v90
    v_mfma_f32_16x16x32_bf16 v[124:127], a[200:203], a[128:131], v[124:127]
    ds_read_b64_tr_b16 a[176:177], v8 offset:32768
    v_mul_f32 v59, v59, v91
    v_mfma_f32_16x16x32_bf16 v[124:127], a[204:207], a[132:135], v[124:127]
    v_exp_f32 v56, v56
    v_mfma_f32_16x16x32_bf16 v[124:127], a[208:211], a[136:139], v[124:127]
    s_add_u32 m0, s82, 106496
    ds_read_b64_tr_b16 a[178:179], v8 offset:34816
    ds_read_b64_tr_b16 a[180:181], v9 offset:0
    v_mfma_f32_16x16x32_bf16 v[124:127], a[212:215], a[140:143], v[124:127]
    s_add_u32 s83, s83, 73728
    ds_read_b64_tr_b16 a[182:183], v9 offset:2048
    buffer_load_dwordx4 v213, s[36:39], s83 offen lds
    v_mfma_f32_16x16x32_bf16 v[64:67], a[144:147], a[0:3], 0
    s_waitcnt lgkmcnt(5)
    v_exp_f32 v57, v57
    v_mfma_f32_16x16x32_bf16 v[64:67], a[148:151], a[4:7], v[64:67]
    ds_read_b64_tr_b16 a[184:185], v9 offset:4096
    ds_read_b64_tr_b16 a[186:187], v9 offset:6144
    v_mfma_f32_16x16x32_bf16 v[64:67], a[152:155], a[8:11], v[64:67]
    ds_read_b64_tr_b16 a[188:189], v9 offset:8192
    v_exp_f32 v58, v58
    v_mfma_f32_16x16x32_bf16 v[64:67], a[156:159], a[12:15], v[64:67]
    ds_read_b64_tr_b16 a[190:191], v9 offset:10240
    v_exp_f32 v59, v59
    v_mfma_f32_16x16x32_bf16 v[64:67], a[160:163], a[16:19], v[64:67]
    ds_read_b64_tr_b16 a[192:193], v9 offset:12288
    v_add_f32 v56, 1.0, v56
    v_mfma_f32_16x16x32_bf16 v[64:67], a[164:167], a[20:23], v[64:67]
    ds_read_b64_tr_b16 a[194:195], v9 offset:14336
    v_add_f32 v57, 1.0, v57
    v_mfma_f32_16x16x32_bf16 v[64:67], a[168:171], a[24:27], v[64:67]
    s_waitcnt lgkmcnt(6)
    ds_read_b64_tr_b16 a[196:197], v9 offset:16384
    v_add_f32 v58, 1.0, v58
    v_mfma_f32_16x16x32_bf16 v[64:67], a[172:175], a[28:31], v[64:67]
    ds_read_b64_tr_b16 a[198:199], v9 offset:18432
    v_add_f32 v59, 1.0, v59
    v_mfma_f32_16x16x32_bf16 v[64:67], a[176:179], a[32:35], v[64:67]
    v_rcp_f32 v56, v56
    v_mfma_f32_16x16x32_bf16 v[68:71], a[144:147], a[72:75], 0
    ds_read_b64_tr_b16 a[200:201], v9 offset:20480
    ds_read_b64_tr_b16 a[202:203], v9 offset:22528
    v_mfma_f32_16x16x32_bf16 v[68:71], a[148:151], a[76:79], v[68:71]
    v_rcp_f32 v57, v57
    v_mfma_f32_16x16x32_bf16 v[68:71], a[152:155], a[80:83], v[68:71]
    ds_read_b64_tr_b16 a[204:205], v9 offset:24576
    ds_read_b64_tr_b16 a[206:207], v9 offset:26624
    v_mfma_f32_16x16x32_bf16 v[68:71], a[156:159], a[84:87], v[68:71]
    ds_read_b64_tr_b16 a[208:209], v9 offset:28672
    buffer_load_dword v26, v215, s[32:35], 0 offen sc1
    v_mfma_f32_16x16x32_bf16 v[68:71], a[160:163], a[88:91], v[68:71]
    ds_read_b64_tr_b16 a[210:211], v9 offset:30720
    v_rcp_f32 v58, v58
    v_mfma_f32_16x16x32_bf16 v[68:71], a[164:167], a[92:95], v[68:71]
    ds_read_b64_tr_b16 a[212:213], v9 offset:32768
    v_rcp_f32 v59, v59
    v_mfma_f32_16x16x32_bf16 v[68:71], a[168:171], a[96:99], v[68:71]
    ds_read_b64_tr_b16 a[214:215], v9 offset:34816
    v_mul_f32 v56, v56, v88
    v_mfma_f32_16x16x32_bf16 v[68:71], a[172:175], a[100:103], v[68:71]
    ds_read_b64_tr_b16 a[144:145], v10 offset:0
    v_mul_f32 v57, v57, v89
    v_mfma_f32_16x16x32_bf16 v[68:71], a[176:179], a[104:107], v[68:71]
    ds_read_b64_tr_b16 a[146:147], v10 offset:2048
    v_mul_f32 v58, v58, v90
    v_mfma_f32_16x16x32_bf16 v[72:75], a[180:183], a[0:3], 0
    s_waitcnt lgkmcnt(5)
    ds_read_b64_tr_b16 a[148:149], v10 offset:4096
    v_mul_f32 v59, v59, v91
    v_mfma_f32_16x16x32_bf16 v[72:75], a[184:187], a[4:7], v[72:75]
    ds_read_b64_tr_b16 a[150:151], v10 offset:6144
    v_fma_f32 v60, -v92, v92, s89
    v_mfma_f32_16x16x32_bf16 v[72:75], a[188:191], a[8:11], v[72:75]
L_w15:
    s_cbranch_execz L_w19
    ds_read_b64_tr_b16 a[152:153], v10 offset:8192
    v_fma_f32 v61, -v93, v93, s89
    v_mfma_f32_16x16x32_bf16 v[72:75], a[192:195], a[12:15], v[72:75]
    ds_read_b64_tr_b16 a[154:155], v10 offset:10240
    v_fma_f32 v62, -v94, v94, s89
    v_mfma_f32_16x16x32_bf16 v[72:75], a[196:199], a[16:19], v[72:75]
    ds_read_b64_tr_b16 a[156:157], v10 offset:12288
    v_fma_f32 v63, -v95, v95, s89
    v_mfma_f32_16x16x32_bf16 v[72:75], a[200:203], a[20:23], v[72:75]
    ds_read_b64_tr_b16 a[158:159], v10 offset:14336
    v_mul_f32 v60, v60, v92
    v_mfma_f32_16x16x32_bf16 v[72:75], a[204:207], a[24:27], v[72:75]
    s_waitcnt lgkmcnt(5)
    ds_read_b64_tr_b16 a[160:161], v10 offset:16384
    v_mul_f32 v61, v61, v93
    v_mfma_f32_16x16x32_bf16 v[72:75], a[208:211], a[28:31], v[72:75]
    ds_read_b64_tr_b16 a[162:163], v10 offset:18432
    v_mul_f32 v62, v62, v94
    v_mfma_f32_16x16x32_bf16 v[72:75], a[212:215], a[32:35], v[72:75]
    ds_read_b64_tr_b16 a[164:165], v10 offset:20480
    v_mul_f32 v63, v63, v95
    v_mfma_f32_16x16x32_bf16 v[76:79], a[180:183], a[72:75], 0
    v_exp_f32 v60, v60
    v_mfma_f32_16x16x32_bf16 v[76:79], a[184:187], a[76:79], v[76:79]
    ds_read_b64_tr_b16 a[166:167], v10 offset:22528
    ds_read_b64_tr_b16 a[168:169], v10 offset:24576
    v_mfma_f32_16x16x32_bf16 v[76:79], a[188:191], a[80:83], v[76:79]
    v_exp_f32 v61, v61
    v_mfma_f32_16x16x32_bf16 v[76:79], a[192:195], a[84:87], v[76:79]
    ds_read_b64_tr_b16 a[170:171], v10 offset:26624
    ds_read_b64_tr_b16 a[172:173], v10 offset:28672
    v_mfma_f32_16x16x32_bf16 v[76:79], a[196:199], a[88:91], v[76:79]
    ds_read_b64_tr_b16 a[174:175], v10 offset:30720
    v_exp_f32 v62, v62
    v_mfma_f32_16x16x32_bf16 v[76:79], a[200:203], a[92:95], v[76:79]
    ds_read_b64_tr_b16 a[176:177], v10 offset:32768
    v_exp_f32 v63, v63
    v_mfma_f32_16x16x32_bf16 v[76:79], a[204:207], a[96:99], v[76:79]
    ds_read_b64_tr_b16 a[178:179], v10 offset:34816
    v_add_f32 v60, 1.0, v60
    v_mfma_f32_16x16x32_bf16 v[76:79], a[208:211], a[100:103], v[76:79]
    ds_read_b64_tr_b16 a[180:181], v11 offset:0
    v_add_f32 v61, 1.0, v61
    v_mfma_f32_16x16x32_bf16 v[76:79], a[212:215], a[104:107], v[76:79]
    ds_read_b64_tr_b16 a[182:183], v11 offset:2048
    v_add_f32 v62, 1.0, v62
    v_mfma_f32_16x16x32_bf16 v[80:83], a[144:147], a[0:3], 0
    s_waitcnt lgkmcnt(5)
    ds_read_b64_tr_b16 a[184:185], v11 offset:4096
    v_add_f32 v63, 1.0, v63
    v_mfma_f32_16x16x32_bf16 v[80:83], a[148:151], a[4:7], v[80:83]
    ds_read_b64_tr_b16 a[186:187], v11 offset:6144
    v_rcp_f32 v60, v60
    v_mfma_f32_16x16x32_bf16 v[80:83], a[152:155], a[8:11], v[80:83]
    ds_read_b64_tr_b16 a[188:189], v11 offset:8192
    v_rcp_f32 v61, v61
    v_mfma_f32_16x16x32_bf16 v[80:83], a[156:159], a[12:15], v[80:83]
    ds_read_b64_tr_b16 a[190:191], v11 offset:10240
    v_rcp_f32 v62, v62
    v_mfma_f32_16x16x32_bf16 v[80:83], a[160:163], a[16:19], v[80:83]
    ds_read_b64_tr_b16 a[192:193], v11 offset:12288
    v_rcp_f32 v63, v63
    v_mfma_f32_16x16x32_bf16 v[80:83], a[164:167], a[20:23], v[80:83]
    ds_read_b64_tr_b16 a[194:195], v11 offset:14336
    v_mul_f32 v60, v60, v92
    v_mfma_f32_16x16x32_bf16 v[80:83], a[168:171], a[24:27], v[80:83]
    s_waitcnt lgkmcnt(5)
    ds_read_b64_tr_b16 a[196:197], v11 offset:16384
    v_mul_f32 v61, v61, v93
    v_mfma_f32_16x16x32_bf16 v[80:83], a[172:175], a[28:31], v[80:83]
    ds_read_b64_tr_b16 a[198:199], v11 offset:18432
    v_mul_f32 v62, v62, v94
    v_mfma_f32_16x16x32_bf16 v[80:83], a[176:179], a[32:35], v[80:83]
    ds_read_b64_tr_b16 a[200:201], v11 offset:20480
    v_mul_f32 v63, v63, v95
    v_mfma_f32_16x16x32_bf16 v[84:87], a[144:147], a[72:75], 0
    ds_read_b64_tr_b16 a[202:203], v11 offset:22528
    v_mul_f32 v32, v32, v96
    v_mfma_f32_16x16x32_bf16 v[84:87], a[148:151], a[76:79], v[84:87]
    ds_read_b64_tr_b16 a[204:205], v11 offset:24576
    v_mul_f32 v33, v33, v97
    v_mfma_f32_16x16x32_bf16 v[84:87], a[152:155], a[80:83], v[84:87]
    ds_read_b64_tr_b16 a[206:207], v11 offset:26624
    v_mul_f32 v34, v34, v98
    v_mfma_f32_16x16x32_bf16 v[84:87], a[156:159], a[84:87], v[84:87]
    ds_read_b64_tr_b16 a[208:209], v11 offset:28672
    v_mul_f32 v35, v35, v99
    v_mfma_f32_16x16x32_bf16 v[84:87], a[160:163], a[88:91], v[84:87]
    ds_read_b64_tr_b16 a[210:211], v11 offset:30720
    v_cvt_pk_bf16_f32 v192, v32, v33
    v_mfma_f32_16x16x32_bf16 v[84:87], a[164:167], a[92:95], v[84:87]
    ds_read_b64_tr_b16 a[212:213], v11 offset:32768
    v_cvt_pk_bf16_f32 v193, v34, v35
    v_mfma_f32_16x16x32_bf16 v[84:87], a[168:171], a[96:99], v[84:87]
    ds_read_b64_tr_b16 a[214:215], v11 offset:34816
    v_mul_f32 v40, v40, v104
    v_mfma_f32_16x16x32_bf16 v[84:87], a[172:175], a[100:103], v[84:87]
    s_waitcnt vmcnt(10) lgkmcnt(6)
    s_barrier
    ds_read_b64_tr_b16 a[144:145], v8 offset:36864
    v_mfma_f32_16x16x32_bf16 v[84:87], a[176:179], a[104:107], v[84:87]
    ds_read_b64_tr_b16 a[146:147], v8 offset:38912
    v_mul_f32 v41, v41, v105
    v_mfma_f32_16x16x32_bf16 v[88:91], a[180:183], a[0:3], 0
    ds_read_b64_tr_b16 a[148:149], v8 offset:40960
    v_mul_f32 v42, v42, v106
    v_mfma_f32_16x16x32_bf16 v[88:91], a[184:187], a[4:7], v[88:91]
    ds_read_b64_tr_b16 a[150:151], v8 offset:43008
    v_mul_f32 v43, v43, v107
    v_mfma_f32_16x16x32_bf16 v[88:91], a[188:191], a[8:11], v[88:91]
    ds_read_b64_tr_b16 a[152:153], v8 offset:45056
    v_mfma_f32_16x16x32_bf16 v[88:91], a[192:195], a[12:15], v[88:91]
    ds_read_b64_tr_b16 a[154:155], v8 offset:47104
    v_cvt_pk_bf16_f32 v194, v40, v41
    v_mfma_f32_16x16x32_bf16 v[88:91], a[196:199], a[16:19], v[88:91]
    ds_read_b64_tr_b16 a[156:157], v8 offset:49152
    v_cvt_pk_bf16_f32 v195, v42, v43
    v_mfma_f32_16x16x32_bf16 v[88:91], a[200:203], a[20:23], v[88:91]
    s_waitcnt lgkmcnt(5)
    ds_read_b64_tr_b16 a[158:159], v8 offset:51200
    v_mul_f32 v48, v48, v112
    v_mfma_f32_16x16x32_bf16 v[88:91], a[204:207], a[24:27], v[88:91]
    ds_read_b64_tr_b16 a[160:161], v8 offset:53248
    v_mfma_f32_16x16x32_bf16 v[88:91], a[208:211], a[28:31], v[88:91]
    ds_read_b64_tr_b16 a[162:163], v8 offset:55296
    v_mul_f32 v49, v49, v113
    v_mfma_f32_16x16x32_bf16 v[88:91], a[212:215], a[32:35], v[88:91]
    ds_read_b64_tr_b16 a[164:165], v8 offset:57344
    v_mul_f32 v50, v50, v114
    v_mfma_f32_16x16x32_bf16 v[92:95], a[180:183], a[72:75], 0
    ds_read_b64_tr_b16 a[166:167], v8 offset:59392
    v_mul_f32 v51, v51, v115
    v_mfma_f32_16x16x32_bf16 v[92:95], a[184:187], a[76:79], v[92:95]
    ds_read_b64_tr_b16 a[168:169], v8 offset:61440
    v_mfma_f32_16x16x32_bf16 v[92:95], a[188:191], a[80:83], v[92:95]
    ds_read_b64_tr_b16 a[170:171], v8 offset:63488
    v_cvt_pk_bf16_f32 v200, v48, v49
    v_mfma_f32_16x16x32_bf16 v[92:95], a[192:195], a[84:87], v[92:95]
    ds_read_b64_tr_b16 a[172:173], v12 offset:0
    v_cvt_pk_bf16_f32 v201, v50, v51
    v_mfma_f32_16x16x32_bf16 v[92:95], a[196:199], a[88:91], v[92:95]
    ds_read_b64_tr_b16 a[174:175], v12 offset:2048
    v_mul_f32 v56, v56, v120
    v_mfma_f32_16x16x32_bf16 v[92:95], a[200:203], a[92:95], v[92:95]
    s_waitcnt vmcnt(0)
    ds_read_b64_tr_b16 a[176:177], v12 offset:4096
    v_cmp_gt_u32 vcc, 16, v26
    v_mfma_f32_16x16x32_bf16 v[92:95], a[204:207], a[96:99], v[92:95]
    s_waitcnt lgkmcnt(5)
    ds_read_b64_tr_b16 a[178:179], v12 offset:6144
    v_mul_f32 v57, v57, v121
    v_mfma_f32_16x16x32_bf16 v[92:95], a[208:211], a[100:103], v[92:95]
    s_cbranch_vccnz L_kvspin
L_kvok:
    ds_read_b64_tr_b16 a[180:181], v9 offset:36864
    v_mfma_f32_16x16x32_bf16 v[92:95], a[212:215], a[104:107], v[92:95]
    s_add_u32 m0, s85, 110592
    ds_read_b64_tr_b16 a[182:183], v9 offset:38912
    v_mul_f32 v58, v58, v122
    v_mfma_f32_16x16x32_bf16 v[64:67], a[144:147], a[36:39], v[64:67]
    s_add_u32 s83, s85, 0
    ds_read_b64_tr_b16 a[184:185], v9 offset:40960
    buffer_load_dwordx4 v6, s[24:27], s83 offen offset:0 sc1 lds
    v_mfma_f32_16x16x32_bf16 v[64:67], a[148:151], a[40:43], v[64:67]
    ds_read_b64_tr_b16 a[186:187], v9 offset:43008
    v_mul_f32 v59, v59, v123
    v_mfma_f32_16x16x32_bf16 v[64:67], a[152:155], a[44:47], v[64:67]
    ds_read_b64_tr_b16 a[188:189], v9 offset:45056
    v_cvt_pk_bf16_f32 v202, v56, v57
    v_mfma_f32_16x16x32_bf16 v[64:67], a[156:159], a[48:51], v[64:67]
    ds_read_b64_tr_b16 a[190:191], v9 offset:47104
    v_cvt_pk_bf16_f32 v203, v58, v59
    v_mfma_f32_16x16x32_bf16 v[64:67], a[160:163], a[52:55], v[64:67]
    ds_read_b64_tr_b16 a[192:193], v9 offset:49152
    buffer_load_dwordx4 v6, s[24:27], s83 offen offset:1024 sc1 lds
    v_mfma_f32_16x16x32_bf16 v[64:67], a[164:167], a[56:59], v[64:67]
    s_waitcnt lgkmcnt(5)
    ds_read_b64_tr_b16 a[194:195], v9 offset:51200
    v_mul_f32 v36, v36, v100
    v_mfma_f32_16x16x32_bf16 v[64:67], a[168:171], a[60:63], v[64:67]
    ds_read_b64_tr_b16 a[196:197], v9 offset:53248
    v_mul_f32 v37, v37, v101
    v_mfma_f32_16x16x32_bf16 v[64:67], a[172:175], a[64:67], v[64:67]
    ds_read_b64_tr_b16 a[198:199], v9 offset:55296
    v_mul_f32 v38, v38, v102
    v_mfma_f32_16x16x32_bf16 v[64:67], a[176:179], a[68:71], v[64:67]
    ds_read_b64_tr_b16 a[200:201], v9 offset:57344
    buffer_load_dwordx4 v6, s[24:27], s83 offen offset:2048 sc1 lds
    v_mfma_f32_16x16x32_bf16 v[68:71], a[144:147], a[108:111], v[68:71]
    ds_read_b64_tr_b16 a[202:203], v9 offset:59392
    v_mul_f32 v39, v39, v103
    v_mfma_f32_16x16x32_bf16 v[68:71], a[148:151], a[112:115], v[68:71]
    ds_read_b64_tr_b16 a[204:205], v9 offset:61440
    v_cvt_pk_bf16_f32 v196, v36, v37
    v_mfma_f32_16x16x32_bf16 v[68:71], a[152:155], a[116:119], v[68:71]
    ds_read_b64_tr_b16 a[206:207], v9 offset:63488
    v_cvt_pk_bf16_f32 v197, v38, v39
    v_mfma_f32_16x16x32_bf16 v[68:71], a[156:159], a[120:123], v[68:71]
    ds_read_b64_tr_b16 a[208:209], v13 offset:0
    buffer_load_dwordx4 v6, s[24:27], s83 offen offset:3072 sc1 lds
    v_mfma_f32_16x16x32_bf16 v[68:71], a[160:163], a[124:127], v[68:71]
    ds_read_b64_tr_b16 a[210:211], v13 offset:2048
    v_mul_f32 v44, v44, v108
    v_mfma_f32_16x16x32_bf16 v[68:71], a[164:167], a[128:131], v[68:71]
    ds_read_b64_tr_b16 a[212:213], v13 offset:4096
    v_mul_f32 v45, v45, v109
    v_mfma_f32_16x16x32_bf16 v[68:71], a[168:171], a[132:135], v[68:71]
    s_add_u32 m0, s85, 114688
    ds_read_b64_tr_b16 a[214:215], v13 offset:6144
    v_mul_f32 v46, v46, v110
    v_mfma_f32_16x16x32_bf16 v[68:71], a[172:175], a[136:139], v[68:71]
    s_add_u32 s83, s85, 4096
    ds_read_b64_tr_b16 a[144:145], v10 offset:36864
    buffer_load_dwordx4 v6, s[24:27], s83 offen offset:0 sc1 lds
    v_mfma_f32_16x16x32_bf16 v[68:71], a[176:179], a[140:143], v[68:71]
    ds_read_b64_tr_b16 a[146:147], v10 offset:38912
    v_mul_f32 v47, v47, v111
    v_mfma_f32_16x16x32_bf16 v[72:75], a[180:183], a[36:39], v[72:75]
    s_waitcnt lgkmcnt(5)
    ds_read_b64_tr_b16 a[148:149], v10 offset:40960
    v_cvt_pk_bf16_f32 v198, v44, v45
    v_mfma_f32_16x16x32_bf16 v[72:75], a[184:187], a[40:43], v[72:75]
    s_add_u32 m0, s85, 131072
    ds_read_b64_tr_b16 a[150:151], v10 offset:43008
    v_cvt_pk_bf16_f32 v199, v46, v47
    v_mfma_f32_16x16x32_bf16 v[72:75], a[188:191], a[44:47], v[72:75]
    s_add_u32 s83, s85, 20480
    ds_read_b64_tr_b16 a[152:153], v10 offset:45056
    buffer_load_dwordx4 v6, s[24:27], s83 offen offset:0 sc1 lds
    v_mfma_f32_16x16x32_bf16 v[72:75], a[192:195], a[48:51], v[72:75]
    ds_read_b64_tr_b16 a[154:155], v10 offset:47104
    v_mul_f32 v52, v52, v116
    v_mfma_f32_16x16x32_bf16 v[72:75], a[196:199], a[52:55], v[72:75]
    ds_read_b64_tr_b16 a[156:157], v10 offset:49152
    v_mul_f32 v53, v53, v117
    v_mfma_f32_16x16x32_bf16 v[72:75], a[200:203], a[56:59], v[72:75]
    ds_read_b64_tr_b16 a[158:159], v10 offset:51200
    v_mul_f32 v54, v54, v118
    v_mfma_f32_16x16x32_bf16 v[72:75], a[204:207], a[60:63], v[72:75]
    s_waitcnt lgkmcnt(5)
    ds_read_b64_tr_b16 a[160:161], v10 offset:53248
    buffer_load_dwordx4 v6, s[24:27], s83 offen offset:1024 sc1 lds
    v_mfma_f32_16x16x32_bf16 v[72:75], a[208:211], a[64:67], v[72:75]
    ds_read_b64_tr_b16 a[162:163], v10 offset:55296
    v_mul_f32 v55, v55, v119
    v_mfma_f32_16x16x32_bf16 v[72:75], a[212:215], a[68:71], v[72:75]
    ds_read_b64_tr_b16 a[164:165], v10 offset:57344
    v_cvt_pk_bf16_f32 v204, v52, v53
    v_mfma_f32_16x16x32_bf16 v[76:79], a[180:183], a[108:111], v[76:79]
    ds_read_b64_tr_b16 a[166:167], v10 offset:59392
    v_cvt_pk_bf16_f32 v205, v54, v55
    v_mfma_f32_16x16x32_bf16 v[76:79], a[184:187], a[112:115], v[76:79]
    ds_read_b64_tr_b16 a[168:169], v10 offset:61440
    buffer_load_dwordx4 v6, s[24:27], s83 offen offset:2048 sc1 lds
    v_mfma_f32_16x16x32_bf16 v[76:79], a[188:191], a[116:119], v[76:79]
    ds_read_b64_tr_b16 a[170:171], v10 offset:63488
    v_mul_f32 v60, v60, v124
    v_mfma_f32_16x16x32_bf16 v[76:79], a[192:195], a[120:123], v[76:79]
    ds_read_b64_tr_b16 a[172:173], v14 offset:0
    v_mul_f32 v61, v61, v125
    v_mfma_f32_16x16x32_bf16 v[76:79], a[196:199], a[124:127], v[76:79]
    ds_read_b64_tr_b16 a[174:175], v14 offset:2048
    v_mul_f32 v62, v62, v126
    v_mfma_f32_16x16x32_bf16 v[76:79], a[200:203], a[128:131], v[76:79]
    ds_read_b64_tr_b16 a[176:177], v14 offset:4096
    buffer_load_dwordx4 v6, s[24:27], s83 offen offset:3072 sc1 lds
    v_mfma_f32_16x16x32_bf16 v[76:79], a[204:207], a[132:135], v[76:79]
    ds_read_b64_tr_b16 a[178:179], v14 offset:6144
    v_mul_f32 v63, v63, v127
    v_mfma_f32_16x16x32_bf16 v[76:79], a[208:211], a[136:139], v[76:79]
    s_waitcnt lgkmcnt(5)
    ds_read_b64_tr_b16 a[180:181], v11 offset:36864
    v_cvt_pk_bf16_f32 v206, v60, v61
    v_mfma_f32_16x16x32_bf16 v[76:79], a[212:215], a[140:143], v[76:79]
    s_add_u32 m0, s85, 135168
    ds_read_b64_tr_b16 a[182:183], v11 offset:38912
    v_cvt_pk_bf16_f32 v207, v62, v63
    v_mfma_f32_16x16x32_bf16 v[80:83], a[144:147], a[36:39], v[80:83]
    s_add_u32 s83, s85, 24576
    ds_read_b64_tr_b16 a[184:185], v11 offset:40960
    buffer_load_dwordx4 v6, s[24:27], s83 offen offset:0 sc1 lds
    v_mfma_f32_16x16x32_bf16 v[80:83], a[148:151], a[40:43], v[80:83]
    ds_read_b64_tr_b16 a[186:187], v11 offset:43008
    v_mfma_f32_16x16x32_bf16 v[80:83], a[152:155], a[44:47], v[80:83]
    ds_read_b64_tr_b16 a[188:189], v11 offset:45056
    v_mfma_f32_16x16x32_bf16 v[80:83], a[156:159], a[48:51], v[80:83]
    ds_read_b64_tr_b16 a[190:191], v11 offset:47104
    v_mfma_f32_16x16x32_bf16 v[80:83], a[160:163], a[52:55], v[80:83]
    s_waitcnt lgkmcnt(5)
    ds_read_b64_tr_b16 a[192:193], v11 offset:49152
    v_mfma_f32_16x16x32_bf16 v[80:83], a[164:167], a[56:59], v[80:83]
    s_mov_b32 s90, 384
    ds_read_b64_tr_b16 a[194:195], v11 offset:51200
    buffer_load_dword v5, v25, s[72:75], s90 offen
    v_mfma_f32_16x16x32_bf16 v[80:83], a[168:171], a[60:63], v[80:83]
    ds_read_b64_tr_b16 a[196:197], v11 offset:53248
    v_mfma_f32_16x16x32_bf16 v[80:83], a[172:175], a[64:67], v[80:83]
    ds_read_b64_tr_b16 a[198:199], v11 offset:55296
    v_mfma_f32_16x16x32_bf16 v[80:83], a[176:179], a[68:71], v[80:83]
    ds_read_b64_tr_b16 a[200:201], v11 offset:57344
    v_mfma_f32_16x16x32_bf16 v[84:87], a[144:147], a[108:111], v[84:87]
    s_mov_b32 s90, 512
    ds_read_b64_tr_b16 a[202:203], v11 offset:59392
    buffer_load_dword v5, v25, s[72:75], s90 offen
    v_mfma_f32_16x16x32_bf16 v[84:87], a[148:151], a[112:115], v[84:87]
    ds_read_b64_tr_b16 a[204:205], v11 offset:61440
    v_mfma_f32_16x16x32_bf16 v[84:87], a[152:155], a[116:119], v[84:87]
    ds_read_b64_tr_b16 a[206:207], v11 offset:63488
    v_cvt_pk_bf16_f32 v96, v64, v65
    v_mfma_f32_16x16x32_bf16 v[84:87], a[156:159], a[120:123], v[84:87]
    ds_read_b64_tr_b16 a[208:209], v15 offset:0
    v_cvt_pk_bf16_f32 v97, v66, v67
    v_mfma_f32_16x16x32_bf16 v[84:87], a[160:163], a[124:127], v[84:87]
    ds_read_b64_tr_b16 a[210:211], v15 offset:2048
    v_cvt_pk_bf16_f32 v104, v68, v69
    v_mfma_f32_16x16x32_bf16 v[84:87], a[164:167], a[128:131], v[84:87]
    ds_read_b64_tr_b16 a[212:213], v15 offset:4096
    v_cvt_pk_bf16_f32 v105, v70, v71
    v_mfma_f32_16x16x32_bf16 v[84:87], a[168:171], a[132:135], v[84:87]
    ds_read_b64_tr_b16 a[214:215], v15 offset:6144
    v_cvt_pk_bf16_f32 v98, v72, v73
    v_mfma_f32_16x16x32_bf16 v[84:87], a[172:175], a[136:139], v[84:87]
    s_waitcnt vmcnt(13) lgkmcnt(6)
    s_barrier
    ds_read_b64_tr_b16 a[144:145], v214 offset:0
    v_mfma_f32_16x16x32_bf16 v[84:87], a[176:179], a[140:143], v[84:87]
    ds_read_b64_tr_b16 a[146:147], v214 offset:256
    v_cvt_pk_bf16_f32 v99, v74, v75
    v_mfma_f32_16x16x32_bf16 v[88:91], a[180:183], a[36:39], v[88:91]
    ds_read_b64_tr_b16 a[148:149], v214 offset:2048
    v_cvt_pk_bf16_f32 v106, v76, v77
    v_mfma_f32_16x16x32_bf16 v[88:91], a[184:187], a[40:43], v[88:91]
    ds_read_b64_tr_b16 a[150:151], v214 offset:2304
    v_cvt_pk_bf16_f32 v107, v78, v79
    v_mfma_f32_16x16x32_bf16 v[88:91], a[188:191], a[44:47], v[88:91]
    ds_read_b64_tr_b16 a[152:153], v214 offset:4096
    v_cvt_pk_bf16_f32 v100, v80, v81
    v_mfma_f32_16x16x32_bf16 v[88:91], a[192:195], a[48:51], v[88:91]
    ds_read_b64_tr_b16 a[154:155], v214 offset:4352
    v_cvt_pk_bf16_f32 v101, v82, v83
    v_mfma_f32_16x16x32_bf16 v[88:91], a[196:199], a[52:55], v[88:91]
    ds_read_b64_tr_b16 a[156:157], v214 offset:6144
    v_mfma_f32_16x16x32_bf16 v[88:91], a[200:203], a[56:59], v[88:91]
    s_waitcnt lgkmcnt(5)
    ds_read_b64_tr_b16 a[158:159], v214 offset:6400
    v_mfma_f32_16x16x32_bf16 v[88:91], a[204:207], a[60:63], v[88:91]
    s_mov_b32 s87, 0
    ds_read_b64_tr_b16 a[160:161], v214 offset:8192
    v_mfma_f32_16x16x32_bf16 v[88:91], a[208:211], a[64:67], v[88:91]
    s_add_u32 s86, s85, 20480
    ds_read_b64_tr_b16 a[162:163], v214 offset:8448
    v_cvt_pk_bf16_f32 v108, v84, v85
    v_mfma_f32_16x16x32_bf16 v[88:91], a[212:215], a[68:71], v[88:91]
    s_add_u32 s56, s24, s86
    ds_read_b64_tr_b16 a[164:165], v214 offset:10240
    v_cvt_pk_bf16_f32 v109, v86, v87
    v_mfma_f32_16x16x32_bf16 v[92:95], a[180:183], a[108:111], v[92:95]
    s_addc_u32 s57, s25, 0
    ds_read_b64_tr_b16 a[166:167], v214 offset:10496
    v_mov_b32 v113, 0
    v_mfma_f32_16x16x32_bf16 v[92:95], a[184:187], a[112:115], v[92:95]
    s_mov_b32 s58, 5120
    ds_read_b64_tr_b16 a[168:169], v214 offset:12288
    v_mov_b32 v114, 0
    v_mov_b32 v117, 0
    v_mfma_f32_16x16x32_bf16 v[92:95], a[188:191], a[116:119], v[92:95]
    s_and_b32 s65, s78, 0
    ds_read_b64_tr_b16 a[170:171], v214 offset:12544
    v_mov_b32 v118, 0
    v_mov_b32 v121, 0
    v_mfma_f32_16x16x32_bf16 v[92:95], a[192:195], a[120:123], v[92:95]
    s_mul_i32 s88, s65, 36864
    ds_read_b64_tr_b16 a[172:173], v214 offset:14336
    v_mfma_f32_16x16x32_bf16 v[92:95], a[196:199], a[124:127], v[92:95]
    s_mul_i32 s65, s65, 9216
    ds_read_b64_tr_b16 a[174:175], v214 offset:14592
    v_mfma_f32_16x16x32_bf16 v[92:95], a[200:203], a[128:131], v[92:95]
    s_add_u32 s63, s71, s65
    ds_read_b64_tr_b16 a[176:177], v214 offset:16384
    v_mfma_f32_16x16x32_bf16 v[92:95], a[204:207], a[132:135], v[92:95]
    s_sub_u32 s64, s71, s65
    ds_read_b64_tr_b16 a[178:179], v214 offset:16640
    v_mfma_f32_16x16x32_bf16 v[92:95], a[208:211], a[136:139], v[92:95]
    s_mov_b32 s84, 0
    ds_read_b64_tr_b16 a[180:181], v214 offset:18432
    v_cvt_pk_bf16_f32 v102, v88, v89
    v_mfma_f32_16x16x32_bf16 v[92:95], a[212:215], a[140:143], v[92:95]
    s_mov_b32 s98, 0
    ds_read_b64_tr_b16 a[182:183], v214 offset:18688
    v_cvt_pk_bf16_f32 v103, v90, v91
    v_mfma_f32_16x16x32_bf16 v[32:35], a[144:147], a[0:3], 0
    s_waitcnt lgkmcnt(5)
    s_mov_b32 s61, 0xff
    ds_read_b64_tr_b16 a[184:185], v214 offset:20480
    v_mov_b32 v122, 0
    v_mfma_f32_16x16x32_bf16 v[32:35], a[148:151], a[4:7], v[32:35]
    s_mov_b32 s66, 0xff
    ds_read_b64_tr_b16 a[186:187], v214 offset:20736
    v_mov_b32 v125, 0
    v_mov_b32 v126, 0
    v_mfma_f32_16x16x32_bf16 v[32:35], a[152:155], a[8:11], v[32:35]
    s_bitset0_b32 s66, s78
    ds_read_b64_tr_b16 a[188:189], v214 offset:22528
    v_mov_b32 v116, 0
    v_mov_b32 v124, 0
    v_mfma_f32_16x16x32_bf16 v[32:35], a[156:159], a[12:15], v[32:35]
    s_lshl_b32 s63, s78, 11
    ds_read_b64_tr_b16 a[190:191], v214 offset:22784
    v_mfma_f32_16x16x32_bf16 v[32:35], a[160:163], a[16:19], v[32:35]
    s_add_u32 s63, s63, s71
    ds_read_b64_tr_b16 a[192:193], v214 offset:24576
    v_mfma_f32_16x16x32_bf16 v[32:35], a[164:167], a[20:23], v[32:35]
    s_add_u32 s64, s63, 18432
    ds_read_b64_tr_b16 a[194:195], v214 offset:24832
    v_mfma_f32_16x16x32_bf16 v[32:35], a[168:171], a[24:27], v[32:35]
    s_waitcnt lgkmcnt(5)
    s_add_u32 s67, s0, 96
    ds_read_b64_tr_b16 a[196:197], v214 offset:26624
    v_mfma_f32_16x16x32_bf16 v[32:35], a[172:175], a[28:31], v[32:35]
    ds_read_b64_tr_b16 a[198:199], v214 offset:26880
    v_cvt_pk_bf16_f32 v110, v92, v93
    v_mfma_f32_16x16x32_bf16 v[32:35], a[176:179], a[32:35], v[32:35]
    ds_read_b64_tr_b16 a[200:201], v214 offset:28672
    v_cvt_pk_bf16_f32 v111, v94, v95
    v_mfma_f32_16x16x32_bf16 v[36:39], a[144:147], a[72:75], 0
    ds_read_b64_tr_b16 a[202:203], v214 offset:28928
    v_accvgpr_write_b32 a240, 0
    v_mfma_f32_16x16x32_bf16 v[36:39], a[148:151], a[76:79], v[36:39]
    ds_read_b64_tr_b16 a[204:205], v214 offset:30720
    v_accvgpr_write_b32 a241, 0
    v_mfma_f32_16x16x32_bf16 v[36:39], a[152:155], a[80:83], v[36:39]
    ds_read_b64_tr_b16 a[206:207], v214 offset:30976
    v_accvgpr_write_b32 a242, 0
    v_mfma_f32_16x16x32_bf16 v[36:39], a[156:159], a[84:87], v[36:39]
    ds_read_b64_tr_b16 a[208:209], v214 offset:32768
    v_accvgpr_write_b32 a243, 0
    v_mfma_f32_16x16x32_bf16 v[36:39], a[160:163], a[88:91], v[36:39]
    ds_read_b64_tr_b16 a[210:211], v214 offset:33024
    v_accvgpr_write_b32 a244, 0
    v_mfma_f32_16x16x32_bf16 v[36:39], a[164:167], a[92:95], v[36:39]
    ds_read_b64_tr_b16 a[212:213], v214 offset:34816
    v_accvgpr_write_b32 a245, 0
    v_mfma_f32_16x16x32_bf16 v[36:39], a[168:171], a[96:99], v[36:39]
    ds_read_b64_tr_b16 a[214:215], v214 offset:35072
    v_accvgpr_write_b32 a246, 0
    v_mfma_f32_16x16x32_bf16 v[36:39], a[172:175], a[100:103], v[36:39]
    v_accvgpr_write_b32 a247, 0
    v_mfma_f32_16x16x32_bf16 v[36:39], a[176:179], a[104:107], v[36:39]
    v_and_b32 v2, 7, v1
    v_lshrrev_b32 v3, 3, v1
    v_mfma_f32_16x16x32_bf16 v[32:35], a[180:183], a[36:39], v[32:35]
    s_waitcnt lgkmcnt(3)
    v_lshlrev_b32 v2, 9, v2
    v_mul_u32_u24 v3, 96, v3
    v_lshrrev_b32 v4, 4, v1
    v_mfma_f32_16x16x32_bf16 v[32:35], a[184:187], a[40:43], v[32:35]
    v_lshlrev_b32 v4, 28, v4
    v_add3_u32 v214, v2, v3, v4
    v_add_u32 v212, 18432, v6
    v_mfma_f32_16x16x32_bf16 v[32:35], a[188:191], a[44:47], v[32:35]
    v_permlane16_swap_b32 v96, v98
    v_permlane16_swap_b32 v97, v99
    v_permlane16_swap_b32 v100, v102
    v_mfma_f32_16x16x32_bf16 v[32:35], a[192:195], a[48:51], v[32:35]
    v_permlane16_swap_b32 v101, v103
    v_permlane16_swap_b32 v104, v106
    v_permlane16_swap_b32 v105, v107
    v_mfma_f32_16x16x32_bf16 v[32:35], a[196:199], a[52:55], v[32:35]
    v_permlane16_swap_b32 v108, v110
    v_permlane16_swap_b32 v109, v111
    v_mfma_f32_16x16x32_bf16 v[32:35], a[200:203], a[56:59], v[32:35]
    v_mfma_f32_16x16x32_bf16 v[32:35], a[204:207], a[60:63], v[32:35]
    s_waitcnt lgkmcnt(0)
    v_mfma_f32_16x16x32_bf16 v[32:35], a[208:211], a[64:67], v[32:35]
    v_mfma_f32_16x16x32_bf16 v[32:35], a[212:215], a[68:71], v[32:35]
    v_mfma_f32_16x16x32_bf16 v[36:39], a[180:183], a[108:111], v[36:39]
    v_mfma_f32_16x16x32_bf16 v[36:39], a[184:187], a[112:115], v[36:39]
    v_mfma_f32_16x16x32_bf16 v[36:39], a[188:191], a[116:119], v[36:39]
    v_mfma_f32_16x16x32_bf16 v[36:39], a[192:195], a[120:123], v[36:39]
    v_mfma_f32_16x16x32_bf16 v[36:39], a[196:199], a[124:127], v[36:39]
    v_mfma_f32_16x16x32_bf16 v[36:39], a[200:203], a[128:131], v[36:39]
    v_mfma_f32_16x16x32_bf16 v[36:39], a[204:207], a[132:135], v[36:39]
    v_mfma_f32_16x16x32_bf16 v[36:39], a[208:211], a[136:139], v[36:39]
    v_mfma_f32_16x16x32_bf16 v[36:39], a[212:215], a[140:143], v[36:39]
    s_waitcnt vmcnt(7) lgkmcnt(0)
    s_barrier
    ds_read_b128 a[216:219], v216 offset:0
    ds_read_b128 a[224:227], v217 offset:0
    ds_read_b128 a[220:223], v216 offset:1024
    ds_read_b128 a[232:235], v218 offset:0
    ds_read_b128 a[236:239], v218 offset:640
    v_cvt_pk_bf16_f32 v112, v32, v33
    v_cvt_pk_bf16_f32 v120, v36, v37
    s_nop 0
    v_permlane32_swap_b32 v112, v116
    v_permlane32_swap_b32 v120, v124
    v_mov_b32 v115, v112
    v_mov_b32 v119, v116
    v_mov_b32 v123, v120
    v_mov_b32 v127, v124
    s_waitcnt lgkmcnt(2)
    v_mfma_f32_32x32x16_bf16 v[32:47], a[220:223], v[96:99], 0
    buffer_store_dwordx4 v[192:195], v6, s[24:27], s94 offen offset:0 sc1
    v_mfma_f32_32x32x8bf16_1k v[32:47], a[224:225], v[114:115], v[32:47]
    v_mfma_f32_32x32x16_bf16 v[48:63], a[220:223], v[100:103], 0
    buffer_store_dwordx4 v[196:199], v6, s[24:27], s94 offen offset:1024 sc1
    v_mfma_f32_32x32x8bf16_1k v[48:63], a[224:225], v[118:119], v[48:63]
    v_mfma_f32_32x32x16_bf16 v[64:79], a[220:223], v[104:107], 0
    buffer_store_dwordx4 v[200:203], v6, s[24:27], s94 offen offset:2048 sc1
    v_mfma_f32_32x32x8bf16_1k v[64:79], a[224:225], v[122:123], v[64:79]
    v_mfma_f32_32x32x16_bf16 v[80:95], a[220:223], v[108:111], 0
    buffer_store_dwordx4 v[204:207], v6, s[24:27], s94 offen offset:3072 sc1
    v_mfma_f32_32x32x8bf16_1k v[80:95], a[224:225], v[126:127], v[80:95]
    s_nop 2
    v_max_f32 v28, v32, v33
    v_max3_f32 v28, v28, v34, v35
    v_max3_f32 v28, v28, v36, v37
    v_max3_f32 v28, v28, v38, v39
    v_max3_f32 v28, v28, v40, v41
    v_max3_f32 v28, v28, v42, v43
    v_max3_f32 v28, v28, v44, v45
    v_max3_f32 v28, v28, v46, v47
    v_mfma_f32_32x32x16_bf16 v[32:47], a[216:219], v[96:99], 0
    buffer_store_dwordx4 v[248:251], v6, s[24:27], s99 offen offset:0 sc1
    v_max_f32_e64 v29, v48, v49
    v_max3_f32 v29, v29, v50, v51
    v_max3_f32 v29, v29, v52, v53
    v_max3_f32 v29, v29, v54, v55
    v_mfma_f32_32x32x8bf16_1k v[32:47], a[224:225], v[112:113], v[32:47]
    v_max3_f32 v29, v29, v56, v57
    v_max3_f32 v29, v29, v58, v59
    v_max3_f32 v29, v29, v60, v61
    v_max3_f32 v29, v29, v62, v63
    v_mfma_f32_32x32x16_bf16 v[48:63], a[216:219], v[100:103], 0
    buffer_store_dwordx4 v[248:251], v6, s[24:27], s99 offen offset:1024 sc1
    v_max_f32_e64 v30, v64, v65
    v_max3_f32 v30, v30, v66, v67
    v_max3_f32 v30, v30, v68, v69
    v_max3_f32 v30, v30, v70, v71
    v_mfma_f32_32x32x8bf16_1k v[48:63], a[224:225], v[116:117], v[48:63]
    v_max3_f32 v30, v30, v72, v73
    v_max3_f32 v30, v30, v74, v75
    v_max3_f32 v30, v30, v76, v77
    v_max3_f32 v30, v30, v78, v79
    v_mfma_f32_32x32x16_bf16 v[64:79], a[216:219], v[104:107], 0
    buffer_store_dwordx4 v[248:251], v6, s[24:27], s99 offen offset:2048 sc1
    v_max_f32_e64 v31, v80, v81
    v_max3_f32 v31, v31, v82, v83
    v_max3_f32 v31, v31, v84, v85
    v_max3_f32 v31, v31, v86, v87
    v_mfma_f32_32x32x8bf16_1k v[64:79], a[224:225], v[120:121], v[64:79]
    v_max3_f32 v31, v31, v88, v89
    v_max3_f32 v31, v31, v90, v91
    v_max3_f32 v31, v31, v92, v93
    v_max3_f32 v31, v31, v94, v95
    v_mfma_f32_32x32x16_bf16 v[80:95], a[216:219], v[108:111], 0
    buffer_store_dwordx4 v[248:251], v6, s[24:27], s99 offen offset:3072 sc1
    v_max3_f32 v28, v28, v32, v33
    v_max3_f32 v28, v28, v34, v35
    v_max3_f32 v28, v28, v36, v37
    v_max3_f32 v28, v28, v38, v39
    v_mfma_f32_32x32x8bf16_1k v[80:95], a[224:225], v[124:125], v[80:95]
    v_max3_f32 v28, v28, v40, v41
    v_max3_f32 v28, v28, v42, v43
    v_max3_f32 v28, v28, v44, v45
    v_max3_f32 v28, v28, v46, v47
    v_mov_b32_e64 v32, v28
    v_max3_f32 v29, v29, v48, v49
    v_max3_f32 v29, v29, v50, v51
    v_max3_f32 v29, v29, v52, v53
    v_max3_f32 v29, v29, v54, v55
    v_max3_f32 v29, v29, v56, v57
    v_max3_f32 v29, v29, v58, v59
    v_max3_f32 v29, v29, v60, v61
    v_max3_f32 v29, v29, v62, v63
    v_mov_b32 v48, v29
    v_permlane32_swap_b32 v28, v32
    v_max_f32_e64 v28, v28, v32
    v_sub_f32 v28, 0xc2c40000, v28
    v_cvt_pk_bf16_f32 v28, v28, 0
    v_cndmask_b32 v112, v112, v28, s[4:5]
L_w16:
    s_cbranch_execz L_w20
    v_mov_b32 v115, v112
    v_max3_f32 v30, v30, v64, v65
    v_max3_f32 v30, v30, v66, v67
    v_mfma_f32_32x32x16_bf16 v[32:47], a[216:219], v[96:99], 0
    v_max3_f32 v30, v30, v68, v69
    v_max3_f32 v30, v30, v70, v71
    v_max3_f32 v30, v30, v72, v73
    v_max3_f32 v30, v30, v74, v75
    v_max3_f32 v30, v30, v76, v77
    v_max3_f32 v30, v30, v78, v79
    v_mov_b32_e64 v64, v30
    v_mfma_f32_32x32x8bf16_1k v[32:47], a[224:225], v[112:113], v[32:47]
    v_permlane32_swap_b32 v29, v48
    v_max_f32 v29, v29, v48
    v_sub_f32 v29, 0xc2c40000, v29
    v_cvt_pk_bf16_f32 v29, v29, 0
    v_cndmask_b32 v116, v116, v29, s[4:5]
    v_mov_b32_e64 v119, v116
    v_mfma_f32_32x32x8bf16_1k v[176:191], a[240:241], a[240:241], 0
    v_max3_f32 v31, v31, v80, v81
    v_max3_f32 v31, v31, v82, v83
    v_max3_f32 v31, v31, v84, v85
    v_max3_f32 v31, v31, v86, v87
    v_max3_f32 v31, v31, v88, v89
    v_max3_f32 v31, v31, v90, v91
    v_max3_f32 v31, v31, v92, v93
    v_mfma_f32_32x32x8bf16_1k v[160:175], a[240:241], a[240:241], 0
    v_max3_f32 v31, v31, v94, v95
    v_mov_b32 v80, v31
    v_permlane32_swap_b32 v30, v64
    v_max_f32_e64 v30, v30, v64
    v_sub_f32 v30, 0xc2c40000, v30
    v_cvt_pk_bf16_f32 v30, v30, 0
    v_cndmask_b32 v120, v120, v30, s[4:5]
    v_mfma_f32_32x32x8bf16_1k v[144:159], a[240:241], a[240:241], 0
    v_mov_b32 v123, v120
    v_permlane32_swap_b32 v31, v80
    v_max_f32_e64 v31, v31, v80
    v_sub_f32 v31, 0xc2c40000, v31
    v_cvt_pk_bf16_f32 v31, v31, 0
    v_cndmask_b32 v124, v124, v31, s[4:5]
    v_mov_b32_e64 v127, v124
    v_mfma_f32_32x32x8bf16_1k v[128:143], a[240:241], a[240:241], 0
    v_mov_b32 v80, 0
    v_mov_b32 v81, 0
    v_mov_b32 v82, 0
    v_mov_b32 v83, 0
    v_mov_b32 v84, 0
    v_mov_b32 v85, 0
    v_mov_b32 v86, 0
    v_mov_b32 v87, 0
    v_mov_b32 v88, 0
    v_mov_b32 v89, 0
    v_mov_b32 v90, 0
    v_mov_b32 v91, 0
    v_mov_b32 v92, 0
    v_mov_b32 v93, 0
    v_mov_b32 v94, 0
    v_mov_b32 v95, 0
    s_waitcnt lgkmcnt(0)
.p2align 3
L_att:
    v_mfma_f32_32x32x16_bf16 v[48:63], a[216:219], v[100:103], 0
    ds_read_b128 a[220:223], v216 offset:1024
    v_exp_f32 v32, v32
    v_exp_f32 v33, v33
    v_exp_f32 v34, v34
    v_exp_f32 v35, v35
    v_mfma_f32_32x32x8bf16_1k v[48:63], a[224:225], v[116:117], v[48:63]
    v_exp_f32 v36, v36
    v_exp_f32 v37, v37
    v_exp_f32 v38, v38
    v_exp_f32 v39, v39
    v_smfmac_f32_32x32x32_bf16 v[176:191], a[240:243], v[80:87], v219
    v_exp_f32 v40, v40
    v_exp_f32 v41, v41
    v_exp_f32 v42, v42
    v_exp_f32 v43, v43
    v_smfmac_f32_32x32x32_bf16 v[176:191], a[244:247], v[88:95], v219
    v_exp_f32 v44, v44
    v_exp_f32 v45, v45
    v_exp_f32 v46, v46
    v_exp_f32 v47, v47
    v_mfma_f32_32x32x16_bf16 v[64:79], a[216:219], v[104:107], 0
    ds_read_b128 a[240:243], v218 offset:1280
    v_exp_f32 v48, v48
    v_exp_f32 v49, v49
    v_exp_f32 v50, v50
    v_exp_f32 v51, v51
    v_mfma_f32_32x32x8bf16_1k v[64:79], a[224:225], v[120:121], v[64:79]
    v_exp_f32 v52, v52
    v_exp_f32 v53, v53
    v_exp_f32 v54, v54
    v_exp_f32 v55, v55
    v_smfmac_f32_32x32x32_bf16 v[128:143], a[232:235], v[32:39], v219
    ds_read_b128 a[244:247], v218 offset:1920
    v_exp_f32 v56, v56
    v_exp_f32 v57, v57
    v_exp_f32 v58, v58
    v_exp_f32 v59, v59
    v_smfmac_f32_32x32x32_bf16 v[128:143], a[236:239], v[40:47], v219
    v_exp_f32 v60, v60
    v_exp_f32 v61, v61
    v_exp_f32 v62, v62
    v_exp_f32 v63, v63
    v_mfma_f32_32x32x16_bf16 v[80:95], a[216:219], v[108:111], 0
    v_exp_f32 v64, v64
    v_exp_f32 v65, v65
    v_exp_f32 v66, v66
    v_exp_f32 v67, v67
    v_mfma_f32_32x32x8bf16_1k v[80:95], a[224:225], v[124:125], v[80:95]
    v_exp_f32 v68, v68
    v_exp_f32 v69, v69
    v_exp_f32 v70, v70
    v_exp_f32 v71, v71
    v_smfmac_f32_32x32x32_bf16 v[144:159], a[232:235], v[48:55], v219
    v_exp_f32 v72, v72
    v_exp_f32 v73, v73
    v_exp_f32 v74, v74
    v_exp_f32 v75, v75
    v_smfmac_f32_32x32x32_bf16 v[144:159], a[236:239], v[56:63], v219
    s_waitcnt lgkmcnt(0)
    v_exp_f32 v76, v76
    v_exp_f32 v77, v77
    v_exp_f32 v78, v78
    v_exp_f32 v79, v79
    v_mfma_f32_32x32x16_bf16 v[32:47], a[220:223], v[96:99], 0
    s_add_u32 m0, s88, s82
    v_exp_f32 v80, v80
    v_exp_f32 v81, v81
    v_exp_f32 v82, v82
    v_exp_f32 v83, v83
    v_mfma_f32_32x32x8bf16_1k v[32:47], a[224:225], v[114:115], v[32:47]
    v_exp_f32 v84, v84
    v_exp_f32 v85, v85
    v_exp_f32 v86, v86
    v_exp_f32 v87, v87
    v_smfmac_f32_32x32x32_bf16 v[160:175], a[232:235], v[64:71], v219
    s_add_u32 s88, s88, 4096
    buffer_load_dwordx4 v220, s[44:47], s84 offen lds
    v_exp_f32 v88, v88
    v_exp_f32 v89, v89
    v_exp_f32 v90, v90
    v_exp_f32 v91, v91
    v_smfmac_f32_32x32x32_bf16 v[160:175], a[236:239], v[72:79], v219
    s_add_u32 s84, s84, 41472
    v_exp_f32 v92, v92
    v_exp_f32 v93, v93
    v_exp_f32 v94, v94
    v_exp_f32 v95, v95
    v_mfma_f32_32x32x16_bf16 v[48:63], a[220:223], v[100:103], 0
    ds_read_b128 a[216:219], v216 offset:2048
    v_exp_f32 v32, v32
    v_exp_f32 v33, v33
    v_exp_f32 v34, v34
    v_exp_f32 v35, v35
    v_mfma_f32_32x32x8bf16_1k v[48:63], a[224:225], v[118:119], v[48:63]
    v_exp_f32 v36, v36
    v_exp_f32 v37, v37
    v_exp_f32 v38, v38
    v_exp_f32 v39, v39
    v_smfmac_f32_32x32x32_bf16 v[176:191], a[232:235], v[80:87], v219
    v_exp_f32 v40, v40
    v_exp_f32 v41, v41
    v_exp_f32 v42, v42
    v_exp_f32 v43, v43
    v_smfmac_f32_32x32x32_bf16 v[176:191], a[236:239], v[88:95], v219
    v_exp_f32 v44, v44
    v_exp_f32 v45, v45
    v_exp_f32 v46, v46
    v_exp_f32 v47, v47
    v_mfma_f32_32x32x16_bf16 v[64:79], a[220:223], v[104:107], 0
    ds_read_b128 a[232:235], v218 offset:2560
    v_exp_f32 v48, v48
    v_exp_f32 v49, v49
    v_exp_f32 v50, v50
    v_exp_f32 v51, v51
    v_mfma_f32_32x32x8bf16_1k v[64:79], a[224:225], v[122:123], v[64:79]
    v_exp_f32 v52, v52
    v_exp_f32 v53, v53
    v_exp_f32 v54, v54
    v_exp_f32 v55, v55
    v_smfmac_f32_32x32x32_bf16 v[128:143], a[240:243], v[32:39], v219
    ds_read_b128 a[236:239], v218 offset:3200
    v_exp_f32 v56, v56
    v_exp_f32 v57, v57
    v_exp_f32 v58, v58
    v_exp_f32 v59, v59
    v_smfmac_f32_32x32x32_bf16 v[128:143], a[244:247], v[40:47], v219
    v_exp_f32 v60, v60
    v_exp_f32 v61, v61
    v_exp_f32 v62, v62
    v_exp_f32 v63, v63
    v_mfma_f32_32x32x16_bf16 v[80:95], a[220:223], v[108:111], 0
    s_cmp_eq_u32 s88, 73728
    v_exp_f32 v64, v64
    v_exp_f32 v65, v65
    v_exp_f32 v66, v66
    v_exp_f32 v67, v67
    v_mfma_f32_32x32x8bf16_1k v[80:95], a[224:225], v[126:127], v[80:95]
    v_exp_f32 v68, v68
    v_exp_f32 v69, v69
    v_exp_f32 v70, v70
    v_exp_f32 v71, v71
    v_smfmac_f32_32x32x32_bf16 v[144:159], a[240:243], v[48:55], v219
    s_cselect_b32 s88, 0, s88
    v_exp_f32 v72, v72
    v_exp_f32 v73, v73
    v_exp_f32 v74, v74
    v_exp_f32 v75, v75
    v_smfmac_f32_32x32x32_bf16 v[144:159], a[244:247], v[56:63], v219
    s_waitcnt lgkmcnt(0)
    v_exp_f32 v76, v76
    v_exp_f32 v77, v77
    v_exp_f32 v78, v78
    v_exp_f32 v79, v79
    v_mfma_f32_32x32x16_bf16 v[32:47], a[216:219], v[96:99], 0
    s_add_u32 m0, s88, s82
    v_exp_f32 v80, v80
    v_exp_f32 v81, v81
    v_exp_f32 v82, v82
    v_exp_f32 v83, v83
    v_mfma_f32_32x32x8bf16_1k v[32:47], a[226:227], v[112:113], v[32:47]
    v_exp_f32 v84, v84
    v_exp_f32 v85, v85
    v_exp_f32 v86, v86
    v_exp_f32 v87, v87
    v_smfmac_f32_32x32x32_bf16 v[160:175], a[240:243], v[64:71], v219
    s_add_u32 s88, s88, 4096
    buffer_load_dwordx4 v220, s[44:47], s84 offen lds
    v_exp_f32 v88, v88
    v_exp_f32 v89, v89
    v_exp_f32 v90, v90
    v_exp_f32 v91, v91
    v_smfmac_f32_32x32x32_bf16 v[160:175], a[244:247], v[72:79], v219
    s_add_u32 s84, s84, 41472
    v_exp_f32 v92, v92
    v_exp_f32 v93, v93
    v_exp_f32 v94, v94
    v_exp_f32 v95, v95
    v_mfma_f32_32x32x16_bf16 v[48:63], a[216:219], v[100:103], 0
    ds_read_b128 a[220:223], v216 offset:3072
    v_exp_f32 v32, v32
    v_exp_f32 v33, v33
    v_exp_f32 v34, v34
    v_exp_f32 v35, v35
    v_mfma_f32_32x32x8bf16_1k v[48:63], a[226:227], v[116:117], v[48:63]
    v_exp_f32 v36, v36
    v_exp_f32 v37, v37
    v_exp_f32 v38, v38
    v_exp_f32 v39, v39
    v_smfmac_f32_32x32x32_bf16 v[176:191], a[240:243], v[80:87], v219
    s_lshl_b32 s90, s87, 12
    v_exp_f32 v40, v40
    v_exp_f32 v41, v41
    v_exp_f32 v42, v42
    v_exp_f32 v43, v43
    v_smfmac_f32_32x32x32_bf16 v[176:191], a[244:247], v[88:95], v219
    s_add_u32 s90, s90, s82
    v_exp_f32 v44, v44
    v_exp_f32 v45, v45
    v_exp_f32 v46, v46
    v_exp_f32 v47, v47
    v_mfma_f32_32x32x16_bf16 v[64:79], a[216:219], v[104:107], 0
    s_add_u32 s90, s90, s65
    ds_read_b128 a[240:243], v218 offset:3840
    v_exp_f32 v48, v48
    v_exp_f32 v49, v49
    v_exp_f32 v50, v50
    v_exp_f32 v51, v51
    v_mfma_f32_32x32x8bf16_1k v[64:79], a[226:227], v[120:121], v[64:79]
    v_exp_f32 v52, v52
    v_exp_f32 v53, v53
    v_exp_f32 v54, v54
    v_exp_f32 v55, v55
    v_smfmac_f32_32x32x32_bf16 v[128:143], a[232:235], v[32:39], v219
    s_cmp_ge_u32 s90, 18432
    ds_read_b128 a[244:247], v218 offset:4480
    v_exp_f32 v56, v56
    v_exp_f32 v57, v57
    v_exp_f32 v58, v58
    v_exp_f32 v59, v59
    v_smfmac_f32_32x32x32_bf16 v[128:143], a[236:239], v[40:47], v219
    s_cselect_b32 s91, 18432, 0
    v_exp_f32 v60, v60
    v_exp_f32 v61, v61
    v_exp_f32 v62, v62
    v_exp_f32 v63, v63
    v_mfma_f32_32x32x16_bf16 v[80:95], a[216:219], v[108:111], 0
    s_sub_u32 s90, s90, s91
    v_exp_f32 v64, v64
    v_exp_f32 v65, v65
    v_exp_f32 v66, v66
    v_exp_f32 v67, v67
    v_mfma_f32_32x32x8bf16_1k v[80:95], a[226:227], v[124:125], v[80:95]
    v_exp_f32 v68, v68
    v_exp_f32 v69, v69
    v_exp_f32 v70, v70
    v_exp_f32 v71, v71
    v_smfmac_f32_32x32x32_bf16 v[144:159], a[232:235], v[48:55], v219
    v_exp_f32 v72, v72
    v_exp_f32 v73, v73
    v_exp_f32 v74, v74
    v_exp_f32 v75, v75
    v_smfmac_f32_32x32x32_bf16 v[144:159], a[236:239], v[56:63], v219
    s_waitcnt lgkmcnt(0)
    v_exp_f32 v76, v76
    v_exp_f32 v77, v77
    v_exp_f32 v78, v78
    v_exp_f32 v79, v79
    v_mfma_f32_32x32x16_bf16 v[32:47], a[220:223], v[96:99], 0
    s_add_u32 m0, s90, 73728
    v_exp_f32 v80, v80
    v_exp_f32 v81, v81
    v_exp_f32 v82, v82
    v_exp_f32 v83, v83
    v_mfma_f32_32x32x8bf16_1k v[32:47], a[226:227], v[114:115], v[32:47]
    v_exp_f32 v84, v84
    v_exp_f32 v85, v85
    v_exp_f32 v86, v86
    v_exp_f32 v87, v87
    v_smfmac_f32_32x32x32_bf16 v[160:175], a[232:235], v[64:71], v219
    s_add_u32 s87, s87, 1
    buffer_load_dwordx4 v222, s[44:47], s98 offen lds
    v_exp_f32 v88, v88
    v_exp_f32 v89, v89
    v_exp_f32 v90, v90
    v_exp_f32 v91, v91
    v_smfmac_f32_32x32x32_bf16 v[160:175], a[236:239], v[72:79], v219
    s_add_u32 s98, s98, 165888
    v_exp_f32 v92, v92
    v_exp_f32 v93, v93
    v_exp_f32 v94, v94
    v_exp_f32 v95, v95
    v_mfma_f32_32x32x16_bf16 v[48:63], a[220:223], v[100:103], 0
    ds_read_b128 a[216:219], v216 offset:4096
    v_exp_f32 v32, v32
    v_exp_f32 v33, v33
    v_exp_f32 v34, v34
    v_exp_f32 v35, v35
    v_mfma_f32_32x32x8bf16_1k v[48:63], a[226:227], v[118:119], v[48:63]
    v_exp_f32 v36, v36
    v_exp_f32 v37, v37
    v_exp_f32 v38, v38
    v_exp_f32 v39, v39
    v_smfmac_f32_32x32x32_bf16 v[176:191], a[232:235], v[80:87], v219
    ds_read_b128 a[228:231], v217 offset:640
    v_exp_f32 v40, v40
    v_exp_f32 v41, v41
    v_exp_f32 v42, v42
    v_exp_f32 v43, v43
    v_smfmac_f32_32x32x32_bf16 v[176:191], a[236:239], v[88:95], v219
    v_exp_f32 v44, v44
    v_exp_f32 v45, v45
    v_exp_f32 v46, v46
    v_exp_f32 v47, v47
    v_mfma_f32_32x32x16_bf16 v[64:79], a[220:223], v[104:107], 0
    ds_read_b128 a[232:235], v218 offset:5120
    v_exp_f32 v48, v48
    v_exp_f32 v49, v49
    v_exp_f32 v50, v50
    v_exp_f32 v51, v51
    v_mfma_f32_32x32x8bf16_1k v[64:79], a[226:227], v[122:123], v[64:79]
    v_exp_f32 v52, v52
    v_exp_f32 v53, v53
    v_exp_f32 v54, v54
    v_exp_f32 v55, v55
    v_smfmac_f32_32x32x32_bf16 v[128:143], a[240:243], v[32:39], v219
    ds_read_b128 a[236:239], v218 offset:5760
    v_exp_f32 v56, v56
    v_exp_f32 v57, v57
    v_exp_f32 v58, v58
    v_exp_f32 v59, v59
    v_smfmac_f32_32x32x32_bf16 v[128:143], a[244:247], v[40:47], v219
    v_exp_f32 v60, v60
    v_exp_f32 v61, v61
    v_exp_f32 v62, v62
    v_exp_f32 v63, v63
    v_mfma_f32_32x32x16_bf16 v[80:95], a[220:223], v[108:111], 0
    s_cmp_lt_u32 s87, 3
    v_exp_f32 v64, v64
    v_exp_f32 v65, v65
    v_exp_f32 v66, v66
    v_exp_f32 v67, v67
    v_mfma_f32_32x32x8bf16_1k v[80:95], a[226:227], v[126:127], v[80:95]
    v_exp_f32 v68, v68
    v_exp_f32 v69, v69
    v_exp_f32 v70, v70
    v_exp_f32 v71, v71
    v_smfmac_f32_32x32x32_bf16 v[144:159], a[240:243], v[48:55], v219
    s_cselect_b32 s90, 0, 1073741824
    v_exp_f32 v72, v72
    v_exp_f32 v73, v73
    v_exp_f32 v74, v74
    v_exp_f32 v75, v75
    v_smfmac_f32_32x32x32_bf16 v[144:159], a[244:247], v[56:63], v219
    s_waitcnt lgkmcnt(0)
    v_exp_f32 v76, v76
    v_exp_f32 v77, v77
    v_exp_f32 v78, v78
    v_exp_f32 v79, v79
    v_mfma_f32_32x32x16_bf16 v[32:47], a[216:219], v[96:99], 0
    s_add_u32 s91, s90, s51
    v_exp_f32 v80, v80
    v_exp_f32 v81, v81
    v_exp_f32 v82, v82
    v_exp_f32 v83, v83
    v_mfma_f32_32x32x8bf16_1k v[32:47], a[228:229], v[112:113], v[32:47]
    v_exp_f32 v84, v84
    v_exp_f32 v85, v85
    v_exp_f32 v86, v86
    v_exp_f32 v87, v87
    v_smfmac_f32_32x32x32_bf16 v[160:175], a[240:243], v[64:71], v219
    buffer_load_dword v5, v25, s[72:75], s91 offen
    v_exp_f32 v88, v88
    v_exp_f32 v89, v89
    v_exp_f32 v90, v90
    v_exp_f32 v91, v91
    v_smfmac_f32_32x32x32_bf16 v[160:175], a[244:247], v[72:79], v219
    s_add_u32 s51, s51, 128
    v_exp_f32 v92, v92
    v_exp_f32 v93, v93
    v_exp_f32 v94, v94
    v_exp_f32 v95, v95
    v_mfma_f32_32x32x16_bf16 v[48:63], a[216:219], v[100:103], 0
    ds_read_b128 a[220:223], v216 offset:5120
    v_exp_f32 v32, v32
    v_exp_f32 v33, v33
    v_exp_f32 v34, v34
    v_exp_f32 v35, v35
    v_mfma_f32_32x32x8bf16_1k v[48:63], a[228:229], v[116:117], v[48:63]
    v_exp_f32 v36, v36
    v_exp_f32 v37, v37
    v_exp_f32 v38, v38
    v_exp_f32 v39, v39
    v_smfmac_f32_32x32x32_bf16 v[176:191], a[240:243], v[80:87], v219
    s_cmp_eq_u32 s87, 2
    v_exp_f32 v40, v40
    v_exp_f32 v41, v41
    v_exp_f32 v42, v42
    v_exp_f32 v43, v43
    v_smfmac_f32_32x32x32_bf16 v[176:191], a[244:247], v[88:95], v219
    s_cselect_b32 s91, s96, 1073741824
    v_exp_f32 v44, v44
    v_exp_f32 v45, v45
    v_exp_f32 v46, v46
    v_exp_f32 v47, v47
    v_mfma_f32_32x32x16_bf16 v[64:79], a[216:219], v[104:107], 0
    ds_read_b128 a[240:243], v218 offset:6400
    v_exp_f32 v48, v48
    v_exp_f32 v49, v49
    v_exp_f32 v50, v50
    v_exp_f32 v51, v51
    v_mfma_f32_32x32x8bf16_1k v[64:79], a[228:229], v[120:121], v[64:79]
    v_exp_f32 v52, v52
    v_exp_f32 v53, v53
    v_exp_f32 v54, v54
    v_exp_f32 v55, v55
    v_smfmac_f32_32x32x32_bf16 v[128:143], a[232:235], v[32:39], v219
    ds_read_b128 a[244:247], v218 offset:7040
    v_exp_f32 v56, v56
    v_exp_f32 v57, v57
    v_exp_f32 v58, v58
    v_exp_f32 v59, v59
    v_smfmac_f32_32x32x32_bf16 v[128:143], a[236:239], v[40:47], v219
    v_exp_f32 v60, v60
    v_exp_f32 v61, v61
    v_exp_f32 v62, v62
    v_exp_f32 v63, v63
    v_mfma_f32_32x32x16_bf16 v[80:95], a[216:219], v[108:111], 0
    s_add_u32 s90, s91, 0
    v_exp_f32 v64, v64
    v_exp_f32 v65, v65
    v_exp_f32 v66, v66
    v_exp_f32 v67, v67
    v_mfma_f32_32x32x8bf16_1k v[80:95], a[228:229], v[124:125], v[80:95]
    v_exp_f32 v68, v68
    v_exp_f32 v69, v69
    v_exp_f32 v70, v70
    v_exp_f32 v71, v71
    v_smfmac_f32_32x32x32_bf16 v[144:159], a[232:235], v[48:55], v219
    buffer_load_dword v5, v225, s[20:23], s90 offen
    v_exp_f32 v72, v72
    v_exp_f32 v73, v73
    v_exp_f32 v74, v74
    v_exp_f32 v75, v75
    v_smfmac_f32_32x32x32_bf16 v[144:159], a[236:239], v[56:63], v219
    s_waitcnt lgkmcnt(0)
    v_exp_f32 v76, v76
    v_exp_f32 v77, v77
    v_exp_f32 v78, v78
    v_exp_f32 v79, v79
    v_mfma_f32_32x32x16_bf16 v[32:47], a[220:223], v[96:99], 0
    s_add_u32 s90, s91, 5248
    v_exp_f32 v80, v80
    v_exp_f32 v81, v81
    v_exp_f32 v82, v82
    v_exp_f32 v83, v83
    v_mfma_f32_32x32x8bf16_1k v[32:47], a[228:229], v[114:115], v[32:47]
    v_exp_f32 v84, v84
    v_exp_f32 v85, v85
    v_exp_f32 v86, v86
    v_exp_f32 v87, v87
    v_smfmac_f32_32x32x32_bf16 v[160:175], a[232:235], v[64:71], v219
    buffer_load_dword v5, v225, s[20:23], s90 offen
    v_exp_f32 v88, v88
    v_exp_f32 v89, v89
    v_exp_f32 v90, v90
    v_exp_f32 v91, v91
    v_smfmac_f32_32x32x32_bf16 v[160:175], a[236:239], v[72:79], v219
    v_exp_f32 v92, v92
    v_exp_f32 v93, v93
    v_exp_f32 v94, v94
    v_exp_f32 v95, v95
    v_mfma_f32_32x32x16_bf16 v[48:63], a[220:223], v[100:103], 0
    ds_read_b128 a[216:219], v216 offset:6144
    v_exp_f32 v32, v32
    v_exp_f32 v33, v33
    v_exp_f32 v34, v34
    v_exp_f32 v35, v35
    v_mfma_f32_32x32x8bf16_1k v[48:63], a[228:229], v[118:119], v[48:63]
    v_exp_f32 v36, v36
    v_exp_f32 v37, v37
    v_exp_f32 v38, v38
    v_exp_f32 v39, v39
    v_smfmac_f32_32x32x32_bf16 v[176:191], a[232:235], v[80:87], v219
    v_exp_f32 v40, v40
    v_exp_f32 v41, v41
    v_exp_f32 v42, v42
    v_exp_f32 v43, v43
    v_smfmac_f32_32x32x32_bf16 v[176:191], a[236:239], v[88:95], v219
    v_exp_f32 v44, v44
    v_exp_f32 v45, v45
    v_exp_f32 v46, v46
    v_exp_f32 v47, v47
    v_mfma_f32_32x32x16_bf16 v[64:79], a[220:223], v[104:107], 0
    ds_read_b128 a[232:235], v218 offset:7680
    v_exp_f32 v48, v48
    v_exp_f32 v49, v49
    v_exp_f32 v50, v50
    v_exp_f32 v51, v51
    v_mfma_f32_32x32x8bf16_1k v[64:79], a[228:229], v[122:123], v[64:79]
    v_exp_f32 v52, v52
    v_exp_f32 v53, v53
    v_exp_f32 v54, v54
    v_exp_f32 v55, v55
    v_smfmac_f32_32x32x32_bf16 v[128:143], a[240:243], v[32:39], v219
    ds_read_b128 a[236:239], v218 offset:8320
    v_exp_f32 v56, v56
    v_exp_f32 v57, v57
    v_exp_f32 v58, v58
    v_exp_f32 v59, v59
    v_smfmac_f32_32x32x32_bf16 v[128:143], a[244:247], v[40:47], v219
    v_exp_f32 v60, v60
    v_exp_f32 v61, v61
    v_exp_f32 v62, v62
    v_exp_f32 v63, v63
    v_mfma_f32_32x32x16_bf16 v[80:95], a[220:223], v[108:111], 0
    s_add_u32 s56, s56, 20480
    v_exp_f32 v64, v64
    v_exp_f32 v65, v65
    v_exp_f32 v66, v66
    v_exp_f32 v67, v67
    v_mfma_f32_32x32x8bf16_1k v[80:95], a[228:229], v[126:127], v[80:95]
    v_exp_f32 v68, v68
    v_exp_f32 v69, v69
    v_exp_f32 v70, v70
    v_exp_f32 v71, v71
    v_smfmac_f32_32x32x32_bf16 v[144:159], a[240:243], v[48:55], v219
    s_addc_u32 s57, s57, 0
    v_exp_f32 v72, v72
    v_exp_f32 v73, v73
    v_exp_f32 v74, v74
    v_exp_f32 v75, v75
    v_smfmac_f32_32x32x32_bf16 v[144:159], a[244:247], v[56:63], v219
    s_waitcnt lgkmcnt(0)
    v_exp_f32 v76, v76
    v_exp_f32 v77, v77
    v_exp_f32 v78, v78
    v_exp_f32 v79, v79
    v_mfma_f32_32x32x16_bf16 v[32:47], a[216:219], v[96:99], 0
    global_load_dword v5, v[252:253], off
    v_exp_f32 v80, v80
    v_exp_f32 v81, v81
    v_exp_f32 v82, v82
    v_exp_f32 v83, v83
    v_mfma_f32_32x32x8bf16_1k v[32:47], a[230:231], v[112:113], v[32:47]
    v_exp_f32 v84, v84
    v_exp_f32 v85, v85
    v_exp_f32 v86, v86
    v_exp_f32 v87, v87
    v_smfmac_f32_32x32x32_bf16 v[160:175], a[240:243], v[64:71], v219
    v_exp_f32 v88, v88
    v_exp_f32 v89, v89
    v_exp_f32 v90, v90
    v_exp_f32 v91, v91
    v_smfmac_f32_32x32x32_bf16 v[160:175], a[244:247], v[72:79], v219
    v_exp_f32 v92, v92
    v_exp_f32 v93, v93
    v_exp_f32 v94, v94
    v_exp_f32 v95, v95
    v_mfma_f32_32x32x16_bf16 v[48:63], a[216:219], v[100:103], 0
    ds_read_b128 a[220:223], v216 offset:7168
    v_exp_f32 v32, v32
    v_exp_f32 v33, v33
    v_exp_f32 v34, v34
    v_exp_f32 v35, v35
    v_mfma_f32_32x32x8bf16_1k v[48:63], a[230:231], v[116:117], v[48:63]
    v_exp_f32 v36, v36
    v_exp_f32 v37, v37
    v_exp_f32 v38, v38
    v_exp_f32 v39, v39
    v_smfmac_f32_32x32x32_bf16 v[176:191], a[240:243], v[80:87], v219
    v_exp_f32 v40, v40
    v_exp_f32 v41, v41
    v_exp_f32 v42, v42
    v_exp_f32 v43, v43
    v_smfmac_f32_32x32x32_bf16 v[176:191], a[244:247], v[88:95], v219
    v_exp_f32 v44, v44
    v_exp_f32 v45, v45
    v_exp_f32 v46, v46
    v_exp_f32 v47, v47
    v_mfma_f32_32x32x16_bf16 v[64:79], a[216:219], v[104:107], 0
    ds_read_b128 a[240:243], v218 offset:8960
    v_exp_f32 v48, v48
    v_exp_f32 v49, v49
    v_exp_f32 v50, v50
    v_exp_f32 v51, v51
    v_mfma_f32_32x32x8bf16_1k v[64:79], a[230:231], v[120:121], v[64:79]
    v_exp_f32 v52, v52
    v_exp_f32 v53, v53
    v_exp_f32 v54, v54
    v_exp_f32 v55, v55
    v_smfmac_f32_32x32x32_bf16 v[128:143], a[232:235], v[32:39], v219
    ds_read_b128 a[244:247], v218 offset:9600
    v_exp_f32 v56, v56
    v_exp_f32 v57, v57
    v_exp_f32 v58, v58
    v_exp_f32 v59, v59
    v_smfmac_f32_32x32x32_bf16 v[128:143], a[236:239], v[40:47], v219
    v_exp_f32 v60, v60
    v_exp_f32 v61, v61
    v_exp_f32 v62, v62
    v_exp_f32 v63, v63
    v_mfma_f32_32x32x16_bf16 v[80:95], a[216:219], v[108:111], 0
    v_exp_f32 v64, v64
    v_exp_f32 v65, v65
    v_exp_f32 v66, v66
    v_exp_f32 v67, v67
    v_mfma_f32_32x32x8bf16_1k v[80:95], a[230:231], v[124:125], v[80:95]
    v_exp_f32 v68, v68
    v_exp_f32 v69, v69
    v_exp_f32 v70, v70
    v_exp_f32 v71, v71
    v_smfmac_f32_32x32x32_bf16 v[144:159], a[232:235], v[48:55], v219
    v_exp_f32 v72, v72
    v_exp_f32 v73, v73
    v_exp_f32 v74, v74
    v_exp_f32 v75, v75
    v_smfmac_f32_32x32x32_bf16 v[144:159], a[236:239], v[56:63], v219
    s_waitcnt lgkmcnt(0)
    v_exp_f32 v76, v76
    v_exp_f32 v77, v77
    v_exp_f32 v78, v78
    v_exp_f32 v79, v79
    v_mfma_f32_32x32x16_bf16 v[32:47], a[220:223], v[96:99], 0
    v_exp_f32 v80, v80
    v_exp_f32 v81, v81
    v_exp_f32 v82, v82
    v_exp_f32 v83, v83
    v_mfma_f32_32x32x8bf16_1k v[32:47], a[230:231], v[114:115], v[32:47]
    v_exp_f32 v84, v84
    v_exp_f32 v85, v85
    v_exp_f32 v86, v86
    v_exp_f32 v87, v87
    v_smfmac_f32_32x32x32_bf16 v[160:175], a[232:235], v[64:71], v219
    v_exp_f32 v88, v88
    v_exp_f32 v89, v89
    v_exp_f32 v90, v90
    v_exp_f32 v91, v91
    v_smfmac_f32_32x32x32_bf16 v[160:175], a[236:239], v[72:79], v219
    v_exp_f32 v92, v92
    v_exp_f32 v93, v93
    v_exp_f32 v94, v94
    v_exp_f32 v95, v95
    v_mfma_f32_32x32x16_bf16 v[48:63], a[220:223], v[100:103], 0
    s_waitcnt vmcnt(7)
    s_barrier
    buffer_atomic_add v27, v7, s[32:35], s1 offen sc1
    ds_read_b128 a[216:219], v216 offset:20480
    v_exp_f32 v32, v32
    v_exp_f32 v33, v33
    v_exp_f32 v34, v34
    v_exp_f32 v35, v35
    v_mfma_f32_32x32x8bf16_1k v[48:63], a[230:231], v[118:119], v[48:63]
    v_exp_f32 v36, v36
    v_exp_f32 v37, v37
    v_exp_f32 v38, v38
    v_exp_f32 v39, v39
    v_smfmac_f32_32x32x32_bf16 v[176:191], a[232:235], v[80:87], v219
    s_add_u32 m0, s85, 110592
    ds_read_b128 a[224:227], v217 offset:20480
    v_exp_f32 v40, v40
    v_exp_f32 v41, v41
    v_exp_f32 v42, v42
    v_exp_f32 v43, v43
    v_smfmac_f32_32x32x32_bf16 v[176:191], a[236:239], v[88:95], v219
    s_mov_b32 s1, 1073741824
    buffer_load_dwordx4 v6, s[56:59], 0 offen offset:0 sc1 lds
    v_exp_f32 v44, v44
    v_exp_f32 v45, v45
    v_exp_f32 v46, v46
    v_exp_f32 v47, v47
    v_mfma_f32_32x32x16_bf16 v[64:79], a[220:223], v[104:107], 0
    ds_read_b128 a[232:235], v218 offset:20480
    v_exp_f32 v48, v48
    v_exp_f32 v49, v49
    v_exp_f32 v50, v50
    v_exp_f32 v51, v51
    v_mfma_f32_32x32x8bf16_1k v[64:79], a[230:231], v[122:123], v[64:79]
    v_exp_f32 v52, v52
    v_exp_f32 v53, v53
    v_exp_f32 v54, v54
    v_exp_f32 v55, v55
    v_smfmac_f32_32x32x32_bf16 v[128:143], a[240:243], v[32:39], v219
    ds_read_b128 a[236:239], v218 offset:21120
    v_exp_f32 v56, v56
    v_exp_f32 v57, v57
    v_exp_f32 v58, v58
    v_exp_f32 v59, v59
    v_smfmac_f32_32x32x32_bf16 v[128:143], a[244:247], v[40:47], v219
    buffer_load_dwordx4 v6, s[56:59], 0 offen offset:1024 sc1 lds
    v_exp_f32 v60, v60
    v_exp_f32 v61, v61
    v_exp_f32 v62, v62
    v_exp_f32 v63, v63
    v_mfma_f32_32x32x16_bf16 v[80:95], a[220:223], v[108:111], 0
    buffer_load_dwordx4 v6, s[56:59], 0 offen offset:2048 sc1 lds
    v_exp_f32 v64, v64
    v_exp_f32 v65, v65
    v_exp_f32 v66, v66
    v_exp_f32 v67, v67
    v_mfma_f32_32x32x8bf16_1k v[80:95], a[230:231], v[126:127], v[80:95]
    v_exp_f32 v68, v68
    v_exp_f32 v69, v69
    v_exp_f32 v70, v70
    v_exp_f32 v71, v71
    v_smfmac_f32_32x32x32_bf16 v[144:159], a[240:243], v[48:55], v219
    buffer_load_dwordx4 v6, s[56:59], 0 offen offset:3072 sc1 lds
    v_exp_f32 v72, v72
    v_exp_f32 v73, v73
    v_exp_f32 v74, v74
    v_exp_f32 v75, v75
    v_smfmac_f32_32x32x32_bf16 v[144:159], a[244:247], v[56:63], v219
    s_waitcnt lgkmcnt(0)
    v_exp_f32 v76, v76
    v_exp_f32 v77, v77
    v_exp_f32 v78, v78
    v_exp_f32 v79, v79
    v_mfma_f32_32x32x16_bf16 v[32:47], a[216:219], v[96:99], 0
    s_add_u32 m0, s85, 114688
    v_exp_f32 v80, v80
    v_exp_f32 v81, v81
    v_exp_f32 v82, v82
    v_exp_f32 v83, v83
    v_mfma_f32_32x32x8bf16_1k v[32:47], a[224:225], v[112:113], v[32:47]
    v_exp_f32 v84, v84
    v_exp_f32 v85, v85
    v_exp_f32 v86, v86
    v_exp_f32 v87, v87
    v_smfmac_f32_32x32x32_bf16 v[160:175], a[240:243], v[64:71], v219
    buffer_load_dwordx4 v247, s[56:59], 0 offen sc1 lds
    v_exp_f32 v88, v88
    v_exp_f32 v89, v89
    v_exp_f32 v90, v90
    v_exp_f32 v91, v91
    v_smfmac_f32_32x32x32_bf16 v[160:175], a[244:247], v[72:79], v219
    v_exp_f32 v92, v92
    v_exp_f32 v93, v93
    v_exp_f32 v94, v94
    v_exp_f32 v95, v95
    v_mfma_f32_32x32x16_bf16 v[48:63], a[216:219], v[100:103], 0
    ds_read_b128 a[220:223], v216 offset:21504
    v_exp_f32 v32, v32
    v_exp_f32 v33, v33
    v_exp_f32 v34, v34
    v_exp_f32 v35, v35
    v_mfma_f32_32x32x8bf16_1k v[48:63], a[224:225], v[116:117], v[48:63]
    v_exp_f32 v36, v36
    v_exp_f32 v37, v37
    v_exp_f32 v38, v38
    v_exp_f32 v39, v39
    v_smfmac_f32_32x32x32_bf16 v[176:191], a[240:243], v[80:87], v219
L_w17:
    s_cbranch_execz L_w21
    v_exp_f32 v40, v40
    v_exp_f32 v41, v41
    v_exp_f32 v42, v42
    v_exp_f32 v43, v43
    v_smfmac_f32_32x32x32_bf16 v[176:191], a[244:247], v[88:95], v219
    v_exp_f32 v44, v44
    v_exp_f32 v45, v45
    v_exp_f32 v46, v46
    v_exp_f32 v47, v47
    v_mfma_f32_32x32x16_bf16 v[64:79], a[216:219], v[104:107], 0
    ds_read_b128 a[240:243], v218 offset:21760
    v_exp_f32 v48, v48
    v_exp_f32 v49, v49
    v_exp_f32 v50, v50
    v_exp_f32 v51, v51
    v_mfma_f32_32x32x8bf16_1k v[64:79], a[224:225], v[120:121], v[64:79]
    v_exp_f32 v52, v52
    v_exp_f32 v53, v53
    v_exp_f32 v54, v54
    v_exp_f32 v55, v55
    v_smfmac_f32_32x32x32_bf16 v[128:143], a[232:235], v[32:39], v219
    ds_read_b128 a[244:247], v218 offset:22400
    v_exp_f32 v56, v56
    v_exp_f32 v57, v57
    v_exp_f32 v58, v58
    v_exp_f32 v59, v59
    v_smfmac_f32_32x32x32_bf16 v[128:143], a[236:239], v[40:47], v219
    v_exp_f32 v60, v60
    v_exp_f32 v61, v61
    v_exp_f32 v62, v62
    v_exp_f32 v63, v63
    v_mfma_f32_32x32x16_bf16 v[80:95], a[216:219], v[108:111], 0
    v_exp_f32 v64, v64
    v_exp_f32 v65, v65
    v_exp_f32 v66, v66
    v_exp_f32 v67, v67
    v_mfma_f32_32x32x8bf16_1k v[80:95], a[224:225], v[124:125], v[80:95]
    v_exp_f32 v68, v68
    v_exp_f32 v69, v69
    v_exp_f32 v70, v70
    v_exp_f32 v71, v71
    v_smfmac_f32_32x32x32_bf16 v[144:159], a[232:235], v[48:55], v219
    v_exp_f32 v72, v72
    v_exp_f32 v73, v73
    v_exp_f32 v74, v74
    v_exp_f32 v75, v75
    v_smfmac_f32_32x32x32_bf16 v[144:159], a[236:239], v[56:63], v219
    s_waitcnt lgkmcnt(0)
    v_exp_f32 v76, v76
    v_exp_f32 v77, v77
    v_exp_f32 v78, v78
    v_exp_f32 v79, v79
    v_mfma_f32_32x32x16_bf16 v[32:47], a[220:223], v[96:99], 0
    s_add_u32 m0, s88, s82
    v_exp_f32 v80, v80
    v_exp_f32 v81, v81
    v_exp_f32 v82, v82
    v_exp_f32 v83, v83
    v_mfma_f32_32x32x8bf16_1k v[32:47], a[224:225], v[114:115], v[32:47]
    v_exp_f32 v84, v84
    v_exp_f32 v85, v85
    v_exp_f32 v86, v86
    v_exp_f32 v87, v87
    v_smfmac_f32_32x32x32_bf16 v[160:175], a[232:235], v[64:71], v219
    s_add_u32 s88, s88, 4096
    buffer_load_dwordx4 v220, s[44:47], s84 offen lds
    v_exp_f32 v88, v88
    v_exp_f32 v89, v89
    v_exp_f32 v90, v90
    v_exp_f32 v91, v91
    v_smfmac_f32_32x32x32_bf16 v[160:175], a[236:239], v[72:79], v219
    s_add_u32 s84, s84, 41472
    v_exp_f32 v92, v92
    v_exp_f32 v93, v93
    v_exp_f32 v94, v94
    v_exp_f32 v95, v95
    v_mfma_f32_32x32x16_bf16 v[48:63], a[220:223], v[100:103], 0
    ds_read_b128 a[216:219], v216 offset:22528
    v_exp_f32 v32, v32
    v_exp_f32 v33, v33
    v_exp_f32 v34, v34
    v_exp_f32 v35, v35
    v_mfma_f32_32x32x8bf16_1k v[48:63], a[224:225], v[118:119], v[48:63]
    v_exp_f32 v36, v36
    v_exp_f32 v37, v37
    v_exp_f32 v38, v38
    v_exp_f32 v39, v39
    v_smfmac_f32_32x32x32_bf16 v[176:191], a[232:235], v[80:87], v219
    v_exp_f32 v40, v40
    v_exp_f32 v41, v41
    v_exp_f32 v42, v42
    v_exp_f32 v43, v43
    v_smfmac_f32_32x32x32_bf16 v[176:191], a[236:239], v[88:95], v219
    v_exp_f32 v44, v44
    v_exp_f32 v45, v45
    v_exp_f32 v46, v46
    v_exp_f32 v47, v47
    v_mfma_f32_32x32x16_bf16 v[64:79], a[220:223], v[104:107], 0
    ds_read_b128 a[232:235], v218 offset:23040
    v_exp_f32 v48, v48
    v_exp_f32 v49, v49
    v_exp_f32 v50, v50
    v_exp_f32 v51, v51
    v_mfma_f32_32x32x8bf16_1k v[64:79], a[224:225], v[122:123], v[64:79]
    v_exp_f32 v52, v52
    v_exp_f32 v53, v53
    v_exp_f32 v54, v54
    v_exp_f32 v55, v55
    v_smfmac_f32_32x32x32_bf16 v[128:143], a[240:243], v[32:39], v219
    ds_read_b128 a[236:239], v218 offset:23680
    v_exp_f32 v56, v56
    v_exp_f32 v57, v57
    v_exp_f32 v58, v58
    v_exp_f32 v59, v59
    v_smfmac_f32_32x32x32_bf16 v[128:143], a[244:247], v[40:47], v219
    v_exp_f32 v60, v60
    v_exp_f32 v61, v61
    v_exp_f32 v62, v62
    v_exp_f32 v63, v63
    v_mfma_f32_32x32x16_bf16 v[80:95], a[220:223], v[108:111], 0
    s_cmp_eq_u32 s88, 73728
    v_exp_f32 v64, v64
    v_exp_f32 v65, v65
    v_exp_f32 v66, v66
    v_exp_f32 v67, v67
    v_mfma_f32_32x32x8bf16_1k v[80:95], a[224:225], v[126:127], v[80:95]
    v_exp_f32 v68, v68
    v_exp_f32 v69, v69
    v_exp_f32 v70, v70
    v_exp_f32 v71, v71
    v_smfmac_f32_32x32x32_bf16 v[144:159], a[240:243], v[48:55], v219
    s_cselect_b32 s88, 0, s88
    v_exp_f32 v72, v72
    v_exp_f32 v73, v73
    v_exp_f32 v74, v74
    v_exp_f32 v75, v75
    v_smfmac_f32_32x32x32_bf16 v[144:159], a[244:247], v[56:63], v219
    s_waitcnt lgkmcnt(0)
    v_exp_f32 v76, v76
    v_exp_f32 v77, v77
    v_exp_f32 v78, v78
    v_exp_f32 v79, v79
    v_mfma_f32_32x32x16_bf16 v[32:47], a[216:219], v[96:99], 0
    s_add_u32 m0, s88, s82
    v_exp_f32 v80, v80
    v_exp_f32 v81, v81
    v_exp_f32 v82, v82
    v_exp_f32 v83, v83
    v_mfma_f32_32x32x8bf16_1k v[32:47], a[226:227], v[112:113], v[32:47]
    v_exp_f32 v84, v84
    v_exp_f32 v85, v85
    v_exp_f32 v86, v86
    v_exp_f32 v87, v87
    v_smfmac_f32_32x32x32_bf16 v[160:175], a[240:243], v[64:71], v219
    s_add_u32 s88, s88, 4096
    buffer_load_dwordx4 v220, s[44:47], s84 offen lds
    v_exp_f32 v88, v88
    v_exp_f32 v89, v89
    v_exp_f32 v90, v90
    v_exp_f32 v91, v91
    v_smfmac_f32_32x32x32_bf16 v[160:175], a[244:247], v[72:79], v219
    s_add_u32 s84, s84, 41472
    v_exp_f32 v92, v92
    v_exp_f32 v93, v93
    v_exp_f32 v94, v94
    v_exp_f32 v95, v95
    v_mfma_f32_32x32x16_bf16 v[48:63], a[216:219], v[100:103], 0
    ds_read_b128 a[220:223], v216 offset:23552
    v_exp_f32 v32, v32
    v_exp_f32 v33, v33
    v_exp_f32 v34, v34
    v_exp_f32 v35, v35
    v_mfma_f32_32x32x8bf16_1k v[48:63], a[226:227], v[116:117], v[48:63]
    v_exp_f32 v36, v36
    v_exp_f32 v37, v37
    v_exp_f32 v38, v38
    v_exp_f32 v39, v39
    v_smfmac_f32_32x32x32_bf16 v[176:191], a[240:243], v[80:87], v219
    v_exp_f32 v40, v40
    v_exp_f32 v41, v41
    v_exp_f32 v42, v42
    v_exp_f32 v43, v43
    v_smfmac_f32_32x32x32_bf16 v[176:191], a[244:247], v[88:95], v219
    v_exp_f32 v44, v44
    v_exp_f32 v45, v45
    v_exp_f32 v46, v46
    v_exp_f32 v47, v47
    v_mfma_f32_32x32x16_bf16 v[64:79], a[216:219], v[104:107], 0
    ds_read_b128 a[240:243], v218 offset:24320
    v_exp_f32 v48, v48
    v_exp_f32 v49, v49
    v_exp_f32 v50, v50
    v_exp_f32 v51, v51
    v_mfma_f32_32x32x8bf16_1k v[64:79], a[226:227], v[120:121], v[64:79]
    v_exp_f32 v52, v52
    v_exp_f32 v53, v53
    v_exp_f32 v54, v54
    v_exp_f32 v55, v55
    v_smfmac_f32_32x32x32_bf16 v[128:143], a[232:235], v[32:39], v219
    ds_read_b128 a[244:247], v218 offset:24960
    v_exp_f32 v56, v56
    v_exp_f32 v57, v57
    v_exp_f32 v58, v58
    v_exp_f32 v59, v59
    v_smfmac_f32_32x32x32_bf16 v[128:143], a[236:239], v[40:47], v219
    v_exp_f32 v60, v60
    v_exp_f32 v61, v61
    v_exp_f32 v62, v62
    v_exp_f32 v63, v63
    v_mfma_f32_32x32x16_bf16 v[80:95], a[216:219], v[108:111], 0
    v_exp_f32 v64, v64
    v_exp_f32 v65, v65
    v_exp_f32 v66, v66
    v_exp_f32 v67, v67
    v_mfma_f32_32x32x8bf16_1k v[80:95], a[226:227], v[124:125], v[80:95]
    v_exp_f32 v68, v68
    v_exp_f32 v69, v69
    v_exp_f32 v70, v70
    v_exp_f32 v71, v71
    v_smfmac_f32_32x32x32_bf16 v[144:159], a[232:235], v[48:55], v219
    v_exp_f32 v72, v72
    v_exp_f32 v73, v73
    v_exp_f32 v74, v74
    v_exp_f32 v75, v75
    v_smfmac_f32_32x32x32_bf16 v[144:159], a[236:239], v[56:63], v219
    s_waitcnt lgkmcnt(0)
    v_exp_f32 v76, v76
    v_exp_f32 v77, v77
    v_exp_f32 v78, v78
    v_exp_f32 v79, v79
    v_mfma_f32_32x32x16_bf16 v[32:47], a[220:223], v[96:99], 0
    v_exp_f32 v80, v80
    v_exp_f32 v81, v81
    v_exp_f32 v82, v82
    v_exp_f32 v83, v83
    v_mfma_f32_32x32x8bf16_1k v[32:47], a[226:227], v[114:115], v[32:47]
    v_exp_f32 v84, v84
    v_exp_f32 v85, v85
    v_exp_f32 v86, v86
    v_exp_f32 v87, v87
    v_smfmac_f32_32x32x32_bf16 v[160:175], a[232:235], v[64:71], v219
    v_exp_f32 v88, v88
    v_exp_f32 v89, v89
    v_exp_f32 v90, v90
    v_exp_f32 v91, v91
    v_smfmac_f32_32x32x32_bf16 v[160:175], a[236:239], v[72:79], v219
    v_exp_f32 v92, v92
    v_exp_f32 v93, v93
    v_exp_f32 v94, v94
    v_exp_f32 v95, v95
    v_mfma_f32_32x32x16_bf16 v[48:63], a[220:223], v[100:103], 0
    ds_read_b128 a[216:219], v216 offset:24576
    v_exp_f32 v32, v32
    v_exp_f32 v33, v33
    v_exp_f32 v34, v34
    v_exp_f32 v35, v35
    v_mfma_f32_32x32x8bf16_1k v[48:63], a[226:227], v[118:119], v[48:63]
    v_exp_f32 v36, v36
    v_exp_f32 v37, v37
    v_exp_f32 v38, v38
    v_exp_f32 v39, v39
    v_smfmac_f32_32x32x32_bf16 v[176:191], a[232:235], v[80:87], v219
    ds_read_b128 a[228:231], v217 offset:21120
    v_exp_f32 v40, v40
    v_exp_f32 v41, v41
    v_exp_f32 v42, v42
    v_exp_f32 v43, v43
    v_smfmac_f32_32x32x32_bf16 v[176:191], a[236:239], v[88:95], v219
    v_exp_f32 v44, v44
    v_exp_f32 v45, v45
    v_exp_f32 v46, v46
    v_exp_f32 v47, v47
    v_mfma_f32_32x32x16_bf16 v[64:79], a[220:223], v[104:107], 0
    ds_read_b128 a[232:235], v218 offset:25600
    v_exp_f32 v48, v48
    v_exp_f32 v49, v49
    v_exp_f32 v50, v50
    v_exp_f32 v51, v51
    v_mfma_f32_32x32x8bf16_1k v[64:79], a[226:227], v[122:123], v[64:79]
    v_exp_f32 v52, v52
    v_exp_f32 v53, v53
    v_exp_f32 v54, v54
    v_exp_f32 v55, v55
    v_smfmac_f32_32x32x32_bf16 v[128:143], a[240:243], v[32:39], v219
    ds_read_b128 a[236:239], v218 offset:26240
    v_exp_f32 v56, v56
    v_exp_f32 v57, v57
    v_exp_f32 v58, v58
    v_exp_f32 v59, v59
    v_smfmac_f32_32x32x32_bf16 v[128:143], a[244:247], v[40:47], v219
    v_exp_f32 v60, v60
    v_exp_f32 v61, v61
    v_exp_f32 v62, v62
    v_exp_f32 v63, v63
    v_mfma_f32_32x32x16_bf16 v[80:95], a[220:223], v[108:111], 0
    s_cmp_lt_u32 s87, 3
    v_exp_f32 v64, v64
    v_exp_f32 v65, v65
    v_exp_f32 v66, v66
    v_exp_f32 v67, v67
    v_mfma_f32_32x32x8bf16_1k v[80:95], a[226:227], v[126:127], v[80:95]
    v_exp_f32 v68, v68
    v_exp_f32 v69, v69
    v_exp_f32 v70, v70
    v_exp_f32 v71, v71
    v_smfmac_f32_32x32x32_bf16 v[144:159], a[240:243], v[48:55], v219
    s_cselect_b32 s90, 0, 1073741824
    v_exp_f32 v72, v72
    v_exp_f32 v73, v73
    v_exp_f32 v74, v74
    v_exp_f32 v75, v75
    v_smfmac_f32_32x32x32_bf16 v[144:159], a[244:247], v[56:63], v219
    s_waitcnt lgkmcnt(0)
    v_exp_f32 v76, v76
    v_exp_f32 v77, v77
    v_exp_f32 v78, v78
    v_exp_f32 v79, v79
    v_mfma_f32_32x32x16_bf16 v[32:47], a[216:219], v[96:99], 0
    s_add_u32 s91, s90, s51
    v_exp_f32 v80, v80
    v_exp_f32 v81, v81
    v_exp_f32 v82, v82
    v_exp_f32 v83, v83
    v_mfma_f32_32x32x8bf16_1k v[32:47], a[228:229], v[112:113], v[32:47]
    v_exp_f32 v84, v84
    v_exp_f32 v85, v85
    v_exp_f32 v86, v86
    v_exp_f32 v87, v87
    v_smfmac_f32_32x32x32_bf16 v[160:175], a[240:243], v[64:71], v219
    buffer_load_dword v5, v25, s[72:75], s91 offen
    v_exp_f32 v88, v88
    v_exp_f32 v89, v89
    v_exp_f32 v90, v90
    v_exp_f32 v91, v91
    v_smfmac_f32_32x32x32_bf16 v[160:175], a[244:247], v[72:79], v219
    s_add_u32 s51, s51, 128
    v_exp_f32 v92, v92
    v_exp_f32 v93, v93
    v_exp_f32 v94, v94
    v_exp_f32 v95, v95
    v_mfma_f32_32x32x16_bf16 v[48:63], a[216:219], v[100:103], 0
    ds_read_b128 a[220:223], v216 offset:25600
    v_exp_f32 v32, v32
    v_exp_f32 v33, v33
    v_exp_f32 v34, v34
    v_exp_f32 v35, v35
    v_mfma_f32_32x32x8bf16_1k v[48:63], a[228:229], v[116:117], v[48:63]
    v_exp_f32 v36, v36
    v_exp_f32 v37, v37
    v_exp_f32 v38, v38
    v_exp_f32 v39, v39
    v_smfmac_f32_32x32x32_bf16 v[176:191], a[240:243], v[80:87], v219
    s_cmp_eq_u32 s87, 2
    v_exp_f32 v40, v40
    v_exp_f32 v41, v41
    v_exp_f32 v42, v42
    v_exp_f32 v43, v43
    v_smfmac_f32_32x32x32_bf16 v[176:191], a[244:247], v[88:95], v219
    s_cselect_b32 s91, s96, 1073741824
    v_exp_f32 v44, v44
    v_exp_f32 v45, v45
    v_exp_f32 v46, v46
    v_exp_f32 v47, v47
    v_mfma_f32_32x32x16_bf16 v[64:79], a[216:219], v[104:107], 0
    ds_read_b128 a[240:243], v218 offset:26880
    v_exp_f32 v48, v48
    v_exp_f32 v49, v49
    v_exp_f32 v50, v50
    v_exp_f32 v51, v51
    v_mfma_f32_32x32x8bf16_1k v[64:79], a[228:229], v[120:121], v[64:79]
    v_exp_f32 v52, v52
    v_exp_f32 v53, v53
    v_exp_f32 v54, v54
    v_exp_f32 v55, v55
    v_smfmac_f32_32x32x32_bf16 v[128:143], a[232:235], v[32:39], v219
    ds_read_b128 a[244:247], v218 offset:27520
    v_exp_f32 v56, v56
    v_exp_f32 v57, v57
    v_exp_f32 v58, v58
    v_exp_f32 v59, v59
    v_smfmac_f32_32x32x32_bf16 v[128:143], a[236:239], v[40:47], v219
    v_exp_f32 v60, v60
    v_exp_f32 v61, v61
    v_exp_f32 v62, v62
    v_exp_f32 v63, v63
    v_mfma_f32_32x32x16_bf16 v[80:95], a[216:219], v[108:111], 0
    s_add_u32 s90, s91, 10496
    v_exp_f32 v64, v64
    v_exp_f32 v65, v65
    v_exp_f32 v66, v66
    v_exp_f32 v67, v67
    v_mfma_f32_32x32x8bf16_1k v[80:95], a[228:229], v[124:125], v[80:95]
    v_exp_f32 v68, v68
    v_exp_f32 v69, v69
    v_exp_f32 v70, v70
    v_exp_f32 v71, v71
    v_smfmac_f32_32x32x32_bf16 v[144:159], a[232:235], v[48:55], v219
    buffer_load_dword v5, v225, s[20:23], s90 offen
    v_exp_f32 v72, v72
    v_exp_f32 v73, v73
    v_exp_f32 v74, v74
    v_exp_f32 v75, v75
    v_smfmac_f32_32x32x32_bf16 v[144:159], a[236:239], v[56:63], v219
    s_waitcnt lgkmcnt(0)
    v_exp_f32 v76, v76
    v_exp_f32 v77, v77
    v_exp_f32 v78, v78
    v_exp_f32 v79, v79
    v_mfma_f32_32x32x16_bf16 v[32:47], a[220:223], v[96:99], 0
    s_add_u32 s90, s91, 15744
    v_exp_f32 v80, v80
    v_exp_f32 v81, v81
    v_exp_f32 v82, v82
    v_exp_f32 v83, v83
    v_mfma_f32_32x32x8bf16_1k v[32:47], a[228:229], v[114:115], v[32:47]
    v_exp_f32 v84, v84
    v_exp_f32 v85, v85
    v_exp_f32 v86, v86
    v_exp_f32 v87, v87
    v_smfmac_f32_32x32x32_bf16 v[160:175], a[232:235], v[64:71], v219
    buffer_load_dword v5, v225, s[20:23], s90 offen
    v_exp_f32 v88, v88
    v_exp_f32 v89, v89
    v_exp_f32 v90, v90
    v_exp_f32 v91, v91
    v_smfmac_f32_32x32x32_bf16 v[160:175], a[236:239], v[72:79], v219
    v_exp_f32 v92, v92
    v_exp_f32 v93, v93
    v_exp_f32 v94, v94
    v_exp_f32 v95, v95
    v_mfma_f32_32x32x16_bf16 v[48:63], a[220:223], v[100:103], 0
    ds_read_b128 a[216:219], v216 offset:26624
    v_exp_f32 v32, v32
    v_exp_f32 v33, v33
    v_exp_f32 v34, v34
    v_exp_f32 v35, v35
    v_mfma_f32_32x32x8bf16_1k v[48:63], a[228:229], v[118:119], v[48:63]
    v_exp_f32 v36, v36
    v_exp_f32 v37, v37
    v_exp_f32 v38, v38
    v_exp_f32 v39, v39
    v_smfmac_f32_32x32x32_bf16 v[176:191], a[232:235], v[80:87], v219
    v_exp_f32 v40, v40
    v_exp_f32 v41, v41
    v_exp_f32 v42, v42
    v_exp_f32 v43, v43
    v_smfmac_f32_32x32x32_bf16 v[176:191], a[236:239], v[88:95], v219
    v_exp_f32 v44, v44
    v_exp_f32 v45, v45
    v_exp_f32 v46, v46
    v_exp_f32 v47, v47
    v_mfma_f32_32x32x16_bf16 v[64:79], a[220:223], v[104:107], 0
    ds_read_b128 a[232:235], v218 offset:28160
    v_exp_f32 v48, v48
    v_exp_f32 v49, v49
    v_exp_f32 v50, v50
    v_exp_f32 v51, v51
    v_mfma_f32_32x32x8bf16_1k v[64:79], a[228:229], v[122:123], v[64:79]
    v_exp_f32 v52, v52
    v_exp_f32 v53, v53
    v_exp_f32 v54, v54
    v_exp_f32 v55, v55
    v_smfmac_f32_32x32x32_bf16 v[128:143], a[240:243], v[32:39], v219
    ds_read_b128 a[236:239], v218 offset:28800
    v_exp_f32 v56, v56
    v_exp_f32 v57, v57
    v_exp_f32 v58, v58
    v_exp_f32 v59, v59
    v_smfmac_f32_32x32x32_bf16 v[128:143], a[244:247], v[40:47], v219
    v_exp_f32 v60, v60
    v_exp_f32 v61, v61
    v_exp_f32 v62, v62
    v_exp_f32 v63, v63
    v_mfma_f32_32x32x16_bf16 v[80:95], a[220:223], v[108:111], 0
    s_add_u32 s56, s56, 20480
    v_exp_f32 v64, v64
    v_exp_f32 v65, v65
    v_exp_f32 v66, v66
    v_exp_f32 v67, v67
    v_mfma_f32_32x32x8bf16_1k v[80:95], a[228:229], v[126:127], v[80:95]
    v_exp_f32 v68, v68
    v_exp_f32 v69, v69
    v_exp_f32 v70, v70
    v_exp_f32 v71, v71
    v_smfmac_f32_32x32x32_bf16 v[144:159], a[240:243], v[48:55], v219
    s_addc_u32 s57, s57, 0
    v_exp_f32 v72, v72
    v_exp_f32 v73, v73
    v_exp_f32 v74, v74
    v_exp_f32 v75, v75
    v_smfmac_f32_32x32x32_bf16 v[144:159], a[244:247], v[56:63], v219
    s_waitcnt lgkmcnt(0)
    v_exp_f32 v76, v76
    v_exp_f32 v77, v77
    v_exp_f32 v78, v78
    v_exp_f32 v79, v79
    v_mfma_f32_32x32x16_bf16 v[32:47], a[216:219], v[96:99], 0
    v_exp_f32 v80, v80
    v_exp_f32 v81, v81
    v_exp_f32 v82, v82
    v_exp_f32 v83, v83
    v_mfma_f32_32x32x8bf16_1k v[32:47], a[230:231], v[112:113], v[32:47]
    v_exp_f32 v84, v84
    v_exp_f32 v85, v85
    v_exp_f32 v86, v86
    v_exp_f32 v87, v87
    v_smfmac_f32_32x32x32_bf16 v[160:175], a[240:243], v[64:71], v219
    v_exp_f32 v88, v88
    v_exp_f32 v89, v89
    v_exp_f32 v90, v90
    v_exp_f32 v91, v91
    v_smfmac_f32_32x32x32_bf16 v[160:175], a[244:247], v[72:79], v219
    v_exp_f32 v92, v92
    v_exp_f32 v93, v93
    v_exp_f32 v94, v94
    v_exp_f32 v95, v95
    v_mfma_f32_32x32x16_bf16 v[48:63], a[216:219], v[100:103], 0
    ds_read_b128 a[220:223], v216 offset:27648
    v_exp_f32 v32, v32
    v_exp_f32 v33, v33
    v_exp_f32 v34, v34
    v_exp_f32 v35, v35
    v_mfma_f32_32x32x8bf16_1k v[48:63], a[230:231], v[116:117], v[48:63]
    v_exp_f32 v36, v36
    v_exp_f32 v37, v37
    v_exp_f32 v38, v38
    v_exp_f32 v39, v39
    v_smfmac_f32_32x32x32_bf16 v[176:191], a[240:243], v[80:87], v219
    v_exp_f32 v40, v40
    v_exp_f32 v41, v41
    v_exp_f32 v42, v42
    v_exp_f32 v43, v43
    v_smfmac_f32_32x32x32_bf16 v[176:191], a[244:247], v[88:95], v219
    v_exp_f32 v44, v44
    v_exp_f32 v45, v45
    v_exp_f32 v46, v46
    v_exp_f32 v47, v47
    v_mfma_f32_32x32x16_bf16 v[64:79], a[216:219], v[104:107], 0
    ds_read_b128 a[240:243], v218 offset:29440
    v_exp_f32 v48, v48
    v_exp_f32 v49, v49
    v_exp_f32 v50, v50
    v_exp_f32 v51, v51
    v_mfma_f32_32x32x8bf16_1k v[64:79], a[230:231], v[120:121], v[64:79]
    v_exp_f32 v52, v52
    v_exp_f32 v53, v53
    v_exp_f32 v54, v54
    v_exp_f32 v55, v55
    v_smfmac_f32_32x32x32_bf16 v[128:143], a[232:235], v[32:39], v219
    ds_read_b128 a[244:247], v218 offset:30080
    v_exp_f32 v56, v56
    v_exp_f32 v57, v57
    v_exp_f32 v58, v58
    v_exp_f32 v59, v59
    v_smfmac_f32_32x32x32_bf16 v[128:143], a[236:239], v[40:47], v219
    v_exp_f32 v60, v60
    v_exp_f32 v61, v61
    v_exp_f32 v62, v62
    v_exp_f32 v63, v63
    v_mfma_f32_32x32x16_bf16 v[80:95], a[216:219], v[108:111], 0
    v_exp_f32 v64, v64
    v_exp_f32 v65, v65
    v_exp_f32 v66, v66
    v_exp_f32 v67, v67
    v_mfma_f32_32x32x8bf16_1k v[80:95], a[230:231], v[124:125], v[80:95]
    v_exp_f32 v68, v68
    v_exp_f32 v69, v69
    v_exp_f32 v70, v70
    v_exp_f32 v71, v71
    v_smfmac_f32_32x32x32_bf16 v[144:159], a[232:235], v[48:55], v219
    v_exp_f32 v72, v72
    v_exp_f32 v73, v73
    v_exp_f32 v74, v74
    v_exp_f32 v75, v75
    v_smfmac_f32_32x32x32_bf16 v[144:159], a[236:239], v[56:63], v219
    s_waitcnt lgkmcnt(0)
    v_exp_f32 v76, v76
    v_exp_f32 v77, v77
    v_exp_f32 v78, v78
    v_exp_f32 v79, v79
    v_mfma_f32_32x32x16_bf16 v[32:47], a[220:223], v[96:99], 0
    v_exp_f32 v80, v80
    v_exp_f32 v81, v81
    v_exp_f32 v82, v82
    v_exp_f32 v83, v83
    v_mfma_f32_32x32x8bf16_1k v[32:47], a[230:231], v[114:115], v[32:47]
    v_exp_f32 v84, v84
    v_exp_f32 v85, v85
    v_exp_f32 v86, v86
    v_exp_f32 v87, v87
    v_smfmac_f32_32x32x32_bf16 v[160:175], a[232:235], v[64:71], v219
    v_exp_f32 v88, v88
    v_exp_f32 v89, v89
    v_exp_f32 v90, v90
    v_exp_f32 v91, v91
    v_smfmac_f32_32x32x32_bf16 v[160:175], a[236:239], v[72:79], v219
    v_exp_f32 v92, v92
    v_exp_f32 v93, v93
    v_exp_f32 v94, v94
    v_exp_f32 v95, v95
    v_mfma_f32_32x32x16_bf16 v[48:63], a[220:223], v[100:103], 0
    s_waitcnt vmcnt(5)
    s_barrier
    ds_read_b128 a[216:219], v216 offset:0
    v_exp_f32 v32, v32
    v_exp_f32 v33, v33
    v_exp_f32 v34, v34
    v_exp_f32 v35, v35
    v_mfma_f32_32x32x8bf16_1k v[48:63], a[230:231], v[118:119], v[48:63]
    v_exp_f32 v36, v36
    v_exp_f32 v37, v37
    v_exp_f32 v38, v38
    v_exp_f32 v39, v39
    v_smfmac_f32_32x32x32_bf16 v[176:191], a[232:235], v[80:87], v219
    s_add_u32 m0, s85, 131072
    ds_read_b128 a[224:227], v217 offset:0
    v_exp_f32 v40, v40
    v_exp_f32 v41, v41
    v_exp_f32 v42, v42
    v_exp_f32 v43, v43
    v_smfmac_f32_32x32x32_bf16 v[176:191], a[236:239], v[88:95], v219
    buffer_load_dwordx4 v6, s[56:59], 0 offen offset:0 sc1 lds
    v_exp_f32 v44, v44
    v_exp_f32 v45, v45
    v_exp_f32 v46, v46
    v_exp_f32 v47, v47
    v_mfma_f32_32x32x16_bf16 v[64:79], a[220:223], v[104:107], 0
    ds_read_b128 a[232:235], v218 offset:0
    v_exp_f32 v48, v48
    v_exp_f32 v49, v49
    v_exp_f32 v50, v50
    v_exp_f32 v51, v51
    v_mfma_f32_32x32x8bf16_1k v[64:79], a[230:231], v[122:123], v[64:79]
    v_exp_f32 v52, v52
    v_exp_f32 v53, v53
    v_exp_f32 v54, v54
    v_exp_f32 v55, v55
    v_smfmac_f32_32x32x32_bf16 v[128:143], a[240:243], v[32:39], v219
    ds_read_b128 a[236:239], v218 offset:640
    v_exp_f32 v56, v56
    v_exp_f32 v57, v57
    v_exp_f32 v58, v58
    v_exp_f32 v59, v59
    v_smfmac_f32_32x32x32_bf16 v[128:143], a[244:247], v[40:47], v219
    buffer_load_dwordx4 v6, s[56:59], 0 offen offset:1024 sc1 lds
    v_exp_f32 v60, v60
    v_exp_f32 v61, v61
    v_exp_f32 v62, v62
    v_exp_f32 v63, v63
    v_mfma_f32_32x32x16_bf16 v[80:95], a[220:223], v[108:111], 0
    buffer_load_dwordx4 v6, s[56:59], 0 offen offset:2048 sc1 lds
    v_exp_f32 v64, v64
    v_exp_f32 v65, v65
    v_exp_f32 v66, v66
    v_exp_f32 v67, v67
    v_mfma_f32_32x32x8bf16_1k v[80:95], a[230:231], v[126:127], v[80:95]
    v_exp_f32 v68, v68
    v_exp_f32 v69, v69
    v_exp_f32 v70, v70
    v_exp_f32 v71, v71
    v_smfmac_f32_32x32x32_bf16 v[144:159], a[240:243], v[48:55], v219
    buffer_load_dwordx4 v6, s[56:59], 0 offen offset:3072 sc1 lds
    v_exp_f32 v72, v72
    v_exp_f32 v73, v73
    v_exp_f32 v74, v74
    v_exp_f32 v75, v75
    v_smfmac_f32_32x32x32_bf16 v[144:159], a[244:247], v[56:63], v219
    s_waitcnt lgkmcnt(0)
    v_exp_f32 v76, v76
    v_exp_f32 v77, v77
    v_exp_f32 v78, v78
    v_exp_f32 v79, v79
    v_mfma_f32_32x32x16_bf16 v[32:47], a[216:219], v[96:99], 0
    s_add_u32 m0, s85, 135168
    v_exp_f32 v80, v80
    v_exp_f32 v81, v81
    v_exp_f32 v82, v82
    v_exp_f32 v83, v83
    v_mfma_f32_32x32x8bf16_1k v[32:47], a[224:225], v[112:113], v[32:47]
    v_exp_f32 v84, v84
    v_exp_f32 v85, v85
    v_exp_f32 v86, v86
    v_exp_f32 v87, v87
    v_smfmac_f32_32x32x32_bf16 v[160:175], a[240:243], v[64:71], v219
    buffer_load_dwordx4 v247, s[56:59], 0 offen sc1 lds
    v_exp_f32 v88, v88
    v_exp_f32 v89, v89
    v_exp_f32 v90, v90
    v_exp_f32 v91, v91
    v_smfmac_f32_32x32x32_bf16 v[160:175], a[244:247], v[72:79], v219
    s_cmp_lt_u32 s87, 3
    v_exp_f32 v92, v92
    v_exp_f32 v93, v93
    v_exp_f32 v94, v94
    v_exp_f32 v95, v95
    s_cbranch_scc1 L_att
    v_mfma_f32_32x32x16_bf16 v[48:63], a[216:219], v[104:107], 0
    s_add_u32 m0, s82, 49152
    ds_read_b128 a[220:223], v216 offset:1024
    v_exp_f32 v32, v32
    v_exp_f32 v33, v33
    v_exp_f32 v34, v34
    v_exp_f32 v35, v35
    v_mfma_f32_32x32x8bf16_1k v[48:63], a[224:225], v[120:121], v[48:63]
    v_exp_f32 v36, v36
    v_exp_f32 v37, v37
    v_exp_f32 v38, v38
    v_exp_f32 v39, v39
    v_smfmac_f32_32x32x32_bf16 v[176:191], a[240:243], v[80:87], v219
    s_mov_b32 s90, 497664
    buffer_load_dwordx4 v220, s[44:47], s90 offen lds
    v_exp_f32 v40, v40
    v_exp_f32 v41, v41
    v_exp_f32 v42, v42
    v_exp_f32 v43, v43
    v_smfmac_f32_32x32x32_bf16 v[176:191], a[244:247], v[88:95], v219
    s_add_u32 m0, s82, 53248
    s_waitcnt lgkmcnt(0)
    v_exp_f32 v44, v44
    v_exp_f32 v45, v45
    v_exp_f32 v46, v46
    v_exp_f32 v47, v47
    v_mfma_f32_32x32x16_bf16 v[64:79], a[220:223], v[96:99], 0
    s_mov_b32 s90, 539136
    ds_read_b128 a[240:243], v218 offset:1280
    buffer_load_dwordx4 v220, s[44:47], s90 offen lds
    v_exp_f32 v48, v48
    v_exp_f32 v49, v49
    v_exp_f32 v50, v50
    v_exp_f32 v51, v51
    v_mfma_f32_32x32x8bf16_1k v[64:79], a[224:225], v[114:115], v[64:79]
    v_exp_f32 v52, v52
    v_exp_f32 v53, v53
    v_exp_f32 v54, v54
    v_exp_f32 v55, v55
    v_smfmac_f32_32x32x32_bf16 v[128:143], a[232:235], v[32:39], v219
    s_add_u32 m0, s82, 57344
    ds_read_b128 a[244:247], v218 offset:1920
    v_exp_f32 v56, v56
    v_exp_f32 v57, v57
    v_exp_f32 v58, v58
    v_exp_f32 v59, v59
    v_smfmac_f32_32x32x32_bf16 v[128:143], a[236:239], v[40:47], v219
    s_mov_b32 s90, 580608
    buffer_load_dwordx4 v220, s[44:47], s90 offen lds
    v_exp_f32 v60, v60
    v_exp_f32 v61, v61
    v_exp_f32 v62, v62
    v_exp_f32 v63, v63
    v_mfma_f32_32x32x16_bf16 v[80:95], a[220:223], v[104:107], 0
    s_add_u32 m0, s82, 61440
    ds_read_b128 a[216:219], v216 offset:2048
    v_exp_f32 v64, v64
    v_exp_f32 v65, v65
    v_exp_f32 v66, v66
    v_exp_f32 v67, v67
    v_mfma_f32_32x32x8bf16_1k v[80:95], a[224:225], v[122:123], v[80:95]
    v_exp_f32 v68, v68
    v_exp_f32 v69, v69
    v_exp_f32 v70, v70
    v_exp_f32 v71, v71
    v_smfmac_f32_32x32x32_bf16 v[160:175], a[232:235], v[48:55], v219
    s_mov_b32 s90, 622080
    buffer_load_dwordx4 v220, s[44:47], s90 offen lds
    v_exp_f32 v72, v72
    v_exp_f32 v73, v73
    v_exp_f32 v74, v74
    v_exp_f32 v75, v75
    v_smfmac_f32_32x32x32_bf16 v[160:175], a[236:239], v[56:63], v219
    s_add_u32 m0, s82, 86016
    s_waitcnt lgkmcnt(0)
    v_exp_f32 v76, v76
    v_exp_f32 v77, v77
    v_exp_f32 v78, v78
    v_exp_f32 v79, v79
    v_mfma_f32_32x32x16_bf16 v[32:47], a[216:219], v[96:99], 0
    ds_read_b128 a[232:235], v218 offset:2560
    buffer_load_dwordx4 v222, s[44:47], s98 offen lds
    v_exp_f32 v80, v80
    v_exp_f32 v81, v81
    v_exp_f32 v82, v82
    v_exp_f32 v83, v83
    v_mfma_f32_32x32x8bf16_1k v[32:47], a[226:227], v[112:113], v[32:47]
    v_exp_f32 v84, v84
    v_exp_f32 v85, v85
    v_exp_f32 v86, v86
    v_exp_f32 v87, v87
    v_smfmac_f32_32x32x32_bf16 v[128:143], a[240:243], v[64:71], v219
    s_add_u32 m0, s82, 65536
    ds_read_b128 a[236:239], v218 offset:3200
    v_exp_f32 v88, v88
    v_exp_f32 v89, v89
    v_exp_f32 v90, v90
    v_exp_f32 v91, v91
    v_smfmac_f32_32x32x32_bf16 v[128:143], a[244:247], v[72:79], v219
    s_mov_b32 s90, 0
    buffer_load_dwordx4 v221, s[44:47], s90 offen lds
    v_exp_f32 v92, v92
    v_exp_f32 v93, v93
    v_exp_f32 v94, v94
    v_exp_f32 v95, v95
    v_mfma_f32_32x32x16_bf16 v[48:63], a[216:219], v[104:107], 0
    s_add_u32 m0, s82, 69632
    ds_read_b128 a[220:223], v216 offset:3072
    v_exp_f32 v32, v32
    v_exp_f32 v33, v33
    v_exp_f32 v34, v34
    v_exp_f32 v35, v35
    v_mfma_f32_32x32x8bf16_1k v[48:63], a[226:227], v[120:121], v[48:63]
    v_exp_f32 v36, v36
    v_exp_f32 v37, v37
    v_exp_f32 v38, v38
    v_exp_f32 v39, v39
    v_smfmac_f32_32x32x32_bf16 v[160:175], a[240:243], v[80:87], v219
    s_mov_b32 s90, 331776
    buffer_load_dwordx4 v221, s[44:47], s90 offen lds
    v_exp_f32 v40, v40
L_w18:
    s_cbranch_execz L_w22
    v_exp_f32 v41, v41
    v_exp_f32 v42, v42
    v_exp_f32 v43, v43
    v_smfmac_f32_32x32x32_bf16 v[160:175], a[244:247], v[88:95], v219
    s_add_u32 m0, s82, 90112
    s_waitcnt lgkmcnt(0)
    v_exp_f32 v44, v44
    v_exp_f32 v45, v45
    v_exp_f32 v46, v46
    v_exp_f32 v47, v47
    v_mfma_f32_32x32x16_bf16 v[64:79], a[220:223], v[96:99], 0
    s_lshl_b32 s84, s78, 7
    ds_read_b128 a[240:243], v218 offset:3840
    buffer_load_dwordx4 v223, s[44:47], 0 offen lds
    v_exp_f32 v48, v48
    v_exp_f32 v49, v49
    v_exp_f32 v50, v50
    v_exp_f32 v51, v51
    v_mfma_f32_32x32x8bf16_1k v[64:79], a[226:227], v[114:115], v[64:79]
    v_exp_f32 v52, v52
    v_exp_f32 v53, v53
    v_exp_f32 v54, v54
    v_exp_f32 v55, v55
    v_smfmac_f32_32x32x32_bf16 v[128:143], a[232:235], v[32:39], v219
    s_add_u32 m0, s48, 0
    ds_read_b128 a[244:247], v218 offset:4480
    v_exp_f32 v56, v56
    v_exp_f32 v57, v57
    v_exp_f32 v58, v58
    v_exp_f32 v59, v59
    v_smfmac_f32_32x32x32_bf16 v[128:143], a[236:239], v[40:47], v219
    s_add_u32 s90, s84, 0
    buffer_load_dwordx4 v20, s[8:11], s90 offen lds
    v_exp_f32 v60, v60
    v_exp_f32 v61, v61
    v_exp_f32 v62, v62
    v_exp_f32 v63, v63
    v_mfma_f32_32x32x16_bf16 v[80:95], a[220:223], v[104:107], 0
    s_add_u32 m0, s48, 1024
    ds_read_b128 a[216:219], v216 offset:4096
    ds_read_b128 a[228:231], v217 offset:640
    v_exp_f32 v64, v64
    v_exp_f32 v65, v65
    v_exp_f32 v66, v66
    v_exp_f32 v67, v67
    v_mfma_f32_32x32x8bf16_1k v[80:95], a[226:227], v[122:123], v[80:95]
    v_exp_f32 v68, v68
    v_exp_f32 v69, v69
    v_exp_f32 v70, v70
    v_exp_f32 v71, v71
    v_smfmac_f32_32x32x32_bf16 v[160:175], a[232:235], v[48:55], v219
    s_add_u32 s90, s84, 9216
    buffer_load_dwordx4 v20, s[8:11], s90 offen lds
    v_exp_f32 v72, v72
    v_exp_f32 v73, v73
    v_exp_f32 v74, v74
    v_exp_f32 v75, v75
    v_smfmac_f32_32x32x32_bf16 v[160:175], a[236:239], v[56:63], v219
    s_add_u32 m0, s48, 2048
    s_waitcnt lgkmcnt(0)
    v_exp_f32 v76, v76
    v_exp_f32 v77, v77
    v_exp_f32 v78, v78
    v_exp_f32 v79, v79
    v_mfma_f32_32x32x16_bf16 v[32:47], a[216:219], v[96:99], 0
    s_add_u32 s90, s84, 18432
    ds_read_b128 a[232:235], v218 offset:5120
    buffer_load_dwordx4 v20, s[8:11], s90 offen lds
    v_exp_f32 v80, v80
    v_exp_f32 v81, v81
    v_exp_f32 v82, v82
    v_exp_f32 v83, v83
    v_mfma_f32_32x32x8bf16_1k v[32:47], a[228:229], v[112:113], v[32:47]
    v_exp_f32 v84, v84
    v_exp_f32 v85, v85
    v_exp_f32 v86, v86
    v_exp_f32 v87, v87
    v_smfmac_f32_32x32x32_bf16 v[128:143], a[240:243], v[64:71], v219
    s_add_u32 m0, s48, 3072
    ds_read_b128 a[236:239], v218 offset:5760
    v_exp_f32 v88, v88
    v_exp_f32 v89, v89
    v_exp_f32 v90, v90
    v_exp_f32 v91, v91
    v_smfmac_f32_32x32x32_bf16 v[128:143], a[244:247], v[72:79], v219
    s_add_u32 s90, s84, 27648
    buffer_load_dwordx4 v20, s[8:11], s90 offen lds
    v_exp_f32 v92, v92
    v_exp_f32 v93, v93
    v_exp_f32 v94, v94
    v_exp_f32 v95, v95
    v_mfma_f32_32x32x16_bf16 v[48:63], a[216:219], v[104:107], 0
    s_add_u32 m0, s82, 151552
    ds_read_b128 a[220:223], v216 offset:5120
    v_exp_f32 v32, v32
    v_exp_f32 v33, v33
    v_exp_f32 v34, v34
    v_exp_f32 v35, v35
    v_mfma_f32_32x32x8bf16_1k v[48:63], a[228:229], v[120:121], v[48:63]
    v_exp_f32 v36, v36
    v_exp_f32 v37, v37
    v_exp_f32 v38, v38
    v_exp_f32 v39, v39
    v_smfmac_f32_32x32x32_bf16 v[160:175], a[240:243], v[80:87], v219
    buffer_load_dwordx4 v224, s[8:11], s49 offen lds
    v_exp_f32 v40, v40
    v_exp_f32 v41, v41
    v_exp_f32 v42, v42
    v_exp_f32 v43, v43
    v_smfmac_f32_32x32x32_bf16 v[160:175], a[244:247], v[88:95], v219
    s_waitcnt lgkmcnt(0)
    v_exp_f32 v44, v44
    v_exp_f32 v45, v45
    v_exp_f32 v46, v46
    v_exp_f32 v47, v47
    v_mfma_f32_32x32x16_bf16 v[64:79], a[220:223], v[96:99], 0
    ds_read_b128 a[240:243], v218 offset:6400
    global_load_dword v5, v[252:253], off
    v_exp_f32 v48, v48
    v_exp_f32 v49, v49
    v_exp_f32 v50, v50
    v_exp_f32 v51, v51
    v_mfma_f32_32x32x8bf16_1k v[64:79], a[228:229], v[114:115], v[64:79]
    v_exp_f32 v52, v52
    v_exp_f32 v53, v53
    v_exp_f32 v54, v54
    v_exp_f32 v55, v55
    v_smfmac_f32_32x32x32_bf16 v[128:143], a[232:235], v[32:39], v219
    ds_read_b128 a[244:247], v218 offset:7040
    v_exp_f32 v56, v56
    v_exp_f32 v57, v57
    v_exp_f32 v58, v58
    v_exp_f32 v59, v59
    v_smfmac_f32_32x32x32_bf16 v[128:143], a[236:239], v[40:47], v219
    v_exp_f32 v60, v60
    v_exp_f32 v61, v61
    v_exp_f32 v62, v62
    v_exp_f32 v63, v63
    v_mfma_f32_32x32x16_bf16 v[80:95], a[220:223], v[104:107], 0
    ds_read_b128 a[216:219], v216 offset:6144
    v_exp_f32 v64, v64
    v_exp_f32 v65, v65
    v_exp_f32 v66, v66
    v_exp_f32 v67, v67
    v_mfma_f32_32x32x8bf16_1k v[80:95], a[228:229], v[122:123], v[80:95]
    v_exp_f32 v68, v68
    v_exp_f32 v69, v69
    v_exp_f32 v70, v70
    v_exp_f32 v71, v71
    v_smfmac_f32_32x32x32_bf16 v[160:175], a[232:235], v[48:55], v219
    v_exp_f32 v72, v72
    v_exp_f32 v73, v73
    v_exp_f32 v74, v74
    v_exp_f32 v75, v75
    v_smfmac_f32_32x32x32_bf16 v[160:175], a[236:239], v[56:63], v219
    s_waitcnt lgkmcnt(0)
    buffer_load_dword v26, v211, s[24:27], s95 offen sc1
    v_exp_f32 v76, v76
    v_exp_f32 v77, v77
    v_exp_f32 v78, v78
    v_exp_f32 v79, v79
    v_mfma_f32_32x32x16_bf16 v[32:47], a[216:219], v[96:99], 0
    ds_read_b128 a[232:235], v218 offset:7680
    v_exp_f32 v80, v80
    v_exp_f32 v81, v81
    v_exp_f32 v82, v82
    v_exp_f32 v83, v83
    v_mfma_f32_32x32x8bf16_1k v[32:47], a[230:231], v[112:113], v[32:47]
    v_exp_f32 v84, v84
    v_exp_f32 v85, v85
    v_exp_f32 v86, v86
    v_exp_f32 v87, v87
    v_smfmac_f32_32x32x32_bf16 v[128:143], a[240:243], v[64:71], v219
    ds_read_b128 a[236:239], v218 offset:8320
    v_exp_f32 v88, v88
    v_exp_f32 v89, v89
    v_exp_f32 v90, v90
    v_exp_f32 v91, v91
    v_smfmac_f32_32x32x32_bf16 v[128:143], a[244:247], v[72:79], v219
    v_exp_f32 v92, v92
    v_exp_f32 v93, v93
    v_exp_f32 v94, v94
    v_exp_f32 v95, v95
    v_mfma_f32_32x32x16_bf16 v[48:63], a[216:219], v[104:107], 0
    ds_read_b128 a[220:223], v216 offset:7168
    v_exp_f32 v32, v32
    v_exp_f32 v33, v33
    v_exp_f32 v34, v34
    v_exp_f32 v35, v35
    v_mfma_f32_32x32x8bf16_1k v[48:63], a[230:231], v[120:121], v[48:63]
    v_exp_f32 v36, v36
    v_exp_f32 v37, v37
    v_exp_f32 v38, v38
    v_exp_f32 v39, v39
    v_smfmac_f32_32x32x32_bf16 v[160:175], a[240:243], v[80:87], v219
    v_exp_f32 v40, v40
    v_exp_f32 v41, v41
    v_exp_f32 v42, v42
    v_exp_f32 v43, v43
    v_smfmac_f32_32x32x32_bf16 v[160:175], a[244:247], v[88:95], v219
    s_waitcnt lgkmcnt(0)
    v_exp_f32 v44, v44
    v_exp_f32 v45, v45
    v_exp_f32 v46, v46
    v_exp_f32 v47, v47
    v_mfma_f32_32x32x16_bf16 v[64:79], a[220:223], v[96:99], 0
    ds_read_b128 a[240:243], v218 offset:8960
    v_exp_f32 v48, v48
    v_exp_f32 v49, v49
    v_exp_f32 v50, v50
    v_exp_f32 v51, v51
    v_mfma_f32_32x32x8bf16_1k v[64:79], a[230:231], v[114:115], v[64:79]
    v_exp_f32 v52, v52
    v_exp_f32 v53, v53
    v_exp_f32 v54, v54
    v_exp_f32 v55, v55
    v_smfmac_f32_32x32x32_bf16 v[128:143], a[232:235], v[32:39], v219
    ds_read_b128 a[244:247], v218 offset:9600
    v_exp_f32 v56, v56
    v_exp_f32 v57, v57
    v_exp_f32 v58, v58
    v_exp_f32 v59, v59
    v_smfmac_f32_32x32x32_bf16 v[128:143], a[236:239], v[40:47], v219
    v_exp_f32 v60, v60
    v_exp_f32 v61, v61
    v_exp_f32 v62, v62
    v_exp_f32 v63, v63
    v_mfma_f32_32x32x16_bf16 v[80:95], a[220:223], v[104:107], 0
    s_waitcnt vmcnt(15)
    s_barrier
    ds_read_b128 a[216:219], v216 offset:20480
    ds_read_b128 a[224:227], v217 offset:20480
    v_exp_f32 v64, v64
    v_exp_f32 v65, v65
    v_exp_f32 v66, v66
    v_exp_f32 v67, v67
    v_mfma_f32_32x32x8bf16_1k v[80:95], a[230:231], v[122:123], v[80:95]
    v_exp_f32 v68, v68
    v_exp_f32 v69, v69
    v_exp_f32 v70, v70
    v_exp_f32 v71, v71
    v_smfmac_f32_32x32x32_bf16 v[160:175], a[232:235], v[48:55], v219
    v_exp_f32 v72, v72
    v_exp_f32 v73, v73
    v_exp_f32 v74, v74
    v_exp_f32 v75, v75
    v_smfmac_f32_32x32x32_bf16 v[160:175], a[236:239], v[56:63], v219
    s_waitcnt lgkmcnt(0)
    v_exp_f32 v76, v76
    v_exp_f32 v77, v77
    v_exp_f32 v78, v78
    v_exp_f32 v79, v79
    v_mfma_f32_32x32x16_bf16 v[32:47], a[216:219], v[96:99], 0
    ds_read_b128 a[232:235], v218 offset:20480
    v_exp_f32 v80, v80
    v_exp_f32 v81, v81
    v_exp_f32 v82, v82
    v_exp_f32 v83, v83
    v_mfma_f32_32x32x8bf16_1k v[32:47], a[224:225], v[112:113], v[32:47]
    v_exp_f32 v84, v84
    v_exp_f32 v85, v85
    v_exp_f32 v86, v86
    v_exp_f32 v87, v87
    v_smfmac_f32_32x32x32_bf16 v[128:143], a[240:243], v[64:71], v219
    ds_read_b128 a[236:239], v218 offset:21120
    v_exp_f32 v88, v88
    v_exp_f32 v89, v89
    v_exp_f32 v90, v90
    v_exp_f32 v91, v91
    v_smfmac_f32_32x32x32_bf16 v[128:143], a[244:247], v[72:79], v219
    v_exp_f32 v92, v92
    v_exp_f32 v93, v93
    v_exp_f32 v94, v94
    v_exp_f32 v95, v95
    v_mfma_f32_32x32x16_bf16 v[48:63], a[216:219], v[104:107], 0
    ds_read_b128 a[220:223], v216 offset:21504
    v_exp_f32 v32, v32
    v_exp_f32 v33, v33
    v_exp_f32 v34, v34
    v_exp_f32 v35, v35
    v_mfma_f32_32x32x8bf16_1k v[48:63], a[224:225], v[120:121], v[48:63]
    v_exp_f32 v36, v36
    v_exp_f32 v37, v37
    v_exp_f32 v38, v38
    v_exp_f32 v39, v39
    v_smfmac_f32_32x32x32_bf16 v[160:175], a[240:243], v[80:87], v219
    v_exp_f32 v40, v40
    v_exp_f32 v41, v41
    v_exp_f32 v42, v42
    v_exp_f32 v43, v43
    v_smfmac_f32_32x32x32_bf16 v[160:175], a[244:247], v[88:95], v219
    s_waitcnt vmcnt(0)
    s_waitcnt lgkmcnt(0)
    v_cmp_ne_u32 vcc, 0, v26
    v_exp_f32 v44, v44
    v_exp_f32 v45, v45
    v_exp_f32 v46, v46
    v_exp_f32 v47, v47
    v_mfma_f32_32x32x16_bf16 v[64:79], a[220:223], v[96:99], 0
    s_lshr_b32 s60, vcc_lo, 8
    ds_read_b128 a[240:243], v218 offset:21760
    v_exp_f32 v48, v48
    v_exp_f32 v49, v49
    v_exp_f32 v50, v50
    v_exp_f32 v51, v51
    v_mfma_f32_32x32x8bf16_1k v[64:79], a[224:225], v[114:115], v[64:79]
    v_exp_f32 v52, v52
    v_exp_f32 v53, v53
    v_exp_f32 v54, v54
    v_exp_f32 v55, v55
    v_smfmac_f32_32x32x32_bf16 v[128:143], a[232:235], v[32:39], v219
    s_and_b32 s60, s60, s61
    ds_read_b128 a[244:247], v218 offset:22400
    v_exp_f32 v56, v56
    v_exp_f32 v57, v57
    v_exp_f32 v58, v58
    v_exp_f32 v59, v59
    v_smfmac_f32_32x32x32_bf16 v[128:143], a[236:239], v[40:47], v219
    s_ff1_i32_b32 s91, s60
    v_exp_f32 v60, v60
    v_exp_f32 v61, v61
    v_exp_f32 v62, v62
    v_exp_f32 v63, v63
    v_mfma_f32_32x32x16_bf16 v[80:95], a[220:223], v[104:107], 0
    s_bitset0_b32 s60, s91
    ds_read_b128 a[216:219], v216 offset:22528
    v_exp_f32 v64, v64
    v_exp_f32 v65, v65
    v_exp_f32 v66, v66
    v_exp_f32 v67, v67
    v_mfma_f32_32x32x8bf16_1k v[80:95], a[224:225], v[122:123], v[80:95]
    v_exp_f32 v68, v68
    v_exp_f32 v69, v69
    v_exp_f32 v70, v70
    v_exp_f32 v71, v71
    v_smfmac_f32_32x32x32_bf16 v[160:175], a[232:235], v[48:55], v219
    s_bitset0_b32 s61, s91
    v_exp_f32 v72, v72
    v_exp_f32 v73, v73
    v_exp_f32 v74, v74
    v_exp_f32 v75, v75
    v_smfmac_f32_32x32x32_bf16 v[160:175], a[236:239], v[56:63], v219
    s_mul_i32 s90, s91, 147456
    s_waitcnt lgkmcnt(0)
    v_exp_f32 v76, v76
    v_exp_f32 v77, v77
    v_exp_f32 v78, v78
    v_exp_f32 v79, v79
    v_mfma_f32_32x32x16_bf16 v[32:47], a[216:219], v[96:99], 0
    s_add_u32 s90, s90, s50
    ds_read_b128 a[232:235], v218 offset:23040
    v_exp_f32 v80, v80
    v_exp_f32 v81, v81
    v_exp_f32 v82, v82
    v_exp_f32 v83, v83
    v_mfma_f32_32x32x8bf16_1k v[32:47], a[226:227], v[112:113], v[32:47]
    v_exp_f32 v84, v84
    v_exp_f32 v85, v85
    v_exp_f32 v86, v86
    v_exp_f32 v87, v87
    v_smfmac_f32_32x32x32_bf16 v[128:143], a[240:243], v[64:71], v219
    s_cmp_lt_i32 s91, 0
    ds_read_b128 a[236:239], v218 offset:23680
    v_exp_f32 v88, v88
    v_exp_f32 v89, v89
    v_exp_f32 v90, v90
    v_exp_f32 v91, v91
    v_smfmac_f32_32x32x32_bf16 v[128:143], a[244:247], v[72:79], v219
    s_cselect_b32 s83, 1073741824, s90
    buffer_load_dwordx4 a[40:43], v6, s[24:27], s83 offen offset:0 sc1
    v_exp_f32 v92, v92
    v_exp_f32 v93, v93
    v_exp_f32 v94, v94
    v_exp_f32 v95, v95
    v_mfma_f32_32x32x16_bf16 v[48:63], a[216:219], v[104:107], 0
    s_ff1_i32_b32 s91, s60
    ds_read_b128 a[220:223], v216 offset:23552
    v_exp_f32 v32, v32
    v_exp_f32 v33, v33
    v_exp_f32 v34, v34
    v_exp_f32 v35, v35
    v_mfma_f32_32x32x8bf16_1k v[48:63], a[226:227], v[120:121], v[48:63]
    v_exp_f32 v36, v36
    v_exp_f32 v37, v37
    v_exp_f32 v38, v38
    v_exp_f32 v39, v39
    v_smfmac_f32_32x32x32_bf16 v[160:175], a[240:243], v[80:87], v219
    s_bitset0_b32 s60, s91
    buffer_load_dwordx4 a[44:47], v6, s[24:27], s83 offen offset:1024 sc1
    v_exp_f32 v40, v40
    v_exp_f32 v41, v41
    v_exp_f32 v42, v42
    v_exp_f32 v43, v43
    v_smfmac_f32_32x32x32_bf16 v[160:175], a[244:247], v[88:95], v219
    s_bitset0_b32 s61, s91
    s_waitcnt lgkmcnt(0)
    v_exp_f32 v44, v44
    v_exp_f32 v45, v45
    v_exp_f32 v46, v46
    v_exp_f32 v47, v47
    v_mfma_f32_32x32x16_bf16 v[64:79], a[220:223], v[96:99], 0
    s_mul_i32 s90, s91, 147456
    ds_read_b128 a[240:243], v218 offset:24320
    buffer_load_dwordx4 a[48:51], v6, s[24:27], s83 offen offset:2048 sc1
    v_exp_f32 v48, v48
    v_exp_f32 v49, v49
    v_exp_f32 v50, v50
    v_exp_f32 v51, v51
    v_mfma_f32_32x32x8bf16_1k v[64:79], a[226:227], v[114:115], v[64:79]
    v_exp_f32 v52, v52
    v_exp_f32 v53, v53
    v_exp_f32 v54, v54
    v_exp_f32 v55, v55
    v_smfmac_f32_32x32x32_bf16 v[128:143], a[232:235], v[32:39], v219
    s_add_u32 s90, s90, s50
    ds_read_b128 a[244:247], v218 offset:24960
    v_exp_f32 v56, v56
    v_exp_f32 v57, v57
    v_exp_f32 v58, v58
    v_exp_f32 v59, v59
    v_smfmac_f32_32x32x32_bf16 v[128:143], a[236:239], v[40:47], v219
    s_cmp_lt_i32 s91, 0
    buffer_load_dwordx4 a[52:55], v6, s[24:27], s83 offen offset:3072 sc1
    v_exp_f32 v60, v60
    v_exp_f32 v61, v61
    v_exp_f32 v62, v62
    v_exp_f32 v63, v63
    v_mfma_f32_32x32x16_bf16 v[80:95], a[220:223], v[104:107], 0
    s_cselect_b32 s83, 1073741824, s90
    ds_read_b128 a[216:219], v216 offset:24576
    ds_read_b128 a[228:231], v217 offset:21120
    v_exp_f32 v64, v64
    v_exp_f32 v65, v65
    v_exp_f32 v66, v66
    v_exp_f32 v67, v67
    v_mfma_f32_32x32x8bf16_1k v[80:95], a[226:227], v[122:123], v[80:95]
    v_exp_f32 v68, v68
    v_exp_f32 v69, v69
    v_exp_f32 v70, v70
    v_exp_f32 v71, v71
    v_smfmac_f32_32x32x32_bf16 v[160:175], a[232:235], v[48:55], v219
    buffer_load_dwordx4 a[56:59], v6, s[24:27], s83 offen offset:0 sc1
    v_exp_f32 v72, v72
    v_exp_f32 v73, v73
    v_exp_f32 v74, v74
    v_exp_f32 v75, v75
    v_smfmac_f32_32x32x32_bf16 v[160:175], a[236:239], v[56:63], v219
    s_ff1_i32_b32 s91, s60
    s_waitcnt lgkmcnt(0)
    v_exp_f32 v76, v76
    v_exp_f32 v77, v77
    v_exp_f32 v78, v78
    v_exp_f32 v79, v79
    v_mfma_f32_32x32x16_bf16 v[32:47], a[216:219], v[96:99], 0
    s_bitset0_b32 s60, s91
    ds_read_b128 a[232:235], v218 offset:25600
    buffer_load_dwordx4 a[60:63], v6, s[24:27], s83 offen offset:1024 sc1
    v_exp_f32 v80, v80
    v_exp_f32 v81, v81
    v_exp_f32 v82, v82
    v_exp_f32 v83, v83
    v_mfma_f32_32x32x8bf16_1k v[32:47], a[228:229], v[112:113], v[32:47]
    v_exp_f32 v84, v84
    v_exp_f32 v85, v85
    v_exp_f32 v86, v86
    v_exp_f32 v87, v87
    v_smfmac_f32_32x32x32_bf16 v[128:143], a[240:243], v[64:71], v219
    s_bitset0_b32 s61, s91
    ds_read_b128 a[236:239], v218 offset:26240
    v_exp_f32 v88, v88
    v_exp_f32 v89, v89
    v_exp_f32 v90, v90
    v_exp_f32 v91, v91
    v_smfmac_f32_32x32x32_bf16 v[128:143], a[244:247], v[72:79], v219
    s_mul_i32 s90, s91, 147456
    buffer_load_dwordx4 a[64:67], v6, s[24:27], s83 offen offset:2048 sc1
    v_exp_f32 v92, v92
    v_exp_f32 v93, v93
    v_exp_f32 v94, v94
    v_exp_f32 v95, v95
    v_mfma_f32_32x32x16_bf16 v[48:63], a[216:219], v[104:107], 0
    s_add_u32 s90, s90, s50
    ds_read_b128 a[220:223], v216 offset:25600
    v_exp_f32 v32, v32
    v_exp_f32 v33, v33
    v_exp_f32 v34, v34
    v_exp_f32 v35, v35
    v_mfma_f32_32x32x8bf16_1k v[48:63], a[228:229], v[120:121], v[48:63]
    v_exp_f32 v36, v36
    v_exp_f32 v37, v37
    v_exp_f32 v38, v38
    v_exp_f32 v39, v39
    v_smfmac_f32_32x32x32_bf16 v[160:175], a[240:243], v[80:87], v219
    s_cmp_lt_i32 s91, 0
    buffer_load_dwordx4 a[68:71], v6, s[24:27], s83 offen offset:3072 sc1
    v_exp_f32 v40, v40
    v_exp_f32 v41, v41
    v_exp_f32 v42, v42
    v_exp_f32 v43, v43
    v_smfmac_f32_32x32x32_bf16 v[160:175], a[244:247], v[88:95], v219
    s_cselect_b32 s83, 1073741824, s90
    s_waitcnt lgkmcnt(0)
    v_exp_f32 v44, v44
    v_exp_f32 v45, v45
    v_exp_f32 v46, v46
    v_exp_f32 v47, v47
    v_mfma_f32_32x32x16_bf16 v[64:79], a[220:223], v[96:99], 0
    ds_read_b128 a[240:243], v218 offset:26880
    buffer_load_dwordx4 a[112:115], v6, s[24:27], s83 offen offset:0 sc1
    v_exp_f32 v48, v48
    v_exp_f32 v49, v49
    v_exp_f32 v50, v50
    v_exp_f32 v51, v51
    v_mfma_f32_32x32x8bf16_1k v[64:79], a[228:229], v[114:115], v[64:79]
    v_exp_f32 v52, v52
    v_exp_f32 v53, v53
    v_exp_f32 v54, v54
    v_exp_f32 v55, v55
    v_smfmac_f32_32x32x32_bf16 v[128:143], a[232:235], v[32:39], v219
    ds_read_b128 a[244:247], v218 offset:27520
    v_exp_f32 v56, v56
    v_exp_f32 v57, v57
    v_exp_f32 v58, v58
    v_exp_f32 v59, v59
    v_smfmac_f32_32x32x32_bf16 v[128:143], a[236:239], v[40:47], v219
    buffer_load_dwordx4 a[116:119], v6, s[24:27], s83 offen offset:1024 sc1
    v_exp_f32 v60, v60
    v_exp_f32 v61, v61
    v_exp_f32 v62, v62
    v_exp_f32 v63, v63
    v_mfma_f32_32x32x16_bf16 v[80:95], a[220:223], v[104:107], 0
    ds_read_b128 a[216:219], v216 offset:26624
    v_exp_f32 v64, v64
    v_exp_f32 v65, v65
    v_exp_f32 v66, v66
    v_exp_f32 v67, v67
    v_mfma_f32_32x32x8bf16_1k v[80:95], a[228:229], v[122:123], v[80:95]
    v_exp_f32 v68, v68
    v_exp_f32 v69, v69
    v_exp_f32 v70, v70
    v_exp_f32 v71, v71
    v_smfmac_f32_32x32x32_bf16 v[160:175], a[232:235], v[48:55], v219
    buffer_load_dwordx4 a[120:123], v6, s[24:27], s83 offen offset:2048 sc1
    v_exp_f32 v72, v72
    v_exp_f32 v73, v73
    v_exp_f32 v74, v74
    v_exp_f32 v75, v75
    v_smfmac_f32_32x32x32_bf16 v[160:175], a[236:239], v[56:63], v219
    s_waitcnt lgkmcnt(0)
    v_exp_f32 v76, v76
    v_exp_f32 v77, v77
    v_exp_f32 v78, v78
    v_exp_f32 v79, v79
    v_mfma_f32_32x32x16_bf16 v[32:47], a[216:219], v[96:99], 0
    ds_read_b128 a[232:235], v218 offset:28160
    buffer_load_dwordx4 a[124:127], v6, s[24:27], s83 offen offset:3072 sc1
    v_exp_f32 v80, v80
    v_exp_f32 v81, v81
    v_exp_f32 v82, v82
    v_exp_f32 v83, v83
    v_mfma_f32_32x32x8bf16_1k v[32:47], a[230:231], v[112:113], v[32:47]
    v_exp_f32 v84, v84
    v_exp_f32 v85, v85
    v_exp_f32 v86, v86
    v_exp_f32 v87, v87
    v_smfmac_f32_32x32x32_bf16 v[128:143], a[240:243], v[64:71], v219
    ds_read_b128 a[236:239], v218 offset:28800
    v_exp_f32 v88, v88
    v_exp_f32 v89, v89
    v_exp_f32 v90, v90
    v_exp_f32 v91, v91
    v_smfmac_f32_32x32x32_bf16 v[128:143], a[244:247], v[72:79], v219
    v_exp_f32 v92, v92
    v_exp_f32 v93, v93
    v_exp_f32 v94, v94
    v_exp_f32 v95, v95
    v_mfma_f32_32x32x16_bf16 v[48:63], a[216:219], v[104:107], 0
    ds_read_b128 a[220:223], v216 offset:27648
    v_exp_f32 v32, v32
    v_exp_f32 v33, v33
    v_exp_f32 v34, v34
    v_exp_f32 v35, v35
    v_mfma_f32_32x32x8bf16_1k v[48:63], a[230:231], v[120:121], v[48:63]
    v_exp_f32 v36, v36
    v_exp_f32 v37, v37
    v_exp_f32 v38, v38
    v_exp_f32 v39, v39
    v_smfmac_f32_32x32x32_bf16 v[160:175], a[240:243], v[80:87], v219
    v_exp_f32 v40, v40
    v_exp_f32 v41, v41
    v_exp_f32 v42, v42
    v_exp_f32 v43, v43
    v_smfmac_f32_32x32x32_bf16 v[160:175], a[244:247], v[88:95], v219
    s_waitcnt lgkmcnt(0)
    v_exp_f32 v44, v44
    v_exp_f32 v45, v45
    v_exp_f32 v46, v46
    v_exp_f32 v47, v47
    v_mfma_f32_32x32x16_bf16 v[64:79], a[220:223], v[96:99], 0
    ds_read_b128 a[240:243], v218 offset:29440
    v_exp_f32 v48, v48
    v_exp_f32 v49, v49
    v_exp_f32 v50, v50
    v_exp_f32 v51, v51
    v_mfma_f32_32x32x8bf16_1k v[64:79], a[230:231], v[114:115], v[64:79]
    v_exp_f32 v52, v52
    v_exp_f32 v53, v53
    v_exp_f32 v54, v54
    v_exp_f32 v55, v55
    v_smfmac_f32_32x32x32_bf16 v[128:143], a[232:235], v[32:39], v219
    ds_read_b128 a[244:247], v218 offset:30080
    v_exp_f32 v56, v56
    v_exp_f32 v57, v57
    v_exp_f32 v58, v58
    v_exp_f32 v59, v59
    v_smfmac_f32_32x32x32_bf16 v[128:143], a[236:239], v[40:47], v219
    v_exp_f32 v60, v60
    v_exp_f32 v61, v61
    v_exp_f32 v62, v62
    v_exp_f32 v63, v63
    v_mfma_f32_32x32x16_bf16 v[80:95], a[220:223], v[104:107], 0
    ds_read_b128 a[216:219], v216 offset:0
    ds_read_b128 a[224:227], v217 offset:0
    v_exp_f32 v64, v64
    v_exp_f32 v65, v65
    v_exp_f32 v66, v66
    v_exp_f32 v67, v67
    v_mfma_f32_32x32x8bf16_1k v[80:95], a[230:231], v[122:123], v[80:95]
    v_exp_f32 v68, v68
    v_exp_f32 v69, v69
    v_exp_f32 v70, v70
    v_exp_f32 v71, v71
    v_smfmac_f32_32x32x32_bf16 v[160:175], a[232:235], v[48:55], v219
    v_exp_f32 v72, v72
    v_exp_f32 v73, v73
    v_exp_f32 v74, v74
    v_exp_f32 v75, v75
    v_smfmac_f32_32x32x32_bf16 v[160:175], a[236:239], v[56:63], v219
    s_waitcnt lgkmcnt(0)
    v_exp_f32 v76, v76
    v_exp_f32 v77, v77
    v_exp_f32 v78, v78
    v_exp_f32 v79, v79
    v_mfma_f32_32x32x16_bf16 v[32:47], a[216:219], v[100:103], 0
    ds_read_b128 a[232:235], v218 offset:0
    v_exp_f32 v80, v80
    v_exp_f32 v81, v81
    v_exp_f32 v82, v82
    v_exp_f32 v83, v83
    v_mfma_f32_32x32x8bf16_1k v[32:47], a[224:225], v[116:117], v[32:47]
    v_exp_f32 v84, v84
    v_exp_f32 v85, v85
    v_exp_f32 v86, v86
    v_exp_f32 v87, v87
    v_smfmac_f32_32x32x32_bf16 v[128:143], a[240:243], v[64:71], v219
    ds_read_b128 a[236:239], v218 offset:640
    v_exp_f32 v88, v88
    v_exp_f32 v89, v89
    v_exp_f32 v90, v90
    v_exp_f32 v91, v91
    v_smfmac_f32_32x32x32_bf16 v[128:143], a[244:247], v[72:79], v219
    v_exp_f32 v92, v92
    v_exp_f32 v93, v93
    v_exp_f32 v94, v94
    v_exp_f32 v95, v95
    v_mfma_f32_32x32x16_bf16 v[48:63], a[216:219], v[108:111], 0
    s_waitcnt vmcnt(14)
    s_barrier
    ds_read_b128 a[220:223], v216 offset:1024
    v_exp_f32 v32, v32
    v_exp_f32 v33, v33
    v_exp_f32 v34, v34
    v_exp_f32 v35, v35
    v_mfma_f32_32x32x8bf16_1k v[48:63], a[224:225], v[124:125], v[48:63]
    v_exp_f32 v36, v36
    v_exp_f32 v37, v37
    v_exp_f32 v38, v38
    v_exp_f32 v39, v39
    v_smfmac_f32_32x32x32_bf16 v[160:175], a[240:243], v[80:87], v219
    v_exp_f32 v40, v40
    v_exp_f32 v41, v41
    v_exp_f32 v42, v42
    v_exp_f32 v43, v43
    v_smfmac_f32_32x32x32_bf16 v[160:175], a[244:247], v[88:95], v219
    s_waitcnt lgkmcnt(0)
    v_exp_f32 v44, v44
    v_exp_f32 v45, v45
    v_exp_f32 v46, v46
    v_exp_f32 v47, v47
    v_mfma_f32_32x32x16_bf16 v[64:79], a[220:223], v[100:103], 0
    ds_read_b128 a[240:243], v218 offset:1280
    v_exp_f32 v48, v48
    v_exp_f32 v49, v49
    v_exp_f32 v50, v50
    v_exp_f32 v51, v51
    v_mfma_f32_32x32x8bf16_1k v[64:79], a[224:225], v[118:119], v[64:79]
    v_exp_f32 v52, v52
    v_exp_f32 v53, v53
    v_exp_f32 v54, v54
    v_exp_f32 v55, v55
    v_smfmac_f32_32x32x32_bf16 v[144:159], a[232:235], v[32:39], v219
    ds_read_b128 a[244:247], v218 offset:1920
    v_exp_f32 v56, v56
    v_exp_f32 v57, v57
    v_exp_f32 v58, v58
    v_exp_f32 v59, v59
    v_smfmac_f32_32x32x32_bf16 v[144:159], a[236:239], v[40:47], v219
    v_exp_f32 v60, v60
    v_exp_f32 v61, v61
    v_exp_f32 v62, v62
    v_exp_f32 v63, v63
    v_rcp_f32 v192, v138
    s_nop 0
    v_mul_f32 v192, 0x3eeff558, v192
    v_mul_f32 v196, v128, v192
    v_mul_f32 v197, v129, v192
    v_mul_f32 v198, v130, v192
    v_mul_f32 v199, v131, v192
    v_mul_f32 v200, v132, v192
    v_mul_f32 v201, v133, v192
    v_mul_f32 v202, v134, v192
    v_mul_f32 v203, v135, v192
    v_mul_f32 v204, v136, v192
    v_mul_f32 v205, v137, v192
    v_rcp_f32 v193, v170
    v_cvt_pk_bf16_f32 v28, v204, v205
    v_cvt_pk_bf16_f32 v140, v196, v197
    v_cvt_pk_bf16_f32 v141, v198, v199
    v_cvt_pk_bf16_f32 v142, v200, v201
    v_cvt_pk_bf16_f32 v143, v202, v203
    buffer_store_dwordx4 v[140:143], v6, s[24:27], s63 offen offset:0 sc1
    v_mul_f32 v193, 0x3eeff558, v193
    v_mul_f32 v196, v160, v193
    v_mul_f32 v197, v161, v193
    v_mul_f32 v198, v162, v193
    v_mul_f32 v199, v163, v193
    v_mul_f32 v200, v164, v193
    v_mul_f32 v201, v165, v193
    v_mul_f32 v202, v166, v193
    v_mul_f32 v203, v167, v193
    v_mul_f32 v204, v168, v193
    v_mul_f32 v205, v169, v193
    v_cvt_pk_bf16_f32 v29, v204, v205
    v_cvt_pk_bf16_f32 v172, v196, v197
    v_cvt_pk_bf16_f32 v173, v198, v199
    v_cvt_pk_bf16_f32 v174, v200, v201
    v_cvt_pk_bf16_f32 v175, v202, v203
    v_permlane16_swap_b32 v28, v29
    buffer_store_dwordx4 v[172:175], v6, s[24:27], s64 offen offset:0 sc1
    s_mov_b32 s90, 0x00800000
    s_mov_b32 s91, 0x7d800000
    v_cndmask_b32 v194, v136, v138, s[4:5]
    v_cndmask_b32 v195, v137, v138, s[4:5]
    v_min3_f32 v192, abs(v194), abs(v195), v138
    v_add_f32 v193, abs(v194), v138
    v_add_f32 v193, v193, abs(v195)
    v_min3_f32 v192, v192, abs(v128), abs(v129)
    v_add_f32 v193, v193, abs(v128)
    v_add_f32 v193, v193, abs(v129)
    v_min3_f32 v192, v192, abs(v130), abs(v131)
    v_add_f32 v193, v193, abs(v130)
    v_add_f32 v193, v193, abs(v131)
    v_min3_f32 v192, v192, abs(v132), abs(v133)
    v_add_f32 v193, v193, abs(v132)
    v_add_f32 v193, v193, abs(v133)
    v_min3_f32 v192, v192, abs(v134), abs(v135)
    v_add_f32 v193, v193, abs(v134)
    v_add_f32 v193, v193, abs(v135)
    v_cndmask_b32 v194, v168, v170, s[4:5]
    v_cndmask_b32 v195, v169, v170, s[4:5]
    v_min3_f32 v192, v192, abs(v194), abs(v195)
    v_min_f32 v192, v192, v170
    v_add_f32 v193, v193, v170
    v_add_f32 v193, v193, abs(v194)
    v_add_f32 v193, v193, abs(v195)
    v_min3_f32 v192, v192, abs(v160), abs(v161)
    v_add_f32 v193, v193, abs(v160)
    v_add_f32 v193, v193, abs(v161)
    v_min3_f32 v192, v192, abs(v162), abs(v163)
    v_add_f32 v193, v193, abs(v162)
    v_add_f32 v193, v193, abs(v163)
    v_min3_f32 v192, v192, abs(v164), abs(v165)
L_w19:
    s_cbranch_execz L_w23
    v_add_f32 v193, v193, abs(v164)
    v_add_f32 v193, v193, abs(v165)
    v_min3_f32 v192, v192, abs(v166), abs(v167)
    v_add_f32 v193, v193, abs(v166)
    v_add_f32 v193, v193, abs(v167)
    v_cmp_nle_f32 vcc, s90, v192
    v_cmp_ngt_f32 s[6:7], s91, v193
    s_nop 0
    s_or_b64 vcc, vcc, s[6:7]
    s_cselect_b32 s67, 1073741824, s67
    s_cselect_b32 s101, 0xff, s66
    v_mfma_f32_32x32x16_bf16 v[80:95], a[220:223], v[108:111], 0
    ds_read_b128 a[216:219], v216 offset:2048
    v_exp_f32 v64, v64
    v_exp_f32 v65, v65
    v_exp_f32 v66, v66
    v_exp_f32 v67, v67
    v_mfma_f32_32x32x8bf16_1k v[80:95], a[224:225], v[126:127], v[80:95]
    v_exp_f32 v68, v68
    v_exp_f32 v69, v69
    v_exp_f32 v70, v70
    v_exp_f32 v71, v71
    v_smfmac_f32_32x32x32_bf16 v[176:191], a[232:235], v[48:55], v219
    v_exp_f32 v72, v72
    v_exp_f32 v73, v73
    v_exp_f32 v74, v74
    v_exp_f32 v75, v75
    v_smfmac_f32_32x32x32_bf16 v[176:191], a[236:239], v[56:63], v219
    s_waitcnt lgkmcnt(0)
    buffer_load_dword v26, v211, s[24:27], s95 offen sc1
    v_exp_f32 v76, v76
    v_exp_f32 v77, v77
    v_exp_f32 v78, v78
    v_exp_f32 v79, v79
    v_mfma_f32_32x32x16_bf16 v[32:47], a[216:219], v[100:103], 0
    ds_read_b128 a[232:235], v218 offset:2560
    v_exp_f32 v80, v80
    v_exp_f32 v81, v81
    v_exp_f32 v82, v82
    v_exp_f32 v83, v83
    v_mfma_f32_32x32x8bf16_1k v[32:47], a[226:227], v[116:117], v[32:47]
    v_exp_f32 v84, v84
    v_exp_f32 v85, v85
    v_exp_f32 v86, v86
    v_exp_f32 v87, v87
    v_smfmac_f32_32x32x32_bf16 v[144:159], a[240:243], v[64:71], v219
    ds_read_b128 a[236:239], v218 offset:3200
    v_exp_f32 v88, v88
    v_exp_f32 v89, v89
    v_exp_f32 v90, v90
    v_exp_f32 v91, v91
    v_smfmac_f32_32x32x32_bf16 v[144:159], a[244:247], v[72:79], v219
    v_exp_f32 v92, v92
    v_exp_f32 v93, v93
    v_exp_f32 v94, v94
    v_exp_f32 v95, v95
    v_mfma_f32_32x32x16_bf16 v[48:63], a[216:219], v[108:111], 0
    ds_read_b128 a[220:223], v216 offset:3072
    v_exp_f32 v32, v32
    v_exp_f32 v33, v33
    v_exp_f32 v34, v34
    v_exp_f32 v35, v35
    v_mfma_f32_32x32x8bf16_1k v[48:63], a[226:227], v[124:125], v[48:63]
    v_exp_f32 v36, v36
    v_exp_f32 v37, v37
    v_exp_f32 v38, v38
    v_exp_f32 v39, v39
    v_smfmac_f32_32x32x32_bf16 v[176:191], a[240:243], v[80:87], v219
    v_exp_f32 v40, v40
    v_exp_f32 v41, v41
    v_exp_f32 v42, v42
    v_exp_f32 v43, v43
    v_smfmac_f32_32x32x32_bf16 v[176:191], a[244:247], v[88:95], v219
    s_waitcnt lgkmcnt(0)
    v_exp_f32 v44, v44
    v_exp_f32 v45, v45
    v_exp_f32 v46, v46
    v_exp_f32 v47, v47
    v_mfma_f32_32x32x16_bf16 v[64:79], a[220:223], v[100:103], 0
    ds_read_b128 a[240:243], v218 offset:3840
    v_exp_f32 v48, v48
    v_exp_f32 v49, v49
    v_exp_f32 v50, v50
    v_exp_f32 v51, v51
    v_mfma_f32_32x32x8bf16_1k v[64:79], a[226:227], v[118:119], v[64:79]
    v_exp_f32 v52, v52
    v_exp_f32 v53, v53
    v_exp_f32 v54, v54
    v_exp_f32 v55, v55
    v_smfmac_f32_32x32x32_bf16 v[144:159], a[232:235], v[32:39], v219
    ds_read_b128 a[244:247], v218 offset:4480
    v_exp_f32 v56, v56
    v_exp_f32 v57, v57
    v_exp_f32 v58, v58
    v_exp_f32 v59, v59
    v_smfmac_f32_32x32x32_bf16 v[144:159], a[236:239], v[40:47], v219
    v_exp_f32 v60, v60
    v_exp_f32 v61, v61
    v_exp_f32 v62, v62
    v_exp_f32 v63, v63
    v_mfma_f32_32x32x16_bf16 v[80:95], a[220:223], v[108:111], 0
    ds_read_b128 a[216:219], v216 offset:4096
    ds_read_b128 a[228:231], v217 offset:640
    v_exp_f32 v64, v64
    v_exp_f32 v65, v65
    v_exp_f32 v66, v66
    v_exp_f32 v67, v67
    v_mfma_f32_32x32x8bf16_1k v[80:95], a[226:227], v[126:127], v[80:95]
    v_exp_f32 v68, v68
    v_exp_f32 v69, v69
    v_exp_f32 v70, v70
    v_exp_f32 v71, v71
    v_smfmac_f32_32x32x32_bf16 v[176:191], a[232:235], v[48:55], v219
    v_exp_f32 v72, v72
    v_exp_f32 v73, v73
    v_exp_f32 v74, v74
    v_exp_f32 v75, v75
    v_smfmac_f32_32x32x32_bf16 v[176:191], a[236:239], v[56:63], v219
    s_waitcnt vmcnt(1)
    s_waitcnt lgkmcnt(0)
    buffer_store_dword v27, v227, s[24:27], s67 offen sc1
    v_exp_f32 v76, v76
    v_exp_f32 v77, v77
    v_exp_f32 v78, v78
    v_exp_f32 v79, v79
    v_mfma_f32_32x32x16_bf16 v[32:47], a[216:219], v[100:103], 0
    s_waitcnt vmcnt(1)
    ds_read_b128 a[232:235], v218 offset:5120
    v_cmp_ne_u32 vcc, 0, v26
    v_exp_f32 v80, v80
    v_exp_f32 v81, v81
    v_exp_f32 v82, v82
    v_exp_f32 v83, v83
    v_mfma_f32_32x32x8bf16_1k v[32:47], a[228:229], v[116:117], v[32:47]
    v_exp_f32 v84, v84
    v_exp_f32 v85, v85
    v_exp_f32 v86, v86
    v_exp_f32 v87, v87
    v_smfmac_f32_32x32x32_bf16 v[144:159], a[240:243], v[64:71], v219
    s_lshr_b32 s60, vcc_lo, 8
    ds_read_b128 a[236:239], v218 offset:5760
    v_exp_f32 v88, v88
    v_exp_f32 v89, v89
    v_exp_f32 v90, v90
    v_exp_f32 v91, v91
    v_smfmac_f32_32x32x32_bf16 v[144:159], a[244:247], v[72:79], v219
    s_and_b32 s60, s60, s61
    v_exp_f32 v92, v92
    v_exp_f32 v93, v93
    v_exp_f32 v94, v94
    v_exp_f32 v95, v95
    v_mfma_f32_32x32x16_bf16 v[48:63], a[216:219], v[108:111], 0
    s_ff1_i32_b32 s91, s60
    ds_read_b128 a[220:223], v216 offset:5120
    v_exp_f32 v32, v32
    v_exp_f32 v33, v33
    v_exp_f32 v34, v34
    v_exp_f32 v35, v35
    v_mfma_f32_32x32x8bf16_1k v[48:63], a[228:229], v[124:125], v[48:63]
    v_exp_f32 v36, v36
    v_exp_f32 v37, v37
    v_exp_f32 v38, v38
    v_exp_f32 v39, v39
    v_smfmac_f32_32x32x32_bf16 v[176:191], a[240:243], v[80:87], v219
    s_bitset0_b32 s60, s91
    v_exp_f32 v40, v40
    v_exp_f32 v41, v41
    v_exp_f32 v42, v42
    v_exp_f32 v43, v43
    v_smfmac_f32_32x32x32_bf16 v[176:191], a[244:247], v[88:95], v219
    s_bitset0_b32 s61, s91
    s_waitcnt lgkmcnt(0)
    v_exp_f32 v44, v44
    v_exp_f32 v45, v45
    v_exp_f32 v46, v46
    v_exp_f32 v47, v47
    v_mfma_f32_32x32x16_bf16 v[64:79], a[220:223], v[100:103], 0
    s_mul_i32 s90, s91, 147456
    ds_read_b128 a[240:243], v218 offset:6400
    v_exp_f32 v48, v48
    v_exp_f32 v49, v49
    v_exp_f32 v50, v50
    v_exp_f32 v51, v51
    v_mfma_f32_32x32x8bf16_1k v[64:79], a[228:229], v[118:119], v[64:79]
    v_exp_f32 v52, v52
    v_exp_f32 v53, v53
    v_exp_f32 v54, v54
    v_exp_f32 v55, v55
    v_smfmac_f32_32x32x32_bf16 v[144:159], a[232:235], v[32:39], v219
    s_add_u32 s90, s90, s50
    ds_read_b128 a[244:247], v218 offset:7040
    v_exp_f32 v56, v56
    v_exp_f32 v57, v57
    v_exp_f32 v58, v58
    v_exp_f32 v59, v59
    v_smfmac_f32_32x32x32_bf16 v[144:159], a[236:239], v[40:47], v219
    s_cmp_lt_i32 s91, 0
    v_exp_f32 v60, v60
    v_exp_f32 v61, v61
    v_exp_f32 v62, v62
    v_exp_f32 v63, v63
    v_mfma_f32_32x32x16_bf16 v[80:95], a[220:223], v[108:111], 0
    s_cselect_b32 s83, 1073741824, s90
    ds_read_b128 a[216:219], v216 offset:6144
    buffer_load_dwordx4 a[128:131], v6, s[24:27], s83 offen offset:0 sc1
    v_exp_f32 v64, v64
    v_exp_f32 v65, v65
    v_exp_f32 v66, v66
    v_exp_f32 v67, v67
    v_mfma_f32_32x32x8bf16_1k v[80:95], a[228:229], v[126:127], v[80:95]
    v_exp_f32 v68, v68
    v_exp_f32 v69, v69
    v_exp_f32 v70, v70
    v_exp_f32 v71, v71
    v_smfmac_f32_32x32x32_bf16 v[176:191], a[232:235], v[48:55], v219
    s_ff1_i32_b32 s91, s60
    v_exp_f32 v72, v72
    v_exp_f32 v73, v73
    v_exp_f32 v74, v74
    v_exp_f32 v75, v75
    v_smfmac_f32_32x32x32_bf16 v[176:191], a[236:239], v[56:63], v219
    s_bitset0_b32 s60, s91
    s_waitcnt lgkmcnt(0)
    buffer_load_dwordx4 a[132:135], v6, s[24:27], s83 offen offset:1024 sc1
    v_exp_f32 v76, v76
    v_exp_f32 v77, v77
    v_exp_f32 v78, v78
    v_exp_f32 v79, v79
    v_mfma_f32_32x32x16_bf16 v[32:47], a[216:219], v[100:103], 0
    s_bitset0_b32 s61, s91
    ds_read_b128 a[232:235], v218 offset:7680
    buffer_load_dword v26, v211, s[24:27], s95 offen sc1
    v_exp_f32 v80, v80
    v_exp_f32 v81, v81
    v_exp_f32 v82, v82
    v_exp_f32 v83, v83
    v_mfma_f32_32x32x8bf16_1k v[32:47], a[230:231], v[116:117], v[32:47]
    v_exp_f32 v84, v84
    v_exp_f32 v85, v85
    v_exp_f32 v86, v86
    v_exp_f32 v87, v87
    v_smfmac_f32_32x32x32_bf16 v[144:159], a[240:243], v[64:71], v219
    s_mul_i32 s90, s91, 147456
    ds_read_b128 a[236:239], v218 offset:8320
    buffer_load_dwordx4 a[136:139], v6, s[24:27], s83 offen offset:2048 sc1
    v_exp_f32 v88, v88
    v_exp_f32 v89, v89
    v_exp_f32 v90, v90
    v_exp_f32 v91, v91
    v_smfmac_f32_32x32x32_bf16 v[144:159], a[244:247], v[72:79], v219
    s_add_u32 s90, s90, s50
    v_exp_f32 v92, v92
    v_exp_f32 v93, v93
    v_exp_f32 v94, v94
    v_exp_f32 v95, v95
    v_mfma_f32_32x32x16_bf16 v[48:63], a[216:219], v[108:111], 0
    s_cmp_lt_i32 s91, 0
    ds_read_b128 a[220:223], v216 offset:7168
    buffer_load_dwordx4 a[140:143], v6, s[24:27], s83 offen offset:3072 sc1
    v_exp_f32 v32, v32
    v_exp_f32 v33, v33
    v_exp_f32 v34, v34
    v_exp_f32 v35, v35
    v_mfma_f32_32x32x8bf16_1k v[48:63], a[230:231], v[124:125], v[48:63]
    v_exp_f32 v36, v36
    v_exp_f32 v37, v37
    v_exp_f32 v38, v38
    v_exp_f32 v39, v39
    v_smfmac_f32_32x32x32_bf16 v[176:191], a[240:243], v[80:87], v219
    s_cselect_b32 s83, 1073741824, s90
    v_exp_f32 v40, v40
    v_exp_f32 v41, v41
    v_exp_f32 v42, v42
    v_exp_f32 v43, v43
    v_smfmac_f32_32x32x32_bf16 v[176:191], a[244:247], v[88:95], v219
    s_waitcnt lgkmcnt(0)
    buffer_load_dwordx4 a[200:203], v6, s[24:27], s83 offen offset:0 sc1
    v_exp_f32 v44, v44
    v_exp_f32 v45, v45
    v_exp_f32 v46, v46
    v_exp_f32 v47, v47
    v_mfma_f32_32x32x16_bf16 v[64:79], a[220:223], v[100:103], 0
    ds_read_b128 a[240:243], v218 offset:8960
    v_exp_f32 v48, v48
    v_exp_f32 v49, v49
    v_exp_f32 v50, v50
    v_exp_f32 v51, v51
    v_mfma_f32_32x32x8bf16_1k v[64:79], a[230:231], v[118:119], v[64:79]
    v_exp_f32 v52, v52
    v_exp_f32 v53, v53
    v_exp_f32 v54, v54
    v_exp_f32 v55, v55
    v_smfmac_f32_32x32x32_bf16 v[144:159], a[232:235], v[32:39], v219
    ds_read_b128 a[244:247], v218 offset:9600
    buffer_load_dwordx4 a[204:207], v6, s[24:27], s83 offen offset:1024 sc1
    v_exp_f32 v56, v56
    v_exp_f32 v57, v57
    v_exp_f32 v58, v58
    v_exp_f32 v59, v59
    v_smfmac_f32_32x32x32_bf16 v[144:159], a[236:239], v[40:47], v219
    v_exp_f32 v60, v60
    v_exp_f32 v61, v61
    v_exp_f32 v62, v62
    v_exp_f32 v63, v63
    v_mfma_f32_32x32x16_bf16 v[80:95], a[220:223], v[108:111], 0
    ds_read_b128 a[216:219], v216 offset:20480
    ds_read_b128 a[224:227], v217 offset:20480
    buffer_load_dwordx4 a[208:211], v6, s[24:27], s83 offen offset:2048 sc1
    v_exp_f32 v64, v64
    v_exp_f32 v65, v65
    v_exp_f32 v66, v66
    v_exp_f32 v67, v67
    v_mfma_f32_32x32x8bf16_1k v[80:95], a[230:231], v[126:127], v[80:95]
    v_exp_f32 v68, v68
    v_exp_f32 v69, v69
    v_exp_f32 v70, v70
    v_exp_f32 v71, v71
    v_smfmac_f32_32x32x32_bf16 v[176:191], a[232:235], v[48:55], v219
    v_exp_f32 v72, v72
    v_exp_f32 v73, v73
    v_exp_f32 v74, v74
    v_exp_f32 v75, v75
    v_smfmac_f32_32x32x32_bf16 v[176:191], a[236:239], v[56:63], v219
    s_waitcnt lgkmcnt(0)
    buffer_load_dwordx4 a[212:215], v6, s[24:27], s83 offen offset:3072 sc1
    v_exp_f32 v76, v76
    v_exp_f32 v77, v77
    v_exp_f32 v78, v78
    v_exp_f32 v79, v79
    v_mfma_f32_32x32x16_bf16 v[32:47], a[216:219], v[100:103], 0
    ds_read_b128 a[232:235], v218 offset:20480
    v_exp_f32 v80, v80
    v_exp_f32 v81, v81
    v_exp_f32 v82, v82
    v_exp_f32 v83, v83
    v_mfma_f32_32x32x8bf16_1k v[32:47], a[224:225], v[116:117], v[32:47]
    v_exp_f32 v84, v84
    v_exp_f32 v85, v85
    v_exp_f32 v86, v86
    v_exp_f32 v87, v87
    v_smfmac_f32_32x32x32_bf16 v[144:159], a[240:243], v[64:71], v219
    ds_read_b128 a[236:239], v218 offset:21120
    v_exp_f32 v88, v88
    v_exp_f32 v89, v89
    v_exp_f32 v90, v90
    v_exp_f32 v91, v91
    v_smfmac_f32_32x32x32_bf16 v[144:159], a[244:247], v[72:79], v219
    v_exp_f32 v92, v92
    v_exp_f32 v93, v93
    v_exp_f32 v94, v94
    v_exp_f32 v95, v95
    v_mfma_f32_32x32x16_bf16 v[48:63], a[216:219], v[108:111], 0
    ds_read_b128 a[220:223], v216 offset:21504
    v_exp_f32 v32, v32
    v_exp_f32 v33, v33
    v_exp_f32 v34, v34
    v_exp_f32 v35, v35
    v_mfma_f32_32x32x8bf16_1k v[48:63], a[224:225], v[124:125], v[48:63]
    v_exp_f32 v36, v36
    v_exp_f32 v37, v37
    v_exp_f32 v38, v38
    v_exp_f32 v39, v39
    v_smfmac_f32_32x32x32_bf16 v[176:191], a[240:243], v[80:87], v219
    v_exp_f32 v40, v40
    v_exp_f32 v41, v41
    v_exp_f32 v42, v42
    v_exp_f32 v43, v43
    v_smfmac_f32_32x32x32_bf16 v[176:191], a[244:247], v[88:95], v219
    s_waitcnt vmcnt(6)
    s_waitcnt lgkmcnt(0)
    v_cmp_ne_u32 vcc, 0, v26
    v_exp_f32 v44, v44
    v_exp_f32 v45, v45
    v_exp_f32 v46, v46
    v_exp_f32 v47, v47
    v_mfma_f32_32x32x16_bf16 v[64:79], a[220:223], v[100:103], 0
    s_lshr_b32 s90, vcc_lo, 24
    ds_read_b128 a[240:243], v218 offset:21760
    v_exp_f32 v48, v48
    v_exp_f32 v49, v49
    v_exp_f32 v50, v50
    v_exp_f32 v51, v51
    v_mfma_f32_32x32x8bf16_1k v[64:79], a[224:225], v[118:119], v[64:79]
    v_exp_f32 v52, v52
    v_exp_f32 v53, v53
    v_exp_f32 v54, v54
    v_exp_f32 v55, v55
    v_smfmac_f32_32x32x32_bf16 v[144:159], a[232:235], v[32:39], v219
    s_andn2_b32 s100, s101, s90
    ds_read_b128 a[244:247], v218 offset:22400
    v_exp_f32 v56, v56
    v_exp_f32 v57, v57
    v_exp_f32 v58, v58
    v_exp_f32 v59, v59
    v_smfmac_f32_32x32x32_bf16 v[144:159], a[236:239], v[40:47], v219
    s_lshr_b32 s60, vcc_lo, 8
    v_exp_f32 v60, v60
    v_exp_f32 v61, v61
    v_exp_f32 v62, v62
    v_exp_f32 v63, v63
    v_mfma_f32_32x32x16_bf16 v[80:95], a[220:223], v[108:111], 0
    s_and_b32 s60, s60, s61
    ds_read_b128 a[216:219], v216 offset:22528
    v_exp_f32 v64, v64
    v_exp_f32 v65, v65
    v_exp_f32 v66, v66
    v_exp_f32 v67, v67
    v_mfma_f32_32x32x8bf16_1k v[80:95], a[224:225], v[126:127], v[80:95]
    v_exp_f32 v68, v68
    v_exp_f32 v69, v69
    v_exp_f32 v70, v70
    v_exp_f32 v71, v71
    v_smfmac_f32_32x32x32_bf16 v[176:191], a[232:235], v[48:55], v219
    s_add_u32 s90, s71, 0
    v_exp_f32 v72, v72
    v_exp_f32 v73, v73
    v_exp_f32 v74, v74
    v_exp_f32 v75, v75
    v_smfmac_f32_32x32x32_bf16 v[176:191], a[236:239], v[56:63], v219
    s_bitcmp1_b32 s100, 0
    s_waitcnt lgkmcnt(0)
    v_exp_f32 v76, v76
    v_exp_f32 v77, v77
    v_exp_f32 v78, v78
    v_exp_f32 v79, v79
    v_mfma_f32_32x32x16_bf16 v[32:47], a[216:219], v[100:103], 0
    s_cselect_b32 s86, 1073741824, s90
    ds_read_b128 a[232:235], v218 offset:23040
    buffer_load_dwordx4 a[0:3], v6, s[24:27], s86 offen offset:0 sc1
    v_exp_f32 v80, v80
    v_exp_f32 v81, v81
    v_exp_f32 v82, v82
    v_exp_f32 v83, v83
    v_mfma_f32_32x32x8bf16_1k v[32:47], a[226:227], v[116:117], v[32:47]
    v_exp_f32 v84, v84
    v_exp_f32 v85, v85
    v_exp_f32 v86, v86
    v_exp_f32 v87, v87
    v_smfmac_f32_32x32x32_bf16 v[144:159], a[240:243], v[64:71], v219
    s_add_u32 s90, s71, 2048
    ds_read_b128 a[236:239], v218 offset:23680
    buffer_load_dwordx4 a[72:75], v212, s[24:27], s86 offen offset:0 sc1
    v_exp_f32 v88, v88
    v_exp_f32 v89, v89
    v_exp_f32 v90, v90
    v_exp_f32 v91, v91
    v_smfmac_f32_32x32x32_bf16 v[144:159], a[244:247], v[72:79], v219
    s_bitcmp1_b32 s100, 1
    v_exp_f32 v92, v92
    v_exp_f32 v93, v93
    v_exp_f32 v94, v94
    v_exp_f32 v95, v95
    v_mfma_f32_32x32x16_bf16 v[48:63], a[216:219], v[108:111], 0
    s_cselect_b32 s86, 1073741824, s90
    ds_read_b128 a[220:223], v216 offset:23552
    buffer_load_dwordx4 a[4:7], v6, s[24:27], s86 offen offset:0 sc1
    v_exp_f32 v32, v32
    v_exp_f32 v33, v33
    v_exp_f32 v34, v34
    v_exp_f32 v35, v35
    v_mfma_f32_32x32x8bf16_1k v[48:63], a[226:227], v[124:125], v[48:63]
    v_exp_f32 v36, v36
    v_exp_f32 v37, v37
    v_exp_f32 v38, v38
    v_exp_f32 v39, v39
    v_smfmac_f32_32x32x32_bf16 v[176:191], a[240:243], v[80:87], v219
    s_add_u32 s90, s71, 4096
    buffer_load_dwordx4 a[76:79], v212, s[24:27], s86 offen offset:0 sc1
    v_exp_f32 v40, v40
    v_exp_f32 v41, v41
    v_exp_f32 v42, v42
    v_exp_f32 v43, v43
    v_smfmac_f32_32x32x32_bf16 v[176:191], a[244:247], v[88:95], v219
    s_bitcmp1_b32 s100, 2
    s_waitcnt lgkmcnt(0)
    v_exp_f32 v44, v44
    v_exp_f32 v45, v45
    v_exp_f32 v46, v46
    v_exp_f32 v47, v47
    v_mfma_f32_32x32x16_bf16 v[64:79], a[220:223], v[100:103], 0
    s_cselect_b32 s86, 1073741824, s90
    ds_read_b128 a[240:243], v218 offset:24320
    buffer_load_dwordx4 a[8:11], v6, s[24:27], s86 offen offset:0 sc1
    v_exp_f32 v48, v48
    v_exp_f32 v49, v49
    v_exp_f32 v50, v50
    v_exp_f32 v51, v51
    v_mfma_f32_32x32x8bf16_1k v[64:79], a[226:227], v[118:119], v[64:79]
    v_exp_f32 v52, v52
    v_exp_f32 v53, v53
    v_exp_f32 v54, v54
    v_exp_f32 v55, v55
    v_smfmac_f32_32x32x32_bf16 v[144:159], a[232:235], v[32:39], v219
    s_add_u32 s90, s71, 6144
    ds_read_b128 a[244:247], v218 offset:24960
    buffer_load_dwordx4 a[80:83], v212, s[24:27], s86 offen offset:0 sc1
    v_exp_f32 v56, v56
    v_exp_f32 v57, v57
    v_exp_f32 v58, v58
    v_exp_f32 v59, v59
    v_smfmac_f32_32x32x32_bf16 v[144:159], a[236:239], v[40:47], v219
    s_bitcmp1_b32 s100, 3
    v_exp_f32 v60, v60
    v_exp_f32 v61, v61
    v_exp_f32 v62, v62
    v_exp_f32 v63, v63
    v_mfma_f32_32x32x16_bf16 v[80:95], a[220:223], v[108:111], 0
    s_cselect_b32 s86, 1073741824, s90
    ds_read_b128 a[216:219], v216 offset:24576
    ds_read_b128 a[228:231], v217 offset:21120
    buffer_load_dwordx4 a[12:15], v6, s[24:27], s86 offen offset:0 sc1
    v_exp_f32 v64, v64
    v_exp_f32 v65, v65
    v_exp_f32 v66, v66
    v_exp_f32 v67, v67
    v_mfma_f32_32x32x8bf16_1k v[80:95], a[226:227], v[126:127], v[80:95]
    v_exp_f32 v68, v68
    v_exp_f32 v69, v69
    v_exp_f32 v70, v70
    v_exp_f32 v71, v71
    v_smfmac_f32_32x32x32_bf16 v[176:191], a[232:235], v[48:55], v219
    s_add_u32 s90, s71, 8192
    buffer_load_dwordx4 a[84:87], v212, s[24:27], s86 offen offset:0 sc1
    v_exp_f32 v72, v72
    v_exp_f32 v73, v73
    v_exp_f32 v74, v74
    v_exp_f32 v75, v75
    v_smfmac_f32_32x32x32_bf16 v[176:191], a[236:239], v[56:63], v219
    s_bitcmp1_b32 s100, 4
    s_waitcnt lgkmcnt(0)
    v_exp_f32 v76, v76
    v_exp_f32 v77, v77
    v_exp_f32 v78, v78
    v_exp_f32 v79, v79
    v_mfma_f32_32x32x16_bf16 v[32:47], a[216:219], v[100:103], 0
    s_cselect_b32 s86, 1073741824, s90
    ds_read_b128 a[232:235], v218 offset:25600
    buffer_load_dwordx4 a[16:19], v6, s[24:27], s86 offen offset:0 sc1
    v_exp_f32 v80, v80
    v_exp_f32 v81, v81
    v_exp_f32 v82, v82
    v_exp_f32 v83, v83
    v_mfma_f32_32x32x8bf16_1k v[32:47], a[228:229], v[116:117], v[32:47]
    v_exp_f32 v84, v84
    v_exp_f32 v85, v85
    v_exp_f32 v86, v86
    v_exp_f32 v87, v87
    v_smfmac_f32_32x32x32_bf16 v[144:159], a[240:243], v[64:71], v219
    s_add_u32 s90, s71, 10240
    ds_read_b128 a[236:239], v218 offset:26240
    buffer_load_dwordx4 a[88:91], v212, s[24:27], s86 offen offset:0 sc1
    v_exp_f32 v88, v88
    v_exp_f32 v89, v89
    v_exp_f32 v90, v90
    v_exp_f32 v91, v91
    v_smfmac_f32_32x32x32_bf16 v[144:159], a[244:247], v[72:79], v219
    s_bitcmp1_b32 s100, 5
    v_exp_f32 v92, v92
    v_exp_f32 v93, v93
    v_exp_f32 v94, v94
    v_exp_f32 v95, v95
    v_mfma_f32_32x32x16_bf16 v[48:63], a[216:219], v[108:111], 0
    s_cselect_b32 s86, 1073741824, s90
    ds_read_b128 a[220:223], v216 offset:25600
    buffer_load_dwordx4 a[20:23], v6, s[24:27], s86 offen offset:0 sc1
    v_exp_f32 v32, v32
    v_exp_f32 v33, v33
    v_exp_f32 v34, v34
    v_exp_f32 v35, v35
    v_mfma_f32_32x32x8bf16_1k v[48:63], a[228:229], v[124:125], v[48:63]
    v_exp_f32 v36, v36
    v_exp_f32 v37, v37
    v_exp_f32 v38, v38
    v_exp_f32 v39, v39
    v_smfmac_f32_32x32x32_bf16 v[176:191], a[240:243], v[80:87], v219
    s_add_u32 s90, s71, 12288
    buffer_load_dwordx4 a[92:95], v212, s[24:27], s86 offen offset:0 sc1
    v_exp_f32 v40, v40
    v_exp_f32 v41, v41
    v_exp_f32 v42, v42
    v_exp_f32 v43, v43
    v_smfmac_f32_32x32x32_bf16 v[176:191], a[244:247], v[88:95], v219
    s_bitcmp1_b32 s100, 6
    s_waitcnt lgkmcnt(0)
    v_exp_f32 v44, v44
    v_exp_f32 v45, v45
    v_exp_f32 v46, v46
    v_exp_f32 v47, v47
    v_mfma_f32_32x32x16_bf16 v[64:79], a[220:223], v[100:103], 0
    s_cselect_b32 s86, 1073741824, s90
    ds_read_b128 a[240:243], v218 offset:26880
    buffer_load_dwordx4 a[24:27], v6, s[24:27], s86 offen offset:0 sc1
    v_exp_f32 v48, v48
    v_exp_f32 v49, v49
    v_exp_f32 v50, v50
    v_exp_f32 v51, v51
    v_mfma_f32_32x32x8bf16_1k v[64:79], a[228:229], v[118:119], v[64:79]
    v_exp_f32 v52, v52
    v_exp_f32 v53, v53
    v_exp_f32 v54, v54
    v_exp_f32 v55, v55
    v_smfmac_f32_32x32x32_bf16 v[144:159], a[232:235], v[32:39], v219
    s_add_u32 s90, s71, 14336
    ds_read_b128 a[244:247], v218 offset:27520
    buffer_load_dwordx4 a[96:99], v212, s[24:27], s86 offen offset:0 sc1
    v_exp_f32 v56, v56
    v_exp_f32 v57, v57
    v_exp_f32 v58, v58
    v_exp_f32 v59, v59
    v_smfmac_f32_32x32x32_bf16 v[144:159], a[236:239], v[40:47], v219
    s_bitcmp1_b32 s100, 7
    v_exp_f32 v60, v60
    v_exp_f32 v61, v61
    v_exp_f32 v62, v62
    v_exp_f32 v63, v63
    v_mfma_f32_32x32x16_bf16 v[80:95], a[220:223], v[108:111], 0
    s_cselect_b32 s86, 1073741824, s90
    ds_read_b128 a[216:219], v216 offset:26624
    buffer_load_dwordx4 a[28:31], v6, s[24:27], s86 offen offset:0 sc1
    v_exp_f32 v64, v64
    v_exp_f32 v65, v65
    v_exp_f32 v66, v66
    v_exp_f32 v67, v67
    v_mfma_f32_32x32x8bf16_1k v[80:95], a[228:229], v[126:127], v[80:95]
    v_exp_f32 v68, v68
    v_exp_f32 v69, v69
    v_exp_f32 v70, v70
    v_exp_f32 v71, v71
    v_smfmac_f32_32x32x32_bf16 v[176:191], a[232:235], v[48:55], v219
    buffer_load_dwordx4 a[100:103], v212, s[24:27], s86 offen offset:0 sc1
    v_exp_f32 v72, v72
    v_exp_f32 v73, v73
    v_exp_f32 v74, v74
    v_exp_f32 v75, v75
    v_smfmac_f32_32x32x32_bf16 v[176:191], a[236:239], v[56:63], v219
    s_ff1_i32_b32 s91, s60
    s_bitset0_b32 s60, s91
    s_waitcnt lgkmcnt(0)
    v_exp_f32 v76, v76
    v_exp_f32 v77, v77
    v_exp_f32 v78, v78
    v_exp_f32 v79, v79
    v_mfma_f32_32x32x16_bf16 v[32:47], a[216:219], v[100:103], 0
    s_bitset0_b32 s61, s91
    s_mul_i32 s90, s91, 147456
    ds_read_b128 a[232:235], v218 offset:28160
    v_exp_f32 v80, v80
    v_exp_f32 v81, v81
    v_exp_f32 v82, v82
    v_exp_f32 v83, v83
    v_mfma_f32_32x32x8bf16_1k v[32:47], a[230:231], v[116:117], v[32:47]
    v_exp_f32 v84, v84
    v_exp_f32 v85, v85
    v_exp_f32 v86, v86
    v_exp_f32 v87, v87
    v_smfmac_f32_32x32x32_bf16 v[144:159], a[240:243], v[64:71], v219
    s_add_u32 s90, s90, s50
    s_cmp_lt_i32 s91, 0
    ds_read_b128 a[236:239], v218 offset:28800
    v_exp_f32 v88, v88
    v_exp_f32 v89, v89
    v_exp_f32 v90, v90
    v_exp_f32 v91, v91
    v_smfmac_f32_32x32x32_bf16 v[144:159], a[244:247], v[72:79], v219
    s_cselect_b32 s83, 1073741824, s90
    buffer_load_dwordx4 a[184:187], v6, s[24:27], s83 offen offset:0 sc1
    v_exp_f32 v92, v92
    v_exp_f32 v93, v93
    v_exp_f32 v94, v94
    v_exp_f32 v95, v95
    v_mfma_f32_32x32x16_bf16 v[48:63], a[216:219], v[108:111], 0
    ds_read_b128 a[220:223], v216 offset:27648
    buffer_load_dwordx4 a[188:191], v6, s[24:27], s83 offen offset:1024 sc1
    v_exp_f32 v32, v32
    v_exp_f32 v33, v33
    v_exp_f32 v34, v34
    v_exp_f32 v35, v35
    v_mfma_f32_32x32x8bf16_1k v[48:63], a[230:231], v[124:125], v[48:63]
    v_exp_f32 v36, v36
    v_exp_f32 v37, v37
    v_exp_f32 v38, v38
    v_exp_f32 v39, v39
    v_smfmac_f32_32x32x32_bf16 v[176:191], a[240:243], v[80:87], v219
    buffer_load_dwordx4 a[192:195], v6, s[24:27], s83 offen offset:2048 sc1
    v_exp_f32 v40, v40
    v_exp_f32 v41, v41
    v_exp_f32 v42, v42
    v_exp_f32 v43, v43
    v_smfmac_f32_32x32x32_bf16 v[176:191], a[244:247], v[88:95], v219
    s_waitcnt lgkmcnt(0)
    buffer_load_dwordx4 a[196:199], v6, s[24:27], s83 offen offset:3072 sc1
    v_exp_f32 v44, v44
    v_exp_f32 v45, v45
    v_exp_f32 v46, v46
    v_exp_f32 v47, v47
    v_mfma_f32_32x32x16_bf16 v[64:79], a[220:223], v[100:103], 0
    ds_read_b128 a[240:243], v218 offset:29440
    v_exp_f32 v48, v48
    v_exp_f32 v49, v49
    v_exp_f32 v50, v50
    v_exp_f32 v51, v51
    v_mfma_f32_32x32x8bf16_1k v[64:79], a[230:231], v[118:119], v[64:79]
    v_exp_f32 v52, v52
    v_exp_f32 v53, v53
    v_exp_f32 v54, v54
    v_exp_f32 v55, v55
    v_smfmac_f32_32x32x32_bf16 v[144:159], a[232:235], v[32:39], v219
    ds_read_b128 a[244:247], v218 offset:30080
    v_exp_f32 v56, v56
    v_exp_f32 v57, v57
    v_exp_f32 v58, v58
    v_exp_f32 v59, v59
    v_smfmac_f32_32x32x32_bf16 v[144:159], a[236:239], v[40:47], v219
    v_exp_f32 v60, v60
    v_exp_f32 v61, v61
    v_exp_f32 v62, v62
    v_exp_f32 v63, v63
    v_mfma_f32_32x32x16_bf16 v[80:95], a[220:223], v[108:111], 0
    v_exp_f32 v64, v64
    v_exp_f32 v65, v65
    v_exp_f32 v66, v66
    v_exp_f32 v67, v67
    v_mfma_f32_32x32x8bf16_1k v[80:95], a[230:231], v[126:127], v[80:95]
    v_exp_f32 v68, v68
    v_exp_f32 v69, v69
    v_exp_f32 v70, v70
    v_exp_f32 v71, v71
    v_smfmac_f32_32x32x32_bf16 v[176:191], a[232:235], v[48:55], v219
    v_exp_f32 v72, v72
    v_exp_f32 v73, v73
    v_exp_f32 v74, v74
    v_exp_f32 v75, v75
    v_smfmac_f32_32x32x32_bf16 v[176:191], a[236:239], v[56:63], v219
    s_waitcnt lgkmcnt(0)
    v_exp_f32 v76, v76
    v_exp_f32 v77, v77
    v_exp_f32 v78, v78
    v_exp_f32 v79, v79
    v_exp_f32 v80, v80
    v_exp_f32 v81, v81
    v_exp_f32 v82, v82
    v_exp_f32 v83, v83
    v_exp_f32 v84, v84
    v_exp_f32 v85, v85
    v_exp_f32 v86, v86
    v_exp_f32 v87, v87
    v_smfmac_f32_32x32x32_bf16 v[144:159], a[240:243], v[64:71], v219
    v_exp_f32 v88, v88
    v_exp_f32 v89, v89
    v_exp_f32 v90, v90
    v_exp_f32 v91, v91
    v_smfmac_f32_32x32x32_bf16 v[144:159], a[244:247], v[72:79], v219
    v_exp_f32 v92, v92
    v_exp_f32 v93, v93
    v_exp_f32 v94, v94
    v_exp_f32 v95, v95
    s_nop 1
    v_smfmac_f32_32x32x32_bf16 v[176:191], a[240:243], v[80:87], v219
    v_smfmac_f32_32x32x32_bf16 v[176:191], a[244:247], v[88:95], v219
L_opub:
    s_lshl_b32 s92, s78, 8
    s_add_u32 s92, s92, s71
    s_add_u32 s92, s92, 16384
    s_nop 0
    v_rcp_f32 v192, v154
    s_nop 0
    v_mul_f32 v192, 0x3eeff558, v192
    v_mul_f32 v196, v144, v192
    v_mul_f32 v197, v145, v192
    v_mul_f32 v198, v146, v192
    v_mul_f32 v199, v147, v192
    v_mul_f32 v200, v148, v192
    v_mul_f32 v201, v149, v192
    v_mul_f32 v202, v150, v192
    v_mul_f32 v203, v151, v192
    v_mul_f32 v204, v152, v192
    v_mul_f32 v205, v153, v192
    v_rcp_f32_e64 v193, v186
    v_cvt_pk_bf16_f32 v30, v204, v205
    v_cvt_pk_bf16_f32 v156, v196, v197
    v_cvt_pk_bf16_f32 v157, v198, v199
    v_cvt_pk_bf16_f32 v158, v200, v201
    v_cvt_pk_bf16_f32 v159, v202, v203
    buffer_store_dwordx4 v[156:159], v6, s[24:27], s63 offen offset:1024 sc1
    v_mul_f32 v193, 0x3eeff558, v193
    v_mul_f32 v196, v176, v193
    v_mul_f32 v197, v177, v193
    v_mul_f32 v198, v178, v193
    v_mul_f32 v199, v179, v193
    v_mul_f32 v200, v180, v193
    v_mul_f32 v201, v181, v193
    v_mul_f32 v202, v182, v193
    v_mul_f32 v203, v183, v193
    v_mul_f32 v204, v184, v193
    v_mul_f32 v205, v185, v193
    v_cvt_pk_bf16_f32 v31, v204, v205
    v_cvt_pk_bf16_f32 v188, v196, v197
    v_cvt_pk_bf16_f32 v189, v198, v199
L_w20:
    s_cbranch_execz L_wb
    v_cvt_pk_bf16_f32 v190, v200, v201
    v_cvt_pk_bf16_f32 v191, v202, v203
    v_permlane16_swap_b32 v30, v31
    buffer_store_dwordx4 v[188:191], v6, s[24:27], s64 offen offset:1024 sc1
    buffer_store_dwordx4 v[28:31], v226, s[24:27], s92 offen sc1
    buffer_load_dword v26, v211, s[24:27], s95 offen sc1
    s_cmp_lg_u32 s3, 0
    s_cbranch_scc1 L_chkd
    s_mov_b32 s90, 0x00800000
    s_mov_b32 s91, 0x7d800000
    v_cndmask_b32 v194, v152, v154, s[4:5]
    v_cndmask_b32 v195, v153, v154, s[4:5]
    v_min3_f32 v192, abs(v194), abs(v195), v154
    v_add_f32 v193, abs(v194), v154
    v_add_f32 v193, v193, abs(v195)
    v_min3_f32 v192, v192, abs(v144), abs(v145)
    v_add_f32 v193, v193, abs(v144)
    v_add_f32 v193, v193, abs(v145)
    v_min3_f32 v192, v192, abs(v146), abs(v147)
    v_add_f32 v193, v193, abs(v146)
    v_add_f32 v193, v193, abs(v147)
    v_min3_f32 v192, v192, abs(v148), abs(v149)
    v_add_f32 v193, v193, abs(v148)
    v_add_f32 v193, v193, abs(v149)
    v_min3_f32 v192, v192, abs(v150), abs(v151)
    v_add_f32 v193, v193, abs(v150)
    v_add_f32 v193, v193, abs(v151)
    v_cndmask_b32 v194, v184, v186, s[4:5]
    v_cndmask_b32 v195, v185, v186, s[4:5]
    v_min3_f32 v192, v192, abs(v194), abs(v195)
    v_min_f32 v192, v192, v186
    v_add_f32 v193, v193, v186
    v_add_f32 v193, v193, abs(v194)
    v_add_f32 v193, v193, abs(v195)
    v_min3_f32 v192, v192, abs(v176), abs(v177)
    v_add_f32 v193, v193, abs(v176)
    v_add_f32 v193, v193, abs(v177)
    v_min3_f32 v192, v192, abs(v178), abs(v179)
    v_add_f32 v193, v193, abs(v178)
    v_add_f32 v193, v193, abs(v179)
    v_min3_f32 v192, v192, abs(v180), abs(v181)
    v_add_f32 v193, v193, abs(v180)
    v_add_f32 v193, v193, abs(v181)
    v_min3_f32 v192, v192, abs(v182), abs(v183)
    v_add_f32 v193, v193, abs(v182)
    v_add_f32 v193, v193, abs(v183)
    v_cmp_nle_f32 vcc, s90, v192
    v_cmp_ngt_f32 s[6:7], s91, v193
    s_nop 0
    s_or_b64 vcc, vcc, s[6:7]
    s_cbranch_scc1 L_fb
    s_cmp_eq_u32 s101, 0xff
    s_cbranch_scc1 L_fb
L_chkd:
    ds_read_b64 v[32:33], v228 offset:0
    ds_read_b64 v[34:35], v228 offset:2048
    ds_read_b64 v[36:37], v21 offset:0
    ds_read_b64 v[38:39], v21 offset:2048
    ds_read_b64 v[40:41], v22 offset:0
    ds_read_b64 v[42:43], v22 offset:2048
    ds_read_b64 v[44:45], v23 offset:0
    ds_read_b64 v[46:47], v23 offset:2048
    ds_read_b64 v[48:49], v229
    s_waitcnt vmcnt(4)
    v_mfma_f32_16x16x32_bf16 v[64:67], v[238:241], a[40:43], 0
    v_mfma_f32_16x16x32_bf16 v[64:67], v[238:241], a[56:59], v[64:67]
    v_mfma_f32_16x16x32_bf16 v[64:67], v[238:241], a[112:115], v[64:67]
    v_mfma_f32_16x16x32_bf16 v[64:67], v[238:241], a[128:131], v[64:67]
    v_mfma_f32_16x16x32_bf16 v[64:67], v[238:241], a[200:203], v[64:67]
    v_mfma_f32_16x16x32_bf16 v[64:67], v[238:241], a[184:187], v[64:67]
    s_waitcnt lgkmcnt(0)
    v_lshlrev_b32 v96, 16, v32
    v_and_b32 v97, 0xffff0000, v32
    v_mfma_f32_16x16x32_bf16 v[68:71], v[238:241], a[44:47], 0
    v_lshlrev_b32 v98, 16, v33
    v_and_b32 v99, 0xffff0000, v33
    v_mfma_f32_16x16x32_bf16 v[68:71], v[238:241], a[60:63], v[68:71]
    v_lshlrev_b32 v100, 16, v34
    v_and_b32 v101, 0xffff0000, v34
    v_mfma_f32_16x16x32_bf16 v[68:71], v[238:241], a[116:119], v[68:71]
    v_lshlrev_b32 v102, 16, v35
    v_and_b32 v103, 0xffff0000, v35
    v_mfma_f32_16x16x32_bf16 v[68:71], v[238:241], a[132:135], v[68:71]
    v_lshlrev_b32 v104, 16, v36
    v_and_b32 v105, 0xffff0000, v36
    v_mfma_f32_16x16x32_bf16 v[68:71], v[238:241], a[204:207], v[68:71]
    v_lshlrev_b32 v106, 16, v37
    v_and_b32 v107, 0xffff0000, v37
    v_mfma_f32_16x16x32_bf16 v[68:71], v[238:241], a[188:191], v[68:71]
    v_lshlrev_b32 v108, 16, v38
    v_and_b32 v109, 0xffff0000, v38
    v_mfma_f32_16x16x32_bf16 v[72:75], v[236:239], a[40:43], 0
    v_lshlrev_b32 v110, 16, v39
    v_and_b32 v111, 0xffff0000, v39
    v_mfma_f32_16x16x32_bf16 v[72:75], v[236:239], a[56:59], v[72:75]
    v_lshlrev_b32 v112, 16, v40
    v_and_b32 v113, 0xffff0000, v40
    v_mfma_f32_16x16x32_bf16 v[72:75], v[236:239], a[112:115], v[72:75]
    v_lshlrev_b32 v114, 16, v41
    v_and_b32 v115, 0xffff0000, v41
    v_mfma_f32_16x16x32_bf16 v[72:75], v[236:239], a[128:131], v[72:75]
    v_lshlrev_b32 v116, 16, v42
    v_and_b32 v117, 0xffff0000, v42
    v_mfma_f32_16x16x32_bf16 v[72:75], v[236:239], a[200:203], v[72:75]
    v_lshlrev_b32 v118, 16, v43
    v_and_b32 v119, 0xffff0000, v43
    v_mfma_f32_16x16x32_bf16 v[72:75], v[236:239], a[184:187], v[72:75]
    v_lshlrev_b32 v120, 16, v44
    v_and_b32 v121, 0xffff0000, v44
    v_mfma_f32_16x16x32_bf16 v[76:79], v[236:239], a[44:47], 0
    v_lshlrev_b32 v122, 16, v45
    v_and_b32 v123, 0xffff0000, v45
    v_mfma_f32_16x16x32_bf16 v[76:79], v[236:239], a[60:63], v[76:79]
    v_lshlrev_b32 v124, 16, v46
    v_and_b32 v125, 0xffff0000, v46
    v_mfma_f32_16x16x32_bf16 v[76:79], v[236:239], a[116:119], v[76:79]
    v_lshlrev_b32 v126, 16, v47
    v_and_b32 v127, 0xffff0000, v47
    v_mfma_f32_16x16x32_bf16 v[76:79], v[236:239], a[132:135], v[76:79]
    v_lshlrev_b32 v252, 16, v48
    v_and_b32 v253, 0xffff0000, v48
    v_mfma_f32_16x16x32_bf16 v[76:79], v[236:239], a[204:207], v[76:79]
    v_lshlrev_b32 v254, 16, v49
    v_and_b32 v255, 0xffff0000, v49
    v_mfma_f32_16x16x32_bf16 v[76:79], v[236:239], a[188:191], v[76:79]
    v_mfma_f32_16x16x32_bf16 v[80:83], v[238:241], a[48:51], 0
    v_mfma_f32_16x16x32_bf16 v[80:83], v[238:241], a[64:67], v[80:83]
    v_mfma_f32_16x16x32_bf16 v[80:83], v[238:241], a[120:123], v[80:83]
    v_mfma_f32_16x16x32_bf16 v[80:83], v[238:241], a[136:139], v[80:83]
    v_mfma_f32_16x16x32_bf16 v[80:83], v[238:241], a[208:211], v[80:83]
    v_mfma_f32_16x16x32_bf16 v[80:83], v[238:241], a[192:195], v[80:83]
    v_mfma_f32_16x16x32_bf16 v[84:87], v[238:241], a[52:55], 0
    v_mfma_f32_16x16x32_bf16 v[84:87], v[238:241], a[68:71], v[84:87]
    v_mfma_f32_16x16x32_bf16 v[84:87], v[238:241], a[124:127], v[84:87]
    v_mfma_f32_16x16x32_bf16 v[84:87], v[238:241], a[140:143], v[84:87]
    v_mfma_f32_16x16x32_bf16 v[84:87], v[238:241], a[212:215], v[84:87]
    v_mfma_f32_16x16x32_bf16 v[84:87], v[238:241], a[196:199], v[84:87]
    v_mfma_f32_16x16x32_bf16 v[88:91], v[236:239], a[48:51], 0
    v_mfma_f32_16x16x32_bf16 v[88:91], v[236:239], a[64:67], v[88:91]
    v_mfma_f32_16x16x32_bf16 v[88:91], v[236:239], a[120:123], v[88:91]
    v_mfma_f32_16x16x32_bf16 v[88:91], v[236:239], a[136:139], v[88:91]
    v_mfma_f32_16x16x32_bf16 v[88:91], v[236:239], a[208:211], v[88:91]
    v_mfma_f32_16x16x32_bf16 v[88:91], v[236:239], a[192:195], v[88:91]
    v_mfma_f32_16x16x32_bf16 v[92:95], v[236:239], a[52:55], 0
    v_mfma_f32_16x16x32_bf16 v[92:95], v[236:239], a[68:71], v[92:95]
    v_mfma_f32_16x16x32_bf16 v[92:95], v[236:239], a[124:127], v[92:95]
    v_mfma_f32_16x16x32_bf16 v[92:95], v[236:239], a[140:143], v[92:95]
    v_mfma_f32_16x16x32_bf16 v[92:95], v[236:239], a[212:215], v[92:95]
    v_mfma_f32_16x16x32_bf16 v[92:95], v[236:239], a[196:199], v[92:95]
    ds_read_b64_tr_b16 a[144:145], v8 offset:0
    ds_read_b64_tr_b16 a[146:147], v8 offset:2048
    ds_read_b64_tr_b16 a[148:149], v8 offset:8192
    ds_read_b64_tr_b16 a[150:151], v8 offset:10240
    ds_read_b64_tr_b16 a[152:153], v8 offset:16384
    ds_read_b64_tr_b16 a[154:155], v8 offset:18432
    ds_read_b64_tr_b16 a[156:157], v8 offset:24576
    ds_read_b64_tr_b16 a[158:159], v8 offset:26624
    ds_read_b64_tr_b16 a[160:161], v9 offset:0
    ds_read_b64_tr_b16 a[162:163], v9 offset:2048
    ds_read_b64_tr_b16 a[164:165], v9 offset:8192
    ds_read_b64_tr_b16 a[166:167], v9 offset:10240
    ds_read_b64_tr_b16 a[168:169], v9 offset:16384
    ds_read_b64_tr_b16 a[170:171], v9 offset:18432
    ds_read_b64_tr_b16 a[172:173], v9 offset:24576
    ds_read_b64_tr_b16 a[174:175], v9 offset:26624
    s_waitcnt vmcnt(0)
    buffer_store_dword v27, v214, s[24:27], s0 offen sc1
    s_mov_b32 s93, 0
    s_cmp_eq_u32 s100, 0
    s_cbranch_scc1 L_ga
L_pa1:
    v_cmp_ne_u32 vcc, 0, v26
    s_add_u32 s93, s93, 1
    s_lshr_b32 s90, vcc_lo, 24
    s_orn2_b32 s90, s90, s66
    s_and_b32 s51, s90, s100
    s_cbranch_scc0 L_fa8
    s_andn2_b32 s100, s100, s51
    s_bitcmp1_b32 s51, 0
    s_cbranch_scc0 L_fa1
    s_add_u32 s86, s71, 0
    buffer_load_dwordx4 a[0:3], v6, s[24:27], s86 offen offset:0 sc1
    buffer_load_dwordx4 a[72:75], v212, s[24:27], s86 offen offset:0 sc1
L_fa1:
    s_bitcmp1_b32 s51, 1
    s_cbranch_scc0 L_fa2
    s_add_u32 s86, s71, 2048
    buffer_load_dwordx4 a[4:7], v6, s[24:27], s86 offen offset:0 sc1
    buffer_load_dwordx4 a[76:79], v212, s[24:27], s86 offen offset:0 sc1
L_fa2:
    s_bitcmp1_b32 s51, 2
    s_cbranch_scc0 L_fa3
    s_add_u32 s86, s71, 4096
    buffer_load_dwordx4 a[8:11], v6, s[24:27], s86 offen offset:0 sc1
    buffer_load_dwordx4 a[80:83], v212, s[24:27], s86 offen offset:0 sc1
L_fa3:
    s_bitcmp1_b32 s51, 3
    s_cbranch_scc0 L_fa4
    s_add_u32 s86, s71, 6144
    buffer_load_dwordx4 a[12:15], v6, s[24:27], s86 offen offset:0 sc1
    buffer_load_dwordx4 a[84:87], v212, s[24:27], s86 offen offset:0 sc1
L_fa4:
    s_bitcmp1_b32 s51, 4
    s_cbranch_scc0 L_fa5
    s_add_u32 s86, s71, 8192
    buffer_load_dwordx4 a[16:19], v6, s[24:27], s86 offen offset:0 sc1
    buffer_load_dwordx4 a[88:91], v212, s[24:27], s86 offen offset:0 sc1
L_fa5:
    s_bitcmp1_b32 s51, 5
    s_cbranch_scc0 L_fa6
    s_add_u32 s86, s71, 10240
    buffer_load_dwordx4 a[20:23], v6, s[24:27], s86 offen offset:0 sc1
    buffer_load_dwordx4 a[92:95], v212, s[24:27], s86 offen offset:0 sc1
L_fa6:
    s_bitcmp1_b32 s51, 6
    s_cbranch_scc0 L_fa7
    s_add_u32 s86, s71, 12288
    buffer_load_dwordx4 a[24:27], v6, s[24:27], s86 offen offset:0 sc1
    buffer_load_dwordx4 a[96:99], v212, s[24:27], s86 offen offset:0 sc1
L_fa7:
    s_bitcmp1_b32 s51, 7
    s_cbranch_scc0 L_fa8
    s_add_u32 s86, s71, 14336
    buffer_load_dwordx4 a[28:31], v6, s[24:27], s86 offen offset:0 sc1
    buffer_load_dwordx4 a[100:103], v212, s[24:27], s86 offen offset:0 sc1
L_fa8:
    s_cmp_eq_u32 s100, 0
    s_cbranch_scc1 L_ga
    buffer_load_dword v26, v211, s[24:27], s95 offen sc1
    s_cmp_gt_u32 s93, 0x100000
    s_cbranch_scc1 L_end
    s_waitcnt vmcnt(0)
    s_branch L_pa1
L_ga:
    v_cmp_ne_u32 vcc, 0, v26
    s_mov_b32 s62, 0
    s_andn2_b32 s96, s66, vcc_lo
    s_add_u32 s90, s71, 0
    s_bitcmp1_b32 s96, 0
    s_cselect_b32 s86, 1073741824, s90
    buffer_load_dwordx4 a[32:35], v6, s[24:27], s86 offen offset:1024 sc1
    buffer_load_dwordx4 a[104:107], v212, s[24:27], s86 offen offset:1024 sc1
    s_add_u32 s90, s71, 2048
    s_bitcmp1_b32 s96, 1
    s_cselect_b32 s86, 1073741824, s90
    buffer_load_dwordx4 a[36:39], v6, s[24:27], s86 offen offset:1024 sc1
    buffer_load_dwordx4 a[108:111], v212, s[24:27], s86 offen offset:1024 sc1
    s_add_u32 s90, s71, 4096
    s_bitcmp1_b32 s96, 2
    s_cselect_b32 s86, 1073741824, s90
    buffer_load_dwordx4 a[40:43], v6, s[24:27], s86 offen offset:1024 sc1
    buffer_load_dwordx4 a[112:115], v212, s[24:27], s86 offen offset:1024 sc1
    s_add_u32 s90, s71, 6144
    s_bitcmp1_b32 s96, 3
    s_cselect_b32 s86, 1073741824, s90
    buffer_load_dwordx4 a[44:47], v6, s[24:27], s86 offen offset:1024 sc1
    buffer_load_dwordx4 a[116:119], v212, s[24:27], s86 offen offset:1024 sc1
    s_waitcnt vmcnt(8) lgkmcnt(0)
    v_mfma_f32_16x16x32_bf16 v[64:67], a[144:147], a[0:3], v[64:67]
    s_add_u32 s90, s71, 8192
    ds_read_b64_tr_b16 a[176:177], v10 offset:0
    v_mfma_f32_16x16x32_bf16 v[64:67], a[148:151], a[4:7], v[64:67]
    s_bitcmp1_b32 s96, 4
    ds_read_b64_tr_b16 a[178:179], v10 offset:2048
    v_mfma_f32_16x16x32_bf16 v[64:67], a[152:155], a[8:11], v[64:67]
    s_cselect_b32 s86, 1073741824, s90
    ds_read_b64_tr_b16 a[180:181], v10 offset:8192
    buffer_load_dwordx4 a[48:51], v6, s[24:27], s86 offen offset:1024 sc1
    v_mfma_f32_16x16x32_bf16 v[64:67], a[156:159], a[12:15], v[64:67]
    ds_read_b64_tr_b16 a[182:183], v10 offset:10240
    v_mfma_f32_16x16x32_bf16 v[68:71], a[144:147], a[72:75], v[68:71]
    ds_read_b64_tr_b16 a[184:185], v10 offset:16384
    v_mfma_f32_16x16x32_bf16 v[68:71], a[148:151], a[76:79], v[68:71]
    ds_read_b64_tr_b16 a[186:187], v10 offset:18432
    v_mfma_f32_16x16x32_bf16 v[68:71], a[152:155], a[80:83], v[68:71]
    ds_read_b64_tr_b16 a[188:189], v10 offset:24576
    buffer_load_dwordx4 a[120:123], v212, s[24:27], s86 offen offset:1024 sc1
    v_mfma_f32_16x16x32_bf16 v[68:71], a[156:159], a[84:87], v[68:71]
    ds_read_b64_tr_b16 a[190:191], v10 offset:26624
    v_mfma_f32_16x16x32_bf16 v[72:75], a[160:163], a[0:3], v[72:75]
    s_add_u32 s90, s71, 10240
    ds_read_b64_tr_b16 a[192:193], v11 offset:0
    v_mfma_f32_16x16x32_bf16 v[72:75], a[164:167], a[4:7], v[72:75]
    s_bitcmp1_b32 s96, 5
    ds_read_b64_tr_b16 a[194:195], v11 offset:2048
    v_mfma_f32_16x16x32_bf16 v[72:75], a[168:171], a[8:11], v[72:75]
    s_cselect_b32 s86, 1073741824, s90
    ds_read_b64_tr_b16 a[196:197], v11 offset:8192
    buffer_load_dwordx4 a[52:55], v6, s[24:27], s86 offen offset:1024 sc1
    v_mfma_f32_16x16x32_bf16 v[72:75], a[172:175], a[12:15], v[72:75]
    ds_read_b64_tr_b16 a[198:199], v11 offset:10240
    v_mfma_f32_16x16x32_bf16 v[76:79], a[160:163], a[72:75], v[76:79]
    ds_read_b64_tr_b16 a[200:201], v11 offset:16384
    v_mfma_f32_16x16x32_bf16 v[76:79], a[164:167], a[76:79], v[76:79]
    ds_read_b64_tr_b16 a[202:203], v11 offset:18432
    v_mfma_f32_16x16x32_bf16 v[76:79], a[168:171], a[80:83], v[76:79]
    ds_read_b64_tr_b16 a[204:205], v11 offset:24576
    buffer_load_dwordx4 a[124:127], v212, s[24:27], s86 offen offset:1024 sc1
    v_mfma_f32_16x16x32_bf16 v[76:79], a[172:175], a[84:87], v[76:79]
    s_waitcnt lgkmcnt(5)
    ds_read_b64_tr_b16 a[206:207], v11 offset:26624
    v_mfma_f32_16x16x32_bf16 v[80:83], a[176:179], a[0:3], v[80:83]
    s_add_u32 s90, s71, 12288
    ds_read_b64_tr_b16 a[208:209], v231 offset:0
    v_mfma_f32_16x16x32_bf16 v[80:83], a[180:183], a[4:7], v[80:83]
    s_bitcmp1_b32 s96, 6
    ds_read_b64_tr_b16 a[210:211], v231 offset:512
    v_mfma_f32_16x16x32_bf16 v[80:83], a[184:187], a[8:11], v[80:83]
    s_cselect_b32 s86, 1073741824, s90
    ds_read_b64_tr_b16 a[212:213], v231 offset:2048
    buffer_load_dwordx4 a[56:59], v6, s[24:27], s86 offen offset:1024 sc1
    v_mfma_f32_16x16x32_bf16 v[80:83], a[188:191], a[12:15], v[80:83]
    ds_read_b64_tr_b16 a[214:215], v231 offset:2560
    v_mfma_f32_16x16x32_bf16 v[84:87], a[176:179], a[72:75], v[84:87]
    ds_read_b64_tr_b16 a[144:145], v231 offset:4096
    v_mfma_f32_16x16x32_bf16 v[84:87], a[180:183], a[76:79], v[84:87]
    ds_read_b64_tr_b16 a[146:147], v231 offset:4608
    v_mfma_f32_16x16x32_bf16 v[84:87], a[184:187], a[80:83], v[84:87]
    ds_read_b64_tr_b16 a[148:149], v231 offset:6144
    buffer_load_dwordx4 a[128:131], v212, s[24:27], s86 offen offset:1024 sc1
    v_mfma_f32_16x16x32_bf16 v[84:87], a[188:191], a[84:87], v[84:87]
    s_waitcnt lgkmcnt(5)
    ds_read_b64_tr_b16 a[150:151], v231 offset:6656
    v_mfma_f32_16x16x32_bf16 v[88:91], a[192:195], a[0:3], v[88:91]
    s_add_u32 s90, s71, 14336
    ds_read_b64_tr_b16 a[152:153], v8 offset:32768
    v_mfma_f32_16x16x32_bf16 v[88:91], a[196:199], a[4:7], v[88:91]
    s_bitcmp1_b32 s96, 7
    ds_read_b64_tr_b16 a[154:155], v8 offset:34816
    v_mfma_f32_16x16x32_bf16 v[88:91], a[200:203], a[8:11], v[88:91]
    s_cselect_b32 s86, 1073741824, s90
    ds_read_b64_tr_b16 a[156:157], v8 offset:40960
    buffer_load_dwordx4 a[60:63], v6, s[24:27], s86 offen offset:1024 sc1
    v_mfma_f32_16x16x32_bf16 v[88:91], a[204:207], a[12:15], v[88:91]
    ds_read_b64_tr_b16 a[158:159], v8 offset:43008
    v_mfma_f32_16x16x32_bf16 v[92:95], a[192:195], a[72:75], v[92:95]
    ds_read_b64_tr_b16 a[160:161], v8 offset:49152
    v_mfma_f32_16x16x32_bf16 v[92:95], a[196:199], a[76:79], v[92:95]
    ds_read_b64_tr_b16 a[162:163], v8 offset:51200
    v_mfma_f32_16x16x32_bf16 v[92:95], a[200:203], a[80:83], v[92:95]
    ds_read_b64_tr_b16 a[164:165], v8 offset:57344
    buffer_load_dwordx4 a[132:135], v212, s[24:27], s86 offen offset:1024 sc1
    v_mfma_f32_16x16x32_bf16 v[92:95], a[204:207], a[84:87], v[92:95]
    s_waitcnt lgkmcnt(5)
    ds_read_b64_tr_b16 a[166:167], v8 offset:59392
    v_mfma_f32_16x16x32_bf16 v[248:251], a[208:211], a[0:3], 0
    s_add_u32 s90, s71, 16384
    ds_read_b64_tr_b16 a[168:169], v9 offset:32768
    v_mfma_f32_16x16x32_bf16 v[248:251], a[212:215], a[4:7], v[248:251]
    s_cmp_lg_u32 s96, 0
    ds_read_b64_tr_b16 a[170:171], v9 offset:34816
    v_mfma_f32_16x16x32_bf16 v[248:251], a[144:147], a[8:11], v[248:251]
    s_cselect_b32 s86, 1073741824, s90
    ds_read_b64_tr_b16 a[172:173], v9 offset:40960
    buffer_load_dwordx4 a[64:67], v6, s[24:27], s86 offen offset:0 sc1
    v_mfma_f32_16x16x32_bf16 v[248:251], a[148:151], a[12:15], v[248:251]
    ds_read_b64_tr_b16 a[174:175], v9 offset:43008
    v_mfma_f32_16x16x32_bf16 v[28:31], a[208:211], a[72:75], 0
    ds_read_b64_tr_b16 a[176:177], v9 offset:49152
    v_mfma_f32_16x16x32_bf16 v[28:31], a[212:215], a[76:79], v[28:31]
    ds_read_b64_tr_b16 a[178:179], v9 offset:51200
    v_mfma_f32_16x16x32_bf16 v[28:31], a[144:147], a[80:83], v[28:31]
    ds_read_b64_tr_b16 a[180:181], v9 offset:57344
    buffer_load_dwordx4 a[136:139], v212, s[24:27], s86 offen offset:0 sc1
    v_mfma_f32_16x16x32_bf16 v[28:31], a[148:151], a[84:87], v[28:31]
    s_waitcnt vmcnt(63)
    ds_read_b64_tr_b16 a[182:183], v9 offset:59392
    v_mfma_f32_16x16x32_bf16 v[64:67], a[152:155], a[16:19], v[64:67]
    s_waitcnt lgkmcnt(5)
    ds_read_b64_tr_b16 a[184:185], v10 offset:32768
    v_mfma_f32_16x16x32_bf16 v[64:67], a[156:159], a[20:23], v[64:67]
    ds_read_b64_tr_b16 a[186:187], v10 offset:34816
    v_mfma_f32_16x16x32_bf16 v[64:67], a[160:163], a[24:27], v[64:67]
    ds_read_b64_tr_b16 a[188:189], v10 offset:40960
    buffer_load_dwordx4 a[68:71], v6, s[24:27], s86 offen offset:1024 sc1
    v_mfma_f32_16x16x32_bf16 v[64:67], a[164:167], a[28:31], v[64:67]
    ds_read_b64_tr_b16 a[190:191], v10 offset:43008
    v_mfma_f32_16x16x32_bf16 v[68:71], a[152:155], a[88:91], v[68:71]
    ds_read_b64_tr_b16 a[192:193], v10 offset:49152
    v_mfma_f32_16x16x32_bf16 v[68:71], a[156:159], a[92:95], v[68:71]
    ds_read_b64_tr_b16 a[194:195], v10 offset:51200
    v_mfma_f32_16x16x32_bf16 v[68:71], a[160:163], a[96:99], v[68:71]
    ds_read_b64_tr_b16 a[196:197], v10 offset:57344
    buffer_load_dwordx4 a[140:143], v212, s[24:27], s86 offen offset:1024 sc1
    v_mfma_f32_16x16x32_bf16 v[68:71], a[164:167], a[100:103], v[68:71]
    ds_read_b64_tr_b16 a[198:199], v10 offset:59392
    v_mfma_f32_16x16x32_bf16 v[72:75], a[168:171], a[16:19], v[72:75]
    s_waitcnt lgkmcnt(5)
    ds_read_b64_tr_b16 a[200:201], v11 offset:32768
    v_mfma_f32_16x16x32_bf16 v[72:75], a[172:175], a[20:23], v[72:75]
    ds_read_b64_tr_b16 a[202:203], v11 offset:34816
    v_mfma_f32_16x16x32_bf16 v[72:75], a[176:179], a[24:27], v[72:75]
    ds_read_b64_tr_b16 a[204:205], v11 offset:40960
    v_mfma_f32_16x16x32_bf16 v[72:75], a[180:183], a[28:31], v[72:75]
    ds_read_b64_tr_b16 a[206:207], v11 offset:43008
    v_mfma_f32_16x16x32_bf16 v[76:79], a[168:171], a[88:91], v[76:79]
    ds_read_b64_tr_b16 a[208:209], v11 offset:49152
    v_mfma_f32_16x16x32_bf16 v[76:79], a[172:175], a[92:95], v[76:79]
    ds_read_b64_tr_b16 a[210:211], v11 offset:51200
    v_mfma_f32_16x16x32_bf16 v[76:79], a[176:179], a[96:99], v[76:79]
    ds_read_b64_tr_b16 a[212:213], v11 offset:57344
    v_mfma_f32_16x16x32_bf16 v[76:79], a[180:183], a[100:103], v[76:79]
    ds_read_b64_tr_b16 a[214:215], v11 offset:59392
    buffer_load_dword v26, v211, s[24:27], s95 offen sc1
    v_mfma_f32_16x16x32_bf16 v[80:83], a[184:187], a[16:19], v[80:83]
    s_waitcnt lgkmcnt(5)
    ds_read_b64_tr_b16 a[144:145], v231 offset:8192
    v_mfma_f32_16x16x32_bf16 v[80:83], a[188:191], a[20:23], v[80:83]
    ds_read_b64_tr_b16 a[146:147], v231 offset:8704
    v_mfma_f32_16x16x32_bf16 v[80:83], a[192:195], a[24:27], v[80:83]
    ds_read_b64_tr_b16 a[148:149], v231 offset:10240
    v_mfma_f32_16x16x32_bf16 v[80:83], a[196:199], a[28:31], v[80:83]
    ds_read_b64_tr_b16 a[150:151], v231 offset:10752
    v_mfma_f32_16x16x32_bf16 v[84:87], a[184:187], a[88:91], v[84:87]
    ds_read_b64_tr_b16 a[152:153], v231 offset:12288
    v_mfma_f32_16x16x32_bf16 v[84:87], a[188:191], a[92:95], v[84:87]
    ds_read_b64_tr_b16 a[154:155], v231 offset:12800
    v_mfma_f32_16x16x32_bf16 v[84:87], a[192:195], a[96:99], v[84:87]
    ds_read_b64_tr_b16 a[156:157], v231 offset:14336
    v_mfma_f32_16x16x32_bf16 v[84:87], a[196:199], a[100:103], v[84:87]
    ds_read_b64_tr_b16 a[158:159], v231 offset:14848
    v_mfma_f32_16x16x32_bf16 v[88:91], a[200:203], a[16:19], v[88:91]
    s_waitcnt lgkmcnt(5)
    ds_read_b64_tr_b16 a[160:161], v8 offset:4096
    v_mfma_f32_16x16x32_bf16 v[88:91], a[204:207], a[20:23], v[88:91]
    ds_read_b64_tr_b16 a[162:163], v8 offset:6144
    v_mfma_f32_16x16x32_bf16 v[88:91], a[208:211], a[24:27], v[88:91]
    ds_read_b64_tr_b16 a[164:165], v8 offset:12288
    v_mfma_f32_16x16x32_bf16 v[88:91], a[212:215], a[28:31], v[88:91]
    ds_read_b64_tr_b16 a[166:167], v8 offset:14336
    v_mfma_f32_16x16x32_bf16 v[92:95], a[200:203], a[88:91], v[92:95]
    ds_read_b64_tr_b16 a[168:169], v9 offset:4096
    v_mfma_f32_16x16x32_bf16 v[92:95], a[204:207], a[92:95], v[92:95]
    ds_read_b64_tr_b16 a[170:171], v9 offset:6144
    v_mfma_f32_16x16x32_bf16 v[92:95], a[208:211], a[96:99], v[92:95]
    ds_read_b64_tr_b16 a[172:173], v9 offset:12288
    v_mfma_f32_16x16x32_bf16 v[92:95], a[212:215], a[100:103], v[92:95]
    ds_read_b64_tr_b16 a[174:175], v9 offset:14336
    v_mfma_f32_16x16x32_bf16 v[248:251], a[144:147], a[16:19], v[248:251]
    s_waitcnt lgkmcnt(5)
    ds_read_b64_tr_b16 a[176:177], v10 offset:4096
    v_mfma_f32_16x16x32_bf16 v[248:251], a[148:151], a[20:23], v[248:251]
    ds_read_b64_tr_b16 a[178:179], v10 offset:6144
    v_mfma_f32_16x16x32_bf16 v[248:251], a[152:155], a[24:27], v[248:251]
    ds_read_b64_tr_b16 a[180:181], v10 offset:12288
    v_mfma_f32_16x16x32_bf16 v[248:251], a[156:159], a[28:31], v[248:251]
    ds_read_b64_tr_b16 a[182:183], v10 offset:14336
    v_mfma_f32_16x16x32_bf16 v[28:31], a[144:147], a[88:91], v[28:31]
    ds_read_b64_tr_b16 a[184:185], v11 offset:4096
    v_mfma_f32_16x16x32_bf16 v[28:31], a[148:151], a[92:95], v[28:31]
    ds_read_b64_tr_b16 a[186:187], v11 offset:6144
    v_mfma_f32_16x16x32_bf16 v[28:31], a[152:155], a[96:99], v[28:31]
    s_cmp_lg_u32 s96, 0
    ds_read_b64_tr_b16 a[188:189], v11 offset:12288
    v_mfma_f32_16x16x32_bf16 v[28:31], a[156:159], a[100:103], v[28:31]
    s_waitcnt vmcnt(17)
    ds_read_b64_tr_b16 a[190:191], v11 offset:14336
    s_cbranch_scc1 L_wo0
L_gb:
    v_mfma_f32_16x16x32_bf16 v[64:67], a[160:163], a[32:35], v[64:67]
    s_waitcnt lgkmcnt(5)
    ds_read_b64_tr_b16 a[192:193], v231 offset:1024
    v_mfma_f32_16x16x32_bf16 v[64:67], a[164:167], a[36:39], v[64:67]
    ds_read_b64_tr_b16 a[194:195], v231 offset:1536
    v_mfma_f32_16x16x32_bf16 v[68:71], a[160:163], a[104:107], v[68:71]
    ds_read_b64_tr_b16 a[196:197], v231 offset:3072
    v_mfma_f32_16x16x32_bf16 v[68:71], a[164:167], a[108:111], v[68:71]
    ds_read_b64_tr_b16 a[198:199], v231 offset:3584
    v_mfma_f32_16x16x32_bf16 v[72:75], a[168:171], a[32:35], v[72:75]
    ds_read_b64_tr_b16 a[200:201], v8 offset:20480
    v_mfma_f32_16x16x32_bf16 v[72:75], a[172:175], a[36:39], v[72:75]
    ds_read_b64_tr_b16 a[202:203], v8 offset:22528
    v_mfma_f32_16x16x32_bf16 v[76:79], a[168:171], a[104:107], v[76:79]
    ds_read_b64_tr_b16 a[204:205], v8 offset:28672
    v_mfma_f32_16x16x32_bf16 v[76:79], a[172:175], a[108:111], v[76:79]
    ds_read_b64_tr_b16 a[206:207], v8 offset:30720
    v_mfma_f32_16x16x32_bf16 v[80:83], a[176:179], a[32:35], v[80:83]
    s_waitcnt lgkmcnt(5)
    ds_read_b64_tr_b16 a[208:209], v9 offset:20480
    v_mfma_f32_16x16x32_bf16 v[80:83], a[180:183], a[36:39], v[80:83]
    ds_read_b64_tr_b16 a[210:211], v9 offset:22528
    v_mfma_f32_16x16x32_bf16 v[84:87], a[176:179], a[104:107], v[84:87]
    ds_read_b64_tr_b16 a[212:213], v9 offset:28672
    v_mfma_f32_16x16x32_bf16 v[84:87], a[180:183], a[108:111], v[84:87]
    ds_read_b64_tr_b16 a[214:215], v9 offset:30720
    v_mfma_f32_16x16x32_bf16 v[88:91], a[184:187], a[32:35], v[88:91]
    ds_read_b64_tr_b16 a[144:145], v10 offset:20480
    v_mfma_f32_16x16x32_bf16 v[88:91], a[188:191], a[36:39], v[88:91]
    ds_read_b64_tr_b16 a[146:147], v10 offset:22528
    v_mfma_f32_16x16x32_bf16 v[92:95], a[184:187], a[104:107], v[92:95]
    ds_read_b64_tr_b16 a[148:149], v10 offset:28672
    v_mfma_f32_16x16x32_bf16 v[92:95], a[188:191], a[108:111], v[92:95]
    ds_read_b64_tr_b16 a[150:151], v10 offset:30720
    v_mfma_f32_16x16x32_bf16 v[248:251], a[192:195], a[32:35], v[248:251]
    s_waitcnt lgkmcnt(5)
    ds_read_b64_tr_b16 a[152:153], v11 offset:20480
    v_mfma_f32_16x16x32_bf16 v[248:251], a[196:199], a[36:39], v[248:251]
    ds_read_b64_tr_b16 a[154:155], v11 offset:22528
    v_mfma_f32_16x16x32_bf16 v[28:31], a[192:195], a[104:107], v[28:31]
    s_waitcnt lgkmcnt(5)
    ds_read_b64_tr_b16 a[156:157], v11 offset:28672
    v_mfma_f32_16x16x32_bf16 v[28:31], a[196:199], a[108:111], v[28:31]
    s_waitcnt vmcnt(13)
    ds_read_b64_tr_b16 a[158:159], v11 offset:30720
    v_mfma_f32_16x16x32_bf16 v[64:67], a[200:203], a[40:43], v[64:67]
    s_waitcnt vmcnt(0)
    ds_read_b64_tr_b16 a[160:161], v231 offset:5120
    v_cmp_ne_u32 vcc, 0, v26
    v_mfma_f32_16x16x32_bf16 v[64:67], a[204:207], a[44:47], v[64:67]
    s_lshr_b32 s60, vcc_lo, 8
    ds_read_b64_tr_b16 a[162:163], v231 offset:5632
    buffer_load_dword v26, v211, s[24:27], s95 offen sc1
    v_mfma_f32_16x16x32_bf16 v[68:71], a[200:203], a[112:115], v[68:71]
    s_and_b32 s60, s60, s61
    ds_read_b64_tr_b16 a[164:165], v231 offset:7168
    v_mfma_f32_16x16x32_bf16 v[68:71], a[204:207], a[116:119], v[68:71]
    s_ff1_i32_b32 s91, s60
    ds_read_b64_tr_b16 a[166:167], v231 offset:7680
    v_mfma_f32_16x16x32_bf16 v[72:75], a[208:211], a[40:43], v[72:75]
    s_bitset0_b32 s60, s91
    ds_read_b64_tr_b16 a[168:169], v8 offset:36864
    v_mfma_f32_16x16x32_bf16 v[72:75], a[212:215], a[44:47], v[72:75]
    s_bitset0_b32 s61, s91
    ds_read_b64_tr_b16 a[170:171], v8 offset:38912
    v_mfma_f32_16x16x32_bf16 v[76:79], a[208:211], a[112:115], v[76:79]
    s_mul_i32 s90, s91, 147456
    ds_read_b64_tr_b16 a[172:173], v8 offset:45056
    v_mfma_f32_16x16x32_bf16 v[76:79], a[212:215], a[116:119], v[76:79]
    s_waitcnt lgkmcnt(5)
    s_add_u32 s90, s90, s50
    ds_read_b64_tr_b16 a[174:175], v8 offset:47104
    v_mfma_f32_16x16x32_bf16 v[80:83], a[144:147], a[40:43], v[80:83]
    s_cmp_lt_i32 s91, 0
    ds_read_b64_tr_b16 a[176:177], v8 offset:53248
    v_mfma_f32_16x16x32_bf16 v[80:83], a[148:151], a[44:47], v[80:83]
    s_cselect_b32 s68, 1073741824, s90
    ds_read_b64_tr_b16 a[178:179], v8 offset:55296
    buffer_load_dwordx4 v[160:163], v6, s[24:27], s68 offen offset:0 sc1
    v_mfma_f32_16x16x32_bf16 v[84:87], a[144:147], a[112:115], v[84:87]
    s_ff1_i32_b32 s91, s60
    ds_read_b64_tr_b16 a[180:181], v9 offset:36864
    v_mfma_f32_16x16x32_bf16 v[84:87], a[148:151], a[116:119], v[84:87]
    s_bitset0_b32 s60, s91
    ds_read_b64_tr_b16 a[182:183], v9 offset:38912
    v_mfma_f32_16x16x32_bf16 v[88:91], a[152:155], a[40:43], v[88:91]
    ds_read_b64_tr_b16 a[184:185], v9 offset:45056
    buffer_load_dwordx4 v[164:167], v6, s[24:27], s68 offen offset:1024 sc1
    v_mfma_f32_16x16x32_bf16 v[88:91], a[156:159], a[44:47], v[88:91]
    s_bitset0_b32 s61, s91
    ds_read_b64_tr_b16 a[186:187], v9 offset:47104
    v_mfma_f32_16x16x32_bf16 v[92:95], a[152:155], a[112:115], v[92:95]
    s_mul_i32 s90, s91, 147456
    ds_read_b64_tr_b16 a[188:189], v9 offset:53248
    v_mfma_f32_16x16x32_bf16 v[92:95], a[156:159], a[116:119], v[92:95]
    s_waitcnt lgkmcnt(5)
    ds_read_b64_tr_b16 a[190:191], v9 offset:55296
    buffer_load_dwordx4 v[168:171], v6, s[24:27], s68 offen offset:2048 sc1
    v_mfma_f32_16x16x32_bf16 v[248:251], a[160:163], a[40:43], v[248:251]
    s_add_u32 s90, s90, s50
    ds_read_b64_tr_b16 a[192:193], v10 offset:36864
    v_mfma_f32_16x16x32_bf16 v[248:251], a[164:167], a[44:47], v[248:251]
    s_cmp_lt_i32 s91, 0
    ds_read_b64_tr_b16 a[194:195], v10 offset:38912
    v_mfma_f32_16x16x32_bf16 v[28:31], a[160:163], a[112:115], v[28:31]
    ds_read_b64_tr_b16 a[196:197], v10 offset:45056
    buffer_load_dwordx4 v[172:175], v6, s[24:27], s68 offen offset:3072 sc1
    v_mfma_f32_16x16x32_bf16 v[28:31], a[164:167], a[116:119], v[28:31]
    s_waitcnt vmcnt(12)
    s_cselect_b32 s69, 1073741824, s90
    ds_read_b64_tr_b16 a[198:199], v10 offset:47104
    v_mfma_f32_16x16x32_bf16 v[64:67], a[168:171], a[48:51], v[64:67]
    ds_read_b64_tr_b16 a[200:201], v10 offset:53248
    v_mfma_f32_16x16x32_bf16 v[64:67], a[172:175], a[52:55], v[64:67]
    ds_read_b64_tr_b16 a[202:203], v10 offset:55296
    buffer_load_dwordx4 v[176:179], v6, s[24:27], s69 offen offset:0 sc1
    v_mfma_f32_16x16x32_bf16 v[64:67], a[176:179], a[56:59], v[64:67]
    s_ff1_i32_b32 s91, s60
    ds_read_b64_tr_b16 a[204:205], v11 offset:36864
    v_mfma_f32_16x16x32_bf16 v[68:71], a[168:171], a[120:123], v[68:71]
    s_bitset0_b32 s60, s91
    ds_read_b64_tr_b16 a[206:207], v11 offset:38912
    v_mfma_f32_16x16x32_bf16 v[68:71], a[172:175], a[124:127], v[68:71]
    s_waitcnt lgkmcnt(5)
    ds_read_b64_tr_b16 a[208:209], v11 offset:45056
    buffer_load_dwordx4 v[180:183], v6, s[24:27], s69 offen offset:1024 sc1
    v_mfma_f32_16x16x32_bf16 v[68:71], a[176:179], a[128:131], v[68:71]
L_w21:
    s_cbranch_execz L_w0
    s_bitset0_b32 s61, s91
    ds_read_b64_tr_b16 a[210:211], v11 offset:47104
    v_mfma_f32_16x16x32_bf16 v[72:75], a[180:183], a[48:51], v[72:75]
    s_mul_i32 s90, s91, 147456
    ds_read_b64_tr_b16 a[212:213], v11 offset:53248
    v_mfma_f32_16x16x32_bf16 v[72:75], a[184:187], a[52:55], v[72:75]
    ds_read_b64_tr_b16 a[214:215], v11 offset:55296
    buffer_load_dwordx4 v[184:187], v6, s[24:27], s69 offen offset:2048 sc1
    v_mfma_f32_16x16x32_bf16 v[72:75], a[188:191], a[56:59], v[72:75]
    s_add_u32 s90, s90, s50
    ds_read_b64_tr_b16 a[144:145], v231 offset:9216
    v_mfma_f32_16x16x32_bf16 v[76:79], a[180:183], a[120:123], v[76:79]
    s_cmp_lt_i32 s91, 0
    ds_read_b64_tr_b16 a[146:147], v231 offset:9728
    v_mfma_f32_16x16x32_bf16 v[76:79], a[184:187], a[124:127], v[76:79]
    ds_read_b64_tr_b16 a[148:149], v231 offset:11264
    buffer_load_dwordx4 v[188:191], v6, s[24:27], s69 offen offset:3072 sc1
    v_mfma_f32_16x16x32_bf16 v[76:79], a[188:191], a[128:131], v[76:79]
    s_cselect_b32 s70, 1073741824, s90
    ds_read_b64_tr_b16 a[150:151], v231 offset:11776
    v_mfma_f32_16x16x32_bf16 v[80:83], a[192:195], a[48:51], v[80:83]
    s_waitcnt lgkmcnt(5)
    ds_read_b64_tr_b16 a[152:153], v231 offset:13312
    v_mfma_f32_16x16x32_bf16 v[80:83], a[196:199], a[52:55], v[80:83]
    ds_read_b64_tr_b16 a[154:155], v231 offset:13824
    buffer_load_dwordx4 v[192:195], v6, s[24:27], s70 offen offset:0 sc1
    v_mfma_f32_16x16x32_bf16 v[80:83], a[200:203], a[56:59], v[80:83]
    ds_read_b64_tr_b16 a[156:157], v8 offset:61440
    v_mfma_f32_16x16x32_bf16 v[84:87], a[192:195], a[120:123], v[84:87]
    ds_read_b64_tr_b16 a[158:159], v8 offset:63488
    v_mfma_f32_16x16x32_bf16 v[84:87], a[196:199], a[124:127], v[84:87]
    ds_read_b64_tr_b16 a[160:161], v12 offset:0
    buffer_load_dwordx4 v[196:199], v6, s[24:27], s70 offen offset:1024 sc1
    v_mfma_f32_16x16x32_bf16 v[84:87], a[200:203], a[128:131], v[84:87]
    ds_read_b64_tr_b16 a[162:163], v12 offset:2048
    v_mfma_f32_16x16x32_bf16 v[88:91], a[204:207], a[48:51], v[88:91]
    ds_read_b64_tr_b16 a[164:165], v12 offset:4096
    v_mfma_f32_16x16x32_bf16 v[88:91], a[208:211], a[52:55], v[88:91]
    s_waitcnt lgkmcnt(5)
    ds_read_b64_tr_b16 a[166:167], v12 offset:6144
    buffer_load_dwordx4 v[200:203], v6, s[24:27], s70 offen offset:2048 sc1
    v_mfma_f32_16x16x32_bf16 v[88:91], a[212:215], a[56:59], v[88:91]
    ds_read_b64_tr_b16 a[168:169], v9 offset:61440
    v_mfma_f32_16x16x32_bf16 v[92:95], a[204:207], a[120:123], v[92:95]
    ds_read_b64_tr_b16 a[170:171], v9 offset:63488
    v_mfma_f32_16x16x32_bf16 v[92:95], a[208:211], a[124:127], v[92:95]
    ds_read_b64_tr_b16 a[172:173], v13 offset:0
    buffer_load_dwordx4 v[204:207], v6, s[24:27], s70 offen offset:3072 sc1
    v_mfma_f32_16x16x32_bf16 v[92:95], a[212:215], a[128:131], v[92:95]
    ds_read_b64_tr_b16 a[174:175], v13 offset:2048
    v_mfma_f32_16x16x32_bf16 v[248:251], a[144:147], a[48:51], v[248:251]
    ds_read_b64_tr_b16 a[176:177], v13 offset:4096
    v_mfma_f32_16x16x32_bf16 v[248:251], a[148:151], a[52:55], v[248:251]
    ds_read_b64_tr_b16 a[178:179], v13 offset:6144
    v_mfma_f32_16x16x32_bf16 v[248:251], a[152:155], a[56:59], v[248:251]
    ds_read_b64_tr_b16 a[180:181], v10 offset:61440
    v_mfma_f32_16x16x32_bf16 v[28:31], a[144:147], a[120:123], v[28:31]
    ds_read_b64_tr_b16 a[182:183], v10 offset:63488
    v_mfma_f32_16x16x32_bf16 v[28:31], a[148:151], a[124:127], v[28:31]
    s_waitcnt lgkmcnt(5)
    ds_read_b64_tr_b16 a[184:185], v14 offset:0
    v_mfma_f32_16x16x32_bf16 v[28:31], a[152:155], a[128:131], v[28:31]
    s_waitcnt vmcnt(14)
    ds_read_b64_tr_b16 a[186:187], v14 offset:2048
    v_mfma_f32_16x16x32_bf16 v[64:67], a[156:159], a[60:63], v[64:67]
    ds_read_b64_tr_b16 a[188:189], v14 offset:4096
    v_mfma_f32_16x16x32_bf16 v[64:67], a[160:163], a[64:67], v[64:67]
    ds_read_b64_tr_b16 a[190:191], v14 offset:6144
    v_mfma_f32_16x16x32_bf16 v[64:67], a[164:167], a[68:71], v[64:67]
    ds_read_b64_tr_b16 a[192:193], v11 offset:61440
    v_mfma_f32_16x16x32_bf16 v[68:71], a[156:159], a[132:135], v[68:71]
    ds_read_b64_tr_b16 a[194:195], v11 offset:63488
    v_mfma_f32_16x16x32_bf16 v[68:71], a[160:163], a[136:139], v[68:71]
    ds_read_b64_tr_b16 a[196:197], v15 offset:0
    v_mfma_f32_16x16x32_bf16 v[68:71], a[164:167], a[140:143], v[68:71]
    s_waitcnt lgkmcnt(5)
    ds_read_b64_tr_b16 a[198:199], v15 offset:2048
    v_mfma_f32_16x16x32_bf16 v[72:75], a[168:171], a[60:63], v[72:75]
    s_waitcnt vmcnt(12)
    ds_read_b64_tr_b16 a[200:201], v15 offset:4096
    v_cmp_ne_u32 vcc, 0, v26
    v_mfma_f32_16x16x32_bf16 v[72:75], a[172:175], a[64:67], v[72:75]
    s_lshr_b32 s60, vcc_lo, 8
    ds_read_b64_tr_b16 a[202:203], v15 offset:6144
    buffer_load_dword v26, v211, s[24:27], s95 offen sc1
    v_mfma_f32_16x16x32_bf16 v[72:75], a[176:179], a[68:71], v[72:75]
    s_and_b32 s60, s60, s61
    ds_read_b64_tr_b16 a[204:205], v231 offset:15360
    v_mfma_f32_16x16x32_bf16 v[76:79], a[168:171], a[132:135], v[76:79]
    s_ff1_i32_b32 s91, s60
    ds_read_b64_tr_b16 a[206:207], v231 offset:15872
    v_mfma_f32_16x16x32_bf16 v[76:79], a[172:175], a[136:139], v[76:79]
    s_bitset0_b32 s60, s91
    ds_read_b64_tr_b16 a[208:209], v231 offset:16384
    v_mfma_f32_16x16x32_bf16 v[76:79], a[176:179], a[140:143], v[76:79]
    s_bitset0_b32 s61, s91
    ds_read_b64_tr_b16 a[210:211], v231 offset:16896
    v_mfma_f32_16x16x32_bf16 v[80:83], a[180:183], a[60:63], v[80:83]
    s_mul_i32 s90, s91, 147456
    ds_read_b64_tr_b16 a[212:213], v231 offset:17408
    v_mfma_f32_16x16x32_bf16 v[80:83], a[184:187], a[64:67], v[80:83]
    s_waitcnt lgkmcnt(5)
    s_add_u32 s90, s90, s50
    ds_read_b64_tr_b16 a[214:215], v231 offset:17920
    v_mfma_f32_16x16x32_bf16 v[80:83], a[188:191], a[68:71], v[80:83]
    s_cmp_lt_i32 s91, 0
    v_mfma_f32_16x16x32_bf16 v[84:87], a[180:183], a[132:135], v[84:87]
    s_cselect_b32 s88, 1073741824, s90
    buffer_load_dwordx4 v[128:131], v6, s[24:27], s88 offen offset:0 sc1
    v_mfma_f32_16x16x32_bf16 v[84:87], a[184:187], a[136:139], v[84:87]
    v_mfma_f32_16x16x32_bf16 v[84:87], a[188:191], a[140:143], v[84:87]
    v_mfma_f32_16x16x32_bf16 v[88:91], a[192:195], a[60:63], v[88:91]
    buffer_load_dwordx4 v[132:135], v6, s[24:27], s88 offen offset:1024 sc1
    v_mfma_f32_16x16x32_bf16 v[88:91], a[196:199], a[64:67], v[88:91]
    v_mfma_f32_16x16x32_bf16 v[88:91], a[200:203], a[68:71], v[88:91]
    v_mfma_f32_16x16x32_bf16 v[92:95], a[192:195], a[132:135], v[92:95]
    buffer_load_dwordx4 v[136:139], v6, s[24:27], s88 offen offset:2048 sc1
    v_mfma_f32_16x16x32_bf16 v[92:95], a[196:199], a[136:139], v[92:95]
    v_mfma_f32_16x16x32_bf16 v[92:95], a[200:203], a[140:143], v[92:95]
    s_waitcnt lgkmcnt(0)
    v_mfma_f32_16x16x32_bf16 v[248:251], a[204:207], a[60:63], v[248:251]
    buffer_load_dwordx4 v[140:143], v6, s[24:27], s88 offen offset:3072 sc1
    v_mfma_f32_16x16x32_bf16 v[248:251], a[208:211], a[64:67], v[248:251]
    v_mfma_f32_16x16x32_bf16 v[248:251], a[212:215], a[68:71], v[248:251]
    v_mfma_f32_16x16x32_bf16 v[28:31], a[204:207], a[132:135], v[28:31]
    v_mfma_f32_16x16x32_bf16 v[28:31], a[208:211], a[136:139], v[28:31]
    v_mfma_f32_16x16x32_bf16 v[28:31], a[212:215], a[140:143], v[28:31]
    s_mov_b32 s92, 0x4091afa4
    s_mov_b32 s93, 0
    s_cmp_eq_u32 s68, 1073741824
    s_cbranch_scc1 L_sk3
    s_waitcnt vmcnt(13)
    v_mfma_f32_16x16x32_bf16 v[64:67], v[238:241], v[160:163], v[64:67]
    v_mfma_f32_16x16x32_bf16 v[68:71], v[238:241], v[164:167], v[68:71]
    v_mfma_f32_16x16x32_bf16 v[72:75], v[236:239], v[160:163], v[72:75]
    v_mfma_f32_16x16x32_bf16 v[76:79], v[236:239], v[164:167], v[76:79]
    v_mfma_f32_16x16x32_bf16 v[80:83], v[238:241], v[168:171], v[80:83]
    v_mfma_f32_16x16x32_bf16 v[84:87], v[238:241], v[172:175], v[84:87]
    v_mfma_f32_16x16x32_bf16 v[88:91], v[236:239], v[168:171], v[88:91]
    v_mfma_f32_16x16x32_bf16 v[92:95], v[236:239], v[172:175], v[92:95]
    s_cmp_eq_u32 s69, 1073741824
    s_cbranch_scc1 L_sk3
    s_waitcnt vmcnt(9)
    v_mfma_f32_16x16x32_bf16 v[64:67], v[238:241], v[176:179], v[64:67]
    v_mfma_f32_16x16x32_bf16 v[68:71], v[238:241], v[180:183], v[68:71]
    v_mfma_f32_16x16x32_bf16 v[72:75], v[236:239], v[176:179], v[72:75]
    v_mfma_f32_16x16x32_bf16 v[76:79], v[236:239], v[180:183], v[76:79]
    v_mfma_f32_16x16x32_bf16 v[80:83], v[238:241], v[184:187], v[80:83]
    v_mfma_f32_16x16x32_bf16 v[84:87], v[238:241], v[188:191], v[84:87]
    v_mfma_f32_16x16x32_bf16 v[88:91], v[236:239], v[184:187], v[88:91]
    v_mfma_f32_16x16x32_bf16 v[92:95], v[236:239], v[188:191], v[92:95]
    s_cmp_eq_u32 s70, 1073741824
    s_cbranch_scc1 L_sk3
    s_waitcnt vmcnt(5)
    v_mfma_f32_16x16x32_bf16 v[64:67], v[238:241], v[192:195], v[64:67]
    v_mfma_f32_16x16x32_bf16 v[68:71], v[238:241], v[196:199], v[68:71]
    v_mfma_f32_16x16x32_bf16 v[72:75], v[236:239], v[192:195], v[72:75]
    v_mfma_f32_16x16x32_bf16 v[76:79], v[236:239], v[196:199], v[76:79]
    v_mfma_f32_16x16x32_bf16 v[80:83], v[238:241], v[200:203], v[80:83]
    v_mfma_f32_16x16x32_bf16 v[84:87], v[238:241], v[204:207], v[84:87]
    v_mfma_f32_16x16x32_bf16 v[88:91], v[236:239], v[200:203], v[88:91]
    v_mfma_f32_16x16x32_bf16 v[92:95], v[236:239], v[204:207], v[92:95]
L_sk3:
    s_nop 3
    s_bitcmp1_b32 s78, 2
    s_cselect_b64 s[6:7], -1, 0
    v_cndmask_b32 v248, v248, v28, s[6:7]
    v_cndmask_b32 v249, v249, v29, s[6:7]
    v_cndmask_b32 v250, v250, v30, s[6:7]
    v_cndmask_b32 v251, v251, v31, s[6:7]
L_e1:
    s_cmp_eq_u32 s61, 0
    s_cbranch_scc1 L_e2
    s_waitcnt vmcnt(0)
    v_mfma_f32_16x16x32_bf16 v[64:67], v[238:241], v[128:131], v[64:67]
    v_mfma_f32_16x16x32_bf16 v[68:71], v[238:241], v[132:135], v[68:71]
    v_mfma_f32_16x16x32_bf16 v[72:75], v[236:239], v[128:131], v[72:75]
    v_mfma_f32_16x16x32_bf16 v[76:79], v[236:239], v[132:135], v[76:79]
    v_mfma_f32_16x16x32_bf16 v[80:83], v[238:241], v[136:139], v[80:83]
    v_mfma_f32_16x16x32_bf16 v[84:87], v[238:241], v[140:143], v[84:87]
    v_mfma_f32_16x16x32_bf16 v[88:91], v[236:239], v[136:139], v[88:91]
    v_mfma_f32_16x16x32_bf16 v[92:95], v[236:239], v[140:143], v[92:95]
L_e1c:
    v_cmp_ne_u32 vcc, 0, v26
    s_nop 0
    s_lshr_b32 s60, vcc_lo, 8
    buffer_load_dword v26, v211, s[24:27], s95 offen sc1
    s_add_u32 s93, s93, 1
    s_cmp_gt_u32 s93, 0x100000
    s_cbranch_scc1 L_end
    s_and_b32 s60, s60, s61
    s_cbranch_scc1 L_e1e
    s_waitcnt vmcnt(0)
    s_branch L_e1c
L_e1e:
    s_ff1_i32_b32 s91, s60
    s_bitset0_b32 s60, s91
    s_bitset0_b32 s61, s91
    s_mul_i32 s90, s91, 147456
    s_add_u32 s90, s90, s50
    s_cmp_lt_i32 s91, 0
    s_cselect_b32 s88, 1073741824, s90
    buffer_load_dwordx4 v[128:131], v6, s[24:27], s88 offen offset:0 sc1
    buffer_load_dwordx4 v[132:135], v6, s[24:27], s88 offen offset:1024 sc1
    buffer_load_dwordx4 v[136:139], v6, s[24:27], s88 offen offset:2048 sc1
    buffer_load_dwordx4 v[140:143], v6, s[24:27], s88 offen offset:3072 sc1
    s_branch L_e1
L_e2:
    s_mov_b32 s62, 1
    buffer_load_dwordx2 v[32:33], v246, s[24:27], s99 offen offset:0 sc1
    buffer_load_dwordx2 v[34:35], v246, s[24:27], s99 offen offset:512 sc1
    buffer_load_dwordx2 v[36:37], v246, s[24:27], s99 offen offset:1024 sc1
    buffer_load_dwordx2 v[38:39], v246, s[24:27], s99 offen offset:1536 sc1
    buffer_load_dwordx2 v[40:41], v246, s[24:27], s99 offen offset:2048 sc1
    buffer_load_dwordx2 v[42:43], v246, s[24:27], s99 offen offset:2560 sc1
    buffer_load_dwordx2 v[44:45], v246, s[24:27], s99 offen offset:3072 sc1
    buffer_load_dwordx2 v[46:47], v246, s[24:27], s99 offen offset:3584 sc1
    s_cmp_eq_u32 s88, 1073741824
    s_cbranch_scc1 L_sk4
    s_waitcnt vmcnt(8)
    v_mfma_f32_16x16x32_bf16 v[64:67], v[238:241], v[128:131], v[64:67]
    v_mfma_f32_16x16x32_bf16 v[68:71], v[238:241], v[132:135], v[68:71]
    v_mfma_f32_16x16x32_bf16 v[72:75], v[236:239], v[128:131], v[72:75]
    v_mfma_f32_16x16x32_bf16 v[76:79], v[236:239], v[132:135], v[76:79]
    v_mfma_f32_16x16x32_bf16 v[80:83], v[238:241], v[136:139], v[80:83]
    v_mfma_f32_16x16x32_bf16 v[84:87], v[238:241], v[140:143], v[84:87]
    v_mfma_f32_16x16x32_bf16 v[88:91], v[236:239], v[136:139], v[88:91]
    v_mfma_f32_16x16x32_bf16 v[92:95], v[236:239], v[140:143], v[92:95]
L_sk4:
    buffer_load_dword v26, v211, s[24:27], s95 offen sc1
    v_fma_f32 v64, v64, s92, v96
    v_fma_f32 v65, v65, s92, v97
    v_fma_f32 v66, v66, s92, v98
    v_fma_f32 v67, v67, s92, v99
    v_cvt_pk_bf16_f32 v64, v64, v65
    v_cvt_pk_bf16_f32 v65, v66, v67
    v_fma_f32 v68, v68, s92, v100
    v_fma_f32 v69, v69, s92, v101
    v_fma_f32 v70, v70, s92, v102
    v_fma_f32 v71, v71, s92, v103
    v_cvt_pk_bf16_f32 v68, v68, v69
    v_cvt_pk_bf16_f32 v69, v70, v71
    v_fma_f32 v72, v72, s92, v104
    v_fma_f32 v73, v73, s92, v105
    v_fma_f32 v74, v74, s92, v106
    v_fma_f32 v75, v75, s92, v107
    v_cvt_pk_bf16_f32 v72, v72, v73
    v_cvt_pk_bf16_f32 v73, v74, v75
    v_fma_f32 v76, v76, s92, v108
    v_fma_f32 v77, v77, s92, v109
    v_fma_f32 v78, v78, s92, v110
    v_fma_f32 v79, v79, s92, v111
    v_cvt_pk_bf16_f32 v76, v76, v77
    v_cvt_pk_bf16_f32 v77, v78, v79
    v_fma_f32 v80, v80, s92, v112
    v_fma_f32 v81, v81, s92, v113
    v_fma_f32 v82, v82, s92, v114
    v_fma_f32 v83, v83, s92, v115
    v_cvt_pk_bf16_f32 v80, v80, v81
    v_cvt_pk_bf16_f32 v81, v82, v83
    v_fma_f32 v84, v84, s92, v116
    v_fma_f32 v85, v85, s92, v117
    v_fma_f32 v86, v86, s92, v118
    v_fma_f32 v87, v87, s92, v119
    v_cvt_pk_bf16_f32 v84, v84, v85
    v_cvt_pk_bf16_f32 v85, v86, v87
    v_fma_f32 v88, v88, s92, v120
    v_fma_f32 v89, v89, s92, v121
    v_fma_f32 v90, v90, s92, v122
    v_fma_f32 v91, v91, s92, v123
    v_cvt_pk_bf16_f32 v88, v88, v89
    v_cvt_pk_bf16_f32 v89, v90, v91
    v_fma_f32 v92, v92, s92, v124
    v_fma_f32 v93, v93, s92, v125
    v_fma_f32 v94, v94, s92, v126
    v_fma_f32 v95, v95, s92, v127
    v_cvt_pk_bf16_f32 v92, v92, v93
    v_cvt_pk_bf16_f32 v93, v94, v95
    ds_write_b64 v228, v[64:65] offset:0
    ds_write_b64 v228, v[68:69] offset:2048
    ds_write_b64 v21, v[72:73] offset:0
    ds_write_b64 v21, v[76:77] offset:2048
    ds_write_b64 v22, v[80:81] offset:0
    ds_write_b64 v22, v[84:85] offset:2048
    ds_write_b64 v23, v[88:89] offset:0
    ds_write_b64 v23, v[92:93] offset:2048
    ds_read_b128 v[96:99], v232 offset:0
    ds_read_b128 v[100:103], v232 offset:1024
    ds_read_b128 v[104:107], v232 offset:2048
    ds_read_b128 v[108:111], v232 offset:3072
    s_waitcnt lgkmcnt(3)
    buffer_store_dwordx4 v[96:99], v20, s[28:31], s84 offen
    s_add_u32 s84, s84, 9216
    s_waitcnt lgkmcnt(2)
    buffer_store_dwordx4 v[100:103], v20, s[28:31], s84 offen
    s_add_u32 s84, s84, 9216
    s_waitcnt lgkmcnt(1)
    buffer_store_dwordx4 v[104:107], v20, s[28:31], s84 offen
    s_add_u32 s84, s84, 9216
    s_waitcnt lgkmcnt(0)
    buffer_store_dwordx4 v[108:111], v20, s[28:31], s84 offen
    s_waitcnt vmcnt(5)
L_e3:
    v_max3_u32 v2, v32, v33, v34
    v_max3_u32 v2, v2, v35, v36
    v_max3_u32 v2, v2, v37, v38
    v_max3_u32 v2, v2, v39, v40
    v_max3_u32 v2, v2, v41, v42
    v_max3_u32 v2, v2, v43, v44
    v_max3_u32 v2, v2, v45, v46
    v_max_u32 v2, v2, v47
    v_cmp_eq_u32 vcc, -1, v2
    s_cmp_eq_u32 s62, 0
    s_cbranch_vccz L_fin
    s_cbranch_scc1 L_fin
    s_waitcnt vmcnt(4)
    v_cmp_eq_u32 vcc, 0, v26
    buffer_load_dwordx2 v[32:33], v246, s[24:27], s99 offen offset:0 sc1
    buffer_load_dwordx2 v[34:35], v246, s[24:27], s99 offen offset:512 sc1
    buffer_load_dwordx2 v[36:37], v246, s[24:27], s99 offen offset:1024 sc1
    buffer_load_dwordx2 v[38:39], v246, s[24:27], s99 offen offset:1536 sc1
    buffer_load_dwordx2 v[40:41], v246, s[24:27], s99 offen offset:2048 sc1
    buffer_load_dwordx2 v[42:43], v246, s[24:27], s99 offen offset:2560 sc1
    buffer_load_dwordx2 v[44:45], v246, s[24:27], s99 offen offset:3072 sc1
    buffer_load_dwordx2 v[46:47], v246, s[24:27], s99 offen offset:3584 sc1
    s_and_b32 s62, vcc_lo, 0xff0000
    buffer_load_dword v26, v211, s[24:27], s95 offen sc1
    s_add_u32 s93, s93, 1
    s_cmp_lt_u32 s93, 0x100000
    s_waitcnt vmcnt(0)
    s_cbranch_scc1 L_e3
    s_endpgm
L_fin:
    v_mfma_f32_16x16x32_bf16 v[248:251], v[242:245], v[32:35], v[248:251]
    v_mfma_f32_16x16x32_bf16 v[248:251], v[242:245], v[36:39], v[248:251]
    v_mfma_f32_16x16x32_bf16 v[248:251], v[242:245], v[40:43], v[248:251]
    v_mfma_f32_16x16x32_bf16 v[248:251], v[242:245], v[44:47], v[248:251]
    s_nop 7
    v_fma_f32 v248, v248, s92, v252
    v_fma_f32 v249, v249, s92, v253
    v_fma_f32 v250, v250, s92, v254
    v_fma_f32 v251, v251, s92, v255
    v_cvt_pk_bf16_f32 v248, v248, v249
    v_cvt_pk_bf16_f32 v249, v250, v251
    buffer_store_dwordx2 v[248:249], v230, s[28:31], s49 offen
    s_endpgm
L_wo0:
    s_mov_b32 s93, 0
    s_waitcnt vmcnt(0)
L_wo1:
    v_cmp_ne_u32 vcc, 0, v26
    s_nop 0
    s_lshr_b32 s60, vcc_lo, 8
    s_and_b32 s51, vcc_lo, s96
L_w22:
    s_cbranch_execz L_wb
    s_cbranch_scc0 L_wo1b
    s_andn2_b32 s96, s96, s51
    s_bitcmp1_b32 s51, 0
    s_cbranch_scc0 L_fb_1
    s_add_u32 s86, s71, 0
    buffer_load_dwordx4 a[32:35], v6, s[24:27], s86 offen offset:1024 sc1
    buffer_load_dwordx4 a[104:107], v212, s[24:27], s86 offen offset:1024 sc1
L_fb_1:
    s_bitcmp1_b32 s51, 1
    s_cbranch_scc0 L_fb_2
    s_add_u32 s86, s71, 2048
    buffer_load_dwordx4 a[36:39], v6, s[24:27], s86 offen offset:1024 sc1
    buffer_load_dwordx4 a[108:111], v212, s[24:27], s86 offen offset:1024 sc1
L_fb_2:
    s_bitcmp1_b32 s51, 2
    s_cbranch_scc0 L_fb_3
    s_add_u32 s86, s71, 4096
    buffer_load_dwordx4 a[40:43], v6, s[24:27], s86 offen offset:1024 sc1
    buffer_load_dwordx4 a[112:115], v212, s[24:27], s86 offen offset:1024 sc1
L_fb_3:
    s_bitcmp1_b32 s51, 3
    s_cbranch_scc0 L_fb_4
    s_add_u32 s86, s71, 6144
    buffer_load_dwordx4 a[44:47], v6, s[24:27], s86 offen offset:1024 sc1
    buffer_load_dwordx4 a[116:119], v212, s[24:27], s86 offen offset:1024 sc1
L_fb_4:
    s_bitcmp1_b32 s51, 4
    s_cbranch_scc0 L_fb_5
    s_add_u32 s86, s71, 8192
    buffer_load_dwordx4 a[48:51], v6, s[24:27], s86 offen offset:1024 sc1
    buffer_load_dwordx4 a[120:123], v212, s[24:27], s86 offen offset:1024 sc1
L_fb_5:
    s_bitcmp1_b32 s51, 5
    s_cbranch_scc0 L_fb_6
    s_add_u32 s86, s71, 10240
    buffer_load_dwordx4 a[52:55], v6, s[24:27], s86 offen offset:1024 sc1
    buffer_load_dwordx4 a[124:127], v212, s[24:27], s86 offen offset:1024 sc1
L_fb_6:
    s_bitcmp1_b32 s51, 6
    s_cbranch_scc0 L_fb_7
    s_add_u32 s86, s71, 12288
    buffer_load_dwordx4 a[56:59], v6, s[24:27], s86 offen offset:1024 sc1
    buffer_load_dwordx4 a[128:131], v212, s[24:27], s86 offen offset:1024 sc1
L_fb_7:
    s_bitcmp1_b32 s51, 7
    s_cbranch_scc0 L_fb_8
    s_add_u32 s86, s71, 14336
    buffer_load_dwordx4 a[60:63], v6, s[24:27], s86 offen offset:1024 sc1
    buffer_load_dwordx4 a[132:135], v212, s[24:27], s86 offen offset:1024 sc1
L_fb_8:
    s_cmp_eq_u32 s96, 0
    s_cbranch_scc1 L_ogat
L_wo1b:
    buffer_load_dword v26, v211, s[24:27], s95 offen sc1
    s_add_u32 s93, s93, 1
    s_cmp_gt_u32 s93, 0x100000
    s_cbranch_scc1 L_end
    s_and_b32 s60, s60, s61
    s_cbranch_scc1 L_wo2
    s_waitcnt vmcnt(0)
    s_branch L_wo1
L_wo2:
    s_cmp_eq_u32 s62, 0
    s_cbranch_scc1 L_wo4
    s_waitcnt vmcnt(1)
    v_mfma_f32_16x16x32_bf16 v[64:67], v[238:241], v[128:131], v[64:67]
    v_mfma_f32_16x16x32_bf16 v[64:67], v[238:241], v[144:147], v[64:67]
    v_mfma_f32_16x16x32_bf16 v[68:71], v[238:241], v[132:135], v[68:71]
    v_mfma_f32_16x16x32_bf16 v[68:71], v[238:241], v[148:151], v[68:71]
    v_mfma_f32_16x16x32_bf16 v[72:75], v[236:239], v[128:131], v[72:75]
    v_mfma_f32_16x16x32_bf16 v[72:75], v[236:239], v[144:147], v[72:75]
    v_mfma_f32_16x16x32_bf16 v[76:79], v[236:239], v[132:135], v[76:79]
    v_mfma_f32_16x16x32_bf16 v[76:79], v[236:239], v[148:151], v[76:79]
    v_mfma_f32_16x16x32_bf16 v[80:83], v[238:241], v[136:139], v[80:83]
    v_mfma_f32_16x16x32_bf16 v[80:83], v[238:241], v[152:155], v[80:83]
    v_mfma_f32_16x16x32_bf16 v[84:87], v[238:241], v[140:143], v[84:87]
    v_mfma_f32_16x16x32_bf16 v[84:87], v[238:241], v[156:159], v[84:87]
    v_mfma_f32_16x16x32_bf16 v[88:91], v[236:239], v[136:139], v[88:91]
    v_mfma_f32_16x16x32_bf16 v[88:91], v[236:239], v[152:155], v[88:91]
    v_mfma_f32_16x16x32_bf16 v[92:95], v[236:239], v[140:143], v[92:95]
    v_mfma_f32_16x16x32_bf16 v[92:95], v[236:239], v[156:159], v[92:95]
L_wo4:
    s_mov_b32 s62, 1
    s_ff1_i32_b32 s91, s60
    s_bitset0_b32 s60, s91
    s_bitset0_b32 s61, s91
    s_mul_i32 s90, s91, 147456
    s_add_u32 s90, s90, s50
    s_cmp_lt_i32 s91, 0
    s_cselect_b32 s83, 1073741824, s90
    buffer_load_dwordx4 v[128:131], v6, s[24:27], s83 offen offset:0 sc1
    s_ff1_i32_b32 s91, s60
    s_bitset0_b32 s60, s91
    buffer_load_dwordx4 v[132:135], v6, s[24:27], s83 offen offset:1024 sc1
    s_bitset0_b32 s61, s91
    s_mul_i32 s90, s91, 147456
    buffer_load_dwordx4 v[136:139], v6, s[24:27], s83 offen offset:2048 sc1
    s_add_u32 s90, s90, s50
    s_cmp_lt_i32 s91, 0
    buffer_load_dwordx4 v[140:143], v6, s[24:27], s83 offen offset:3072 sc1
    s_cselect_b32 s83, 1073741824, s90
    buffer_load_dwordx4 v[144:147], v6, s[24:27], s83 offen offset:0 sc1
    buffer_load_dwordx4 v[148:151], v6, s[24:27], s83 offen offset:1024 sc1
    buffer_load_dwordx4 v[152:155], v6, s[24:27], s83 offen offset:2048 sc1
    buffer_load_dwordx4 v[156:159], v6, s[24:27], s83 offen offset:3072 sc1
    s_waitcnt vmcnt(8)
    s_branch L_wo1
L_ogat:
    s_add_u32 s86, s71, 16384
    buffer_load_dwordx4 a[64:67], v6, s[24:27], s86 offen offset:0 sc1
    buffer_load_dwordx4 a[136:139], v212, s[24:27], s86 offen offset:0 sc1
    buffer_load_dwordx4 a[68:71], v6, s[24:27], s86 offen offset:1024 sc1
    buffer_load_dwordx4 a[140:143], v212, s[24:27], s86 offen offset:1024 sc1
    buffer_load_dword v26, v211, s[24:27], s95 offen sc1
L_w23:
    s_cbranch_execz L_wb
    s_cmp_eq_u32 s62, 0
    s_cbranch_scc1 L_ogat3
    s_waitcnt vmcnt(7)
    v_mfma_f32_16x16x32_bf16 v[64:67], v[238:241], v[128:131], v[64:67]
    v_mfma_f32_16x16x32_bf16 v[64:67], v[238:241], v[144:147], v[64:67]
    v_mfma_f32_16x16x32_bf16 v[68:71], v[238:241], v[132:135], v[68:71]
    v_mfma_f32_16x16x32_bf16 v[68:71], v[238:241], v[148:151], v[68:71]
    v_mfma_f32_16x16x32_bf16 v[72:75], v[236:239], v[128:131], v[72:75]
    v_mfma_f32_16x16x32_bf16 v[72:75], v[236:239], v[144:147], v[72:75]
    v_mfma_f32_16x16x32_bf16 v[76:79], v[236:239], v[132:135], v[76:79]
    v_mfma_f32_16x16x32_bf16 v[76:79], v[236:239], v[148:151], v[76:79]
    v_mfma_f32_16x16x32_bf16 v[80:83], v[238:241], v[136:139], v[80:83]
    v_mfma_f32_16x16x32_bf16 v[80:83], v[238:241], v[152:155], v[80:83]
    v_mfma_f32_16x16x32_bf16 v[84:87], v[238:241], v[140:143], v[84:87]
    v_mfma_f32_16x16x32_bf16 v[84:87], v[238:241], v[156:159], v[84:87]
    v_mfma_f32_16x16x32_bf16 v[88:91], v[236:239], v[136:139], v[88:91]
    v_mfma_f32_16x16x32_bf16 v[88:91], v[236:239], v[152:155], v[88:91]
    v_mfma_f32_16x16x32_bf16 v[92:95], v[236:239], v[140:143], v[92:95]
    v_mfma_f32_16x16x32_bf16 v[92:95], v[236:239], v[156:159], v[92:95]
L_ogat3:
    s_waitcnt vmcnt(5) lgkmcnt(0)
    s_branch L_gb
L_kvspin:
    s_mov_b32 s91, 0
L_kvspin2:
    buffer_load_dword v26, v215, s[32:35], 0 offen sc1
    s_add_u32 s91, s91, 1
    s_cmp_gt_u32 s91, 0x100000
    s_cbranch_scc1 L_end
    s_waitcnt vmcnt(0)
    v_cmp_gt_u32 vcc, 16, v26
    s_nop 1
    s_cbranch_vccnz L_kvspin2
    s_branch L_kvok
L_fb:
    s_waitcnt vmcnt(0) lgkmcnt(0)
    v_and_b32 v2, 31, v1
    v_lshlrev_b32 v2, 4, v2
    v_subrev_u32 v3, 110592, v218
    v_accvgpr_write_b32 a225, 0
    s_mov_b32 s87, 0
    s_mov_b32 s3, 1
    v_cndmask_b32 v112, v112, 0, s[4:5]
    v_mov_b32 v192, 0xff800000
    v_cndmask_b32 v116, v116, 0, s[4:5]
    v_mov_b32 v193, 0xff800000
    v_cndmask_b32 v120, v120, 0, s[4:5]
    v_mov_b32 v194, 0xff800000
    v_cndmask_b32 v124, v124, 0, s[4:5]
    v_mov_b32 v195, 0xff800000
    v_mov_b32 v128, 0
    v_mov_b32 v129, 0
    v_mov_b32 v130, 0
    v_mov_b32 v131, 0
    v_mov_b32 v132, 0
    v_mov_b32 v133, 0
    v_mov_b32 v134, 0
    v_mov_b32 v135, 0
    v_mov_b32 v136, 0
    v_mov_b32 v137, 0
    v_mov_b32 v138, 0
    v_mov_b32 v139, 0
    v_mov_b32 v140, 0
    v_mov_b32 v141, 0
    v_mov_b32 v142, 0
    v_mov_b32 v143, 0
    v_mov_b32 v144, 0
    v_mov_b32 v145, 0
    v_mov_b32 v146, 0
    v_mov_b32 v147, 0
    v_mov_b32 v148, 0
    v_mov_b32 v149, 0
    v_mov_b32 v150, 0
    v_mov_b32 v151, 0
    v_mov_b32 v152, 0
    v_mov_b32 v153, 0
    v_mov_b32 v154, 0
    v_mov_b32 v155, 0
    v_mov_b32 v156, 0
    v_mov_b32 v157, 0
    v_mov_b32 v158, 0
    v_mov_b32 v159, 0
    v_mov_b32 v160, 0
    v_mov_b32 v161, 0
    v_mov_b32 v162, 0
    v_mov_b32 v163, 0
    v_mov_b32 v164, 0
    v_mov_b32 v165, 0
    v_mov_b32 v166, 0
    v_mov_b32 v167, 0
    v_mov_b32 v168, 0
    v_mov_b32 v169, 0
    v_mov_b32 v170, 0
    v_mov_b32 v171, 0
    v_mov_b32 v172, 0
    v_mov_b32 v173, 0
    v_mov_b32 v174, 0
    v_mov_b32 v175, 0
    v_mov_b32 v176, 0
    v_mov_b32 v177, 0
    v_mov_b32 v178, 0
    v_mov_b32 v179, 0
    v_mov_b32 v180, 0
    v_mov_b32 v181, 0
    v_mov_b32 v182, 0
    v_mov_b32 v183, 0
    v_mov_b32 v184, 0
    v_mov_b32 v185, 0
    v_mov_b32 v186, 0
    v_mov_b32 v187, 0
    v_mov_b32 v188, 0
    v_mov_b32 v189, 0
    v_mov_b32 v190, 0
    v_mov_b32 v191, 0
L_fb1:
    s_lshr_b32 s90, s87, 3
    s_mul_i32 s90, s90, 20480
    s_and_b32 s91, s87, 7
    s_lshl_b32 s92, s91, 10
    s_add_u32 s92, s92, s90
    buffer_load_dwordx4 a[216:219], v6, s[24:27], s92 offen sc1
    s_lshr_b32 s92, s91, 2
    s_mul_i32 s92, s92, 640
    s_and_b32 s93, s91, 3
    s_lshl_b32 s93, s93, 2
    s_add_u32 s92, s92, s93
    s_add_u32 s92, s92, s90
    s_add_u32 s92, s92, 18432
    buffer_load_dword a224, v2, s[24:27], s92 offen sc1
    s_waitcnt vmcnt(0)
    v_mfma_f32_32x32x16_bf16 v[32:47], a[216:219], v[96:99], 0
    v_mfma_f32_32x32x8bf16_1k v[32:47], a[224:225], v[112:113], v[32:47]
    v_mfma_f32_32x32x16_bf16 v[48:63], a[216:219], v[100:103], 0
    v_mfma_f32_32x32x8bf16_1k v[48:63], a[224:225], v[116:117], v[48:63]
    v_mfma_f32_32x32x16_bf16 v[64:79], a[216:219], v[104:107], 0
    v_mfma_f32_32x32x8bf16_1k v[64:79], a[224:225], v[120:121], v[64:79]
    v_mfma_f32_32x32x16_bf16 v[80:95], a[216:219], v[108:111], 0
    v_mfma_f32_32x32x8bf16_1k v[80:95], a[224:225], v[124:125], v[80:95]
    s_nop 11
    v_max3_f32 v192, v192, v32, v33
    v_max3_f32 v192, v192, v34, v35
    v_max3_f32 v192, v192, v36, v37
    v_max3_f32 v192, v192, v38, v39
    v_max3_f32 v192, v192, v40, v41
    v_max3_f32 v192, v192, v42, v43
    v_max3_f32 v192, v192, v44, v45
    v_max3_f32 v192, v192, v46, v47
    v_max3_f32 v193, v193, v48, v49
    v_max3_f32 v193, v193, v50, v51
    v_max3_f32 v193, v193, v52, v53
    v_max3_f32 v193, v193, v54, v55
    v_max3_f32 v193, v193, v56, v57
    v_max3_f32 v193, v193, v58, v59
    v_max3_f32 v193, v193, v60, v61
    v_max3_f32 v193, v193, v62, v63
    v_max3_f32 v194, v194, v64, v65
    v_max3_f32 v194, v194, v66, v67
    v_max3_f32 v194, v194, v68, v69
    v_max3_f32 v194, v194, v70, v71
    v_max3_f32 v194, v194, v72, v73
    v_max3_f32 v194, v194, v74, v75
    v_max3_f32 v194, v194, v76, v77
    v_max3_f32 v194, v194, v78, v79
    v_max3_f32 v195, v195, v80, v81
    v_max3_f32 v195, v195, v82, v83
    v_max3_f32 v195, v195, v84, v85
    v_max3_f32 v195, v195, v86, v87
    v_max3_f32 v195, v195, v88, v89
    v_max3_f32 v195, v195, v90, v91
    v_max3_f32 v195, v195, v92, v93
    v_max3_f32 v195, v195, v94, v95
    s_add_u32 s87, s87, 1
    s_cmp_lt_u32 s87, 64
    s_cbranch_scc1 L_fb1
    v_mov_b32 v32, v192
    v_mov_b32 v33, v193
    v_mov_b32 v34, v194
    v_mov_b32 v35, v195
    s_nop 0
    v_permlane32_swap_b32 v192, v32
    v_permlane32_swap_b32 v193, v33
    v_permlane32_swap_b32 v194, v34
    v_permlane32_swap_b32 v195, v35
    v_max_f32 v192, v192, v32
    v_max_f32 v193, v193, v33
    v_max_f32 v194, v194, v34
    v_max_f32 v195, v195, v35
    s_mov_b32 s87, 0
L_fb3:
    s_lshr_b32 s90, s87, 3
    s_mul_i32 s90, s90, 20480
    s_and_b32 s91, s87, 7
    s_lshl_b32 s92, s91, 10
    s_add_u32 s92, s92, s90
    buffer_load_dwordx4 a[216:219], v6, s[24:27], s92 offen sc1
    s_lshr_b32 s92, s91, 2
    s_mul_i32 s92, s92, 640
    s_and_b32 s93, s91, 3
    s_lshl_b32 s93, s93, 2
    s_add_u32 s92, s92, s93
    s_add_u32 s92, s92, s90
    s_add_u32 s92, s92, 18432
    buffer_load_dword a224, v2, s[24:27], s92 offen sc1
    s_mul_i32 s92, s91, 1280
    s_add_u32 s92, s92, s90
    buffer_load_dwordx4 a[232:235], v3, s[24:27], s92 offen sc1
    buffer_load_dwordx4 a[236:239], v3, s[24:27], s92 offen offset:640 sc1
    s_waitcnt vmcnt(0)
    v_mfma_f32_32x32x16_bf16 v[32:47], a[216:219], v[96:99], 0
    v_mfma_f32_32x32x8bf16_1k v[32:47], a[224:225], v[112:113], v[32:47]
    v_mfma_f32_32x32x16_bf16 v[48:63], a[216:219], v[100:103], 0
    v_mfma_f32_32x32x8bf16_1k v[48:63], a[224:225], v[116:117], v[48:63]
    v_mfma_f32_32x32x16_bf16 v[64:79], a[216:219], v[104:107], 0
    v_mfma_f32_32x32x8bf16_1k v[64:79], a[224:225], v[120:121], v[64:79]
    v_mfma_f32_32x32x16_bf16 v[80:95], a[216:219], v[108:111], 0
    v_mfma_f32_32x32x8bf16_1k v[80:95], a[224:225], v[124:125], v[80:95]
    s_nop 11
    v_sub_f32 v32, v32, v192
    v_sub_f32 v33, v33, v192
    v_sub_f32 v34, v34, v192
    v_sub_f32 v35, v35, v192
    v_sub_f32 v36, v36, v192
    v_sub_f32 v37, v37, v192
    v_sub_f32 v38, v38, v192
    v_sub_f32 v39, v39, v192
    v_sub_f32 v40, v40, v192
    v_sub_f32 v41, v41, v192
    v_sub_f32 v42, v42, v192
    v_sub_f32 v43, v43, v192
    v_sub_f32 v44, v44, v192
    v_sub_f32 v45, v45, v192
    v_sub_f32 v46, v46, v192
    v_sub_f32 v47, v47, v192
    v_exp_f32 v32, v32
    v_exp_f32 v33, v33
    v_exp_f32 v34, v34
    v_exp_f32 v35, v35
    v_exp_f32 v36, v36
    v_exp_f32 v37, v37
    v_exp_f32 v38, v38
    v_exp_f32 v39, v39
    v_exp_f32 v40, v40
    v_exp_f32 v41, v41
    v_exp_f32 v42, v42
    v_exp_f32 v43, v43
    v_exp_f32 v44, v44
    v_exp_f32 v45, v45
    v_exp_f32 v46, v46
    v_exp_f32 v47, v47
    v_sub_f32 v48, v48, v193
    v_sub_f32 v49, v49, v193
    v_sub_f32 v50, v50, v193
    v_sub_f32 v51, v51, v193
    v_sub_f32 v52, v52, v193
    v_sub_f32 v53, v53, v193
    v_sub_f32 v54, v54, v193
    v_sub_f32 v55, v55, v193
    v_sub_f32 v56, v56, v193
    v_sub_f32 v57, v57, v193
    v_sub_f32 v58, v58, v193
    v_sub_f32 v59, v59, v193
    v_sub_f32 v60, v60, v193
    v_sub_f32 v61, v61, v193
    v_sub_f32 v62, v62, v193
    v_sub_f32 v63, v63, v193
    v_exp_f32 v48, v48
    v_exp_f32 v49, v49
    v_exp_f32 v50, v50
    v_exp_f32 v51, v51
    v_exp_f32 v52, v52
    v_exp_f32 v53, v53
    v_exp_f32 v54, v54
    v_exp_f32 v55, v55
    v_exp_f32 v56, v56
    v_exp_f32 v57, v57
    v_exp_f32 v58, v58
    v_exp_f32 v59, v59
    v_exp_f32 v60, v60
    v_exp_f32 v61, v61
    v_exp_f32 v62, v62
    v_exp_f32 v63, v63
    v_sub_f32 v64, v64, v194
    v_sub_f32 v65, v65, v194
    v_sub_f32 v66, v66, v194
    v_sub_f32 v67, v67, v194
    v_sub_f32 v68, v68, v194
    v_sub_f32 v69, v69, v194
    v_sub_f32 v70, v70, v194
    v_sub_f32 v71, v71, v194
    v_sub_f32 v72, v72, v194
    v_sub_f32 v73, v73, v194
    v_sub_f32 v74, v74, v194
    v_sub_f32 v75, v75, v194
    v_sub_f32 v76, v76, v194
    v_sub_f32 v77, v77, v194
    v_sub_f32 v78, v78, v194
    v_sub_f32 v79, v79, v194
    v_exp_f32 v64, v64
    v_exp_f32 v65, v65
    v_exp_f32 v66, v66
    v_exp_f32 v67, v67
    v_exp_f32 v68, v68
    v_exp_f32 v69, v69
    v_exp_f32 v70, v70
    v_exp_f32 v71, v71
    v_exp_f32 v72, v72
    v_exp_f32 v73, v73
    v_exp_f32 v74, v74
    v_exp_f32 v75, v75
    v_exp_f32 v76, v76
    v_exp_f32 v77, v77
    v_exp_f32 v78, v78
    v_exp_f32 v79, v79
    v_sub_f32 v80, v80, v195
    v_sub_f32 v81, v81, v195
    v_sub_f32 v82, v82, v195
    v_sub_f32 v83, v83, v195
    v_sub_f32 v84, v84, v195
    v_sub_f32 v85, v85, v195
    v_sub_f32 v86, v86, v195
    v_sub_f32 v87, v87, v195
    v_sub_f32 v88, v88, v195
    v_sub_f32 v89, v89, v195
    v_sub_f32 v90, v90, v195
    v_sub_f32 v91, v91, v195
    v_sub_f32 v92, v92, v195
    v_sub_f32 v93, v93, v195
    v_sub_f32 v94, v94, v195
    v_sub_f32 v95, v95, v195
    v_exp_f32 v80, v80
    v_exp_f32 v81, v81
    v_exp_f32 v82, v82
    v_exp_f32 v83, v83
    v_exp_f32 v84, v84
    v_exp_f32 v85, v85
    v_exp_f32 v86, v86
    v_exp_f32 v87, v87
    v_exp_f32 v88, v88
    v_exp_f32 v89, v89
    v_exp_f32 v90, v90
    v_exp_f32 v91, v91
    v_exp_f32 v92, v92
    v_exp_f32 v93, v93
    v_exp_f32 v94, v94
    v_exp_f32 v95, v95
    s_nop 1
    v_smfmac_f32_32x32x32_bf16 v[128:143], a[232:235], v[32:39], v219
    v_smfmac_f32_32x32x32_bf16 v[128:143], a[236:239], v[40:47], v219
    v_smfmac_f32_32x32x32_bf16 v[144:159], a[232:235], v[48:55], v219
    v_smfmac_f32_32x32x32_bf16 v[144:159], a[236:239], v[56:63], v219
    v_smfmac_f32_32x32x32_bf16 v[160:175], a[232:235], v[64:71], v219
    v_smfmac_f32_32x32x32_bf16 v[160:175], a[236:239], v[72:79], v219
    v_smfmac_f32_32x32x32_bf16 v[176:191], a[232:235], v[80:87], v219
    v_smfmac_f32_32x32x32_bf16 v[176:191], a[236:239], v[88:95], v219
    s_add_u32 s87, s87, 1
    s_cmp_lt_u32 s87, 64
    s_cbranch_scc1 L_fb3
    s_nop 11
    s_cmp_eq_u32 s101, 0xff
    s_cbranch_scc0 L_opub
    v_rcp_f32 v192, v138
    s_nop 0
    v_mul_f32 v192, 0x3eeff558, v192
    v_mul_f32 v196, v128, v192
    v_mul_f32 v197, v129, v192
    v_mul_f32 v198, v130, v192
    v_mul_f32 v199, v131, v192
    v_mul_f32 v200, v132, v192
    v_mul_f32 v201, v133, v192
    v_mul_f32 v202, v134, v192
    v_mul_f32 v203, v135, v192
    v_mul_f32 v204, v136, v192
    v_mul_f32 v205, v137, v192
    v_rcp_f32 v193, v170
    v_cvt_pk_bf16_f32 v28, v204, v205
    v_cvt_pk_bf16_f32 v140, v196, v197
    v_cvt_pk_bf16_f32 v141, v198, v199
    v_cvt_pk_bf16_f32 v142, v200, v201
    v_cvt_pk_bf16_f32 v143, v202, v203
    buffer_store_dwordx4 v[140:143], v6, s[24:27], s63 offen offset:0 sc1
    v_mul_f32 v193, 0x3eeff558, v193
    v_mul_f32 v196, v160, v193
    v_mul_f32 v197, v161, v193
    v_mul_f32 v198, v162, v193
    v_mul_f32 v199, v163, v193
    v_mul_f32 v200, v164, v193
    v_mul_f32 v201, v165, v193
    v_mul_f32 v202, v166, v193
    v_mul_f32 v203, v167, v193
    v_mul_f32 v204, v168, v193
    v_mul_f32 v205, v169, v193
    v_cvt_pk_bf16_f32 v29, v204, v205
    v_cvt_pk_bf16_f32 v172, v196, v197
    v_cvt_pk_bf16_f32 v173, v198, v199
    v_cvt_pk_bf16_f32 v174, v200, v201
    v_cvt_pk_bf16_f32 v175, v202, v203
    v_permlane16_swap_b32 v28, v29
    buffer_store_dwordx4 v[172:175], v6, s[24:27], s64 offen offset:0 sc1
    s_branch L_opub
L_end:
    s_endpgm
.section .rodata,"a"
.p2align 6
.amdhsa_kernel parallel_sum__grouped_kv_mqa__geglu_ffn__prompt_kernel
  .amdhsa_next_free_vgpr 512
  .amdhsa_next_free_sgpr 102
  .amdhsa_accum_offset 256
  .amdhsa_group_segment_fixed_size 0
  .amdhsa_kernarg_size 96
  .amdhsa_user_sgpr_count 2
  .amdhsa_user_sgpr_kernarg_segment_ptr 1
  .amdhsa_system_sgpr_workgroup_id_x 1
.end_amdhsa_kernel
```
